```python
import torch

def _softmax(x, axis=-1):
    return torch.softmax(x, dim=axis)
def _gelu(x):
    return torch.nn.functional.gelu(x, approximate="tanh")
def _silu(x):
    return torch.nn.functional.silu(x)
def _sigmoid(x):
    return torch.sigmoid(x)
def _layernorm(x, axis=-1, eps=1e-5):
    m = x.mean(dim=axis, keepdim=True)
    v = x.var(dim=axis, keepdim=True, unbiased=False)
    return (x - m) / torch.sqrt(v + eps)
def _scatter_add(tgt, idx, src, axis=0):
    return tgt.clone().index_add_(axis, idx, src)
def _segment_sum(src, seg, n):
    out = torch.zeros((n,) + src.shape[1:], dtype=src.dtype)
    return out.index_add_(0, seg, src)
def _pad(x, pw):
    flat = tuple(v for pair in reversed(pw) for v in pair)
    return torch.nn.functional.pad(x, flat)

kernel_name = 'interleave_layers__softmax_full_mha__dense_activation_silu__prompt'

def setup_inputs():

    _w = (lambda a: (lambda t: t.to(torch.bfloat16) if t.is_floating_point() else t)(torch.as_tensor(a)))
    def _A_setup():
        B, S, D = 1, 2048, 512
        return {
            "x": _w((lambda *s: torch.randn(*s, dtype=torch.bfloat16) * 0.05)(B, S, D)),
            "wqkv": _w((lambda *s: torch.randn(*s, dtype=torch.bfloat16) * 0.05)(D, 3 * D)),
            "wo": _w((lambda *s: torch.randn(*s, dtype=torch.bfloat16) * 0.05)(D, D)),
        }
    _A_in = _A_setup()

    def _B_setup():
        B, S, D, F = 1, 2048, 512, 1792
        return {
            "x": _w((lambda *s: torch.randn(*s, dtype=torch.bfloat16) * 0.05)(B, S, D)),
            "w1": _w((lambda *s: torch.randn(*s, dtype=torch.bfloat16) * 0.8)(D, F) * (D ** -0.5)),
            "w2": _w((lambda *s: torch.randn(*s, dtype=torch.bfloat16) * 0.2)(F, D) * (F ** -0.5)),
        }
    _B_in = _B_setup()

    return {
        "A_x": _A_in["x"],
        "A_wqkv": _A_in["wqkv"],
        "A_wo": _A_in["wo"],
        "B_x": _B_in["x"],
        "B_w1": _B_in["w1"],
        "B_w2": _B_in["w2"],
    }

def reference(A_x, A_wqkv, A_wo, B_x, B_w1, B_w2):
    def _A_ref(x, wqkv, wo):
        B, S, D = x.shape
        H = 32; Dh = D // H
        qkv = (lambda x, *d: x.permute(*d))((x @ wqkv).reshape(B, S, 3, H, Dh), 2, 0, 3, 1, 4)
        q, k, v = qkv[0], qkv[1], qkv[2]
        scale = Dh ** -0.5
        scores = torch.einsum("bhqd,bhkd->bhqk", q, k) * scale
        p = _softmax(scores, axis=-1)
        o = torch.einsum("bhqk,bhkd->bhqd", p, v)
        return (lambda x, *d: x.permute(*d))(o, 0, 2, 1, 3).reshape(B, S, D) @ wo

    def _B_ref(x, w1, w2):
        h = torch.einsum("bsd,df->bsf", x, w1)
        h = _silu(h)
        out = torch.einsum("bsf,fd->bsd", h, w2)
        return out

    x = A_x
    x = x + _A_ref(_layernorm(x, axis=-1), A_wqkv, A_wo)
    x = x + _B_ref(_layernorm(x, axis=-1), B_w1, B_w2)
    x = x + _A_ref(_layernorm(x, axis=-1), A_wqkv, A_wo)
    x = x + _B_ref(_layernorm(x, axis=-1), B_w1, B_w2)
    return x
```

```asm
; @launch kernel=qkv_a_kernel grid=(254,1,1) block=(512,1,1) lds=163840
; @launch kernel=attn_kernel grid=(256,1,1) block=(512,1,1) lds=141376
; @launch kernel=wo_a_kernel grid=(256,1,1) block=(512,1,1) lds=163840
; @launch kernel=ffn1_kernel grid=(224,1,1) block=(512,1,1) lds=163840
; @launch kernel=w2_a_kernel grid=(256,1,1) block=(512,1,1) lds=163840
; @launch kernel=qkv_b_kernel grid=(192,1,1) block=(512,1,1) lds=163840
; @launch kernel=attn_kernel grid=(256,1,1) block=(512,1,1) lds=141376
; @launch kernel=wo_b_kernel grid=(256,1,1) block=(512,1,1) lds=163840
; @launch kernel=ffn1_kernel grid=(224,1,1) block=(512,1,1) lds=163840
; @launch kernel=w2_b_kernel grid=(256,1,1) block=(512,1,1) lds=163840
.amdgcn_target "amdgcn-amd-amdhsa--gfx950"
.text
.globl qkv_a_kernel
.p2align 8
.type qkv_a_kernel,@function
qkv_a_kernel:
    s_cmp_ge_u32 s2, 254
    s_cbranch_scc1 qkv_a_kernel_done
    s_load_dwordx2 s[8:9], s[0:1], 0
    s_load_dwordx2 s[12:13], s[0:1], 8
    v_lshrrev_b32 v1, 6, v0
    v_and_b32 v2, 63, v0
    s_cmp_ge_u32 s2, 192
    s_cbranch_scc1 qkv_a_kernel_cs
    s_and_b32 s3, s2, 7
    s_lshr_b32 s4, s2, 3
    v_readfirstlane_b32 s26, v1
    s_and_b32 s5, s3, 3
    s_lshr_b32 s3, s3, 2
    s_lshl_b32 s5, s5, 2
    s_and_b32 s24, s4, 3
    s_add_u32 s24, s24, s5
    s_lshr_b32 s4, s4, 2
    s_mul_i32 s3, s3, 6
    s_add_u32 s25, s3, s4
    v_lshlrev_b32 v3, 4, v2
    s_cmp_lt_u32 s26, 4
    s_cbranch_scc1 qkv_a_kernel_cw
    s_sub_u32 s26, s26, 4
    s_lshr_b32 s27, s26, 1
    s_and_b32 s28, s26, 1
    s_lshl_b32 s30, s26, 12
    v_lshrrev_b32 v12, 4, v2
    v_bfe_u32 v13, v2, 2, 2
    v_xor_b32 v13, v13, v12
    v_lshlrev_b32 v13, 6, v13
    v_and_b32 v14, 3, v2
    v_lshlrev_b32 v14, 4, v14
    v_mul_u32_u24 v12, 3072, v12
    v_add3_u32 v8, v12, v13, v14
    v_add_u32 v9, 11264, v8
    v_add_u32 v10, 22528, v8
    v_add_u32 v11, 33792, v8
    v_lshrrev_b32 v12, 3, v2
    v_lshlrev_b32 v12, 10, v12
    v_lshrrev_b32 v13, 4, v2
    v_and_b32 v14, 7, v2
    v_xor_b32 v13, v13, v14
    v_xor_b32 v15, 0, v13
    v_lshlrev_b32 v15, 4, v15
    v_add_u32 v15, 0, v15
    v_add_u32 v4, v12, v15
    v_xor_b32 v15, 4, v13
    v_lshlrev_b32 v15, 4, v15
    v_add_u32 v15, 7168, v15
    v_add_u32 v5, v12, v15
    v_xor_b32 v15, 0, v13
    v_lshlrev_b32 v15, 4, v15
    v_add_u32 v15, 14336, v15
    v_add_u32 v6, v12, v15
    v_xor_b32 v15, 4, v13
    v_lshlrev_b32 v15, 4, v15
    v_add_u32 v15, 21504, v15
    v_add_u32 v7, v12, v15
    s_lshl_b32 s31, s24, 17
    s_lshl_b32 s3, s26, 15
    s_add_u32 s31, s31, s3
    s_mul_i32 s32, s26, 49152
    s_lshl_b32 s3, s25, 8
    s_add_u32 s32, s32, s3
    s_waitcnt lgkmcnt(0)
    s_mov_b32 s10, 0x200000
    s_mov_b32 s11, 0x00020000
    s_mov_b32 s14, 0x180000
    s_mov_b32 s15, 0x00020000
    s_add_u32 m0, s30, 16384
    s_add_u32 s3, s32, 0
    buffer_load_dwordx4 v8, s[12:15], s3 offen offset:0 lds
    buffer_load_dwordx4 v9, s[12:15], s3 offen offset:1024 lds
    buffer_load_dwordx4 v10, s[12:15], s3 offen offset:2048 lds
    buffer_load_dwordx4 v11, s[12:15], s3 offen offset:3072 lds
    s_add_u32 m0, s30, 0
    s_add_u32 s3, s31, 0
    buffer_load_dwordx4 v4, s[8:11], s3 offen offset:0 lds
    buffer_load_dwordx4 v5, s[8:11], s3 offen offset:1024 lds
    buffer_load_dwordx4 v6, s[8:11], s3 offen offset:2048 lds
    buffer_load_dwordx4 v7, s[8:11], s3 offen offset:3072 lds
    s_add_u32 m0, s30, 49152
    s_add_u32 s3, s32, 196608
    buffer_load_dwordx4 v8, s[12:15], s3 offen offset:0 lds
    buffer_load_dwordx4 v9, s[12:15], s3 offen offset:1024 lds
    buffer_load_dwordx4 v10, s[12:15], s3 offen offset:2048 lds
    buffer_load_dwordx4 v11, s[12:15], s3 offen offset:3072 lds
    s_add_u32 m0, s30, 32768
    s_add_u32 s3, s31, 128
    buffer_load_dwordx4 v4, s[8:11], s3 offen offset:0 lds
    buffer_load_dwordx4 v5, s[8:11], s3 offen offset:1024 lds
    buffer_load_dwordx4 v6, s[8:11], s3 offen offset:2048 lds
    buffer_load_dwordx4 v7, s[8:11], s3 offen offset:3072 lds
    s_waitcnt vmcnt(8)
    s_barrier
    s_add_u32 m0, s30, 81920
    s_add_u32 s3, s32, 393216
    buffer_load_dwordx4 v8, s[12:15], s3 offen offset:0 lds
    buffer_load_dwordx4 v9, s[12:15], s3 offen offset:1024 lds
    buffer_load_dwordx4 v10, s[12:15], s3 offen offset:2048 lds
    buffer_load_dwordx4 v11, s[12:15], s3 offen offset:3072 lds
    s_add_u32 m0, s30, 65536
    s_add_u32 s3, s31, 256
    buffer_load_dwordx4 v4, s[8:11], s3 offen offset:0 lds
    buffer_load_dwordx4 v5, s[8:11], s3 offen offset:1024 lds
    buffer_load_dwordx4 v6, s[8:11], s3 offen offset:2048 lds
    buffer_load_dwordx4 v7, s[8:11], s3 offen offset:3072 lds
    s_waitcnt vmcnt(8)
    s_barrier
    s_add_u32 m0, s30, 114688
    s_add_u32 s3, s32, 589824
    buffer_load_dwordx4 v8, s[12:15], s3 offen offset:0 lds
    buffer_load_dwordx4 v9, s[12:15], s3 offen offset:1024 lds
    buffer_load_dwordx4 v10, s[12:15], s3 offen offset:2048 lds
    buffer_load_dwordx4 v11, s[12:15], s3 offen offset:3072 lds
    s_add_u32 m0, s30, 98304
    s_add_u32 s3, s31, 384
    buffer_load_dwordx4 v4, s[8:11], s3 offen offset:0 lds
    buffer_load_dwordx4 v5, s[8:11], s3 offen offset:1024 lds
    buffer_load_dwordx4 v6, s[8:11], s3 offen offset:2048 lds
    buffer_load_dwordx4 v7, s[8:11], s3 offen offset:3072 lds
    s_waitcnt vmcnt(8)
    s_barrier
    s_add_u32 m0, s30, 147456
    s_add_u32 s3, s32, 786432
    buffer_load_dwordx4 v8, s[12:15], s3 offen offset:0 lds
    buffer_load_dwordx4 v9, s[12:15], s3 offen offset:1024 lds
    buffer_load_dwordx4 v10, s[12:15], s3 offen offset:2048 lds
    buffer_load_dwordx4 v11, s[12:15], s3 offen offset:3072 lds
    s_add_u32 m0, s30, 131072
    s_add_u32 s3, s31, 512
    buffer_load_dwordx4 v4, s[8:11], s3 offen offset:0 lds
    buffer_load_dwordx4 v5, s[8:11], s3 offen offset:1024 lds
    buffer_load_dwordx4 v6, s[8:11], s3 offen offset:2048 lds
    buffer_load_dwordx4 v7, s[8:11], s3 offen offset:3072 lds
    s_waitcnt vmcnt(8)
    s_barrier
    s_add_u32 m0, s30, 16384
    s_add_u32 s3, s32, 983040
    buffer_load_dwordx4 v8, s[12:15], s3 offen offset:0 lds
    buffer_load_dwordx4 v9, s[12:15], s3 offen offset:1024 lds
    buffer_load_dwordx4 v10, s[12:15], s3 offen offset:2048 lds
    buffer_load_dwordx4 v11, s[12:15], s3 offen offset:3072 lds
    s_add_u32 m0, s30, 0
    s_add_u32 s3, s31, 640
    buffer_load_dwordx4 v4, s[8:11], s3 offen offset:0 lds
    buffer_load_dwordx4 v5, s[8:11], s3 offen offset:1024 lds
    buffer_load_dwordx4 v6, s[8:11], s3 offen offset:2048 lds
    buffer_load_dwordx4 v7, s[8:11], s3 offen offset:3072 lds
    s_waitcnt vmcnt(8)
    s_barrier
    s_add_u32 m0, s30, 49152
    s_add_u32 s3, s32, 1179648
    buffer_load_dwordx4 v8, s[12:15], s3 offen offset:0 lds
    buffer_load_dwordx4 v9, s[12:15], s3 offen offset:1024 lds
    buffer_load_dwordx4 v10, s[12:15], s3 offen offset:2048 lds
    buffer_load_dwordx4 v11, s[12:15], s3 offen offset:3072 lds
    s_add_u32 m0, s30, 32768
    s_add_u32 s3, s31, 768
    buffer_load_dwordx4 v4, s[8:11], s3 offen offset:0 lds
    buffer_load_dwordx4 v5, s[8:11], s3 offen offset:1024 lds
    buffer_load_dwordx4 v6, s[8:11], s3 offen offset:2048 lds
    buffer_load_dwordx4 v7, s[8:11], s3 offen offset:3072 lds
    s_waitcnt vmcnt(8)
    s_barrier
    s_add_u32 m0, s30, 81920
    s_add_u32 s3, s32, 1376256
    buffer_load_dwordx4 v8, s[12:15], s3 offen offset:0 lds
    buffer_load_dwordx4 v9, s[12:15], s3 offen offset:1024 lds
    buffer_load_dwordx4 v10, s[12:15], s3 offen offset:2048 lds
    buffer_load_dwordx4 v11, s[12:15], s3 offen offset:3072 lds
    s_add_u32 m0, s30, 65536
    s_add_u32 s3, s31, 896
    buffer_load_dwordx4 v4, s[8:11], s3 offen offset:0 lds
    buffer_load_dwordx4 v5, s[8:11], s3 offen offset:1024 lds
    buffer_load_dwordx4 v6, s[8:11], s3 offen offset:2048 lds
    buffer_load_dwordx4 v7, s[8:11], s3 offen offset:3072 lds
    s_waitcnt vmcnt(8)
    s_barrier
    s_waitcnt vmcnt(0)
    s_barrier
    s_endpgm
qkv_a_kernel_cs:
    s_cmp_ge_u32 s2, 218
    s_cbranch_scc1 qkv_a_kernel_pf
    s_waitcnt lgkmcnt(0)
    s_load_dwordx2 s[12:13], s[0:1], 32
    s_load_dwordx2 s[20:21], s[0:1], 8
    s_load_dwordx2 s[16:17], s[0:1], 64
    s_sub_u32 s24, s2, 192
    v_readfirstlane_b32 s26, v1
    s_mov_b32 s25, 3584
    s_mov_b32 s27, 0x1300000
    s_lshl_b32 s28, s24, 9
    s_waitcnt lgkmcnt(0)
    s_mov_b32 s14, 1835008
    s_cmp_lt_u32 s24, 14
    s_cbranch_scc1 qkv_a_kernel_cs1
    s_mov_b32 s12, s20
    s_mov_b32 s13, s21
    s_mov_b32 s14, 1572864
    s_sub_u32 s24, s24, 14
    s_mov_b32 s25, 3072
    s_lshl_b32 s28, s24, 9
    s_add_u32 s28, s28, 8192
qkv_a_kernel_cs1:
    s_mov_b32 s15, 0x00020000
    s_add_u32 s16, s16, s27
    s_addc_u32 s17, s17, 0
    s_mov_b32 s18, 16384
    s_mov_b32 s19, 0x00020000
    s_mul_i32 s29, s26, s25
    s_lshl_b32 s29, s29, 6
    s_lshl_b32 s3, s24, 8
    s_add_u32 s29, s29, s3
    v_lshlrev_b32 v3, 2, v2
    v_mov_b32 v4, 0
    v_mov_b32 v5, 0
    buffer_load_dword v16, v3, s[12:15], s29 offen
    s_add_u32 s29, s29, s25
    buffer_load_dword v17, v3, s[12:15], s29 offen
    s_add_u32 s29, s29, s25
    buffer_load_dword v18, v3, s[12:15], s29 offen
    s_add_u32 s29, s29, s25
    buffer_load_dword v19, v3, s[12:15], s29 offen
    s_add_u32 s29, s29, s25
    buffer_load_dword v20, v3, s[12:15], s29 offen
    s_add_u32 s29, s29, s25
    buffer_load_dword v21, v3, s[12:15], s29 offen
    s_add_u32 s29, s29, s25
    buffer_load_dword v22, v3, s[12:15], s29 offen
    s_add_u32 s29, s29, s25
    buffer_load_dword v23, v3, s[12:15], s29 offen
    s_add_u32 s29, s29, s25
    buffer_load_dword v24, v3, s[12:15], s29 offen
    s_add_u32 s29, s29, s25
    buffer_load_dword v25, v3, s[12:15], s29 offen
    s_add_u32 s29, s29, s25
    buffer_load_dword v26, v3, s[12:15], s29 offen
    s_add_u32 s29, s29, s25
    buffer_load_dword v27, v3, s[12:15], s29 offen
    s_add_u32 s29, s29, s25
    buffer_load_dword v28, v3, s[12:15], s29 offen
    s_add_u32 s29, s29, s25
    buffer_load_dword v29, v3, s[12:15], s29 offen
    s_add_u32 s29, s29, s25
    buffer_load_dword v30, v3, s[12:15], s29 offen
    s_add_u32 s29, s29, s25
    buffer_load_dword v31, v3, s[12:15], s29 offen
    s_add_u32 s29, s29, s25
    buffer_load_dword v32, v3, s[12:15], s29 offen
    s_add_u32 s29, s29, s25
    buffer_load_dword v33, v3, s[12:15], s29 offen
    s_add_u32 s29, s29, s25
    buffer_load_dword v34, v3, s[12:15], s29 offen
    s_add_u32 s29, s29, s25
    buffer_load_dword v35, v3, s[12:15], s29 offen
    s_add_u32 s29, s29, s25
    buffer_load_dword v36, v3, s[12:15], s29 offen
    s_add_u32 s29, s29, s25
    buffer_load_dword v37, v3, s[12:15], s29 offen
    s_add_u32 s29, s29, s25
    buffer_load_dword v38, v3, s[12:15], s29 offen
    s_add_u32 s29, s29, s25
    buffer_load_dword v39, v3, s[12:15], s29 offen
    s_add_u32 s29, s29, s25
    buffer_load_dword v40, v3, s[12:15], s29 offen
    s_add_u32 s29, s29, s25
    buffer_load_dword v41, v3, s[12:15], s29 offen
    s_add_u32 s29, s29, s25
    buffer_load_dword v42, v3, s[12:15], s29 offen
    s_add_u32 s29, s29, s25
    buffer_load_dword v43, v3, s[12:15], s29 offen
    s_add_u32 s29, s29, s25
    buffer_load_dword v44, v3, s[12:15], s29 offen
    s_add_u32 s29, s29, s25
    buffer_load_dword v45, v3, s[12:15], s29 offen
    s_add_u32 s29, s29, s25
    buffer_load_dword v46, v3, s[12:15], s29 offen
    s_add_u32 s29, s29, s25
    buffer_load_dword v47, v3, s[12:15], s29 offen
    s_add_u32 s29, s29, s25
    buffer_load_dword v48, v3, s[12:15], s29 offen
    s_add_u32 s29, s29, s25
    buffer_load_dword v49, v3, s[12:15], s29 offen
    s_add_u32 s29, s29, s25
    buffer_load_dword v50, v3, s[12:15], s29 offen
    s_add_u32 s29, s29, s25
    buffer_load_dword v51, v3, s[12:15], s29 offen
    s_add_u32 s29, s29, s25
    buffer_load_dword v52, v3, s[12:15], s29 offen
    s_add_u32 s29, s29, s25
    buffer_load_dword v53, v3, s[12:15], s29 offen
    s_add_u32 s29, s29, s25
    buffer_load_dword v54, v3, s[12:15], s29 offen
    s_add_u32 s29, s29, s25
    buffer_load_dword v55, v3, s[12:15], s29 offen
    s_add_u32 s29, s29, s25
    buffer_load_dword v56, v3, s[12:15], s29 offen
    s_add_u32 s29, s29, s25
    buffer_load_dword v57, v3, s[12:15], s29 offen
    s_add_u32 s29, s29, s25
    buffer_load_dword v58, v3, s[12:15], s29 offen
    s_add_u32 s29, s29, s25
    buffer_load_dword v59, v3, s[12:15], s29 offen
    s_add_u32 s29, s29, s25
    buffer_load_dword v60, v3, s[12:15], s29 offen
    s_add_u32 s29, s29, s25
    buffer_load_dword v61, v3, s[12:15], s29 offen
    s_add_u32 s29, s29, s25
    buffer_load_dword v62, v3, s[12:15], s29 offen
    s_add_u32 s29, s29, s25
    buffer_load_dword v63, v3, s[12:15], s29 offen
    s_add_u32 s29, s29, s25
    buffer_load_dword v64, v3, s[12:15], s29 offen
    s_add_u32 s29, s29, s25
    buffer_load_dword v65, v3, s[12:15], s29 offen
    s_add_u32 s29, s29, s25
    buffer_load_dword v66, v3, s[12:15], s29 offen
    s_add_u32 s29, s29, s25
    buffer_load_dword v67, v3, s[12:15], s29 offen
    s_add_u32 s29, s29, s25
    buffer_load_dword v68, v3, s[12:15], s29 offen
    s_add_u32 s29, s29, s25
    buffer_load_dword v69, v3, s[12:15], s29 offen
    s_add_u32 s29, s29, s25
    buffer_load_dword v70, v3, s[12:15], s29 offen
    s_add_u32 s29, s29, s25
    buffer_load_dword v71, v3, s[12:15], s29 offen
    s_add_u32 s29, s29, s25
    buffer_load_dword v72, v3, s[12:15], s29 offen
    s_add_u32 s29, s29, s25
    buffer_load_dword v73, v3, s[12:15], s29 offen
    s_add_u32 s29, s29, s25
    buffer_load_dword v74, v3, s[12:15], s29 offen
    s_add_u32 s29, s29, s25
    buffer_load_dword v75, v3, s[12:15], s29 offen
    s_add_u32 s29, s29, s25
    buffer_load_dword v76, v3, s[12:15], s29 offen
    s_add_u32 s29, s29, s25
    buffer_load_dword v77, v3, s[12:15], s29 offen
    s_add_u32 s29, s29, s25
    buffer_load_dword v78, v3, s[12:15], s29 offen
    s_add_u32 s29, s29, s25
    buffer_load_dword v79, v3, s[12:15], s29 offen
    s_add_u32 s29, s29, s25
    s_waitcnt vmcnt(0)
    v_lshlrev_b32 v6, 16, v16
    v_and_b32 v7, 0xffff0000, v16
    v_add_f32 v4, v4, v6
    v_add_f32 v5, v5, v7
    v_lshlrev_b32 v6, 16, v17
    v_and_b32 v7, 0xffff0000, v17
    v_add_f32 v4, v4, v6
    v_add_f32 v5, v5, v7
    v_lshlrev_b32 v6, 16, v18
    v_and_b32 v7, 0xffff0000, v18
    v_add_f32 v4, v4, v6
    v_add_f32 v5, v5, v7
    v_lshlrev_b32 v6, 16, v19
    v_and_b32 v7, 0xffff0000, v19
    v_add_f32 v4, v4, v6
    v_add_f32 v5, v5, v7
    v_lshlrev_b32 v6, 16, v20
    v_and_b32 v7, 0xffff0000, v20
    v_add_f32 v4, v4, v6
    v_add_f32 v5, v5, v7
    v_lshlrev_b32 v6, 16, v21
    v_and_b32 v7, 0xffff0000, v21
    v_add_f32 v4, v4, v6
    v_add_f32 v5, v5, v7
    v_lshlrev_b32 v6, 16, v22
    v_and_b32 v7, 0xffff0000, v22
    v_add_f32 v4, v4, v6
    v_add_f32 v5, v5, v7
    v_lshlrev_b32 v6, 16, v23
    v_and_b32 v7, 0xffff0000, v23
    v_add_f32 v4, v4, v6
    v_add_f32 v5, v5, v7
    v_lshlrev_b32 v6, 16, v24
    v_and_b32 v7, 0xffff0000, v24
    v_add_f32 v4, v4, v6
    v_add_f32 v5, v5, v7
    v_lshlrev_b32 v6, 16, v25
    v_and_b32 v7, 0xffff0000, v25
    v_add_f32 v4, v4, v6
    v_add_f32 v5, v5, v7
    v_lshlrev_b32 v6, 16, v26
    v_and_b32 v7, 0xffff0000, v26
    v_add_f32 v4, v4, v6
    v_add_f32 v5, v5, v7
    v_lshlrev_b32 v6, 16, v27
    v_and_b32 v7, 0xffff0000, v27
    v_add_f32 v4, v4, v6
    v_add_f32 v5, v5, v7
    v_lshlrev_b32 v6, 16, v28
    v_and_b32 v7, 0xffff0000, v28
    v_add_f32 v4, v4, v6
    v_add_f32 v5, v5, v7
    v_lshlrev_b32 v6, 16, v29
    v_and_b32 v7, 0xffff0000, v29
    v_add_f32 v4, v4, v6
    v_add_f32 v5, v5, v7
    v_lshlrev_b32 v6, 16, v30
    v_and_b32 v7, 0xffff0000, v30
    v_add_f32 v4, v4, v6
    v_add_f32 v5, v5, v7
    v_lshlrev_b32 v6, 16, v31
    v_and_b32 v7, 0xffff0000, v31
    v_add_f32 v4, v4, v6
    v_add_f32 v5, v5, v7
    v_lshlrev_b32 v6, 16, v32
    v_and_b32 v7, 0xffff0000, v32
    v_add_f32 v4, v4, v6
    v_add_f32 v5, v5, v7
    v_lshlrev_b32 v6, 16, v33
    v_and_b32 v7, 0xffff0000, v33
    v_add_f32 v4, v4, v6
    v_add_f32 v5, v5, v7
    v_lshlrev_b32 v6, 16, v34
    v_and_b32 v7, 0xffff0000, v34
    v_add_f32 v4, v4, v6
    v_add_f32 v5, v5, v7
    v_lshlrev_b32 v6, 16, v35
    v_and_b32 v7, 0xffff0000, v35
    v_add_f32 v4, v4, v6
    v_add_f32 v5, v5, v7
    v_lshlrev_b32 v6, 16, v36
    v_and_b32 v7, 0xffff0000, v36
    v_add_f32 v4, v4, v6
    v_add_f32 v5, v5, v7
    v_lshlrev_b32 v6, 16, v37
    v_and_b32 v7, 0xffff0000, v37
    v_add_f32 v4, v4, v6
    v_add_f32 v5, v5, v7
    v_lshlrev_b32 v6, 16, v38
    v_and_b32 v7, 0xffff0000, v38
    v_add_f32 v4, v4, v6
    v_add_f32 v5, v5, v7
    v_lshlrev_b32 v6, 16, v39
    v_and_b32 v7, 0xffff0000, v39
    v_add_f32 v4, v4, v6
    v_add_f32 v5, v5, v7
    v_lshlrev_b32 v6, 16, v40
    v_and_b32 v7, 0xffff0000, v40
    v_add_f32 v4, v4, v6
    v_add_f32 v5, v5, v7
    v_lshlrev_b32 v6, 16, v41
    v_and_b32 v7, 0xffff0000, v41
    v_add_f32 v4, v4, v6
    v_add_f32 v5, v5, v7
    v_lshlrev_b32 v6, 16, v42
    v_and_b32 v7, 0xffff0000, v42
    v_add_f32 v4, v4, v6
    v_add_f32 v5, v5, v7
    v_lshlrev_b32 v6, 16, v43
    v_and_b32 v7, 0xffff0000, v43
    v_add_f32 v4, v4, v6
    v_add_f32 v5, v5, v7
    v_lshlrev_b32 v6, 16, v44
    v_and_b32 v7, 0xffff0000, v44
    v_add_f32 v4, v4, v6
    v_add_f32 v5, v5, v7
    v_lshlrev_b32 v6, 16, v45
    v_and_b32 v7, 0xffff0000, v45
    v_add_f32 v4, v4, v6
    v_add_f32 v5, v5, v7
    v_lshlrev_b32 v6, 16, v46
    v_and_b32 v7, 0xffff0000, v46
    v_add_f32 v4, v4, v6
    v_add_f32 v5, v5, v7
    v_lshlrev_b32 v6, 16, v47
    v_and_b32 v7, 0xffff0000, v47
    v_add_f32 v4, v4, v6
    v_add_f32 v5, v5, v7
    v_lshlrev_b32 v6, 16, v48
    v_and_b32 v7, 0xffff0000, v48
    v_add_f32 v4, v4, v6
    v_add_f32 v5, v5, v7
    v_lshlrev_b32 v6, 16, v49
    v_and_b32 v7, 0xffff0000, v49
    v_add_f32 v4, v4, v6
    v_add_f32 v5, v5, v7
    v_lshlrev_b32 v6, 16, v50
    v_and_b32 v7, 0xffff0000, v50
    v_add_f32 v4, v4, v6
    v_add_f32 v5, v5, v7
    v_lshlrev_b32 v6, 16, v51
    v_and_b32 v7, 0xffff0000, v51
    v_add_f32 v4, v4, v6
    v_add_f32 v5, v5, v7
    v_lshlrev_b32 v6, 16, v52
    v_and_b32 v7, 0xffff0000, v52
    v_add_f32 v4, v4, v6
    v_add_f32 v5, v5, v7
    v_lshlrev_b32 v6, 16, v53
    v_and_b32 v7, 0xffff0000, v53
    v_add_f32 v4, v4, v6
    v_add_f32 v5, v5, v7
    v_lshlrev_b32 v6, 16, v54
    v_and_b32 v7, 0xffff0000, v54
    v_add_f32 v4, v4, v6
    v_add_f32 v5, v5, v7
    v_lshlrev_b32 v6, 16, v55
    v_and_b32 v7, 0xffff0000, v55
    v_add_f32 v4, v4, v6
    v_add_f32 v5, v5, v7
    v_lshlrev_b32 v6, 16, v56
    v_and_b32 v7, 0xffff0000, v56
    v_add_f32 v4, v4, v6
    v_add_f32 v5, v5, v7
    v_lshlrev_b32 v6, 16, v57
    v_and_b32 v7, 0xffff0000, v57
    v_add_f32 v4, v4, v6
    v_add_f32 v5, v5, v7
    v_lshlrev_b32 v6, 16, v58
    v_and_b32 v7, 0xffff0000, v58
    v_add_f32 v4, v4, v6
    v_add_f32 v5, v5, v7
    v_lshlrev_b32 v6, 16, v59
    v_and_b32 v7, 0xffff0000, v59
    v_add_f32 v4, v4, v6
    v_add_f32 v5, v5, v7
    v_lshlrev_b32 v6, 16, v60
    v_and_b32 v7, 0xffff0000, v60
    v_add_f32 v4, v4, v6
    v_add_f32 v5, v5, v7
    v_lshlrev_b32 v6, 16, v61
    v_and_b32 v7, 0xffff0000, v61
    v_add_f32 v4, v4, v6
    v_add_f32 v5, v5, v7
    v_lshlrev_b32 v6, 16, v62
    v_and_b32 v7, 0xffff0000, v62
    v_add_f32 v4, v4, v6
    v_add_f32 v5, v5, v7
    v_lshlrev_b32 v6, 16, v63
    v_and_b32 v7, 0xffff0000, v63
    v_add_f32 v4, v4, v6
    v_add_f32 v5, v5, v7
    v_lshlrev_b32 v6, 16, v64
    v_and_b32 v7, 0xffff0000, v64
    v_add_f32 v4, v4, v6
    v_add_f32 v5, v5, v7
    v_lshlrev_b32 v6, 16, v65
    v_and_b32 v7, 0xffff0000, v65
    v_add_f32 v4, v4, v6
    v_add_f32 v5, v5, v7
    v_lshlrev_b32 v6, 16, v66
    v_and_b32 v7, 0xffff0000, v66
    v_add_f32 v4, v4, v6
    v_add_f32 v5, v5, v7
    v_lshlrev_b32 v6, 16, v67
    v_and_b32 v7, 0xffff0000, v67
    v_add_f32 v4, v4, v6
    v_add_f32 v5, v5, v7
    v_lshlrev_b32 v6, 16, v68
    v_and_b32 v7, 0xffff0000, v68
    v_add_f32 v4, v4, v6
    v_add_f32 v5, v5, v7
    v_lshlrev_b32 v6, 16, v69
    v_and_b32 v7, 0xffff0000, v69
    v_add_f32 v4, v4, v6
    v_add_f32 v5, v5, v7
    v_lshlrev_b32 v6, 16, v70
    v_and_b32 v7, 0xffff0000, v70
    v_add_f32 v4, v4, v6
    v_add_f32 v5, v5, v7
    v_lshlrev_b32 v6, 16, v71
    v_and_b32 v7, 0xffff0000, v71
    v_add_f32 v4, v4, v6
    v_add_f32 v5, v5, v7
    v_lshlrev_b32 v6, 16, v72
    v_and_b32 v7, 0xffff0000, v72
    v_add_f32 v4, v4, v6
    v_add_f32 v5, v5, v7
    v_lshlrev_b32 v6, 16, v73
    v_and_b32 v7, 0xffff0000, v73
    v_add_f32 v4, v4, v6
    v_add_f32 v5, v5, v7
    v_lshlrev_b32 v6, 16, v74
    v_and_b32 v7, 0xffff0000, v74
    v_add_f32 v4, v4, v6
    v_add_f32 v5, v5, v7
    v_lshlrev_b32 v6, 16, v75
    v_and_b32 v7, 0xffff0000, v75
    v_add_f32 v4, v4, v6
    v_add_f32 v5, v5, v7
    v_lshlrev_b32 v6, 16, v76
    v_and_b32 v7, 0xffff0000, v76
    v_add_f32 v4, v4, v6
    v_add_f32 v5, v5, v7
    v_lshlrev_b32 v6, 16, v77
    v_and_b32 v7, 0xffff0000, v77
    v_add_f32 v4, v4, v6
    v_add_f32 v5, v5, v7
    v_lshlrev_b32 v6, 16, v78
    v_and_b32 v7, 0xffff0000, v78
    v_add_f32 v4, v4, v6
    v_add_f32 v5, v5, v7
    v_lshlrev_b32 v6, 16, v79
    v_and_b32 v7, 0xffff0000, v79
    v_add_f32 v4, v4, v6
    v_add_f32 v5, v5, v7
    v_lshlrev_b32 v6, 3, v0
    ds_write_b64 v6, v[4:5]
    s_waitcnt lgkmcnt(0)
    s_barrier
    s_cmp_lg_u32 s26, 0
    s_cbranch_scc1 qkv_a_kernel_done
    v_lshlrev_b32 v6, 3, v2
    ds_read_b64 v[16:17], v6 offset:0
    ds_read_b64 v[18:19], v6 offset:512
    ds_read_b64 v[20:21], v6 offset:1024
    ds_read_b64 v[22:23], v6 offset:1536
    ds_read_b64 v[24:25], v6 offset:2048
    ds_read_b64 v[26:27], v6 offset:2560
    ds_read_b64 v[28:29], v6 offset:3072
    ds_read_b64 v[30:31], v6 offset:3584
    s_waitcnt lgkmcnt(0)
    v_add_f32 v16, v16, v18
    v_add_f32 v17, v17, v19
    v_add_f32 v16, v16, v20
    v_add_f32 v17, v17, v21
    v_add_f32 v16, v16, v22
    v_add_f32 v17, v17, v23
    v_add_f32 v16, v16, v24
    v_add_f32 v17, v17, v25
    v_add_f32 v16, v16, v26
    v_add_f32 v17, v17, v27
    v_add_f32 v16, v16, v28
    v_add_f32 v17, v17, v29
    v_add_f32 v16, v16, v30
    v_add_f32 v17, v17, v31
    buffer_store_dwordx2 v[16:17], v6, s[16:19], s28 offen
    s_endpgm
qkv_a_kernel_pf:
    s_waitcnt lgkmcnt(0)
    s_load_dwordx2 s[12:13], s[0:1], 40
    s_load_dwordx2 s[20:21], s[0:1], 16
    s_sub_u32 s24, s2, 218
    v_lshlrev_b32 v3, 4, v0
    s_waitcnt lgkmcnt(0)
    s_mov_b32 s14, 1835008
    s_cmp_lt_u32 s24, 28
    s_cbranch_scc1 qkv_a_kernel_pf1
    s_mov_b32 s12, s20
    s_mov_b32 s13, s21
    s_mov_b32 s14, 524288
    s_sub_u32 s24, s24, 28
qkv_a_kernel_pf1:
    s_mov_b32 s15, 0x00020000
    s_lshl_b32 s29, s24, 16
    buffer_load_dwordx4 v[16:19], v3, s[12:15], s29 offen
    s_add_u32 s29, s29, 8192
    buffer_load_dwordx4 v[20:23], v3, s[12:15], s29 offen
    s_add_u32 s29, s29, 8192
    buffer_load_dwordx4 v[24:27], v3, s[12:15], s29 offen
    s_add_u32 s29, s29, 8192
    buffer_load_dwordx4 v[28:31], v3, s[12:15], s29 offen
    s_add_u32 s29, s29, 8192
    buffer_load_dwordx4 v[32:35], v3, s[12:15], s29 offen
    s_add_u32 s29, s29, 8192
    buffer_load_dwordx4 v[36:39], v3, s[12:15], s29 offen
    s_add_u32 s29, s29, 8192
    buffer_load_dwordx4 v[40:43], v3, s[12:15], s29 offen
    s_add_u32 s29, s29, 8192
    buffer_load_dwordx4 v[44:47], v3, s[12:15], s29 offen
    s_add_u32 s29, s29, 8192
    s_waitcnt vmcnt(0)
    s_endpgm
qkv_a_kernel_cw:
    s_lshr_b32 s27, s26, 1
    s_and_b32 s28, s26, 1
    s_mov_b32 s29, 0x3f803f80
    s_load_dwordx2 s[16:17], s[0:1], 64
    v_lshrrev_b32 v12, 5, v2
    v_add_u32 v12, 0, v12
    v_bfe_u32 v13, v2, 1, 3
    v_xor_b32 v12, v12, v13
    v_lshlrev_b32 v12, 4, v12
    v_and_b32 v13, 31, v2
    v_lshlrev_b32 v13, 7, v13
    v_add_u32 v16, v12, v13
    v_lshrrev_b32 v12, 5, v2
    v_add_u32 v12, 2, v12
    v_bfe_u32 v13, v2, 1, 3
    v_xor_b32 v12, v12, v13
    v_lshlrev_b32 v12, 4, v12
    v_and_b32 v13, 31, v2
    v_lshlrev_b32 v13, 7, v13
    v_add_u32 v17, v12, v13
    v_lshrrev_b32 v12, 5, v2
    v_add_u32 v12, 4, v12
    v_bfe_u32 v13, v2, 1, 3
    v_xor_b32 v12, v12, v13
    v_lshlrev_b32 v12, 4, v12
    v_and_b32 v13, 31, v2
    v_lshlrev_b32 v13, 7, v13
    v_add_u32 v18, v12, v13
    v_lshrrev_b32 v12, 5, v2
    v_add_u32 v12, 6, v12
    v_bfe_u32 v13, v2, 1, 3
    v_xor_b32 v12, v12, v13
    v_lshlrev_b32 v12, 4, v12
    v_and_b32 v13, 31, v2
    v_lshlrev_b32 v13, 7, v13
    v_add_u32 v19, v12, v13
    s_lshl_b32 s3, s27, 13
    v_add_u32 v16, s3, v16
    v_add_u32 v17, s3, v17
    v_add_u32 v18, s3, v18
    v_add_u32 v19, s3, v19
    v_bfe_u32 v12, v2, 2, 2
    v_lshrrev_b32 v13, 5, v2
    v_lshlrev_b32 v13, 3, v13
    v_add_u32 v13, v13, v12
    v_mul_u32_u24 v13, 256, v13
    v_bfe_u32 v14, v2, 4, 1
    v_lshlrev_b32 v14, 5, v14
    v_and_b32 v15, 3, v2
    v_lshlrev_b32 v15, 3, v15
    v_add3_u32 v13, v13, v14, v15
    v_add_u32 v13, 16384, v13
    s_lshl_b32 s3, s28, 1
    s_add_u32 s3, s3, 0
    v_xor_b32 v14, s3, v12
    v_lshlrev_b32 v14, 6, v14
    v_add_u32 v20, v13, v14
    s_lshl_b32 s3, s28, 1
    s_add_u32 s3, s3, 1
    v_xor_b32 v14, s3, v12
    v_lshlrev_b32 v14, 6, v14
    v_add_u32 v21, v13, v14
    v_add_u32 v4, 0x10000, v16
    v_add_u32 v10, 0x20000, v16
    v_add_u32 v5, 0x10000, v17
    v_add_u32 v11, 0x20000, v17
    v_add_u32 v6, 0x10000, v18
    v_add_u32 v12, 0x20000, v18
    v_add_u32 v7, 0x10000, v19
    v_add_u32 v13, 0x20000, v19
    v_add_u32 v8, 0x10000, v20
    v_add_u32 v14, 0x20000, v20
    v_add_u32 v9, 0x10000, v21
    v_add_u32 v15, 0x20000, v21
    s_waitcnt lgkmcnt(0)
    s_add_u32 s16, s16, 0x200000
    s_addc_u32 s17, s17, 0
    s_mov_b32 s18, 0x600000
    s_mov_b32 s19, 0x00020000
    s_cmp_ge_u32 s25, 8
    s_cbranch_scc1 qkv_a_kernel_v
    s_cmp_lg_u32 s26, 0
    s_cbranch_scc1 qkv_a_kernel_q1
    v_mov_b32 v64, 0
    v_mov_b32 v65, 0
    v_mov_b32 v66, 0
    v_mov_b32 v67, 0
    v_mov_b32 v68, 0
    v_mov_b32 v69, 0
    v_mov_b32 v70, 0
    v_mov_b32 v71, 0
    v_mov_b32 v72, 0
    v_mov_b32 v73, 0
    v_mov_b32 v74, 0
    v_mov_b32 v75, 0
    v_mov_b32 v76, 0
    v_mov_b32 v77, 0
    v_mov_b32 v78, 0
    v_mov_b32 v79, 0
    v_mov_b32 v80, 0
    v_mov_b32 v81, 0
    v_mov_b32 v82, 0
    v_mov_b32 v83, 0
    v_mov_b32 v84, 0
    v_mov_b32 v85, 0
    v_mov_b32 v86, 0
    v_mov_b32 v87, 0
    v_mov_b32 v88, 0
    v_mov_b32 v89, 0
    v_mov_b32 v90, 0
    v_mov_b32 v91, 0
    v_mov_b32 v92, 0
    v_mov_b32 v93, 0
    v_mov_b32 v94, 0
    v_mov_b32 v95, 0
    v_mov_b32 v96, 0
    v_mov_b32 v97, 0
    v_mov_b32 v98, 0
    v_mov_b32 v99, 0
    v_mov_b32 v100, 0
    v_mov_b32 v101, 0
    v_mov_b32 v102, 0
    v_mov_b32 v103, 0
    v_mov_b32 v104, 0
    v_mov_b32 v105, 0
    v_mov_b32 v106, 0
    v_mov_b32 v107, 0
    v_mov_b32 v108, 0
    v_mov_b32 v109, 0
    v_mov_b32 v110, 0
    v_mov_b32 v111, 0
    v_mov_b32 v112, 0
    v_mov_b32 v113, 0
    v_mov_b32 v114, 0
    v_mov_b32 v115, 0
    v_mov_b32 v116, 0
    v_mov_b32 v117, 0
    v_mov_b32 v118, 0
    v_mov_b32 v119, 0
    v_mov_b32 v120, 0
    v_mov_b32 v121, 0
    v_mov_b32 v122, 0
    v_mov_b32 v123, 0
    v_mov_b32 v124, 0
    v_mov_b32 v125, 0
    v_mov_b32 v126, 0
    v_mov_b32 v127, 0
    v_mov_b32 v128, 0
    v_mov_b32 v129, 0
    v_mov_b32 v130, 0
    v_mov_b32 v131, 0
    v_mov_b32 v132, 0
    v_mov_b32 v133, 0
    s_barrier
    ds_read_b128 v[32:35], v16 offset:0
    ds_read_b128 v[36:39], v16 offset:4096
    ds_read_b64_tr_b16 v[48:49], v20 offset:0
    ds_read_b64_tr_b16 v[50:51], v20 offset:1024
    ds_read_b64_tr_b16 v[52:53], v21 offset:0
    ds_read_b64_tr_b16 v[54:55], v21 offset:1024
    ds_read_b128 v[40:43], v17 offset:0
    ds_read_b128 v[44:47], v17 offset:4096
    ds_read_b64_tr_b16 v[56:57], v20 offset:4096
    ds_read_b64_tr_b16 v[58:59], v20 offset:5120
    ds_read_b64_tr_b16 v[60:61], v21 offset:4096
    ds_read_b64_tr_b16 v[62:63], v21 offset:5120
    s_waitcnt lgkmcnt(6)
    v_dot2_f32_bf16 v128, v32, s29, v128
    v_dot2_f32_bf16 v130, v32, v32, v130
    v_dot2_f32_bf16 v132, v48, s29, v132
    v_dot2_f32_bf16 v128, v33, s29, v128
    v_dot2_f32_bf16 v130, v33, v33, v130
    v_dot2_f32_bf16 v132, v49, s29, v132
    v_dot2_f32_bf16 v128, v34, s29, v128
    v_dot2_f32_bf16 v130, v34, v34, v130
    v_dot2_f32_bf16 v132, v50, s29, v132
    v_dot2_f32_bf16 v128, v35, s29, v128
    v_dot2_f32_bf16 v130, v35, v35, v130
    v_dot2_f32_bf16 v132, v51, s29, v132
    v_mfma_f32_32x32x16_bf16 v[64:79], v[48:51], v[32:35], v[64:79]
    ds_read_b128 v[196:199], v18 offset:0
    ds_read_b128 v[200:203], v18 offset:4096
    v_mfma_f32_32x32x16_bf16 v[80:95], v[52:55], v[32:35], v[80:95]
    ds_read_b64_tr_b16 v[204:205], v20 offset:8192
    ds_read_b64_tr_b16 v[206:207], v20 offset:9216
    v_mfma_f32_32x32x16_bf16 v[96:111], v[48:51], v[36:39], v[96:111]
    ds_read_b64_tr_b16 v[208:209], v21 offset:8192
    ds_read_b64_tr_b16 v[210:211], v21 offset:9216
    v_mfma_f32_32x32x16_bf16 v[112:127], v[52:55], v[36:39], v[112:127]
    s_waitcnt lgkmcnt(6)
    v_dot2_f32_bf16 v128, v40, s29, v128
    v_dot2_f32_bf16 v130, v40, v40, v130
    v_dot2_f32_bf16 v132, v56, s29, v132
    v_dot2_f32_bf16 v128, v41, s29, v128
    v_dot2_f32_bf16 v130, v41, v41, v130
    v_dot2_f32_bf16 v132, v57, s29, v132
    v_dot2_f32_bf16 v128, v42, s29, v128
    v_dot2_f32_bf16 v130, v42, v42, v130
    v_dot2_f32_bf16 v132, v58, s29, v132
    v_dot2_f32_bf16 v128, v43, s29, v128
    v_dot2_f32_bf16 v130, v43, v43, v130
    v_dot2_f32_bf16 v132, v59, s29, v132
    v_mfma_f32_32x32x16_bf16 v[64:79], v[56:59], v[40:43], v[64:79]
    ds_read_b128 v[32:35], v19 offset:0
    ds_read_b128 v[36:39], v19 offset:4096
    v_mfma_f32_32x32x16_bf16 v[80:95], v[60:63], v[40:43], v[80:95]
    ds_read_b64_tr_b16 v[48:49], v20 offset:12288
    ds_read_b64_tr_b16 v[50:51], v20 offset:13312
    v_mfma_f32_32x32x16_bf16 v[96:111], v[56:59], v[44:47], v[96:111]
    ds_read_b64_tr_b16 v[52:53], v21 offset:12288
    ds_read_b64_tr_b16 v[54:55], v21 offset:13312
    v_mfma_f32_32x32x16_bf16 v[112:127], v[60:63], v[44:47], v[112:127]
    s_waitcnt lgkmcnt(6)
    v_dot2_f32_bf16 v128, v196, s29, v128
    v_dot2_f32_bf16 v130, v196, v196, v130
    v_dot2_f32_bf16 v132, v204, s29, v132
    v_dot2_f32_bf16 v128, v197, s29, v128
    v_dot2_f32_bf16 v130, v197, v197, v130
    v_dot2_f32_bf16 v132, v205, s29, v132
    v_dot2_f32_bf16 v128, v198, s29, v128
    v_dot2_f32_bf16 v130, v198, v198, v130
    v_dot2_f32_bf16 v132, v206, s29, v132
    v_dot2_f32_bf16 v128, v199, s29, v128
    v_dot2_f32_bf16 v130, v199, v199, v130
    v_dot2_f32_bf16 v132, v207, s29, v132
    v_mfma_f32_32x32x16_bf16 v[64:79], v[204:207], v[196:199], v[64:79]
    s_barrier
    ds_read_b128 v[40:43], v16 offset:32768
    ds_read_b128 v[44:47], v16 offset:36864
    v_mfma_f32_32x32x16_bf16 v[80:95], v[208:211], v[196:199], v[80:95]
    ds_read_b64_tr_b16 v[56:57], v20 offset:32768
    ds_read_b64_tr_b16 v[58:59], v20 offset:33792
    v_mfma_f32_32x32x16_bf16 v[96:111], v[204:207], v[200:203], v[96:111]
    ds_read_b64_tr_b16 v[60:61], v21 offset:32768
    ds_read_b64_tr_b16 v[62:63], v21 offset:33792
    v_mfma_f32_32x32x16_bf16 v[112:127], v[208:211], v[200:203], v[112:127]
    s_waitcnt lgkmcnt(6)
    v_dot2_f32_bf16 v128, v32, s29, v128
    v_dot2_f32_bf16 v130, v32, v32, v130
    v_dot2_f32_bf16 v132, v48, s29, v132
    v_dot2_f32_bf16 v128, v33, s29, v128
    v_dot2_f32_bf16 v130, v33, v33, v130
    v_dot2_f32_bf16 v132, v49, s29, v132
    v_dot2_f32_bf16 v128, v34, s29, v128
    v_dot2_f32_bf16 v130, v34, v34, v130
    v_dot2_f32_bf16 v132, v50, s29, v132
    v_dot2_f32_bf16 v128, v35, s29, v128
    v_dot2_f32_bf16 v130, v35, v35, v130
    v_dot2_f32_bf16 v132, v51, s29, v132
    v_mfma_f32_32x32x16_bf16 v[64:79], v[48:51], v[32:35], v[64:79]
    ds_read_b128 v[196:199], v17 offset:32768
    ds_read_b128 v[200:203], v17 offset:36864
    v_mfma_f32_32x32x16_bf16 v[80:95], v[52:55], v[32:35], v[80:95]
    ds_read_b64_tr_b16 v[204:205], v20 offset:36864
    ds_read_b64_tr_b16 v[206:207], v20 offset:37888
    v_mfma_f32_32x32x16_bf16 v[96:111], v[48:51], v[36:39], v[96:111]
    ds_read_b64_tr_b16 v[208:209], v21 offset:36864
    ds_read_b64_tr_b16 v[210:211], v21 offset:37888
    v_mfma_f32_32x32x16_bf16 v[112:127], v[52:55], v[36:39], v[112:127]
    s_waitcnt lgkmcnt(6)
    v_dot2_f32_bf16 v128, v40, s29, v128
    v_dot2_f32_bf16 v130, v40, v40, v130
    v_dot2_f32_bf16 v132, v56, s29, v132
    v_dot2_f32_bf16 v128, v41, s29, v128
    v_dot2_f32_bf16 v130, v41, v41, v130
    v_dot2_f32_bf16 v132, v57, s29, v132
    v_dot2_f32_bf16 v128, v42, s29, v128
    v_dot2_f32_bf16 v130, v42, v42, v130
    v_dot2_f32_bf16 v132, v58, s29, v132
    v_dot2_f32_bf16 v128, v43, s29, v128
    v_dot2_f32_bf16 v130, v43, v43, v130
    v_dot2_f32_bf16 v132, v59, s29, v132
    v_mfma_f32_32x32x16_bf16 v[64:79], v[56:59], v[40:43], v[64:79]
    ds_read_b128 v[32:35], v18 offset:32768
    ds_read_b128 v[36:39], v18 offset:36864
    v_mfma_f32_32x32x16_bf16 v[80:95], v[60:63], v[40:43], v[80:95]
    ds_read_b64_tr_b16 v[48:49], v20 offset:40960
    ds_read_b64_tr_b16 v[50:51], v20 offset:41984
    v_mfma_f32_32x32x16_bf16 v[96:111], v[56:59], v[44:47], v[96:111]
    ds_read_b64_tr_b16 v[52:53], v21 offset:40960
    ds_read_b64_tr_b16 v[54:55], v21 offset:41984
    v_mfma_f32_32x32x16_bf16 v[112:127], v[60:63], v[44:47], v[112:127]
    s_waitcnt lgkmcnt(6)
    v_dot2_f32_bf16 v128, v196, s29, v128
    v_dot2_f32_bf16 v130, v196, v196, v130
    v_dot2_f32_bf16 v132, v204, s29, v132
    v_dot2_f32_bf16 v128, v197, s29, v128
    v_dot2_f32_bf16 v130, v197, v197, v130
    v_dot2_f32_bf16 v132, v205, s29, v132
    v_dot2_f32_bf16 v128, v198, s29, v128
    v_dot2_f32_bf16 v130, v198, v198, v130
    v_dot2_f32_bf16 v132, v206, s29, v132
    v_dot2_f32_bf16 v128, v199, s29, v128
    v_dot2_f32_bf16 v130, v199, v199, v130
    v_dot2_f32_bf16 v132, v207, s29, v132
    v_mfma_f32_32x32x16_bf16 v[64:79], v[204:207], v[196:199], v[64:79]
    ds_read_b128 v[40:43], v19 offset:32768
    ds_read_b128 v[44:47], v19 offset:36864
    v_mfma_f32_32x32x16_bf16 v[80:95], v[208:211], v[196:199], v[80:95]
    ds_read_b64_tr_b16 v[56:57], v20 offset:45056
    ds_read_b64_tr_b16 v[58:59], v20 offset:46080
    v_mfma_f32_32x32x16_bf16 v[96:111], v[204:207], v[200:203], v[96:111]
    ds_read_b64_tr_b16 v[60:61], v21 offset:45056
    ds_read_b64_tr_b16 v[62:63], v21 offset:46080
    v_mfma_f32_32x32x16_bf16 v[112:127], v[208:211], v[200:203], v[112:127]
    s_waitcnt lgkmcnt(6)
    v_dot2_f32_bf16 v128, v32, s29, v128
    v_dot2_f32_bf16 v130, v32, v32, v130
    v_dot2_f32_bf16 v132, v48, s29, v132
    v_dot2_f32_bf16 v128, v33, s29, v128
    v_dot2_f32_bf16 v130, v33, v33, v130
    v_dot2_f32_bf16 v132, v49, s29, v132
    v_dot2_f32_bf16 v128, v34, s29, v128
    v_dot2_f32_bf16 v130, v34, v34, v130
    v_dot2_f32_bf16 v132, v50, s29, v132
    v_dot2_f32_bf16 v128, v35, s29, v128
    v_dot2_f32_bf16 v130, v35, v35, v130
    v_dot2_f32_bf16 v132, v51, s29, v132
    v_mfma_f32_32x32x16_bf16 v[64:79], v[48:51], v[32:35], v[64:79]
    s_barrier
    ds_read_b128 v[196:199], v4 offset:0
    ds_read_b128 v[200:203], v4 offset:4096
    v_mfma_f32_32x32x16_bf16 v[80:95], v[52:55], v[32:35], v[80:95]
    ds_read_b64_tr_b16 v[204:205], v8 offset:0
    ds_read_b64_tr_b16 v[206:207], v8 offset:1024
    v_mfma_f32_32x32x16_bf16 v[96:111], v[48:51], v[36:39], v[96:111]
    ds_read_b64_tr_b16 v[208:209], v9 offset:0
    ds_read_b64_tr_b16 v[210:211], v9 offset:1024
    v_mfma_f32_32x32x16_bf16 v[112:127], v[52:55], v[36:39], v[112:127]
    s_waitcnt lgkmcnt(6)
    v_dot2_f32_bf16 v128, v40, s29, v128
    v_dot2_f32_bf16 v130, v40, v40, v130
    v_dot2_f32_bf16 v132, v56, s29, v132
    v_dot2_f32_bf16 v128, v41, s29, v128
    v_dot2_f32_bf16 v130, v41, v41, v130
    v_dot2_f32_bf16 v132, v57, s29, v132
    v_dot2_f32_bf16 v128, v42, s29, v128
    v_dot2_f32_bf16 v130, v42, v42, v130
    v_dot2_f32_bf16 v132, v58, s29, v132
    v_dot2_f32_bf16 v128, v43, s29, v128
    v_dot2_f32_bf16 v130, v43, v43, v130
    v_dot2_f32_bf16 v132, v59, s29, v132
    v_mfma_f32_32x32x16_bf16 v[64:79], v[56:59], v[40:43], v[64:79]
    ds_read_b128 v[32:35], v5 offset:0
    ds_read_b128 v[36:39], v5 offset:4096
    v_mfma_f32_32x32x16_bf16 v[80:95], v[60:63], v[40:43], v[80:95]
    ds_read_b64_tr_b16 v[48:49], v8 offset:4096
    ds_read_b64_tr_b16 v[50:51], v8 offset:5120
    v_mfma_f32_32x32x16_bf16 v[96:111], v[56:59], v[44:47], v[96:111]
    ds_read_b64_tr_b16 v[52:53], v9 offset:4096
    ds_read_b64_tr_b16 v[54:55], v9 offset:5120
    v_mfma_f32_32x32x16_bf16 v[112:127], v[60:63], v[44:47], v[112:127]
    s_waitcnt lgkmcnt(6)
    v_dot2_f32_bf16 v128, v196, s29, v128
    v_dot2_f32_bf16 v130, v196, v196, v130
    v_dot2_f32_bf16 v132, v204, s29, v132
    v_dot2_f32_bf16 v128, v197, s29, v128
    v_dot2_f32_bf16 v130, v197, v197, v130
    v_dot2_f32_bf16 v132, v205, s29, v132
    v_dot2_f32_bf16 v128, v198, s29, v128
    v_dot2_f32_bf16 v130, v198, v198, v130
    v_dot2_f32_bf16 v132, v206, s29, v132
    v_dot2_f32_bf16 v128, v199, s29, v128
    v_dot2_f32_bf16 v130, v199, v199, v130
    v_dot2_f32_bf16 v132, v207, s29, v132
    v_mfma_f32_32x32x16_bf16 v[64:79], v[204:207], v[196:199], v[64:79]
    ds_read_b128 v[40:43], v6 offset:0
    ds_read_b128 v[44:47], v6 offset:4096
    v_mfma_f32_32x32x16_bf16 v[80:95], v[208:211], v[196:199], v[80:95]
    ds_read_b64_tr_b16 v[56:57], v8 offset:8192
    ds_read_b64_tr_b16 v[58:59], v8 offset:9216
    v_mfma_f32_32x32x16_bf16 v[96:111], v[204:207], v[200:203], v[96:111]
    ds_read_b64_tr_b16 v[60:61], v9 offset:8192
    ds_read_b64_tr_b16 v[62:63], v9 offset:9216
    v_mfma_f32_32x32x16_bf16 v[112:127], v[208:211], v[200:203], v[112:127]
    s_waitcnt lgkmcnt(6)
    v_dot2_f32_bf16 v128, v32, s29, v128
    v_dot2_f32_bf16 v130, v32, v32, v130
    v_dot2_f32_bf16 v132, v48, s29, v132
    v_dot2_f32_bf16 v128, v33, s29, v128
    v_dot2_f32_bf16 v130, v33, v33, v130
    v_dot2_f32_bf16 v132, v49, s29, v132
    v_dot2_f32_bf16 v128, v34, s29, v128
    v_dot2_f32_bf16 v130, v34, v34, v130
    v_dot2_f32_bf16 v132, v50, s29, v132
    v_dot2_f32_bf16 v128, v35, s29, v128
    v_dot2_f32_bf16 v130, v35, v35, v130
    v_dot2_f32_bf16 v132, v51, s29, v132
    v_mfma_f32_32x32x16_bf16 v[64:79], v[48:51], v[32:35], v[64:79]
    ds_read_b128 v[196:199], v7 offset:0
    ds_read_b128 v[200:203], v7 offset:4096
    v_mfma_f32_32x32x16_bf16 v[80:95], v[52:55], v[32:35], v[80:95]
    ds_read_b64_tr_b16 v[204:205], v8 offset:12288
    ds_read_b64_tr_b16 v[206:207], v8 offset:13312
    v_mfma_f32_32x32x16_bf16 v[96:111], v[48:51], v[36:39], v[96:111]
    ds_read_b64_tr_b16 v[208:209], v9 offset:12288
    ds_read_b64_tr_b16 v[210:211], v9 offset:13312
    v_mfma_f32_32x32x16_bf16 v[112:127], v[52:55], v[36:39], v[112:127]
    s_waitcnt lgkmcnt(6)
    v_dot2_f32_bf16 v128, v40, s29, v128
    v_dot2_f32_bf16 v130, v40, v40, v130
    v_dot2_f32_bf16 v132, v56, s29, v132
    v_dot2_f32_bf16 v128, v41, s29, v128
    v_dot2_f32_bf16 v130, v41, v41, v130
    v_dot2_f32_bf16 v132, v57, s29, v132
    v_dot2_f32_bf16 v128, v42, s29, v128
    v_dot2_f32_bf16 v130, v42, v42, v130
    v_dot2_f32_bf16 v132, v58, s29, v132
    v_dot2_f32_bf16 v128, v43, s29, v128
    v_dot2_f32_bf16 v130, v43, v43, v130
    v_dot2_f32_bf16 v132, v59, s29, v132
    v_mfma_f32_32x32x16_bf16 v[64:79], v[56:59], v[40:43], v[64:79]
    s_barrier
    ds_read_b128 v[32:35], v4 offset:32768
    ds_read_b128 v[36:39], v4 offset:36864
    v_mfma_f32_32x32x16_bf16 v[80:95], v[60:63], v[40:43], v[80:95]
    ds_read_b64_tr_b16 v[48:49], v8 offset:32768
    ds_read_b64_tr_b16 v[50:51], v8 offset:33792
    v_mfma_f32_32x32x16_bf16 v[96:111], v[56:59], v[44:47], v[96:111]
    ds_read_b64_tr_b16 v[52:53], v9 offset:32768
    ds_read_b64_tr_b16 v[54:55], v9 offset:33792
    v_mfma_f32_32x32x16_bf16 v[112:127], v[60:63], v[44:47], v[112:127]
    s_waitcnt lgkmcnt(6)
    v_dot2_f32_bf16 v128, v196, s29, v128
    v_dot2_f32_bf16 v130, v196, v196, v130
    v_dot2_f32_bf16 v132, v204, s29, v132
    v_dot2_f32_bf16 v128, v197, s29, v128
    v_dot2_f32_bf16 v130, v197, v197, v130
    v_dot2_f32_bf16 v132, v205, s29, v132
    v_dot2_f32_bf16 v128, v198, s29, v128
    v_dot2_f32_bf16 v130, v198, v198, v130
    v_dot2_f32_bf16 v132, v206, s29, v132
    v_dot2_f32_bf16 v128, v199, s29, v128
    v_dot2_f32_bf16 v130, v199, v199, v130
    v_dot2_f32_bf16 v132, v207, s29, v132
    v_mfma_f32_32x32x16_bf16 v[64:79], v[204:207], v[196:199], v[64:79]
    ds_read_b128 v[40:43], v5 offset:32768
    ds_read_b128 v[44:47], v5 offset:36864
    v_mfma_f32_32x32x16_bf16 v[80:95], v[208:211], v[196:199], v[80:95]
    ds_read_b64_tr_b16 v[56:57], v8 offset:36864
    ds_read_b64_tr_b16 v[58:59], v8 offset:37888
    v_mfma_f32_32x32x16_bf16 v[96:111], v[204:207], v[200:203], v[96:111]
    ds_read_b64_tr_b16 v[60:61], v9 offset:36864
    ds_read_b64_tr_b16 v[62:63], v9 offset:37888
    v_mfma_f32_32x32x16_bf16 v[112:127], v[208:211], v[200:203], v[112:127]
    s_waitcnt lgkmcnt(6)
    v_dot2_f32_bf16 v128, v32, s29, v128
    v_dot2_f32_bf16 v130, v32, v32, v130
    v_dot2_f32_bf16 v132, v48, s29, v132
    v_dot2_f32_bf16 v128, v33, s29, v128
    v_dot2_f32_bf16 v130, v33, v33, v130
    v_dot2_f32_bf16 v132, v49, s29, v132
    v_dot2_f32_bf16 v128, v34, s29, v128
    v_dot2_f32_bf16 v130, v34, v34, v130
    v_dot2_f32_bf16 v132, v50, s29, v132
    v_dot2_f32_bf16 v128, v35, s29, v128
    v_dot2_f32_bf16 v130, v35, v35, v130
    v_dot2_f32_bf16 v132, v51, s29, v132
    v_mfma_f32_32x32x16_bf16 v[64:79], v[48:51], v[32:35], v[64:79]
    ds_read_b128 v[196:199], v6 offset:32768
    ds_read_b128 v[200:203], v6 offset:36864
    v_mfma_f32_32x32x16_bf16 v[80:95], v[52:55], v[32:35], v[80:95]
    ds_read_b64_tr_b16 v[204:205], v8 offset:40960
    ds_read_b64_tr_b16 v[206:207], v8 offset:41984
    v_mfma_f32_32x32x16_bf16 v[96:111], v[48:51], v[36:39], v[96:111]
    ds_read_b64_tr_b16 v[208:209], v9 offset:40960
    ds_read_b64_tr_b16 v[210:211], v9 offset:41984
    v_mfma_f32_32x32x16_bf16 v[112:127], v[52:55], v[36:39], v[112:127]
    s_waitcnt lgkmcnt(6)
    v_dot2_f32_bf16 v128, v40, s29, v128
    v_dot2_f32_bf16 v130, v40, v40, v130
    v_dot2_f32_bf16 v132, v56, s29, v132
    v_dot2_f32_bf16 v128, v41, s29, v128
    v_dot2_f32_bf16 v130, v41, v41, v130
    v_dot2_f32_bf16 v132, v57, s29, v132
    v_dot2_f32_bf16 v128, v42, s29, v128
    v_dot2_f32_bf16 v130, v42, v42, v130
    v_dot2_f32_bf16 v132, v58, s29, v132
    v_dot2_f32_bf16 v128, v43, s29, v128
    v_dot2_f32_bf16 v130, v43, v43, v130
    v_dot2_f32_bf16 v132, v59, s29, v132
    v_mfma_f32_32x32x16_bf16 v[64:79], v[56:59], v[40:43], v[64:79]
    ds_read_b128 v[32:35], v7 offset:32768
    ds_read_b128 v[36:39], v7 offset:36864
    v_mfma_f32_32x32x16_bf16 v[80:95], v[60:63], v[40:43], v[80:95]
    ds_read_b64_tr_b16 v[48:49], v8 offset:45056
    ds_read_b64_tr_b16 v[50:51], v8 offset:46080
    v_mfma_f32_32x32x16_bf16 v[96:111], v[56:59], v[44:47], v[96:111]
    ds_read_b64_tr_b16 v[52:53], v9 offset:45056
    ds_read_b64_tr_b16 v[54:55], v9 offset:46080
    v_mfma_f32_32x32x16_bf16 v[112:127], v[60:63], v[44:47], v[112:127]
    s_waitcnt lgkmcnt(6)
    v_dot2_f32_bf16 v128, v196, s29, v128
    v_dot2_f32_bf16 v130, v196, v196, v130
    v_dot2_f32_bf16 v132, v204, s29, v132
    v_dot2_f32_bf16 v128, v197, s29, v128
    v_dot2_f32_bf16 v130, v197, v197, v130
    v_dot2_f32_bf16 v132, v205, s29, v132
    v_dot2_f32_bf16 v128, v198, s29, v128
    v_dot2_f32_bf16 v130, v198, v198, v130
    v_dot2_f32_bf16 v132, v206, s29, v132
    v_dot2_f32_bf16 v128, v199, s29, v128
    v_dot2_f32_bf16 v130, v199, v199, v130
    v_dot2_f32_bf16 v132, v207, s29, v132
    v_mfma_f32_32x32x16_bf16 v[64:79], v[204:207], v[196:199], v[64:79]
    s_barrier
    ds_read_b128 v[40:43], v10 offset:0
    ds_read_b128 v[44:47], v10 offset:4096
    v_mfma_f32_32x32x16_bf16 v[80:95], v[208:211], v[196:199], v[80:95]
    ds_read_b64_tr_b16 v[56:57], v14 offset:0
    ds_read_b64_tr_b16 v[58:59], v14 offset:1024
    v_mfma_f32_32x32x16_bf16 v[96:111], v[204:207], v[200:203], v[96:111]
    ds_read_b64_tr_b16 v[60:61], v15 offset:0
    ds_read_b64_tr_b16 v[62:63], v15 offset:1024
    v_mfma_f32_32x32x16_bf16 v[112:127], v[208:211], v[200:203], v[112:127]
    s_waitcnt lgkmcnt(6)
    v_dot2_f32_bf16 v128, v32, s29, v128
    v_dot2_f32_bf16 v130, v32, v32, v130
    v_dot2_f32_bf16 v132, v48, s29, v132
    v_dot2_f32_bf16 v128, v33, s29, v128
    v_dot2_f32_bf16 v130, v33, v33, v130
    v_dot2_f32_bf16 v132, v49, s29, v132
    v_dot2_f32_bf16 v128, v34, s29, v128
    v_dot2_f32_bf16 v130, v34, v34, v130
    v_dot2_f32_bf16 v132, v50, s29, v132
    v_dot2_f32_bf16 v128, v35, s29, v128
    v_dot2_f32_bf16 v130, v35, v35, v130
    v_dot2_f32_bf16 v132, v51, s29, v132
    v_mfma_f32_32x32x16_bf16 v[64:79], v[48:51], v[32:35], v[64:79]
    ds_read_b128 v[196:199], v11 offset:0
    ds_read_b128 v[200:203], v11 offset:4096
    v_mfma_f32_32x32x16_bf16 v[80:95], v[52:55], v[32:35], v[80:95]
    ds_read_b64_tr_b16 v[204:205], v14 offset:4096
    ds_read_b64_tr_b16 v[206:207], v14 offset:5120
    v_mfma_f32_32x32x16_bf16 v[96:111], v[48:51], v[36:39], v[96:111]
    ds_read_b64_tr_b16 v[208:209], v15 offset:4096
    ds_read_b64_tr_b16 v[210:211], v15 offset:5120
    v_mfma_f32_32x32x16_bf16 v[112:127], v[52:55], v[36:39], v[112:127]
    s_waitcnt lgkmcnt(6)
    v_dot2_f32_bf16 v128, v40, s29, v128
    v_dot2_f32_bf16 v130, v40, v40, v130
    v_dot2_f32_bf16 v132, v56, s29, v132
    v_dot2_f32_bf16 v128, v41, s29, v128
    v_dot2_f32_bf16 v130, v41, v41, v130
    v_dot2_f32_bf16 v132, v57, s29, v132
    v_dot2_f32_bf16 v128, v42, s29, v128
    v_dot2_f32_bf16 v130, v42, v42, v130
    v_dot2_f32_bf16 v132, v58, s29, v132
    v_dot2_f32_bf16 v128, v43, s29, v128
    v_dot2_f32_bf16 v130, v43, v43, v130
    v_dot2_f32_bf16 v132, v59, s29, v132
    v_mfma_f32_32x32x16_bf16 v[64:79], v[56:59], v[40:43], v[64:79]
    ds_read_b128 v[32:35], v12 offset:0
    ds_read_b128 v[36:39], v12 offset:4096
    v_mfma_f32_32x32x16_bf16 v[80:95], v[60:63], v[40:43], v[80:95]
    ds_read_b64_tr_b16 v[48:49], v14 offset:8192
    ds_read_b64_tr_b16 v[50:51], v14 offset:9216
    v_mfma_f32_32x32x16_bf16 v[96:111], v[56:59], v[44:47], v[96:111]
    ds_read_b64_tr_b16 v[52:53], v15 offset:8192
    ds_read_b64_tr_b16 v[54:55], v15 offset:9216
    v_mfma_f32_32x32x16_bf16 v[112:127], v[60:63], v[44:47], v[112:127]
    s_waitcnt lgkmcnt(6)
    v_dot2_f32_bf16 v128, v196, s29, v128
    v_dot2_f32_bf16 v130, v196, v196, v130
    v_dot2_f32_bf16 v132, v204, s29, v132
    v_dot2_f32_bf16 v128, v197, s29, v128
    v_dot2_f32_bf16 v130, v197, v197, v130
    v_dot2_f32_bf16 v132, v205, s29, v132
    v_dot2_f32_bf16 v128, v198, s29, v128
    v_dot2_f32_bf16 v130, v198, v198, v130
    v_dot2_f32_bf16 v132, v206, s29, v132
    v_dot2_f32_bf16 v128, v199, s29, v128
    v_dot2_f32_bf16 v130, v199, v199, v130
    v_dot2_f32_bf16 v132, v207, s29, v132
    v_mfma_f32_32x32x16_bf16 v[64:79], v[204:207], v[196:199], v[64:79]
    ds_read_b128 v[40:43], v13 offset:0
    ds_read_b128 v[44:47], v13 offset:4096
    v_mfma_f32_32x32x16_bf16 v[80:95], v[208:211], v[196:199], v[80:95]
    ds_read_b64_tr_b16 v[56:57], v14 offset:12288
    ds_read_b64_tr_b16 v[58:59], v14 offset:13312
    v_mfma_f32_32x32x16_bf16 v[96:111], v[204:207], v[200:203], v[96:111]
    ds_read_b64_tr_b16 v[60:61], v15 offset:12288
    ds_read_b64_tr_b16 v[62:63], v15 offset:13312
    v_mfma_f32_32x32x16_bf16 v[112:127], v[208:211], v[200:203], v[112:127]
    s_waitcnt lgkmcnt(6)
    v_dot2_f32_bf16 v128, v32, s29, v128
    v_dot2_f32_bf16 v130, v32, v32, v130
    v_dot2_f32_bf16 v132, v48, s29, v132
    v_dot2_f32_bf16 v128, v33, s29, v128
    v_dot2_f32_bf16 v130, v33, v33, v130
    v_dot2_f32_bf16 v132, v49, s29, v132
    v_dot2_f32_bf16 v128, v34, s29, v128
    v_dot2_f32_bf16 v130, v34, v34, v130
    v_dot2_f32_bf16 v132, v50, s29, v132
    v_dot2_f32_bf16 v128, v35, s29, v128
    v_dot2_f32_bf16 v130, v35, v35, v130
    v_dot2_f32_bf16 v132, v51, s29, v132
    v_mfma_f32_32x32x16_bf16 v[64:79], v[48:51], v[32:35], v[64:79]
    s_barrier
    ds_read_b128 v[196:199], v16 offset:0
    ds_read_b128 v[200:203], v16 offset:4096
    v_mfma_f32_32x32x16_bf16 v[80:95], v[52:55], v[32:35], v[80:95]
    ds_read_b64_tr_b16 v[204:205], v20 offset:0
    ds_read_b64_tr_b16 v[206:207], v20 offset:1024
    v_mfma_f32_32x32x16_bf16 v[96:111], v[48:51], v[36:39], v[96:111]
    ds_read_b64_tr_b16 v[208:209], v21 offset:0
    ds_read_b64_tr_b16 v[210:211], v21 offset:1024
    v_mfma_f32_32x32x16_bf16 v[112:127], v[52:55], v[36:39], v[112:127]
    s_waitcnt lgkmcnt(6)
    v_dot2_f32_bf16 v128, v40, s29, v128
    v_dot2_f32_bf16 v130, v40, v40, v130
    v_dot2_f32_bf16 v132, v56, s29, v132
    v_dot2_f32_bf16 v128, v41, s29, v128
    v_dot2_f32_bf16 v130, v41, v41, v130
    v_dot2_f32_bf16 v132, v57, s29, v132
    v_dot2_f32_bf16 v128, v42, s29, v128
    v_dot2_f32_bf16 v130, v42, v42, v130
    v_dot2_f32_bf16 v132, v58, s29, v132
    v_dot2_f32_bf16 v128, v43, s29, v128
    v_dot2_f32_bf16 v130, v43, v43, v130
    v_dot2_f32_bf16 v132, v59, s29, v132
    v_mfma_f32_32x32x16_bf16 v[64:79], v[56:59], v[40:43], v[64:79]
    ds_read_b128 v[32:35], v17 offset:0
    ds_read_b128 v[36:39], v17 offset:4096
    v_mfma_f32_32x32x16_bf16 v[80:95], v[60:63], v[40:43], v[80:95]
    ds_read_b64_tr_b16 v[48:49], v20 offset:4096
    ds_read_b64_tr_b16 v[50:51], v20 offset:5120
    v_mfma_f32_32x32x16_bf16 v[96:111], v[56:59], v[44:47], v[96:111]
    ds_read_b64_tr_b16 v[52:53], v21 offset:4096
    ds_read_b64_tr_b16 v[54:55], v21 offset:5120
    v_mfma_f32_32x32x16_bf16 v[112:127], v[60:63], v[44:47], v[112:127]
    s_waitcnt lgkmcnt(6)
    v_dot2_f32_bf16 v128, v196, s29, v128
    v_dot2_f32_bf16 v130, v196, v196, v130
    v_dot2_f32_bf16 v132, v204, s29, v132
    v_dot2_f32_bf16 v128, v197, s29, v128
    v_dot2_f32_bf16 v130, v197, v197, v130
    v_dot2_f32_bf16 v132, v205, s29, v132
    v_dot2_f32_bf16 v128, v198, s29, v128
    v_dot2_f32_bf16 v130, v198, v198, v130
    v_dot2_f32_bf16 v132, v206, s29, v132
    v_dot2_f32_bf16 v128, v199, s29, v128
    v_dot2_f32_bf16 v130, v199, v199, v130
    v_dot2_f32_bf16 v132, v207, s29, v132
    v_mfma_f32_32x32x16_bf16 v[64:79], v[204:207], v[196:199], v[64:79]
    ds_read_b128 v[40:43], v18 offset:0
    ds_read_b128 v[44:47], v18 offset:4096
    v_mfma_f32_32x32x16_bf16 v[80:95], v[208:211], v[196:199], v[80:95]
    ds_read_b64_tr_b16 v[56:57], v20 offset:8192
    ds_read_b64_tr_b16 v[58:59], v20 offset:9216
    v_mfma_f32_32x32x16_bf16 v[96:111], v[204:207], v[200:203], v[96:111]
    ds_read_b64_tr_b16 v[60:61], v21 offset:8192
    ds_read_b64_tr_b16 v[62:63], v21 offset:9216
    v_mfma_f32_32x32x16_bf16 v[112:127], v[208:211], v[200:203], v[112:127]
    s_waitcnt lgkmcnt(6)
    v_dot2_f32_bf16 v128, v32, s29, v128
    v_dot2_f32_bf16 v130, v32, v32, v130
    v_dot2_f32_bf16 v132, v48, s29, v132
    v_dot2_f32_bf16 v128, v33, s29, v128
    v_dot2_f32_bf16 v130, v33, v33, v130
    v_dot2_f32_bf16 v132, v49, s29, v132
    v_dot2_f32_bf16 v128, v34, s29, v128
    v_dot2_f32_bf16 v130, v34, v34, v130
    v_dot2_f32_bf16 v132, v50, s29, v132
    v_dot2_f32_bf16 v128, v35, s29, v128
    v_dot2_f32_bf16 v130, v35, v35, v130
    v_dot2_f32_bf16 v132, v51, s29, v132
    v_mfma_f32_32x32x16_bf16 v[64:79], v[48:51], v[32:35], v[64:79]
    ds_read_b128 v[196:199], v19 offset:0
    ds_read_b128 v[200:203], v19 offset:4096
    v_mfma_f32_32x32x16_bf16 v[80:95], v[52:55], v[32:35], v[80:95]
    ds_read_b64_tr_b16 v[204:205], v20 offset:12288
    ds_read_b64_tr_b16 v[206:207], v20 offset:13312
    v_mfma_f32_32x32x16_bf16 v[96:111], v[48:51], v[36:39], v[96:111]
    ds_read_b64_tr_b16 v[208:209], v21 offset:12288
    ds_read_b64_tr_b16 v[210:211], v21 offset:13312
    v_mfma_f32_32x32x16_bf16 v[112:127], v[52:55], v[36:39], v[112:127]
    s_waitcnt lgkmcnt(6)
    v_dot2_f32_bf16 v128, v40, s29, v128
    v_dot2_f32_bf16 v130, v40, v40, v130
    v_dot2_f32_bf16 v132, v56, s29, v132
    v_dot2_f32_bf16 v128, v41, s29, v128
    v_dot2_f32_bf16 v130, v41, v41, v130
    v_dot2_f32_bf16 v132, v57, s29, v132
    v_dot2_f32_bf16 v128, v42, s29, v128
    v_dot2_f32_bf16 v130, v42, v42, v130
    v_dot2_f32_bf16 v132, v58, s29, v132
    v_dot2_f32_bf16 v128, v43, s29, v128
    v_dot2_f32_bf16 v130, v43, v43, v130
    v_dot2_f32_bf16 v132, v59, s29, v132
    v_mfma_f32_32x32x16_bf16 v[64:79], v[56:59], v[40:43], v[64:79]
    s_barrier
    ds_read_b128 v[32:35], v16 offset:32768
    ds_read_b128 v[36:39], v16 offset:36864
    v_mfma_f32_32x32x16_bf16 v[80:95], v[60:63], v[40:43], v[80:95]
    ds_read_b64_tr_b16 v[48:49], v20 offset:32768
    ds_read_b64_tr_b16 v[50:51], v20 offset:33792
    v_mfma_f32_32x32x16_bf16 v[96:111], v[56:59], v[44:47], v[96:111]
    ds_read_b64_tr_b16 v[52:53], v21 offset:32768
    ds_read_b64_tr_b16 v[54:55], v21 offset:33792
    v_mfma_f32_32x32x16_bf16 v[112:127], v[60:63], v[44:47], v[112:127]
    s_waitcnt lgkmcnt(6)
    v_dot2_f32_bf16 v128, v196, s29, v128
    v_dot2_f32_bf16 v130, v196, v196, v130
    v_dot2_f32_bf16 v132, v204, s29, v132
    v_dot2_f32_bf16 v128, v197, s29, v128
    v_dot2_f32_bf16 v130, v197, v197, v130
    v_dot2_f32_bf16 v132, v205, s29, v132
    v_dot2_f32_bf16 v128, v198, s29, v128
    v_dot2_f32_bf16 v130, v198, v198, v130
    v_dot2_f32_bf16 v132, v206, s29, v132
    v_dot2_f32_bf16 v128, v199, s29, v128
    v_dot2_f32_bf16 v130, v199, v199, v130
    v_dot2_f32_bf16 v132, v207, s29, v132
    v_mfma_f32_32x32x16_bf16 v[64:79], v[204:207], v[196:199], v[64:79]
    ds_read_b128 v[40:43], v17 offset:32768
    ds_read_b128 v[44:47], v17 offset:36864
    v_mfma_f32_32x32x16_bf16 v[80:95], v[208:211], v[196:199], v[80:95]
    ds_read_b64_tr_b16 v[56:57], v20 offset:36864
    ds_read_b64_tr_b16 v[58:59], v20 offset:37888
    v_mfma_f32_32x32x16_bf16 v[96:111], v[204:207], v[200:203], v[96:111]
    ds_read_b64_tr_b16 v[60:61], v21 offset:36864
    ds_read_b64_tr_b16 v[62:63], v21 offset:37888
    v_mfma_f32_32x32x16_bf16 v[112:127], v[208:211], v[200:203], v[112:127]
    s_waitcnt lgkmcnt(6)
    v_dot2_f32_bf16 v128, v32, s29, v128
    v_dot2_f32_bf16 v130, v32, v32, v130
    v_dot2_f32_bf16 v132, v48, s29, v132
    v_dot2_f32_bf16 v128, v33, s29, v128
    v_dot2_f32_bf16 v130, v33, v33, v130
    v_dot2_f32_bf16 v132, v49, s29, v132
    v_dot2_f32_bf16 v128, v34, s29, v128
    v_dot2_f32_bf16 v130, v34, v34, v130
    v_dot2_f32_bf16 v132, v50, s29, v132
    v_dot2_f32_bf16 v128, v35, s29, v128
    v_dot2_f32_bf16 v130, v35, v35, v130
    v_dot2_f32_bf16 v132, v51, s29, v132
    v_mfma_f32_32x32x16_bf16 v[64:79], v[48:51], v[32:35], v[64:79]
    ds_read_b128 v[196:199], v18 offset:32768
    ds_read_b128 v[200:203], v18 offset:36864
    v_mfma_f32_32x32x16_bf16 v[80:95], v[52:55], v[32:35], v[80:95]
    ds_read_b64_tr_b16 v[204:205], v20 offset:40960
    ds_read_b64_tr_b16 v[206:207], v20 offset:41984
    v_mfma_f32_32x32x16_bf16 v[96:111], v[48:51], v[36:39], v[96:111]
    ds_read_b64_tr_b16 v[208:209], v21 offset:40960
    ds_read_b64_tr_b16 v[210:211], v21 offset:41984
    v_mfma_f32_32x32x16_bf16 v[112:127], v[52:55], v[36:39], v[112:127]
    s_waitcnt lgkmcnt(6)
    v_dot2_f32_bf16 v128, v40, s29, v128
    v_dot2_f32_bf16 v130, v40, v40, v130
    v_dot2_f32_bf16 v132, v56, s29, v132
    v_dot2_f32_bf16 v128, v41, s29, v128
    v_dot2_f32_bf16 v130, v41, v41, v130
    v_dot2_f32_bf16 v132, v57, s29, v132
    v_dot2_f32_bf16 v128, v42, s29, v128
    v_dot2_f32_bf16 v130, v42, v42, v130
    v_dot2_f32_bf16 v132, v58, s29, v132
    v_dot2_f32_bf16 v128, v43, s29, v128
    v_dot2_f32_bf16 v130, v43, v43, v130
    v_dot2_f32_bf16 v132, v59, s29, v132
    v_mfma_f32_32x32x16_bf16 v[64:79], v[56:59], v[40:43], v[64:79]
    ds_read_b128 v[32:35], v19 offset:32768
    ds_read_b128 v[36:39], v19 offset:36864
    v_mfma_f32_32x32x16_bf16 v[80:95], v[60:63], v[40:43], v[80:95]
    ds_read_b64_tr_b16 v[48:49], v20 offset:45056
    ds_read_b64_tr_b16 v[50:51], v20 offset:46080
    v_mfma_f32_32x32x16_bf16 v[96:111], v[56:59], v[44:47], v[96:111]
    ds_read_b64_tr_b16 v[52:53], v21 offset:45056
    ds_read_b64_tr_b16 v[54:55], v21 offset:46080
    v_mfma_f32_32x32x16_bf16 v[112:127], v[60:63], v[44:47], v[112:127]
    s_waitcnt lgkmcnt(6)
    v_dot2_f32_bf16 v128, v196, s29, v128
    v_dot2_f32_bf16 v130, v196, v196, v130
    v_dot2_f32_bf16 v132, v204, s29, v132
    v_dot2_f32_bf16 v128, v197, s29, v128
    v_dot2_f32_bf16 v130, v197, v197, v130
    v_dot2_f32_bf16 v132, v205, s29, v132
    v_dot2_f32_bf16 v128, v198, s29, v128
    v_dot2_f32_bf16 v130, v198, v198, v130
    v_dot2_f32_bf16 v132, v206, s29, v132
    v_dot2_f32_bf16 v128, v199, s29, v128
    v_dot2_f32_bf16 v130, v199, v199, v130
    v_dot2_f32_bf16 v132, v207, s29, v132
    v_mfma_f32_32x32x16_bf16 v[64:79], v[204:207], v[196:199], v[64:79]
    s_barrier
    ds_read_b128 v[40:43], v4 offset:0
    ds_read_b128 v[44:47], v4 offset:4096
    v_mfma_f32_32x32x16_bf16 v[80:95], v[208:211], v[196:199], v[80:95]
    ds_read_b64_tr_b16 v[56:57], v8 offset:0
    ds_read_b64_tr_b16 v[58:59], v8 offset:1024
    v_mfma_f32_32x32x16_bf16 v[96:111], v[204:207], v[200:203], v[96:111]
    ds_read_b64_tr_b16 v[60:61], v9 offset:0
    ds_read_b64_tr_b16 v[62:63], v9 offset:1024
    v_mfma_f32_32x32x16_bf16 v[112:127], v[208:211], v[200:203], v[112:127]
    s_waitcnt lgkmcnt(6)
    v_dot2_f32_bf16 v128, v32, s29, v128
    v_dot2_f32_bf16 v130, v32, v32, v130
    v_dot2_f32_bf16 v132, v48, s29, v132
    v_dot2_f32_bf16 v128, v33, s29, v128
    v_dot2_f32_bf16 v130, v33, v33, v130
    v_dot2_f32_bf16 v132, v49, s29, v132
    v_dot2_f32_bf16 v128, v34, s29, v128
    v_dot2_f32_bf16 v130, v34, v34, v130
    v_dot2_f32_bf16 v132, v50, s29, v132
    v_dot2_f32_bf16 v128, v35, s29, v128
    v_dot2_f32_bf16 v130, v35, v35, v130
    v_dot2_f32_bf16 v132, v51, s29, v132
    v_mfma_f32_32x32x16_bf16 v[64:79], v[48:51], v[32:35], v[64:79]
    ds_read_b128 v[196:199], v5 offset:0
    ds_read_b128 v[200:203], v5 offset:4096
    v_mfma_f32_32x32x16_bf16 v[80:95], v[52:55], v[32:35], v[80:95]
    ds_read_b64_tr_b16 v[204:205], v8 offset:4096
    ds_read_b64_tr_b16 v[206:207], v8 offset:5120
    v_mfma_f32_32x32x16_bf16 v[96:111], v[48:51], v[36:39], v[96:111]
    ds_read_b64_tr_b16 v[208:209], v9 offset:4096
    ds_read_b64_tr_b16 v[210:211], v9 offset:5120
    v_mfma_f32_32x32x16_bf16 v[112:127], v[52:55], v[36:39], v[112:127]
    s_waitcnt lgkmcnt(6)
    v_dot2_f32_bf16 v128, v40, s29, v128
    v_dot2_f32_bf16 v130, v40, v40, v130
    v_dot2_f32_bf16 v132, v56, s29, v132
    v_dot2_f32_bf16 v128, v41, s29, v128
    v_dot2_f32_bf16 v130, v41, v41, v130
    v_dot2_f32_bf16 v132, v57, s29, v132
    v_dot2_f32_bf16 v128, v42, s29, v128
    v_dot2_f32_bf16 v130, v42, v42, v130
    v_dot2_f32_bf16 v132, v58, s29, v132
    v_dot2_f32_bf16 v128, v43, s29, v128
    v_dot2_f32_bf16 v130, v43, v43, v130
    v_dot2_f32_bf16 v132, v59, s29, v132
    v_mfma_f32_32x32x16_bf16 v[64:79], v[56:59], v[40:43], v[64:79]
    ds_read_b128 v[32:35], v6 offset:0
    ds_read_b128 v[36:39], v6 offset:4096
    v_mfma_f32_32x32x16_bf16 v[80:95], v[60:63], v[40:43], v[80:95]
    ds_read_b64_tr_b16 v[48:49], v8 offset:8192
    ds_read_b64_tr_b16 v[50:51], v8 offset:9216
    v_mfma_f32_32x32x16_bf16 v[96:111], v[56:59], v[44:47], v[96:111]
    ds_read_b64_tr_b16 v[52:53], v9 offset:8192
    ds_read_b64_tr_b16 v[54:55], v9 offset:9216
    v_mfma_f32_32x32x16_bf16 v[112:127], v[60:63], v[44:47], v[112:127]
    s_waitcnt lgkmcnt(6)
    v_dot2_f32_bf16 v128, v196, s29, v128
    v_dot2_f32_bf16 v130, v196, v196, v130
    v_dot2_f32_bf16 v132, v204, s29, v132
    v_dot2_f32_bf16 v128, v197, s29, v128
    v_dot2_f32_bf16 v130, v197, v197, v130
    v_dot2_f32_bf16 v132, v205, s29, v132
    v_dot2_f32_bf16 v128, v198, s29, v128
    v_dot2_f32_bf16 v130, v198, v198, v130
    v_dot2_f32_bf16 v132, v206, s29, v132
    v_dot2_f32_bf16 v128, v199, s29, v128
    v_dot2_f32_bf16 v130, v199, v199, v130
    v_dot2_f32_bf16 v132, v207, s29, v132
    v_mfma_f32_32x32x16_bf16 v[64:79], v[204:207], v[196:199], v[64:79]
    ds_read_b128 v[40:43], v7 offset:0
    ds_read_b128 v[44:47], v7 offset:4096
    v_mfma_f32_32x32x16_bf16 v[80:95], v[208:211], v[196:199], v[80:95]
    ds_read_b64_tr_b16 v[56:57], v8 offset:12288
    ds_read_b64_tr_b16 v[58:59], v8 offset:13312
    v_mfma_f32_32x32x16_bf16 v[96:111], v[204:207], v[200:203], v[96:111]
    ds_read_b64_tr_b16 v[60:61], v9 offset:12288
    ds_read_b64_tr_b16 v[62:63], v9 offset:13312
    v_mfma_f32_32x32x16_bf16 v[112:127], v[208:211], v[200:203], v[112:127]
    s_waitcnt lgkmcnt(6)
    v_dot2_f32_bf16 v128, v32, s29, v128
    v_dot2_f32_bf16 v130, v32, v32, v130
    v_dot2_f32_bf16 v132, v48, s29, v132
    v_dot2_f32_bf16 v128, v33, s29, v128
    v_dot2_f32_bf16 v130, v33, v33, v130
    v_dot2_f32_bf16 v132, v49, s29, v132
    v_dot2_f32_bf16 v128, v34, s29, v128
    v_dot2_f32_bf16 v130, v34, v34, v130
    v_dot2_f32_bf16 v132, v50, s29, v132
    v_dot2_f32_bf16 v128, v35, s29, v128
    v_dot2_f32_bf16 v130, v35, v35, v130
    v_dot2_f32_bf16 v132, v51, s29, v132
    v_mfma_f32_32x32x16_bf16 v[64:79], v[48:51], v[32:35], v[64:79]
    v_mfma_f32_32x32x16_bf16 v[80:95], v[52:55], v[32:35], v[80:95]
    v_mfma_f32_32x32x16_bf16 v[96:111], v[48:51], v[36:39], v[96:111]
    v_mfma_f32_32x32x16_bf16 v[112:127], v[52:55], v[36:39], v[112:127]
    s_waitcnt lgkmcnt(0)
    v_dot2_f32_bf16 v128, v40, s29, v128
    v_dot2_f32_bf16 v130, v40, v40, v130
    v_dot2_f32_bf16 v132, v56, s29, v132
    v_dot2_f32_bf16 v128, v41, s29, v128
    v_dot2_f32_bf16 v130, v41, v41, v130
    v_dot2_f32_bf16 v132, v57, s29, v132
    v_dot2_f32_bf16 v128, v42, s29, v128
    v_dot2_f32_bf16 v130, v42, v42, v130
    v_dot2_f32_bf16 v132, v58, s29, v132
    v_dot2_f32_bf16 v128, v43, s29, v128
    v_dot2_f32_bf16 v130, v43, v43, v130
    v_dot2_f32_bf16 v132, v59, s29, v132
    v_mfma_f32_32x32x16_bf16 v[64:79], v[56:59], v[40:43], v[64:79]
    v_mfma_f32_32x32x16_bf16 v[80:95], v[60:63], v[40:43], v[80:95]
    v_mfma_f32_32x32x16_bf16 v[96:111], v[56:59], v[44:47], v[96:111]
    v_mfma_f32_32x32x16_bf16 v[112:127], v[60:63], v[44:47], v[112:127]
    s_branch qkv_a_kernel_qe
qkv_a_kernel_q1:
    s_cmp_lg_u32 s26, 1
    s_cbranch_scc1 qkv_a_kernel_q2
    v_mov_b32 v64, 0
    v_mov_b32 v65, 0
    v_mov_b32 v66, 0
    v_mov_b32 v67, 0
    v_mov_b32 v68, 0
    v_mov_b32 v69, 0
    v_mov_b32 v70, 0
    v_mov_b32 v71, 0
    v_mov_b32 v72, 0
    v_mov_b32 v73, 0
    v_mov_b32 v74, 0
    v_mov_b32 v75, 0
    v_mov_b32 v76, 0
    v_mov_b32 v77, 0
    v_mov_b32 v78, 0
    v_mov_b32 v79, 0
    v_mov_b32 v80, 0
    v_mov_b32 v81, 0
    v_mov_b32 v82, 0
    v_mov_b32 v83, 0
    v_mov_b32 v84, 0
    v_mov_b32 v85, 0
    v_mov_b32 v86, 0
    v_mov_b32 v87, 0
    v_mov_b32 v88, 0
    v_mov_b32 v89, 0
    v_mov_b32 v90, 0
    v_mov_b32 v91, 0
    v_mov_b32 v92, 0
    v_mov_b32 v93, 0
    v_mov_b32 v94, 0
    v_mov_b32 v95, 0
    v_mov_b32 v96, 0
    v_mov_b32 v97, 0
    v_mov_b32 v98, 0
    v_mov_b32 v99, 0
    v_mov_b32 v100, 0
    v_mov_b32 v101, 0
    v_mov_b32 v102, 0
    v_mov_b32 v103, 0
    v_mov_b32 v104, 0
    v_mov_b32 v105, 0
    v_mov_b32 v106, 0
    v_mov_b32 v107, 0
    v_mov_b32 v108, 0
    v_mov_b32 v109, 0
    v_mov_b32 v110, 0
    v_mov_b32 v111, 0
    v_mov_b32 v112, 0
    v_mov_b32 v113, 0
    v_mov_b32 v114, 0
    v_mov_b32 v115, 0
    v_mov_b32 v116, 0
    v_mov_b32 v117, 0
    v_mov_b32 v118, 0
    v_mov_b32 v119, 0
    v_mov_b32 v120, 0
    v_mov_b32 v121, 0
    v_mov_b32 v122, 0
    v_mov_b32 v123, 0
    v_mov_b32 v124, 0
    v_mov_b32 v125, 0
    v_mov_b32 v126, 0
    v_mov_b32 v127, 0
    v_mov_b32 v128, 0
    v_mov_b32 v129, 0
    v_mov_b32 v130, 0
    v_mov_b32 v131, 0
    v_mov_b32 v132, 0
    v_mov_b32 v133, 0
    s_barrier
    ds_read_b128 v[32:35], v16 offset:0
    ds_read_b128 v[36:39], v16 offset:4096
    ds_read_b64_tr_b16 v[48:49], v20 offset:0
    ds_read_b64_tr_b16 v[50:51], v20 offset:1024
    ds_read_b64_tr_b16 v[52:53], v21 offset:0
    ds_read_b64_tr_b16 v[54:55], v21 offset:1024
    ds_read_b128 v[40:43], v17 offset:0
    ds_read_b128 v[44:47], v17 offset:4096
    ds_read_b64_tr_b16 v[56:57], v20 offset:4096
    ds_read_b64_tr_b16 v[58:59], v20 offset:5120
    ds_read_b64_tr_b16 v[60:61], v21 offset:4096
    ds_read_b64_tr_b16 v[62:63], v21 offset:5120
    s_waitcnt lgkmcnt(6)
    v_dot2_f32_bf16 v128, v36, s29, v128
    v_dot2_f32_bf16 v130, v36, v36, v130
    v_dot2_f32_bf16 v132, v48, s29, v132
    v_dot2_f32_bf16 v128, v37, s29, v128
    v_dot2_f32_bf16 v130, v37, v37, v130
    v_dot2_f32_bf16 v132, v49, s29, v132
    v_dot2_f32_bf16 v128, v38, s29, v128
    v_dot2_f32_bf16 v130, v38, v38, v130
    v_dot2_f32_bf16 v132, v50, s29, v132
    v_dot2_f32_bf16 v128, v39, s29, v128
    v_dot2_f32_bf16 v130, v39, v39, v130
    v_dot2_f32_bf16 v132, v51, s29, v132
    v_mfma_f32_32x32x16_bf16 v[64:79], v[48:51], v[32:35], v[64:79]
    ds_read_b128 v[196:199], v18 offset:0
    ds_read_b128 v[200:203], v18 offset:4096
    v_mfma_f32_32x32x16_bf16 v[80:95], v[52:55], v[32:35], v[80:95]
    ds_read_b64_tr_b16 v[204:205], v20 offset:8192
    ds_read_b64_tr_b16 v[206:207], v20 offset:9216
    v_mfma_f32_32x32x16_bf16 v[96:111], v[48:51], v[36:39], v[96:111]
    ds_read_b64_tr_b16 v[208:209], v21 offset:8192
    ds_read_b64_tr_b16 v[210:211], v21 offset:9216
    v_mfma_f32_32x32x16_bf16 v[112:127], v[52:55], v[36:39], v[112:127]
    s_waitcnt lgkmcnt(6)
    v_dot2_f32_bf16 v128, v44, s29, v128
    v_dot2_f32_bf16 v130, v44, v44, v130
    v_dot2_f32_bf16 v132, v56, s29, v132
    v_dot2_f32_bf16 v128, v45, s29, v128
    v_dot2_f32_bf16 v130, v45, v45, v130
    v_dot2_f32_bf16 v132, v57, s29, v132
    v_dot2_f32_bf16 v128, v46, s29, v128
    v_dot2_f32_bf16 v130, v46, v46, v130
    v_dot2_f32_bf16 v132, v58, s29, v132
    v_dot2_f32_bf16 v128, v47, s29, v128
    v_dot2_f32_bf16 v130, v47, v47, v130
    v_dot2_f32_bf16 v132, v59, s29, v132
    v_mfma_f32_32x32x16_bf16 v[64:79], v[56:59], v[40:43], v[64:79]
    ds_read_b128 v[32:35], v19 offset:0
    ds_read_b128 v[36:39], v19 offset:4096
    v_mfma_f32_32x32x16_bf16 v[80:95], v[60:63], v[40:43], v[80:95]
    ds_read_b64_tr_b16 v[48:49], v20 offset:12288
    ds_read_b64_tr_b16 v[50:51], v20 offset:13312
    v_mfma_f32_32x32x16_bf16 v[96:111], v[56:59], v[44:47], v[96:111]
    ds_read_b64_tr_b16 v[52:53], v21 offset:12288
    ds_read_b64_tr_b16 v[54:55], v21 offset:13312
    v_mfma_f32_32x32x16_bf16 v[112:127], v[60:63], v[44:47], v[112:127]
    s_waitcnt lgkmcnt(6)
    v_dot2_f32_bf16 v128, v200, s29, v128
    v_dot2_f32_bf16 v130, v200, v200, v130
    v_dot2_f32_bf16 v132, v204, s29, v132
    v_dot2_f32_bf16 v128, v201, s29, v128
    v_dot2_f32_bf16 v130, v201, v201, v130
    v_dot2_f32_bf16 v132, v205, s29, v132
    v_dot2_f32_bf16 v128, v202, s29, v128
    v_dot2_f32_bf16 v130, v202, v202, v130
    v_dot2_f32_bf16 v132, v206, s29, v132
    v_dot2_f32_bf16 v128, v203, s29, v128
    v_dot2_f32_bf16 v130, v203, v203, v130
    v_dot2_f32_bf16 v132, v207, s29, v132
    v_mfma_f32_32x32x16_bf16 v[64:79], v[204:207], v[196:199], v[64:79]
    s_barrier
    ds_read_b128 v[40:43], v16 offset:32768
    ds_read_b128 v[44:47], v16 offset:36864
    v_mfma_f32_32x32x16_bf16 v[80:95], v[208:211], v[196:199], v[80:95]
    ds_read_b64_tr_b16 v[56:57], v20 offset:32768
    ds_read_b64_tr_b16 v[58:59], v20 offset:33792
    v_mfma_f32_32x32x16_bf16 v[96:111], v[204:207], v[200:203], v[96:111]
    ds_read_b64_tr_b16 v[60:61], v21 offset:32768
    ds_read_b64_tr_b16 v[62:63], v21 offset:33792
    v_mfma_f32_32x32x16_bf16 v[112:127], v[208:211], v[200:203], v[112:127]
    s_waitcnt lgkmcnt(6)
    v_dot2_f32_bf16 v128, v36, s29, v128
    v_dot2_f32_bf16 v130, v36, v36, v130
    v_dot2_f32_bf16 v132, v48, s29, v132
    v_dot2_f32_bf16 v128, v37, s29, v128
    v_dot2_f32_bf16 v130, v37, v37, v130
    v_dot2_f32_bf16 v132, v49, s29, v132
    v_dot2_f32_bf16 v128, v38, s29, v128
    v_dot2_f32_bf16 v130, v38, v38, v130
    v_dot2_f32_bf16 v132, v50, s29, v132
    v_dot2_f32_bf16 v128, v39, s29, v128
    v_dot2_f32_bf16 v130, v39, v39, v130
    v_dot2_f32_bf16 v132, v51, s29, v132
    v_mfma_f32_32x32x16_bf16 v[64:79], v[48:51], v[32:35], v[64:79]
    ds_read_b128 v[196:199], v17 offset:32768
    ds_read_b128 v[200:203], v17 offset:36864
    v_mfma_f32_32x32x16_bf16 v[80:95], v[52:55], v[32:35], v[80:95]
    ds_read_b64_tr_b16 v[204:205], v20 offset:36864
    ds_read_b64_tr_b16 v[206:207], v20 offset:37888
    v_mfma_f32_32x32x16_bf16 v[96:111], v[48:51], v[36:39], v[96:111]
    ds_read_b64_tr_b16 v[208:209], v21 offset:36864
    ds_read_b64_tr_b16 v[210:211], v21 offset:37888
    v_mfma_f32_32x32x16_bf16 v[112:127], v[52:55], v[36:39], v[112:127]
    s_waitcnt lgkmcnt(6)
    v_dot2_f32_bf16 v128, v44, s29, v128
    v_dot2_f32_bf16 v130, v44, v44, v130
    v_dot2_f32_bf16 v132, v56, s29, v132
    v_dot2_f32_bf16 v128, v45, s29, v128
    v_dot2_f32_bf16 v130, v45, v45, v130
    v_dot2_f32_bf16 v132, v57, s29, v132
    v_dot2_f32_bf16 v128, v46, s29, v128
    v_dot2_f32_bf16 v130, v46, v46, v130
    v_dot2_f32_bf16 v132, v58, s29, v132
    v_dot2_f32_bf16 v128, v47, s29, v128
    v_dot2_f32_bf16 v130, v47, v47, v130
    v_dot2_f32_bf16 v132, v59, s29, v132
    v_mfma_f32_32x32x16_bf16 v[64:79], v[56:59], v[40:43], v[64:79]
    ds_read_b128 v[32:35], v18 offset:32768
    ds_read_b128 v[36:39], v18 offset:36864
    v_mfma_f32_32x32x16_bf16 v[80:95], v[60:63], v[40:43], v[80:95]
    ds_read_b64_tr_b16 v[48:49], v20 offset:40960
    ds_read_b64_tr_b16 v[50:51], v20 offset:41984
    v_mfma_f32_32x32x16_bf16 v[96:111], v[56:59], v[44:47], v[96:111]
    ds_read_b64_tr_b16 v[52:53], v21 offset:40960
    ds_read_b64_tr_b16 v[54:55], v21 offset:41984
    v_mfma_f32_32x32x16_bf16 v[112:127], v[60:63], v[44:47], v[112:127]
    s_waitcnt lgkmcnt(6)
    v_dot2_f32_bf16 v128, v200, s29, v128
    v_dot2_f32_bf16 v130, v200, v200, v130
    v_dot2_f32_bf16 v132, v204, s29, v132
    v_dot2_f32_bf16 v128, v201, s29, v128
    v_dot2_f32_bf16 v130, v201, v201, v130
    v_dot2_f32_bf16 v132, v205, s29, v132
    v_dot2_f32_bf16 v128, v202, s29, v128
    v_dot2_f32_bf16 v130, v202, v202, v130
    v_dot2_f32_bf16 v132, v206, s29, v132
    v_dot2_f32_bf16 v128, v203, s29, v128
    v_dot2_f32_bf16 v130, v203, v203, v130
    v_dot2_f32_bf16 v132, v207, s29, v132
    v_mfma_f32_32x32x16_bf16 v[64:79], v[204:207], v[196:199], v[64:79]
    ds_read_b128 v[40:43], v19 offset:32768
    ds_read_b128 v[44:47], v19 offset:36864
    v_mfma_f32_32x32x16_bf16 v[80:95], v[208:211], v[196:199], v[80:95]
    ds_read_b64_tr_b16 v[56:57], v20 offset:45056
    ds_read_b64_tr_b16 v[58:59], v20 offset:46080
    v_mfma_f32_32x32x16_bf16 v[96:111], v[204:207], v[200:203], v[96:111]
    ds_read_b64_tr_b16 v[60:61], v21 offset:45056
    ds_read_b64_tr_b16 v[62:63], v21 offset:46080
    v_mfma_f32_32x32x16_bf16 v[112:127], v[208:211], v[200:203], v[112:127]
    s_waitcnt lgkmcnt(6)
    v_dot2_f32_bf16 v128, v36, s29, v128
    v_dot2_f32_bf16 v130, v36, v36, v130
    v_dot2_f32_bf16 v132, v48, s29, v132
    v_dot2_f32_bf16 v128, v37, s29, v128
    v_dot2_f32_bf16 v130, v37, v37, v130
    v_dot2_f32_bf16 v132, v49, s29, v132
    v_dot2_f32_bf16 v128, v38, s29, v128
    v_dot2_f32_bf16 v130, v38, v38, v130
    v_dot2_f32_bf16 v132, v50, s29, v132
    v_dot2_f32_bf16 v128, v39, s29, v128
    v_dot2_f32_bf16 v130, v39, v39, v130
    v_dot2_f32_bf16 v132, v51, s29, v132
    v_mfma_f32_32x32x16_bf16 v[64:79], v[48:51], v[32:35], v[64:79]
    s_barrier
    ds_read_b128 v[196:199], v4 offset:0
    ds_read_b128 v[200:203], v4 offset:4096
    v_mfma_f32_32x32x16_bf16 v[80:95], v[52:55], v[32:35], v[80:95]
    ds_read_b64_tr_b16 v[204:205], v8 offset:0
    ds_read_b64_tr_b16 v[206:207], v8 offset:1024
    v_mfma_f32_32x32x16_bf16 v[96:111], v[48:51], v[36:39], v[96:111]
    ds_read_b64_tr_b16 v[208:209], v9 offset:0
    ds_read_b64_tr_b16 v[210:211], v9 offset:1024
    v_mfma_f32_32x32x16_bf16 v[112:127], v[52:55], v[36:39], v[112:127]
    s_waitcnt lgkmcnt(6)
    v_dot2_f32_bf16 v128, v44, s29, v128
    v_dot2_f32_bf16 v130, v44, v44, v130
    v_dot2_f32_bf16 v132, v56, s29, v132
    v_dot2_f32_bf16 v128, v45, s29, v128
    v_dot2_f32_bf16 v130, v45, v45, v130
    v_dot2_f32_bf16 v132, v57, s29, v132
    v_dot2_f32_bf16 v128, v46, s29, v128
    v_dot2_f32_bf16 v130, v46, v46, v130
    v_dot2_f32_bf16 v132, v58, s29, v132
    v_dot2_f32_bf16 v128, v47, s29, v128
    v_dot2_f32_bf16 v130, v47, v47, v130
    v_dot2_f32_bf16 v132, v59, s29, v132
    v_mfma_f32_32x32x16_bf16 v[64:79], v[56:59], v[40:43], v[64:79]
    ds_read_b128 v[32:35], v5 offset:0
    ds_read_b128 v[36:39], v5 offset:4096
    v_mfma_f32_32x32x16_bf16 v[80:95], v[60:63], v[40:43], v[80:95]
    ds_read_b64_tr_b16 v[48:49], v8 offset:4096
    ds_read_b64_tr_b16 v[50:51], v8 offset:5120
    v_mfma_f32_32x32x16_bf16 v[96:111], v[56:59], v[44:47], v[96:111]
    ds_read_b64_tr_b16 v[52:53], v9 offset:4096
    ds_read_b64_tr_b16 v[54:55], v9 offset:5120
    v_mfma_f32_32x32x16_bf16 v[112:127], v[60:63], v[44:47], v[112:127]
    s_waitcnt lgkmcnt(6)
    v_dot2_f32_bf16 v128, v200, s29, v128
    v_dot2_f32_bf16 v130, v200, v200, v130
    v_dot2_f32_bf16 v132, v204, s29, v132
    v_dot2_f32_bf16 v128, v201, s29, v128
    v_dot2_f32_bf16 v130, v201, v201, v130
    v_dot2_f32_bf16 v132, v205, s29, v132
    v_dot2_f32_bf16 v128, v202, s29, v128
    v_dot2_f32_bf16 v130, v202, v202, v130
    v_dot2_f32_bf16 v132, v206, s29, v132
    v_dot2_f32_bf16 v128, v203, s29, v128
    v_dot2_f32_bf16 v130, v203, v203, v130
    v_dot2_f32_bf16 v132, v207, s29, v132
    v_mfma_f32_32x32x16_bf16 v[64:79], v[204:207], v[196:199], v[64:79]
    ds_read_b128 v[40:43], v6 offset:0
    ds_read_b128 v[44:47], v6 offset:4096
    v_mfma_f32_32x32x16_bf16 v[80:95], v[208:211], v[196:199], v[80:95]
    ds_read_b64_tr_b16 v[56:57], v8 offset:8192
    ds_read_b64_tr_b16 v[58:59], v8 offset:9216
    v_mfma_f32_32x32x16_bf16 v[96:111], v[204:207], v[200:203], v[96:111]
    ds_read_b64_tr_b16 v[60:61], v9 offset:8192
    ds_read_b64_tr_b16 v[62:63], v9 offset:9216
    v_mfma_f32_32x32x16_bf16 v[112:127], v[208:211], v[200:203], v[112:127]
    s_waitcnt lgkmcnt(6)
    v_dot2_f32_bf16 v128, v36, s29, v128
    v_dot2_f32_bf16 v130, v36, v36, v130
    v_dot2_f32_bf16 v132, v48, s29, v132
    v_dot2_f32_bf16 v128, v37, s29, v128
    v_dot2_f32_bf16 v130, v37, v37, v130
    v_dot2_f32_bf16 v132, v49, s29, v132
    v_dot2_f32_bf16 v128, v38, s29, v128
    v_dot2_f32_bf16 v130, v38, v38, v130
    v_dot2_f32_bf16 v132, v50, s29, v132
    v_dot2_f32_bf16 v128, v39, s29, v128
    v_dot2_f32_bf16 v130, v39, v39, v130
    v_dot2_f32_bf16 v132, v51, s29, v132
    v_mfma_f32_32x32x16_bf16 v[64:79], v[48:51], v[32:35], v[64:79]
    ds_read_b128 v[196:199], v7 offset:0
    ds_read_b128 v[200:203], v7 offset:4096
    v_mfma_f32_32x32x16_bf16 v[80:95], v[52:55], v[32:35], v[80:95]
    ds_read_b64_tr_b16 v[204:205], v8 offset:12288
    ds_read_b64_tr_b16 v[206:207], v8 offset:13312
    v_mfma_f32_32x32x16_bf16 v[96:111], v[48:51], v[36:39], v[96:111]
    ds_read_b64_tr_b16 v[208:209], v9 offset:12288
    ds_read_b64_tr_b16 v[210:211], v9 offset:13312
    v_mfma_f32_32x32x16_bf16 v[112:127], v[52:55], v[36:39], v[112:127]
    s_waitcnt lgkmcnt(6)
    v_dot2_f32_bf16 v128, v44, s29, v128
    v_dot2_f32_bf16 v130, v44, v44, v130
    v_dot2_f32_bf16 v132, v56, s29, v132
    v_dot2_f32_bf16 v128, v45, s29, v128
    v_dot2_f32_bf16 v130, v45, v45, v130
    v_dot2_f32_bf16 v132, v57, s29, v132
    v_dot2_f32_bf16 v128, v46, s29, v128
    v_dot2_f32_bf16 v130, v46, v46, v130
    v_dot2_f32_bf16 v132, v58, s29, v132
    v_dot2_f32_bf16 v128, v47, s29, v128
    v_dot2_f32_bf16 v130, v47, v47, v130
    v_dot2_f32_bf16 v132, v59, s29, v132
    v_mfma_f32_32x32x16_bf16 v[64:79], v[56:59], v[40:43], v[64:79]
    s_barrier
    ds_read_b128 v[32:35], v4 offset:32768
    ds_read_b128 v[36:39], v4 offset:36864
    v_mfma_f32_32x32x16_bf16 v[80:95], v[60:63], v[40:43], v[80:95]
    ds_read_b64_tr_b16 v[48:49], v8 offset:32768
    ds_read_b64_tr_b16 v[50:51], v8 offset:33792
    v_mfma_f32_32x32x16_bf16 v[96:111], v[56:59], v[44:47], v[96:111]
    ds_read_b64_tr_b16 v[52:53], v9 offset:32768
    ds_read_b64_tr_b16 v[54:55], v9 offset:33792
    v_mfma_f32_32x32x16_bf16 v[112:127], v[60:63], v[44:47], v[112:127]
    s_waitcnt lgkmcnt(6)
    v_dot2_f32_bf16 v128, v200, s29, v128
    v_dot2_f32_bf16 v130, v200, v200, v130
    v_dot2_f32_bf16 v132, v204, s29, v132
    v_dot2_f32_bf16 v128, v201, s29, v128
    v_dot2_f32_bf16 v130, v201, v201, v130
    v_dot2_f32_bf16 v132, v205, s29, v132
    v_dot2_f32_bf16 v128, v202, s29, v128
    v_dot2_f32_bf16 v130, v202, v202, v130
    v_dot2_f32_bf16 v132, v206, s29, v132
    v_dot2_f32_bf16 v128, v203, s29, v128
    v_dot2_f32_bf16 v130, v203, v203, v130
    v_dot2_f32_bf16 v132, v207, s29, v132
    v_mfma_f32_32x32x16_bf16 v[64:79], v[204:207], v[196:199], v[64:79]
    ds_read_b128 v[40:43], v5 offset:32768
    ds_read_b128 v[44:47], v5 offset:36864
    v_mfma_f32_32x32x16_bf16 v[80:95], v[208:211], v[196:199], v[80:95]
    ds_read_b64_tr_b16 v[56:57], v8 offset:36864
    ds_read_b64_tr_b16 v[58:59], v8 offset:37888
    v_mfma_f32_32x32x16_bf16 v[96:111], v[204:207], v[200:203], v[96:111]
    ds_read_b64_tr_b16 v[60:61], v9 offset:36864
    ds_read_b64_tr_b16 v[62:63], v9 offset:37888
    v_mfma_f32_32x32x16_bf16 v[112:127], v[208:211], v[200:203], v[112:127]
    s_waitcnt lgkmcnt(6)
    v_dot2_f32_bf16 v128, v36, s29, v128
    v_dot2_f32_bf16 v130, v36, v36, v130
    v_dot2_f32_bf16 v132, v48, s29, v132
    v_dot2_f32_bf16 v128, v37, s29, v128
    v_dot2_f32_bf16 v130, v37, v37, v130
    v_dot2_f32_bf16 v132, v49, s29, v132
    v_dot2_f32_bf16 v128, v38, s29, v128
    v_dot2_f32_bf16 v130, v38, v38, v130
    v_dot2_f32_bf16 v132, v50, s29, v132
    v_dot2_f32_bf16 v128, v39, s29, v128
    v_dot2_f32_bf16 v130, v39, v39, v130
    v_dot2_f32_bf16 v132, v51, s29, v132
    v_mfma_f32_32x32x16_bf16 v[64:79], v[48:51], v[32:35], v[64:79]
    ds_read_b128 v[196:199], v6 offset:32768
    ds_read_b128 v[200:203], v6 offset:36864
    v_mfma_f32_32x32x16_bf16 v[80:95], v[52:55], v[32:35], v[80:95]
    ds_read_b64_tr_b16 v[204:205], v8 offset:40960
    ds_read_b64_tr_b16 v[206:207], v8 offset:41984
    v_mfma_f32_32x32x16_bf16 v[96:111], v[48:51], v[36:39], v[96:111]
    ds_read_b64_tr_b16 v[208:209], v9 offset:40960
    ds_read_b64_tr_b16 v[210:211], v9 offset:41984
    v_mfma_f32_32x32x16_bf16 v[112:127], v[52:55], v[36:39], v[112:127]
    s_waitcnt lgkmcnt(6)
    v_dot2_f32_bf16 v128, v44, s29, v128
    v_dot2_f32_bf16 v130, v44, v44, v130
    v_dot2_f32_bf16 v132, v56, s29, v132
    v_dot2_f32_bf16 v128, v45, s29, v128
    v_dot2_f32_bf16 v130, v45, v45, v130
    v_dot2_f32_bf16 v132, v57, s29, v132
    v_dot2_f32_bf16 v128, v46, s29, v128
    v_dot2_f32_bf16 v130, v46, v46, v130
    v_dot2_f32_bf16 v132, v58, s29, v132
    v_dot2_f32_bf16 v128, v47, s29, v128
    v_dot2_f32_bf16 v130, v47, v47, v130
    v_dot2_f32_bf16 v132, v59, s29, v132
    v_mfma_f32_32x32x16_bf16 v[64:79], v[56:59], v[40:43], v[64:79]
    ds_read_b128 v[32:35], v7 offset:32768
    ds_read_b128 v[36:39], v7 offset:36864
    v_mfma_f32_32x32x16_bf16 v[80:95], v[60:63], v[40:43], v[80:95]
    ds_read_b64_tr_b16 v[48:49], v8 offset:45056
    ds_read_b64_tr_b16 v[50:51], v8 offset:46080
    v_mfma_f32_32x32x16_bf16 v[96:111], v[56:59], v[44:47], v[96:111]
    ds_read_b64_tr_b16 v[52:53], v9 offset:45056
    ds_read_b64_tr_b16 v[54:55], v9 offset:46080
    v_mfma_f32_32x32x16_bf16 v[112:127], v[60:63], v[44:47], v[112:127]
    s_waitcnt lgkmcnt(6)
    v_dot2_f32_bf16 v128, v200, s29, v128
    v_dot2_f32_bf16 v130, v200, v200, v130
    v_dot2_f32_bf16 v132, v204, s29, v132
    v_dot2_f32_bf16 v128, v201, s29, v128
    v_dot2_f32_bf16 v130, v201, v201, v130
    v_dot2_f32_bf16 v132, v205, s29, v132
    v_dot2_f32_bf16 v128, v202, s29, v128
    v_dot2_f32_bf16 v130, v202, v202, v130
    v_dot2_f32_bf16 v132, v206, s29, v132
    v_dot2_f32_bf16 v128, v203, s29, v128
    v_dot2_f32_bf16 v130, v203, v203, v130
    v_dot2_f32_bf16 v132, v207, s29, v132
    v_mfma_f32_32x32x16_bf16 v[64:79], v[204:207], v[196:199], v[64:79]
    s_barrier
    ds_read_b128 v[40:43], v10 offset:0
    ds_read_b128 v[44:47], v10 offset:4096
    v_mfma_f32_32x32x16_bf16 v[80:95], v[208:211], v[196:199], v[80:95]
    ds_read_b64_tr_b16 v[56:57], v14 offset:0
    ds_read_b64_tr_b16 v[58:59], v14 offset:1024
    v_mfma_f32_32x32x16_bf16 v[96:111], v[204:207], v[200:203], v[96:111]
    ds_read_b64_tr_b16 v[60:61], v15 offset:0
    ds_read_b64_tr_b16 v[62:63], v15 offset:1024
    v_mfma_f32_32x32x16_bf16 v[112:127], v[208:211], v[200:203], v[112:127]
    s_waitcnt lgkmcnt(6)
    v_dot2_f32_bf16 v128, v36, s29, v128
    v_dot2_f32_bf16 v130, v36, v36, v130
    v_dot2_f32_bf16 v132, v48, s29, v132
    v_dot2_f32_bf16 v128, v37, s29, v128
    v_dot2_f32_bf16 v130, v37, v37, v130
    v_dot2_f32_bf16 v132, v49, s29, v132
    v_dot2_f32_bf16 v128, v38, s29, v128
    v_dot2_f32_bf16 v130, v38, v38, v130
    v_dot2_f32_bf16 v132, v50, s29, v132
    v_dot2_f32_bf16 v128, v39, s29, v128
    v_dot2_f32_bf16 v130, v39, v39, v130
    v_dot2_f32_bf16 v132, v51, s29, v132
    v_mfma_f32_32x32x16_bf16 v[64:79], v[48:51], v[32:35], v[64:79]
    ds_read_b128 v[196:199], v11 offset:0
    ds_read_b128 v[200:203], v11 offset:4096
    v_mfma_f32_32x32x16_bf16 v[80:95], v[52:55], v[32:35], v[80:95]
    ds_read_b64_tr_b16 v[204:205], v14 offset:4096
    ds_read_b64_tr_b16 v[206:207], v14 offset:5120
    v_mfma_f32_32x32x16_bf16 v[96:111], v[48:51], v[36:39], v[96:111]
    ds_read_b64_tr_b16 v[208:209], v15 offset:4096
    ds_read_b64_tr_b16 v[210:211], v15 offset:5120
    v_mfma_f32_32x32x16_bf16 v[112:127], v[52:55], v[36:39], v[112:127]
    s_waitcnt lgkmcnt(6)
    v_dot2_f32_bf16 v128, v44, s29, v128
    v_dot2_f32_bf16 v130, v44, v44, v130
    v_dot2_f32_bf16 v132, v56, s29, v132
    v_dot2_f32_bf16 v128, v45, s29, v128
    v_dot2_f32_bf16 v130, v45, v45, v130
    v_dot2_f32_bf16 v132, v57, s29, v132
    v_dot2_f32_bf16 v128, v46, s29, v128
    v_dot2_f32_bf16 v130, v46, v46, v130
    v_dot2_f32_bf16 v132, v58, s29, v132
    v_dot2_f32_bf16 v128, v47, s29, v128
    v_dot2_f32_bf16 v130, v47, v47, v130
    v_dot2_f32_bf16 v132, v59, s29, v132
    v_mfma_f32_32x32x16_bf16 v[64:79], v[56:59], v[40:43], v[64:79]
    ds_read_b128 v[32:35], v12 offset:0
    ds_read_b128 v[36:39], v12 offset:4096
    v_mfma_f32_32x32x16_bf16 v[80:95], v[60:63], v[40:43], v[80:95]
    ds_read_b64_tr_b16 v[48:49], v14 offset:8192
    ds_read_b64_tr_b16 v[50:51], v14 offset:9216
    v_mfma_f32_32x32x16_bf16 v[96:111], v[56:59], v[44:47], v[96:111]
    ds_read_b64_tr_b16 v[52:53], v15 offset:8192
    ds_read_b64_tr_b16 v[54:55], v15 offset:9216
    v_mfma_f32_32x32x16_bf16 v[112:127], v[60:63], v[44:47], v[112:127]
    s_waitcnt lgkmcnt(6)
    v_dot2_f32_bf16 v128, v200, s29, v128
    v_dot2_f32_bf16 v130, v200, v200, v130
    v_dot2_f32_bf16 v132, v204, s29, v132
    v_dot2_f32_bf16 v128, v201, s29, v128
    v_dot2_f32_bf16 v130, v201, v201, v130
    v_dot2_f32_bf16 v132, v205, s29, v132
    v_dot2_f32_bf16 v128, v202, s29, v128
    v_dot2_f32_bf16 v130, v202, v202, v130
    v_dot2_f32_bf16 v132, v206, s29, v132
    v_dot2_f32_bf16 v128, v203, s29, v128
    v_dot2_f32_bf16 v130, v203, v203, v130
    v_dot2_f32_bf16 v132, v207, s29, v132
    v_mfma_f32_32x32x16_bf16 v[64:79], v[204:207], v[196:199], v[64:79]
    ds_read_b128 v[40:43], v13 offset:0
    ds_read_b128 v[44:47], v13 offset:4096
    v_mfma_f32_32x32x16_bf16 v[80:95], v[208:211], v[196:199], v[80:95]
    ds_read_b64_tr_b16 v[56:57], v14 offset:12288
    ds_read_b64_tr_b16 v[58:59], v14 offset:13312
    v_mfma_f32_32x32x16_bf16 v[96:111], v[204:207], v[200:203], v[96:111]
    ds_read_b64_tr_b16 v[60:61], v15 offset:12288
    ds_read_b64_tr_b16 v[62:63], v15 offset:13312
    v_mfma_f32_32x32x16_bf16 v[112:127], v[208:211], v[200:203], v[112:127]
    s_waitcnt lgkmcnt(6)
    v_dot2_f32_bf16 v128, v36, s29, v128
    v_dot2_f32_bf16 v130, v36, v36, v130
    v_dot2_f32_bf16 v132, v48, s29, v132
    v_dot2_f32_bf16 v128, v37, s29, v128
    v_dot2_f32_bf16 v130, v37, v37, v130
    v_dot2_f32_bf16 v132, v49, s29, v132
    v_dot2_f32_bf16 v128, v38, s29, v128
    v_dot2_f32_bf16 v130, v38, v38, v130
    v_dot2_f32_bf16 v132, v50, s29, v132
    v_dot2_f32_bf16 v128, v39, s29, v128
    v_dot2_f32_bf16 v130, v39, v39, v130
    v_dot2_f32_bf16 v132, v51, s29, v132
    v_mfma_f32_32x32x16_bf16 v[64:79], v[48:51], v[32:35], v[64:79]
    s_barrier
    ds_read_b128 v[196:199], v16 offset:0
    ds_read_b128 v[200:203], v16 offset:4096
    v_mfma_f32_32x32x16_bf16 v[80:95], v[52:55], v[32:35], v[80:95]
    ds_read_b64_tr_b16 v[204:205], v20 offset:0
    ds_read_b64_tr_b16 v[206:207], v20 offset:1024
    v_mfma_f32_32x32x16_bf16 v[96:111], v[48:51], v[36:39], v[96:111]
    ds_read_b64_tr_b16 v[208:209], v21 offset:0
    ds_read_b64_tr_b16 v[210:211], v21 offset:1024
    v_mfma_f32_32x32x16_bf16 v[112:127], v[52:55], v[36:39], v[112:127]
    s_waitcnt lgkmcnt(6)
    v_dot2_f32_bf16 v128, v44, s29, v128
    v_dot2_f32_bf16 v130, v44, v44, v130
    v_dot2_f32_bf16 v132, v56, s29, v132
    v_dot2_f32_bf16 v128, v45, s29, v128
    v_dot2_f32_bf16 v130, v45, v45, v130
    v_dot2_f32_bf16 v132, v57, s29, v132
    v_dot2_f32_bf16 v128, v46, s29, v128
    v_dot2_f32_bf16 v130, v46, v46, v130
    v_dot2_f32_bf16 v132, v58, s29, v132
    v_dot2_f32_bf16 v128, v47, s29, v128
    v_dot2_f32_bf16 v130, v47, v47, v130
    v_dot2_f32_bf16 v132, v59, s29, v132
    v_mfma_f32_32x32x16_bf16 v[64:79], v[56:59], v[40:43], v[64:79]
    ds_read_b128 v[32:35], v17 offset:0
    ds_read_b128 v[36:39], v17 offset:4096
    v_mfma_f32_32x32x16_bf16 v[80:95], v[60:63], v[40:43], v[80:95]
    ds_read_b64_tr_b16 v[48:49], v20 offset:4096
    ds_read_b64_tr_b16 v[50:51], v20 offset:5120
    v_mfma_f32_32x32x16_bf16 v[96:111], v[56:59], v[44:47], v[96:111]
    ds_read_b64_tr_b16 v[52:53], v21 offset:4096
    ds_read_b64_tr_b16 v[54:55], v21 offset:5120
    v_mfma_f32_32x32x16_bf16 v[112:127], v[60:63], v[44:47], v[112:127]
    s_waitcnt lgkmcnt(6)
    v_dot2_f32_bf16 v128, v200, s29, v128
    v_dot2_f32_bf16 v130, v200, v200, v130
    v_dot2_f32_bf16 v132, v204, s29, v132
    v_dot2_f32_bf16 v128, v201, s29, v128
    v_dot2_f32_bf16 v130, v201, v201, v130
    v_dot2_f32_bf16 v132, v205, s29, v132
    v_dot2_f32_bf16 v128, v202, s29, v128
    v_dot2_f32_bf16 v130, v202, v202, v130
    v_dot2_f32_bf16 v132, v206, s29, v132
    v_dot2_f32_bf16 v128, v203, s29, v128
    v_dot2_f32_bf16 v130, v203, v203, v130
    v_dot2_f32_bf16 v132, v207, s29, v132
    v_mfma_f32_32x32x16_bf16 v[64:79], v[204:207], v[196:199], v[64:79]
    ds_read_b128 v[40:43], v18 offset:0
    ds_read_b128 v[44:47], v18 offset:4096
    v_mfma_f32_32x32x16_bf16 v[80:95], v[208:211], v[196:199], v[80:95]
    ds_read_b64_tr_b16 v[56:57], v20 offset:8192
    ds_read_b64_tr_b16 v[58:59], v20 offset:9216
    v_mfma_f32_32x32x16_bf16 v[96:111], v[204:207], v[200:203], v[96:111]
    ds_read_b64_tr_b16 v[60:61], v21 offset:8192
    ds_read_b64_tr_b16 v[62:63], v21 offset:9216
    v_mfma_f32_32x32x16_bf16 v[112:127], v[208:211], v[200:203], v[112:127]
    s_waitcnt lgkmcnt(6)
    v_dot2_f32_bf16 v128, v36, s29, v128
    v_dot2_f32_bf16 v130, v36, v36, v130
    v_dot2_f32_bf16 v132, v48, s29, v132
    v_dot2_f32_bf16 v128, v37, s29, v128
    v_dot2_f32_bf16 v130, v37, v37, v130
    v_dot2_f32_bf16 v132, v49, s29, v132
    v_dot2_f32_bf16 v128, v38, s29, v128
    v_dot2_f32_bf16 v130, v38, v38, v130
    v_dot2_f32_bf16 v132, v50, s29, v132
    v_dot2_f32_bf16 v128, v39, s29, v128
    v_dot2_f32_bf16 v130, v39, v39, v130
    v_dot2_f32_bf16 v132, v51, s29, v132
    v_mfma_f32_32x32x16_bf16 v[64:79], v[48:51], v[32:35], v[64:79]
    ds_read_b128 v[196:199], v19 offset:0
    ds_read_b128 v[200:203], v19 offset:4096
    v_mfma_f32_32x32x16_bf16 v[80:95], v[52:55], v[32:35], v[80:95]
    ds_read_b64_tr_b16 v[204:205], v20 offset:12288
    ds_read_b64_tr_b16 v[206:207], v20 offset:13312
    v_mfma_f32_32x32x16_bf16 v[96:111], v[48:51], v[36:39], v[96:111]
    ds_read_b64_tr_b16 v[208:209], v21 offset:12288
    ds_read_b64_tr_b16 v[210:211], v21 offset:13312
    v_mfma_f32_32x32x16_bf16 v[112:127], v[52:55], v[36:39], v[112:127]
    s_waitcnt lgkmcnt(6)
    v_dot2_f32_bf16 v128, v44, s29, v128
    v_dot2_f32_bf16 v130, v44, v44, v130
    v_dot2_f32_bf16 v132, v56, s29, v132
    v_dot2_f32_bf16 v128, v45, s29, v128
    v_dot2_f32_bf16 v130, v45, v45, v130
    v_dot2_f32_bf16 v132, v57, s29, v132
    v_dot2_f32_bf16 v128, v46, s29, v128
    v_dot2_f32_bf16 v130, v46, v46, v130
    v_dot2_f32_bf16 v132, v58, s29, v132
    v_dot2_f32_bf16 v128, v47, s29, v128
    v_dot2_f32_bf16 v130, v47, v47, v130
    v_dot2_f32_bf16 v132, v59, s29, v132
    v_mfma_f32_32x32x16_bf16 v[64:79], v[56:59], v[40:43], v[64:79]
    s_barrier
    ds_read_b128 v[32:35], v16 offset:32768
    ds_read_b128 v[36:39], v16 offset:36864
    v_mfma_f32_32x32x16_bf16 v[80:95], v[60:63], v[40:43], v[80:95]
    ds_read_b64_tr_b16 v[48:49], v20 offset:32768
    ds_read_b64_tr_b16 v[50:51], v20 offset:33792
    v_mfma_f32_32x32x16_bf16 v[96:111], v[56:59], v[44:47], v[96:111]
    ds_read_b64_tr_b16 v[52:53], v21 offset:32768
    ds_read_b64_tr_b16 v[54:55], v21 offset:33792
    v_mfma_f32_32x32x16_bf16 v[112:127], v[60:63], v[44:47], v[112:127]
    s_waitcnt lgkmcnt(6)
    v_dot2_f32_bf16 v128, v200, s29, v128
    v_dot2_f32_bf16 v130, v200, v200, v130
    v_dot2_f32_bf16 v132, v204, s29, v132
    v_dot2_f32_bf16 v128, v201, s29, v128
    v_dot2_f32_bf16 v130, v201, v201, v130
    v_dot2_f32_bf16 v132, v205, s29, v132
    v_dot2_f32_bf16 v128, v202, s29, v128
    v_dot2_f32_bf16 v130, v202, v202, v130
    v_dot2_f32_bf16 v132, v206, s29, v132
    v_dot2_f32_bf16 v128, v203, s29, v128
    v_dot2_f32_bf16 v130, v203, v203, v130
    v_dot2_f32_bf16 v132, v207, s29, v132
    v_mfma_f32_32x32x16_bf16 v[64:79], v[204:207], v[196:199], v[64:79]
    ds_read_b128 v[40:43], v17 offset:32768
    ds_read_b128 v[44:47], v17 offset:36864
    v_mfma_f32_32x32x16_bf16 v[80:95], v[208:211], v[196:199], v[80:95]
    ds_read_b64_tr_b16 v[56:57], v20 offset:36864
    ds_read_b64_tr_b16 v[58:59], v20 offset:37888
    v_mfma_f32_32x32x16_bf16 v[96:111], v[204:207], v[200:203], v[96:111]
    ds_read_b64_tr_b16 v[60:61], v21 offset:36864
    ds_read_b64_tr_b16 v[62:63], v21 offset:37888
    v_mfma_f32_32x32x16_bf16 v[112:127], v[208:211], v[200:203], v[112:127]
    s_waitcnt lgkmcnt(6)
    v_dot2_f32_bf16 v128, v36, s29, v128
    v_dot2_f32_bf16 v130, v36, v36, v130
    v_dot2_f32_bf16 v132, v48, s29, v132
    v_dot2_f32_bf16 v128, v37, s29, v128
    v_dot2_f32_bf16 v130, v37, v37, v130
    v_dot2_f32_bf16 v132, v49, s29, v132
    v_dot2_f32_bf16 v128, v38, s29, v128
    v_dot2_f32_bf16 v130, v38, v38, v130
    v_dot2_f32_bf16 v132, v50, s29, v132
    v_dot2_f32_bf16 v128, v39, s29, v128
    v_dot2_f32_bf16 v130, v39, v39, v130
    v_dot2_f32_bf16 v132, v51, s29, v132
    v_mfma_f32_32x32x16_bf16 v[64:79], v[48:51], v[32:35], v[64:79]
    ds_read_b128 v[196:199], v18 offset:32768
    ds_read_b128 v[200:203], v18 offset:36864
    v_mfma_f32_32x32x16_bf16 v[80:95], v[52:55], v[32:35], v[80:95]
    ds_read_b64_tr_b16 v[204:205], v20 offset:40960
    ds_read_b64_tr_b16 v[206:207], v20 offset:41984
    v_mfma_f32_32x32x16_bf16 v[96:111], v[48:51], v[36:39], v[96:111]
    ds_read_b64_tr_b16 v[208:209], v21 offset:40960
    ds_read_b64_tr_b16 v[210:211], v21 offset:41984
    v_mfma_f32_32x32x16_bf16 v[112:127], v[52:55], v[36:39], v[112:127]
    s_waitcnt lgkmcnt(6)
    v_dot2_f32_bf16 v128, v44, s29, v128
    v_dot2_f32_bf16 v130, v44, v44, v130
    v_dot2_f32_bf16 v132, v56, s29, v132
    v_dot2_f32_bf16 v128, v45, s29, v128
    v_dot2_f32_bf16 v130, v45, v45, v130
    v_dot2_f32_bf16 v132, v57, s29, v132
    v_dot2_f32_bf16 v128, v46, s29, v128
    v_dot2_f32_bf16 v130, v46, v46, v130
    v_dot2_f32_bf16 v132, v58, s29, v132
    v_dot2_f32_bf16 v128, v47, s29, v128
    v_dot2_f32_bf16 v130, v47, v47, v130
    v_dot2_f32_bf16 v132, v59, s29, v132
    v_mfma_f32_32x32x16_bf16 v[64:79], v[56:59], v[40:43], v[64:79]
    ds_read_b128 v[32:35], v19 offset:32768
    ds_read_b128 v[36:39], v19 offset:36864
    v_mfma_f32_32x32x16_bf16 v[80:95], v[60:63], v[40:43], v[80:95]
    ds_read_b64_tr_b16 v[48:49], v20 offset:45056
    ds_read_b64_tr_b16 v[50:51], v20 offset:46080
    v_mfma_f32_32x32x16_bf16 v[96:111], v[56:59], v[44:47], v[96:111]
    ds_read_b64_tr_b16 v[52:53], v21 offset:45056
    ds_read_b64_tr_b16 v[54:55], v21 offset:46080
    v_mfma_f32_32x32x16_bf16 v[112:127], v[60:63], v[44:47], v[112:127]
    s_waitcnt lgkmcnt(6)
    v_dot2_f32_bf16 v128, v200, s29, v128
    v_dot2_f32_bf16 v130, v200, v200, v130
    v_dot2_f32_bf16 v132, v204, s29, v132
    v_dot2_f32_bf16 v128, v201, s29, v128
    v_dot2_f32_bf16 v130, v201, v201, v130
    v_dot2_f32_bf16 v132, v205, s29, v132
    v_dot2_f32_bf16 v128, v202, s29, v128
    v_dot2_f32_bf16 v130, v202, v202, v130
    v_dot2_f32_bf16 v132, v206, s29, v132
    v_dot2_f32_bf16 v128, v203, s29, v128
    v_dot2_f32_bf16 v130, v203, v203, v130
    v_dot2_f32_bf16 v132, v207, s29, v132
    v_mfma_f32_32x32x16_bf16 v[64:79], v[204:207], v[196:199], v[64:79]
    s_barrier
    ds_read_b128 v[40:43], v4 offset:0
    ds_read_b128 v[44:47], v4 offset:4096
    v_mfma_f32_32x32x16_bf16 v[80:95], v[208:211], v[196:199], v[80:95]
    ds_read_b64_tr_b16 v[56:57], v8 offset:0
    ds_read_b64_tr_b16 v[58:59], v8 offset:1024
    v_mfma_f32_32x32x16_bf16 v[96:111], v[204:207], v[200:203], v[96:111]
    ds_read_b64_tr_b16 v[60:61], v9 offset:0
    ds_read_b64_tr_b16 v[62:63], v9 offset:1024
    v_mfma_f32_32x32x16_bf16 v[112:127], v[208:211], v[200:203], v[112:127]
    s_waitcnt lgkmcnt(6)
    v_dot2_f32_bf16 v128, v36, s29, v128
    v_dot2_f32_bf16 v130, v36, v36, v130
    v_dot2_f32_bf16 v132, v48, s29, v132
    v_dot2_f32_bf16 v128, v37, s29, v128
    v_dot2_f32_bf16 v130, v37, v37, v130
    v_dot2_f32_bf16 v132, v49, s29, v132
    v_dot2_f32_bf16 v128, v38, s29, v128
    v_dot2_f32_bf16 v130, v38, v38, v130
    v_dot2_f32_bf16 v132, v50, s29, v132
    v_dot2_f32_bf16 v128, v39, s29, v128
    v_dot2_f32_bf16 v130, v39, v39, v130
    v_dot2_f32_bf16 v132, v51, s29, v132
    v_mfma_f32_32x32x16_bf16 v[64:79], v[48:51], v[32:35], v[64:79]
    ds_read_b128 v[196:199], v5 offset:0
    ds_read_b128 v[200:203], v5 offset:4096
    v_mfma_f32_32x32x16_bf16 v[80:95], v[52:55], v[32:35], v[80:95]
    ds_read_b64_tr_b16 v[204:205], v8 offset:4096
    ds_read_b64_tr_b16 v[206:207], v8 offset:5120
    v_mfma_f32_32x32x16_bf16 v[96:111], v[48:51], v[36:39], v[96:111]
    ds_read_b64_tr_b16 v[208:209], v9 offset:4096
    ds_read_b64_tr_b16 v[210:211], v9 offset:5120
    v_mfma_f32_32x32x16_bf16 v[112:127], v[52:55], v[36:39], v[112:127]
    s_waitcnt lgkmcnt(6)
    v_dot2_f32_bf16 v128, v44, s29, v128
    v_dot2_f32_bf16 v130, v44, v44, v130
    v_dot2_f32_bf16 v132, v56, s29, v132
    v_dot2_f32_bf16 v128, v45, s29, v128
    v_dot2_f32_bf16 v130, v45, v45, v130
    v_dot2_f32_bf16 v132, v57, s29, v132
    v_dot2_f32_bf16 v128, v46, s29, v128
    v_dot2_f32_bf16 v130, v46, v46, v130
    v_dot2_f32_bf16 v132, v58, s29, v132
    v_dot2_f32_bf16 v128, v47, s29, v128
    v_dot2_f32_bf16 v130, v47, v47, v130
    v_dot2_f32_bf16 v132, v59, s29, v132
    v_mfma_f32_32x32x16_bf16 v[64:79], v[56:59], v[40:43], v[64:79]
    ds_read_b128 v[32:35], v6 offset:0
    ds_read_b128 v[36:39], v6 offset:4096
    v_mfma_f32_32x32x16_bf16 v[80:95], v[60:63], v[40:43], v[80:95]
    ds_read_b64_tr_b16 v[48:49], v8 offset:8192
    ds_read_b64_tr_b16 v[50:51], v8 offset:9216
    v_mfma_f32_32x32x16_bf16 v[96:111], v[56:59], v[44:47], v[96:111]
    ds_read_b64_tr_b16 v[52:53], v9 offset:8192
    ds_read_b64_tr_b16 v[54:55], v9 offset:9216
    v_mfma_f32_32x32x16_bf16 v[112:127], v[60:63], v[44:47], v[112:127]
    s_waitcnt lgkmcnt(6)
    v_dot2_f32_bf16 v128, v200, s29, v128
    v_dot2_f32_bf16 v130, v200, v200, v130
    v_dot2_f32_bf16 v132, v204, s29, v132
    v_dot2_f32_bf16 v128, v201, s29, v128
    v_dot2_f32_bf16 v130, v201, v201, v130
    v_dot2_f32_bf16 v132, v205, s29, v132
    v_dot2_f32_bf16 v128, v202, s29, v128
    v_dot2_f32_bf16 v130, v202, v202, v130
    v_dot2_f32_bf16 v132, v206, s29, v132
    v_dot2_f32_bf16 v128, v203, s29, v128
    v_dot2_f32_bf16 v130, v203, v203, v130
    v_dot2_f32_bf16 v132, v207, s29, v132
    v_mfma_f32_32x32x16_bf16 v[64:79], v[204:207], v[196:199], v[64:79]
    ds_read_b128 v[40:43], v7 offset:0
    ds_read_b128 v[44:47], v7 offset:4096
    v_mfma_f32_32x32x16_bf16 v[80:95], v[208:211], v[196:199], v[80:95]
    ds_read_b64_tr_b16 v[56:57], v8 offset:12288
    ds_read_b64_tr_b16 v[58:59], v8 offset:13312
    v_mfma_f32_32x32x16_bf16 v[96:111], v[204:207], v[200:203], v[96:111]
    ds_read_b64_tr_b16 v[60:61], v9 offset:12288
    ds_read_b64_tr_b16 v[62:63], v9 offset:13312
    v_mfma_f32_32x32x16_bf16 v[112:127], v[208:211], v[200:203], v[112:127]
    s_waitcnt lgkmcnt(6)
    v_dot2_f32_bf16 v128, v36, s29, v128
    v_dot2_f32_bf16 v130, v36, v36, v130
    v_dot2_f32_bf16 v132, v48, s29, v132
    v_dot2_f32_bf16 v128, v37, s29, v128
    v_dot2_f32_bf16 v130, v37, v37, v130
    v_dot2_f32_bf16 v132, v49, s29, v132
    v_dot2_f32_bf16 v128, v38, s29, v128
    v_dot2_f32_bf16 v130, v38, v38, v130
    v_dot2_f32_bf16 v132, v50, s29, v132
    v_dot2_f32_bf16 v128, v39, s29, v128
    v_dot2_f32_bf16 v130, v39, v39, v130
    v_dot2_f32_bf16 v132, v51, s29, v132
    v_mfma_f32_32x32x16_bf16 v[64:79], v[48:51], v[32:35], v[64:79]
    v_mfma_f32_32x32x16_bf16 v[80:95], v[52:55], v[32:35], v[80:95]
    v_mfma_f32_32x32x16_bf16 v[96:111], v[48:51], v[36:39], v[96:111]
    v_mfma_f32_32x32x16_bf16 v[112:127], v[52:55], v[36:39], v[112:127]
    s_waitcnt lgkmcnt(0)
    v_dot2_f32_bf16 v128, v44, s29, v128
    v_dot2_f32_bf16 v130, v44, v44, v130
    v_dot2_f32_bf16 v132, v56, s29, v132
    v_dot2_f32_bf16 v128, v45, s29, v128
    v_dot2_f32_bf16 v130, v45, v45, v130
    v_dot2_f32_bf16 v132, v57, s29, v132
    v_dot2_f32_bf16 v128, v46, s29, v128
    v_dot2_f32_bf16 v130, v46, v46, v130
    v_dot2_f32_bf16 v132, v58, s29, v132
    v_dot2_f32_bf16 v128, v47, s29, v128
    v_dot2_f32_bf16 v130, v47, v47, v130
    v_dot2_f32_bf16 v132, v59, s29, v132
    v_mfma_f32_32x32x16_bf16 v[64:79], v[56:59], v[40:43], v[64:79]
    v_mfma_f32_32x32x16_bf16 v[80:95], v[60:63], v[40:43], v[80:95]
    v_mfma_f32_32x32x16_bf16 v[96:111], v[56:59], v[44:47], v[96:111]
    v_mfma_f32_32x32x16_bf16 v[112:127], v[60:63], v[44:47], v[112:127]
    s_branch qkv_a_kernel_qe
qkv_a_kernel_q2:
    s_cmp_lg_u32 s26, 2
    s_cbranch_scc1 qkv_a_kernel_q3
    v_mov_b32 v64, 0
    v_mov_b32 v65, 0
    v_mov_b32 v66, 0
    v_mov_b32 v67, 0
    v_mov_b32 v68, 0
    v_mov_b32 v69, 0
    v_mov_b32 v70, 0
    v_mov_b32 v71, 0
    v_mov_b32 v72, 0
    v_mov_b32 v73, 0
    v_mov_b32 v74, 0
    v_mov_b32 v75, 0
    v_mov_b32 v76, 0
    v_mov_b32 v77, 0
    v_mov_b32 v78, 0
    v_mov_b32 v79, 0
    v_mov_b32 v80, 0
    v_mov_b32 v81, 0
    v_mov_b32 v82, 0
    v_mov_b32 v83, 0
    v_mov_b32 v84, 0
    v_mov_b32 v85, 0
    v_mov_b32 v86, 0
    v_mov_b32 v87, 0
    v_mov_b32 v88, 0
    v_mov_b32 v89, 0
    v_mov_b32 v90, 0
    v_mov_b32 v91, 0
    v_mov_b32 v92, 0
    v_mov_b32 v93, 0
    v_mov_b32 v94, 0
    v_mov_b32 v95, 0
    v_mov_b32 v96, 0
    v_mov_b32 v97, 0
    v_mov_b32 v98, 0
    v_mov_b32 v99, 0
    v_mov_b32 v100, 0
    v_mov_b32 v101, 0
    v_mov_b32 v102, 0
    v_mov_b32 v103, 0
    v_mov_b32 v104, 0
    v_mov_b32 v105, 0
    v_mov_b32 v106, 0
    v_mov_b32 v107, 0
    v_mov_b32 v108, 0
    v_mov_b32 v109, 0
    v_mov_b32 v110, 0
    v_mov_b32 v111, 0
    v_mov_b32 v112, 0
    v_mov_b32 v113, 0
    v_mov_b32 v114, 0
    v_mov_b32 v115, 0
    v_mov_b32 v116, 0
    v_mov_b32 v117, 0
    v_mov_b32 v118, 0
    v_mov_b32 v119, 0
    v_mov_b32 v120, 0
    v_mov_b32 v121, 0
    v_mov_b32 v122, 0
    v_mov_b32 v123, 0
    v_mov_b32 v124, 0
    v_mov_b32 v125, 0
    v_mov_b32 v126, 0
    v_mov_b32 v127, 0
    v_mov_b32 v128, 0
    v_mov_b32 v129, 0
    v_mov_b32 v130, 0
    v_mov_b32 v131, 0
    v_mov_b32 v132, 0
    v_mov_b32 v133, 0
    s_barrier
    ds_read_b128 v[32:35], v16 offset:0
    ds_read_b128 v[36:39], v16 offset:4096
    ds_read_b64_tr_b16 v[48:49], v20 offset:0
    ds_read_b64_tr_b16 v[50:51], v20 offset:1024
    ds_read_b64_tr_b16 v[52:53], v21 offset:0
    ds_read_b64_tr_b16 v[54:55], v21 offset:1024
    ds_read_b128 v[40:43], v17 offset:0
    ds_read_b128 v[44:47], v17 offset:4096
    ds_read_b64_tr_b16 v[56:57], v20 offset:4096
    ds_read_b64_tr_b16 v[58:59], v20 offset:5120
    ds_read_b64_tr_b16 v[60:61], v21 offset:4096
    ds_read_b64_tr_b16 v[62:63], v21 offset:5120
    s_waitcnt lgkmcnt(6)
    v_dot2_f32_bf16 v128, v32, s29, v128
    v_dot2_f32_bf16 v130, v32, v32, v130
    v_dot2_f32_bf16 v132, v52, s29, v132
    v_dot2_f32_bf16 v128, v33, s29, v128
    v_dot2_f32_bf16 v130, v33, v33, v130
    v_dot2_f32_bf16 v132, v53, s29, v132
    v_dot2_f32_bf16 v128, v34, s29, v128
    v_dot2_f32_bf16 v130, v34, v34, v130
    v_dot2_f32_bf16 v132, v54, s29, v132
    v_dot2_f32_bf16 v128, v35, s29, v128
    v_dot2_f32_bf16 v130, v35, v35, v130
    v_dot2_f32_bf16 v132, v55, s29, v132
    v_mfma_f32_32x32x16_bf16 v[64:79], v[48:51], v[32:35], v[64:79]
    ds_read_b128 v[196:199], v18 offset:0
    ds_read_b128 v[200:203], v18 offset:4096
    v_mfma_f32_32x32x16_bf16 v[80:95], v[52:55], v[32:35], v[80:95]
    ds_read_b64_tr_b16 v[204:205], v20 offset:8192
    ds_read_b64_tr_b16 v[206:207], v20 offset:9216
    v_mfma_f32_32x32x16_bf16 v[96:111], v[48:51], v[36:39], v[96:111]
    ds_read_b64_tr_b16 v[208:209], v21 offset:8192
    ds_read_b64_tr_b16 v[210:211], v21 offset:9216
    v_mfma_f32_32x32x16_bf16 v[112:127], v[52:55], v[36:39], v[112:127]
    s_waitcnt lgkmcnt(6)
    v_dot2_f32_bf16 v128, v40, s29, v128
    v_dot2_f32_bf16 v130, v40, v40, v130
    v_dot2_f32_bf16 v132, v60, s29, v132
    v_dot2_f32_bf16 v128, v41, s29, v128
    v_dot2_f32_bf16 v130, v41, v41, v130
    v_dot2_f32_bf16 v132, v61, s29, v132
    v_dot2_f32_bf16 v128, v42, s29, v128
    v_dot2_f32_bf16 v130, v42, v42, v130
    v_dot2_f32_bf16 v132, v62, s29, v132
    v_dot2_f32_bf16 v128, v43, s29, v128
    v_dot2_f32_bf16 v130, v43, v43, v130
    v_dot2_f32_bf16 v132, v63, s29, v132
    v_mfma_f32_32x32x16_bf16 v[64:79], v[56:59], v[40:43], v[64:79]
    ds_read_b128 v[32:35], v19 offset:0
    ds_read_b128 v[36:39], v19 offset:4096
    v_mfma_f32_32x32x16_bf16 v[80:95], v[60:63], v[40:43], v[80:95]
    ds_read_b64_tr_b16 v[48:49], v20 offset:12288
    ds_read_b64_tr_b16 v[50:51], v20 offset:13312
    v_mfma_f32_32x32x16_bf16 v[96:111], v[56:59], v[44:47], v[96:111]
    ds_read_b64_tr_b16 v[52:53], v21 offset:12288
    ds_read_b64_tr_b16 v[54:55], v21 offset:13312
    v_mfma_f32_32x32x16_bf16 v[112:127], v[60:63], v[44:47], v[112:127]
    s_waitcnt lgkmcnt(6)
    v_dot2_f32_bf16 v128, v196, s29, v128
    v_dot2_f32_bf16 v130, v196, v196, v130
    v_dot2_f32_bf16 v132, v208, s29, v132
    v_dot2_f32_bf16 v128, v197, s29, v128
    v_dot2_f32_bf16 v130, v197, v197, v130
    v_dot2_f32_bf16 v132, v209, s29, v132
    v_dot2_f32_bf16 v128, v198, s29, v128
    v_dot2_f32_bf16 v130, v198, v198, v130
    v_dot2_f32_bf16 v132, v210, s29, v132
    v_dot2_f32_bf16 v128, v199, s29, v128
    v_dot2_f32_bf16 v130, v199, v199, v130
    v_dot2_f32_bf16 v132, v211, s29, v132
    v_mfma_f32_32x32x16_bf16 v[64:79], v[204:207], v[196:199], v[64:79]
    s_barrier
    ds_read_b128 v[40:43], v16 offset:32768
    ds_read_b128 v[44:47], v16 offset:36864
    v_mfma_f32_32x32x16_bf16 v[80:95], v[208:211], v[196:199], v[80:95]
    ds_read_b64_tr_b16 v[56:57], v20 offset:32768
    ds_read_b64_tr_b16 v[58:59], v20 offset:33792
    v_mfma_f32_32x32x16_bf16 v[96:111], v[204:207], v[200:203], v[96:111]
    ds_read_b64_tr_b16 v[60:61], v21 offset:32768
    ds_read_b64_tr_b16 v[62:63], v21 offset:33792
    v_mfma_f32_32x32x16_bf16 v[112:127], v[208:211], v[200:203], v[112:127]
    s_waitcnt lgkmcnt(6)
    v_dot2_f32_bf16 v128, v32, s29, v128
    v_dot2_f32_bf16 v130, v32, v32, v130
    v_dot2_f32_bf16 v132, v52, s29, v132
    v_dot2_f32_bf16 v128, v33, s29, v128
    v_dot2_f32_bf16 v130, v33, v33, v130
    v_dot2_f32_bf16 v132, v53, s29, v132
    v_dot2_f32_bf16 v128, v34, s29, v128
    v_dot2_f32_bf16 v130, v34, v34, v130
    v_dot2_f32_bf16 v132, v54, s29, v132
    v_dot2_f32_bf16 v128, v35, s29, v128
    v_dot2_f32_bf16 v130, v35, v35, v130
    v_dot2_f32_bf16 v132, v55, s29, v132
    v_mfma_f32_32x32x16_bf16 v[64:79], v[48:51], v[32:35], v[64:79]
    ds_read_b128 v[196:199], v17 offset:32768
    ds_read_b128 v[200:203], v17 offset:36864
    v_mfma_f32_32x32x16_bf16 v[80:95], v[52:55], v[32:35], v[80:95]
    ds_read_b64_tr_b16 v[204:205], v20 offset:36864
    ds_read_b64_tr_b16 v[206:207], v20 offset:37888
    v_mfma_f32_32x32x16_bf16 v[96:111], v[48:51], v[36:39], v[96:111]
    ds_read_b64_tr_b16 v[208:209], v21 offset:36864
    ds_read_b64_tr_b16 v[210:211], v21 offset:37888
    v_mfma_f32_32x32x16_bf16 v[112:127], v[52:55], v[36:39], v[112:127]
    s_waitcnt lgkmcnt(6)
    v_dot2_f32_bf16 v128, v40, s29, v128
    v_dot2_f32_bf16 v130, v40, v40, v130
    v_dot2_f32_bf16 v132, v60, s29, v132
    v_dot2_f32_bf16 v128, v41, s29, v128
    v_dot2_f32_bf16 v130, v41, v41, v130
    v_dot2_f32_bf16 v132, v61, s29, v132
    v_dot2_f32_bf16 v128, v42, s29, v128
    v_dot2_f32_bf16 v130, v42, v42, v130
    v_dot2_f32_bf16 v132, v62, s29, v132
    v_dot2_f32_bf16 v128, v43, s29, v128
    v_dot2_f32_bf16 v130, v43, v43, v130
    v_dot2_f32_bf16 v132, v63, s29, v132
    v_mfma_f32_32x32x16_bf16 v[64:79], v[56:59], v[40:43], v[64:79]
    ds_read_b128 v[32:35], v18 offset:32768
    ds_read_b128 v[36:39], v18 offset:36864
    v_mfma_f32_32x32x16_bf16 v[80:95], v[60:63], v[40:43], v[80:95]
    ds_read_b64_tr_b16 v[48:49], v20 offset:40960
    ds_read_b64_tr_b16 v[50:51], v20 offset:41984
    v_mfma_f32_32x32x16_bf16 v[96:111], v[56:59], v[44:47], v[96:111]
    ds_read_b64_tr_b16 v[52:53], v21 offset:40960
    ds_read_b64_tr_b16 v[54:55], v21 offset:41984
    v_mfma_f32_32x32x16_bf16 v[112:127], v[60:63], v[44:47], v[112:127]
    s_waitcnt lgkmcnt(6)
    v_dot2_f32_bf16 v128, v196, s29, v128
    v_dot2_f32_bf16 v130, v196, v196, v130
    v_dot2_f32_bf16 v132, v208, s29, v132
    v_dot2_f32_bf16 v128, v197, s29, v128
    v_dot2_f32_bf16 v130, v197, v197, v130
    v_dot2_f32_bf16 v132, v209, s29, v132
    v_dot2_f32_bf16 v128, v198, s29, v128
    v_dot2_f32_bf16 v130, v198, v198, v130
    v_dot2_f32_bf16 v132, v210, s29, v132
    v_dot2_f32_bf16 v128, v199, s29, v128
    v_dot2_f32_bf16 v130, v199, v199, v130
    v_dot2_f32_bf16 v132, v211, s29, v132
    v_mfma_f32_32x32x16_bf16 v[64:79], v[204:207], v[196:199], v[64:79]
    ds_read_b128 v[40:43], v19 offset:32768
    ds_read_b128 v[44:47], v19 offset:36864
    v_mfma_f32_32x32x16_bf16 v[80:95], v[208:211], v[196:199], v[80:95]
    ds_read_b64_tr_b16 v[56:57], v20 offset:45056
    ds_read_b64_tr_b16 v[58:59], v20 offset:46080
    v_mfma_f32_32x32x16_bf16 v[96:111], v[204:207], v[200:203], v[96:111]
    ds_read_b64_tr_b16 v[60:61], v21 offset:45056
    ds_read_b64_tr_b16 v[62:63], v21 offset:46080
    v_mfma_f32_32x32x16_bf16 v[112:127], v[208:211], v[200:203], v[112:127]
    s_waitcnt lgkmcnt(6)
    v_dot2_f32_bf16 v128, v32, s29, v128
    v_dot2_f32_bf16 v130, v32, v32, v130
    v_dot2_f32_bf16 v132, v52, s29, v132
    v_dot2_f32_bf16 v128, v33, s29, v128
    v_dot2_f32_bf16 v130, v33, v33, v130
    v_dot2_f32_bf16 v132, v53, s29, v132
    v_dot2_f32_bf16 v128, v34, s29, v128
    v_dot2_f32_bf16 v130, v34, v34, v130
    v_dot2_f32_bf16 v132, v54, s29, v132
    v_dot2_f32_bf16 v128, v35, s29, v128
    v_dot2_f32_bf16 v130, v35, v35, v130
    v_dot2_f32_bf16 v132, v55, s29, v132
    v_mfma_f32_32x32x16_bf16 v[64:79], v[48:51], v[32:35], v[64:79]
    s_barrier
    ds_read_b128 v[196:199], v4 offset:0
    ds_read_b128 v[200:203], v4 offset:4096
    v_mfma_f32_32x32x16_bf16 v[80:95], v[52:55], v[32:35], v[80:95]
    ds_read_b64_tr_b16 v[204:205], v8 offset:0
    ds_read_b64_tr_b16 v[206:207], v8 offset:1024
    v_mfma_f32_32x32x16_bf16 v[96:111], v[48:51], v[36:39], v[96:111]
    ds_read_b64_tr_b16 v[208:209], v9 offset:0
    ds_read_b64_tr_b16 v[210:211], v9 offset:1024
    v_mfma_f32_32x32x16_bf16 v[112:127], v[52:55], v[36:39], v[112:127]
    s_waitcnt lgkmcnt(6)
    v_dot2_f32_bf16 v128, v40, s29, v128
    v_dot2_f32_bf16 v130, v40, v40, v130
    v_dot2_f32_bf16 v132, v60, s29, v132
    v_dot2_f32_bf16 v128, v41, s29, v128
    v_dot2_f32_bf16 v130, v41, v41, v130
    v_dot2_f32_bf16 v132, v61, s29, v132
    v_dot2_f32_bf16 v128, v42, s29, v128
    v_dot2_f32_bf16 v130, v42, v42, v130
    v_dot2_f32_bf16 v132, v62, s29, v132
    v_dot2_f32_bf16 v128, v43, s29, v128
    v_dot2_f32_bf16 v130, v43, v43, v130
    v_dot2_f32_bf16 v132, v63, s29, v132
    v_mfma_f32_32x32x16_bf16 v[64:79], v[56:59], v[40:43], v[64:79]
    ds_read_b128 v[32:35], v5 offset:0
    ds_read_b128 v[36:39], v5 offset:4096
    v_mfma_f32_32x32x16_bf16 v[80:95], v[60:63], v[40:43], v[80:95]
    ds_read_b64_tr_b16 v[48:49], v8 offset:4096
    ds_read_b64_tr_b16 v[50:51], v8 offset:5120
    v_mfma_f32_32x32x16_bf16 v[96:111], v[56:59], v[44:47], v[96:111]
    ds_read_b64_tr_b16 v[52:53], v9 offset:4096
    ds_read_b64_tr_b16 v[54:55], v9 offset:5120
    v_mfma_f32_32x32x16_bf16 v[112:127], v[60:63], v[44:47], v[112:127]
    s_waitcnt lgkmcnt(6)
    v_dot2_f32_bf16 v128, v196, s29, v128
    v_dot2_f32_bf16 v130, v196, v196, v130
    v_dot2_f32_bf16 v132, v208, s29, v132
    v_dot2_f32_bf16 v128, v197, s29, v128
    v_dot2_f32_bf16 v130, v197, v197, v130
    v_dot2_f32_bf16 v132, v209, s29, v132
    v_dot2_f32_bf16 v128, v198, s29, v128
    v_dot2_f32_bf16 v130, v198, v198, v130
    v_dot2_f32_bf16 v132, v210, s29, v132
    v_dot2_f32_bf16 v128, v199, s29, v128
    v_dot2_f32_bf16 v130, v199, v199, v130
    v_dot2_f32_bf16 v132, v211, s29, v132
    v_mfma_f32_32x32x16_bf16 v[64:79], v[204:207], v[196:199], v[64:79]
    ds_read_b128 v[40:43], v6 offset:0
    ds_read_b128 v[44:47], v6 offset:4096
    v_mfma_f32_32x32x16_bf16 v[80:95], v[208:211], v[196:199], v[80:95]
    ds_read_b64_tr_b16 v[56:57], v8 offset:8192
    ds_read_b64_tr_b16 v[58:59], v8 offset:9216
    v_mfma_f32_32x32x16_bf16 v[96:111], v[204:207], v[200:203], v[96:111]
    ds_read_b64_tr_b16 v[60:61], v9 offset:8192
    ds_read_b64_tr_b16 v[62:63], v9 offset:9216
    v_mfma_f32_32x32x16_bf16 v[112:127], v[208:211], v[200:203], v[112:127]
    s_waitcnt lgkmcnt(6)
    v_dot2_f32_bf16 v128, v32, s29, v128
    v_dot2_f32_bf16 v130, v32, v32, v130
    v_dot2_f32_bf16 v132, v52, s29, v132
    v_dot2_f32_bf16 v128, v33, s29, v128
    v_dot2_f32_bf16 v130, v33, v33, v130
    v_dot2_f32_bf16 v132, v53, s29, v132
    v_dot2_f32_bf16 v128, v34, s29, v128
    v_dot2_f32_bf16 v130, v34, v34, v130
    v_dot2_f32_bf16 v132, v54, s29, v132
    v_dot2_f32_bf16 v128, v35, s29, v128
    v_dot2_f32_bf16 v130, v35, v35, v130
    v_dot2_f32_bf16 v132, v55, s29, v132
    v_mfma_f32_32x32x16_bf16 v[64:79], v[48:51], v[32:35], v[64:79]
    ds_read_b128 v[196:199], v7 offset:0
    ds_read_b128 v[200:203], v7 offset:4096
    v_mfma_f32_32x32x16_bf16 v[80:95], v[52:55], v[32:35], v[80:95]
    ds_read_b64_tr_b16 v[204:205], v8 offset:12288
    ds_read_b64_tr_b16 v[206:207], v8 offset:13312
    v_mfma_f32_32x32x16_bf16 v[96:111], v[48:51], v[36:39], v[96:111]
    ds_read_b64_tr_b16 v[208:209], v9 offset:12288
    ds_read_b64_tr_b16 v[210:211], v9 offset:13312
    v_mfma_f32_32x32x16_bf16 v[112:127], v[52:55], v[36:39], v[112:127]
    s_waitcnt lgkmcnt(6)
    v_dot2_f32_bf16 v128, v40, s29, v128
    v_dot2_f32_bf16 v130, v40, v40, v130
    v_dot2_f32_bf16 v132, v60, s29, v132
    v_dot2_f32_bf16 v128, v41, s29, v128
    v_dot2_f32_bf16 v130, v41, v41, v130
    v_dot2_f32_bf16 v132, v61, s29, v132
    v_dot2_f32_bf16 v128, v42, s29, v128
    v_dot2_f32_bf16 v130, v42, v42, v130
    v_dot2_f32_bf16 v132, v62, s29, v132
    v_dot2_f32_bf16 v128, v43, s29, v128
    v_dot2_f32_bf16 v130, v43, v43, v130
    v_dot2_f32_bf16 v132, v63, s29, v132
    v_mfma_f32_32x32x16_bf16 v[64:79], v[56:59], v[40:43], v[64:79]
    s_barrier
    ds_read_b128 v[32:35], v4 offset:32768
    ds_read_b128 v[36:39], v4 offset:36864
    v_mfma_f32_32x32x16_bf16 v[80:95], v[60:63], v[40:43], v[80:95]
    ds_read_b64_tr_b16 v[48:49], v8 offset:32768
    ds_read_b64_tr_b16 v[50:51], v8 offset:33792
    v_mfma_f32_32x32x16_bf16 v[96:111], v[56:59], v[44:47], v[96:111]
    ds_read_b64_tr_b16 v[52:53], v9 offset:32768
    ds_read_b64_tr_b16 v[54:55], v9 offset:33792
    v_mfma_f32_32x32x16_bf16 v[112:127], v[60:63], v[44:47], v[112:127]
    s_waitcnt lgkmcnt(6)
    v_dot2_f32_bf16 v128, v196, s29, v128
    v_dot2_f32_bf16 v130, v196, v196, v130
    v_dot2_f32_bf16 v132, v208, s29, v132
    v_dot2_f32_bf16 v128, v197, s29, v128
    v_dot2_f32_bf16 v130, v197, v197, v130
    v_dot2_f32_bf16 v132, v209, s29, v132
    v_dot2_f32_bf16 v128, v198, s29, v128
    v_dot2_f32_bf16 v130, v198, v198, v130
    v_dot2_f32_bf16 v132, v210, s29, v132
    v_dot2_f32_bf16 v128, v199, s29, v128
    v_dot2_f32_bf16 v130, v199, v199, v130
    v_dot2_f32_bf16 v132, v211, s29, v132
    v_mfma_f32_32x32x16_bf16 v[64:79], v[204:207], v[196:199], v[64:79]
    ds_read_b128 v[40:43], v5 offset:32768
    ds_read_b128 v[44:47], v5 offset:36864
    v_mfma_f32_32x32x16_bf16 v[80:95], v[208:211], v[196:199], v[80:95]
    ds_read_b64_tr_b16 v[56:57], v8 offset:36864
    ds_read_b64_tr_b16 v[58:59], v8 offset:37888
    v_mfma_f32_32x32x16_bf16 v[96:111], v[204:207], v[200:203], v[96:111]
    ds_read_b64_tr_b16 v[60:61], v9 offset:36864
    ds_read_b64_tr_b16 v[62:63], v9 offset:37888
    v_mfma_f32_32x32x16_bf16 v[112:127], v[208:211], v[200:203], v[112:127]
    s_waitcnt lgkmcnt(6)
    v_dot2_f32_bf16 v128, v32, s29, v128
    v_dot2_f32_bf16 v130, v32, v32, v130
    v_dot2_f32_bf16 v132, v52, s29, v132
    v_dot2_f32_bf16 v128, v33, s29, v128
    v_dot2_f32_bf16 v130, v33, v33, v130
    v_dot2_f32_bf16 v132, v53, s29, v132
    v_dot2_f32_bf16 v128, v34, s29, v128
    v_dot2_f32_bf16 v130, v34, v34, v130
    v_dot2_f32_bf16 v132, v54, s29, v132
    v_dot2_f32_bf16 v128, v35, s29, v128
    v_dot2_f32_bf16 v130, v35, v35, v130
    v_dot2_f32_bf16 v132, v55, s29, v132
    v_mfma_f32_32x32x16_bf16 v[64:79], v[48:51], v[32:35], v[64:79]
    ds_read_b128 v[196:199], v6 offset:32768
    ds_read_b128 v[200:203], v6 offset:36864
    v_mfma_f32_32x32x16_bf16 v[80:95], v[52:55], v[32:35], v[80:95]
    ds_read_b64_tr_b16 v[204:205], v8 offset:40960
    ds_read_b64_tr_b16 v[206:207], v8 offset:41984
    v_mfma_f32_32x32x16_bf16 v[96:111], v[48:51], v[36:39], v[96:111]
    ds_read_b64_tr_b16 v[208:209], v9 offset:40960
    ds_read_b64_tr_b16 v[210:211], v9 offset:41984
    v_mfma_f32_32x32x16_bf16 v[112:127], v[52:55], v[36:39], v[112:127]
    s_waitcnt lgkmcnt(6)
    v_dot2_f32_bf16 v128, v40, s29, v128
    v_dot2_f32_bf16 v130, v40, v40, v130
    v_dot2_f32_bf16 v132, v60, s29, v132
    v_dot2_f32_bf16 v128, v41, s29, v128
    v_dot2_f32_bf16 v130, v41, v41, v130
    v_dot2_f32_bf16 v132, v61, s29, v132
    v_dot2_f32_bf16 v128, v42, s29, v128
    v_dot2_f32_bf16 v130, v42, v42, v130
    v_dot2_f32_bf16 v132, v62, s29, v132
    v_dot2_f32_bf16 v128, v43, s29, v128
    v_dot2_f32_bf16 v130, v43, v43, v130
    v_dot2_f32_bf16 v132, v63, s29, v132
    v_mfma_f32_32x32x16_bf16 v[64:79], v[56:59], v[40:43], v[64:79]
    ds_read_b128 v[32:35], v7 offset:32768
    ds_read_b128 v[36:39], v7 offset:36864
    v_mfma_f32_32x32x16_bf16 v[80:95], v[60:63], v[40:43], v[80:95]
    ds_read_b64_tr_b16 v[48:49], v8 offset:45056
    ds_read_b64_tr_b16 v[50:51], v8 offset:46080
    v_mfma_f32_32x32x16_bf16 v[96:111], v[56:59], v[44:47], v[96:111]
    ds_read_b64_tr_b16 v[52:53], v9 offset:45056
    ds_read_b64_tr_b16 v[54:55], v9 offset:46080
    v_mfma_f32_32x32x16_bf16 v[112:127], v[60:63], v[44:47], v[112:127]
    s_waitcnt lgkmcnt(6)
    v_dot2_f32_bf16 v128, v196, s29, v128
    v_dot2_f32_bf16 v130, v196, v196, v130
    v_dot2_f32_bf16 v132, v208, s29, v132
    v_dot2_f32_bf16 v128, v197, s29, v128
    v_dot2_f32_bf16 v130, v197, v197, v130
    v_dot2_f32_bf16 v132, v209, s29, v132
    v_dot2_f32_bf16 v128, v198, s29, v128
    v_dot2_f32_bf16 v130, v198, v198, v130
    v_dot2_f32_bf16 v132, v210, s29, v132
    v_dot2_f32_bf16 v128, v199, s29, v128
    v_dot2_f32_bf16 v130, v199, v199, v130
    v_dot2_f32_bf16 v132, v211, s29, v132
    v_mfma_f32_32x32x16_bf16 v[64:79], v[204:207], v[196:199], v[64:79]
    s_barrier
    ds_read_b128 v[40:43], v10 offset:0
    ds_read_b128 v[44:47], v10 offset:4096
    v_mfma_f32_32x32x16_bf16 v[80:95], v[208:211], v[196:199], v[80:95]
    ds_read_b64_tr_b16 v[56:57], v14 offset:0
    ds_read_b64_tr_b16 v[58:59], v14 offset:1024
    v_mfma_f32_32x32x16_bf16 v[96:111], v[204:207], v[200:203], v[96:111]
    ds_read_b64_tr_b16 v[60:61], v15 offset:0
    ds_read_b64_tr_b16 v[62:63], v15 offset:1024
    v_mfma_f32_32x32x16_bf16 v[112:127], v[208:211], v[200:203], v[112:127]
    s_waitcnt lgkmcnt(6)
    v_dot2_f32_bf16 v128, v32, s29, v128
    v_dot2_f32_bf16 v130, v32, v32, v130
    v_dot2_f32_bf16 v132, v52, s29, v132
    v_dot2_f32_bf16 v128, v33, s29, v128
    v_dot2_f32_bf16 v130, v33, v33, v130
    v_dot2_f32_bf16 v132, v53, s29, v132
    v_dot2_f32_bf16 v128, v34, s29, v128
    v_dot2_f32_bf16 v130, v34, v34, v130
    v_dot2_f32_bf16 v132, v54, s29, v132
    v_dot2_f32_bf16 v128, v35, s29, v128
    v_dot2_f32_bf16 v130, v35, v35, v130
    v_dot2_f32_bf16 v132, v55, s29, v132
    v_mfma_f32_32x32x16_bf16 v[64:79], v[48:51], v[32:35], v[64:79]
    ds_read_b128 v[196:199], v11 offset:0
    ds_read_b128 v[200:203], v11 offset:4096
    v_mfma_f32_32x32x16_bf16 v[80:95], v[52:55], v[32:35], v[80:95]
    ds_read_b64_tr_b16 v[204:205], v14 offset:4096
    ds_read_b64_tr_b16 v[206:207], v14 offset:5120
    v_mfma_f32_32x32x16_bf16 v[96:111], v[48:51], v[36:39], v[96:111]
    ds_read_b64_tr_b16 v[208:209], v15 offset:4096
    ds_read_b64_tr_b16 v[210:211], v15 offset:5120
    v_mfma_f32_32x32x16_bf16 v[112:127], v[52:55], v[36:39], v[112:127]
    s_waitcnt lgkmcnt(6)
    v_dot2_f32_bf16 v128, v40, s29, v128
    v_dot2_f32_bf16 v130, v40, v40, v130
    v_dot2_f32_bf16 v132, v60, s29, v132
    v_dot2_f32_bf16 v128, v41, s29, v128
    v_dot2_f32_bf16 v130, v41, v41, v130
    v_dot2_f32_bf16 v132, v61, s29, v132
    v_dot2_f32_bf16 v128, v42, s29, v128
    v_dot2_f32_bf16 v130, v42, v42, v130
    v_dot2_f32_bf16 v132, v62, s29, v132
    v_dot2_f32_bf16 v128, v43, s29, v128
    v_dot2_f32_bf16 v130, v43, v43, v130
    v_dot2_f32_bf16 v132, v63, s29, v132
    v_mfma_f32_32x32x16_bf16 v[64:79], v[56:59], v[40:43], v[64:79]
    ds_read_b128 v[32:35], v12 offset:0
    ds_read_b128 v[36:39], v12 offset:4096
    v_mfma_f32_32x32x16_bf16 v[80:95], v[60:63], v[40:43], v[80:95]
    ds_read_b64_tr_b16 v[48:49], v14 offset:8192
    ds_read_b64_tr_b16 v[50:51], v14 offset:9216
    v_mfma_f32_32x32x16_bf16 v[96:111], v[56:59], v[44:47], v[96:111]
    ds_read_b64_tr_b16 v[52:53], v15 offset:8192
    ds_read_b64_tr_b16 v[54:55], v15 offset:9216
    v_mfma_f32_32x32x16_bf16 v[112:127], v[60:63], v[44:47], v[112:127]
    s_waitcnt lgkmcnt(6)
    v_dot2_f32_bf16 v128, v196, s29, v128
    v_dot2_f32_bf16 v130, v196, v196, v130
    v_dot2_f32_bf16 v132, v208, s29, v132
    v_dot2_f32_bf16 v128, v197, s29, v128
    v_dot2_f32_bf16 v130, v197, v197, v130
    v_dot2_f32_bf16 v132, v209, s29, v132
    v_dot2_f32_bf16 v128, v198, s29, v128
    v_dot2_f32_bf16 v130, v198, v198, v130
    v_dot2_f32_bf16 v132, v210, s29, v132
    v_dot2_f32_bf16 v128, v199, s29, v128
    v_dot2_f32_bf16 v130, v199, v199, v130
    v_dot2_f32_bf16 v132, v211, s29, v132
    v_mfma_f32_32x32x16_bf16 v[64:79], v[204:207], v[196:199], v[64:79]
    ds_read_b128 v[40:43], v13 offset:0
    ds_read_b128 v[44:47], v13 offset:4096
    v_mfma_f32_32x32x16_bf16 v[80:95], v[208:211], v[196:199], v[80:95]
    ds_read_b64_tr_b16 v[56:57], v14 offset:12288
    ds_read_b64_tr_b16 v[58:59], v14 offset:13312
    v_mfma_f32_32x32x16_bf16 v[96:111], v[204:207], v[200:203], v[96:111]
    ds_read_b64_tr_b16 v[60:61], v15 offset:12288
    ds_read_b64_tr_b16 v[62:63], v15 offset:13312
    v_mfma_f32_32x32x16_bf16 v[112:127], v[208:211], v[200:203], v[112:127]
    s_waitcnt lgkmcnt(6)
    v_dot2_f32_bf16 v128, v32, s29, v128
    v_dot2_f32_bf16 v130, v32, v32, v130
    v_dot2_f32_bf16 v132, v52, s29, v132
    v_dot2_f32_bf16 v128, v33, s29, v128
    v_dot2_f32_bf16 v130, v33, v33, v130
    v_dot2_f32_bf16 v132, v53, s29, v132
    v_dot2_f32_bf16 v128, v34, s29, v128
    v_dot2_f32_bf16 v130, v34, v34, v130
    v_dot2_f32_bf16 v132, v54, s29, v132
    v_dot2_f32_bf16 v128, v35, s29, v128
    v_dot2_f32_bf16 v130, v35, v35, v130
    v_dot2_f32_bf16 v132, v55, s29, v132
    v_mfma_f32_32x32x16_bf16 v[64:79], v[48:51], v[32:35], v[64:79]
    s_barrier
    ds_read_b128 v[196:199], v16 offset:0
    ds_read_b128 v[200:203], v16 offset:4096
    v_mfma_f32_32x32x16_bf16 v[80:95], v[52:55], v[32:35], v[80:95]
    ds_read_b64_tr_b16 v[204:205], v20 offset:0
    ds_read_b64_tr_b16 v[206:207], v20 offset:1024
    v_mfma_f32_32x32x16_bf16 v[96:111], v[48:51], v[36:39], v[96:111]
    ds_read_b64_tr_b16 v[208:209], v21 offset:0
    ds_read_b64_tr_b16 v[210:211], v21 offset:1024
    v_mfma_f32_32x32x16_bf16 v[112:127], v[52:55], v[36:39], v[112:127]
    s_waitcnt lgkmcnt(6)
    v_dot2_f32_bf16 v128, v40, s29, v128
    v_dot2_f32_bf16 v130, v40, v40, v130
    v_dot2_f32_bf16 v132, v60, s29, v132
    v_dot2_f32_bf16 v128, v41, s29, v128
    v_dot2_f32_bf16 v130, v41, v41, v130
    v_dot2_f32_bf16 v132, v61, s29, v132
    v_dot2_f32_bf16 v128, v42, s29, v128
    v_dot2_f32_bf16 v130, v42, v42, v130
    v_dot2_f32_bf16 v132, v62, s29, v132
    v_dot2_f32_bf16 v128, v43, s29, v128
    v_dot2_f32_bf16 v130, v43, v43, v130
    v_dot2_f32_bf16 v132, v63, s29, v132
    v_mfma_f32_32x32x16_bf16 v[64:79], v[56:59], v[40:43], v[64:79]
    ds_read_b128 v[32:35], v17 offset:0
    ds_read_b128 v[36:39], v17 offset:4096
    v_mfma_f32_32x32x16_bf16 v[80:95], v[60:63], v[40:43], v[80:95]
    ds_read_b64_tr_b16 v[48:49], v20 offset:4096
    ds_read_b64_tr_b16 v[50:51], v20 offset:5120
    v_mfma_f32_32x32x16_bf16 v[96:111], v[56:59], v[44:47], v[96:111]
    ds_read_b64_tr_b16 v[52:53], v21 offset:4096
    ds_read_b64_tr_b16 v[54:55], v21 offset:5120
    v_mfma_f32_32x32x16_bf16 v[112:127], v[60:63], v[44:47], v[112:127]
    s_waitcnt lgkmcnt(6)
    v_dot2_f32_bf16 v128, v196, s29, v128
    v_dot2_f32_bf16 v130, v196, v196, v130
    v_dot2_f32_bf16 v132, v208, s29, v132
    v_dot2_f32_bf16 v128, v197, s29, v128
    v_dot2_f32_bf16 v130, v197, v197, v130
    v_dot2_f32_bf16 v132, v209, s29, v132
    v_dot2_f32_bf16 v128, v198, s29, v128
    v_dot2_f32_bf16 v130, v198, v198, v130
    v_dot2_f32_bf16 v132, v210, s29, v132
    v_dot2_f32_bf16 v128, v199, s29, v128
    v_dot2_f32_bf16 v130, v199, v199, v130
    v_dot2_f32_bf16 v132, v211, s29, v132
    v_mfma_f32_32x32x16_bf16 v[64:79], v[204:207], v[196:199], v[64:79]
    ds_read_b128 v[40:43], v18 offset:0
    ds_read_b128 v[44:47], v18 offset:4096
    v_mfma_f32_32x32x16_bf16 v[80:95], v[208:211], v[196:199], v[80:95]
    ds_read_b64_tr_b16 v[56:57], v20 offset:8192
    ds_read_b64_tr_b16 v[58:59], v20 offset:9216
    v_mfma_f32_32x32x16_bf16 v[96:111], v[204:207], v[200:203], v[96:111]
    ds_read_b64_tr_b16 v[60:61], v21 offset:8192
    ds_read_b64_tr_b16 v[62:63], v21 offset:9216
    v_mfma_f32_32x32x16_bf16 v[112:127], v[208:211], v[200:203], v[112:127]
    s_waitcnt lgkmcnt(6)
    v_dot2_f32_bf16 v128, v32, s29, v128
    v_dot2_f32_bf16 v130, v32, v32, v130
    v_dot2_f32_bf16 v132, v52, s29, v132
    v_dot2_f32_bf16 v128, v33, s29, v128
    v_dot2_f32_bf16 v130, v33, v33, v130
    v_dot2_f32_bf16 v132, v53, s29, v132
    v_dot2_f32_bf16 v128, v34, s29, v128
    v_dot2_f32_bf16 v130, v34, v34, v130
    v_dot2_f32_bf16 v132, v54, s29, v132
    v_dot2_f32_bf16 v128, v35, s29, v128
    v_dot2_f32_bf16 v130, v35, v35, v130
    v_dot2_f32_bf16 v132, v55, s29, v132
    v_mfma_f32_32x32x16_bf16 v[64:79], v[48:51], v[32:35], v[64:79]
    ds_read_b128 v[196:199], v19 offset:0
    ds_read_b128 v[200:203], v19 offset:4096
    v_mfma_f32_32x32x16_bf16 v[80:95], v[52:55], v[32:35], v[80:95]
    ds_read_b64_tr_b16 v[204:205], v20 offset:12288
    ds_read_b64_tr_b16 v[206:207], v20 offset:13312
    v_mfma_f32_32x32x16_bf16 v[96:111], v[48:51], v[36:39], v[96:111]
    ds_read_b64_tr_b16 v[208:209], v21 offset:12288
    ds_read_b64_tr_b16 v[210:211], v21 offset:13312
    v_mfma_f32_32x32x16_bf16 v[112:127], v[52:55], v[36:39], v[112:127]
    s_waitcnt lgkmcnt(6)
    v_dot2_f32_bf16 v128, v40, s29, v128
    v_dot2_f32_bf16 v130, v40, v40, v130
    v_dot2_f32_bf16 v132, v60, s29, v132
    v_dot2_f32_bf16 v128, v41, s29, v128
    v_dot2_f32_bf16 v130, v41, v41, v130
    v_dot2_f32_bf16 v132, v61, s29, v132
    v_dot2_f32_bf16 v128, v42, s29, v128
    v_dot2_f32_bf16 v130, v42, v42, v130
    v_dot2_f32_bf16 v132, v62, s29, v132
    v_dot2_f32_bf16 v128, v43, s29, v128
    v_dot2_f32_bf16 v130, v43, v43, v130
    v_dot2_f32_bf16 v132, v63, s29, v132
    v_mfma_f32_32x32x16_bf16 v[64:79], v[56:59], v[40:43], v[64:79]
    s_barrier
    ds_read_b128 v[32:35], v16 offset:32768
    ds_read_b128 v[36:39], v16 offset:36864
    v_mfma_f32_32x32x16_bf16 v[80:95], v[60:63], v[40:43], v[80:95]
    ds_read_b64_tr_b16 v[48:49], v20 offset:32768
    ds_read_b64_tr_b16 v[50:51], v20 offset:33792
    v_mfma_f32_32x32x16_bf16 v[96:111], v[56:59], v[44:47], v[96:111]
    ds_read_b64_tr_b16 v[52:53], v21 offset:32768
    ds_read_b64_tr_b16 v[54:55], v21 offset:33792
    v_mfma_f32_32x32x16_bf16 v[112:127], v[60:63], v[44:47], v[112:127]
    s_waitcnt lgkmcnt(6)
    v_dot2_f32_bf16 v128, v196, s29, v128
    v_dot2_f32_bf16 v130, v196, v196, v130
    v_dot2_f32_bf16 v132, v208, s29, v132
    v_dot2_f32_bf16 v128, v197, s29, v128
    v_dot2_f32_bf16 v130, v197, v197, v130
    v_dot2_f32_bf16 v132, v209, s29, v132
    v_dot2_f32_bf16 v128, v198, s29, v128
    v_dot2_f32_bf16 v130, v198, v198, v130
    v_dot2_f32_bf16 v132, v210, s29, v132
    v_dot2_f32_bf16 v128, v199, s29, v128
    v_dot2_f32_bf16 v130, v199, v199, v130
    v_dot2_f32_bf16 v132, v211, s29, v132
    v_mfma_f32_32x32x16_bf16 v[64:79], v[204:207], v[196:199], v[64:79]
    ds_read_b128 v[40:43], v17 offset:32768
    ds_read_b128 v[44:47], v17 offset:36864
    v_mfma_f32_32x32x16_bf16 v[80:95], v[208:211], v[196:199], v[80:95]
    ds_read_b64_tr_b16 v[56:57], v20 offset:36864
    ds_read_b64_tr_b16 v[58:59], v20 offset:37888
    v_mfma_f32_32x32x16_bf16 v[96:111], v[204:207], v[200:203], v[96:111]
    ds_read_b64_tr_b16 v[60:61], v21 offset:36864
    ds_read_b64_tr_b16 v[62:63], v21 offset:37888
    v_mfma_f32_32x32x16_bf16 v[112:127], v[208:211], v[200:203], v[112:127]
    s_waitcnt lgkmcnt(6)
    v_dot2_f32_bf16 v128, v32, s29, v128
    v_dot2_f32_bf16 v130, v32, v32, v130
    v_dot2_f32_bf16 v132, v52, s29, v132
    v_dot2_f32_bf16 v128, v33, s29, v128
    v_dot2_f32_bf16 v130, v33, v33, v130
    v_dot2_f32_bf16 v132, v53, s29, v132
    v_dot2_f32_bf16 v128, v34, s29, v128
    v_dot2_f32_bf16 v130, v34, v34, v130
    v_dot2_f32_bf16 v132, v54, s29, v132
    v_dot2_f32_bf16 v128, v35, s29, v128
    v_dot2_f32_bf16 v130, v35, v35, v130
    v_dot2_f32_bf16 v132, v55, s29, v132
    v_mfma_f32_32x32x16_bf16 v[64:79], v[48:51], v[32:35], v[64:79]
    ds_read_b128 v[196:199], v18 offset:32768
    ds_read_b128 v[200:203], v18 offset:36864
    v_mfma_f32_32x32x16_bf16 v[80:95], v[52:55], v[32:35], v[80:95]
    ds_read_b64_tr_b16 v[204:205], v20 offset:40960
    ds_read_b64_tr_b16 v[206:207], v20 offset:41984
    v_mfma_f32_32x32x16_bf16 v[96:111], v[48:51], v[36:39], v[96:111]
    ds_read_b64_tr_b16 v[208:209], v21 offset:40960
    ds_read_b64_tr_b16 v[210:211], v21 offset:41984
    v_mfma_f32_32x32x16_bf16 v[112:127], v[52:55], v[36:39], v[112:127]
    s_waitcnt lgkmcnt(6)
    v_dot2_f32_bf16 v128, v40, s29, v128
    v_dot2_f32_bf16 v130, v40, v40, v130
    v_dot2_f32_bf16 v132, v60, s29, v132
    v_dot2_f32_bf16 v128, v41, s29, v128
    v_dot2_f32_bf16 v130, v41, v41, v130
    v_dot2_f32_bf16 v132, v61, s29, v132
    v_dot2_f32_bf16 v128, v42, s29, v128
    v_dot2_f32_bf16 v130, v42, v42, v130
    v_dot2_f32_bf16 v132, v62, s29, v132
    v_dot2_f32_bf16 v128, v43, s29, v128
    v_dot2_f32_bf16 v130, v43, v43, v130
    v_dot2_f32_bf16 v132, v63, s29, v132
    v_mfma_f32_32x32x16_bf16 v[64:79], v[56:59], v[40:43], v[64:79]
    ds_read_b128 v[32:35], v19 offset:32768
    ds_read_b128 v[36:39], v19 offset:36864
    v_mfma_f32_32x32x16_bf16 v[80:95], v[60:63], v[40:43], v[80:95]
    ds_read_b64_tr_b16 v[48:49], v20 offset:45056
    ds_read_b64_tr_b16 v[50:51], v20 offset:46080
    v_mfma_f32_32x32x16_bf16 v[96:111], v[56:59], v[44:47], v[96:111]
    ds_read_b64_tr_b16 v[52:53], v21 offset:45056
    ds_read_b64_tr_b16 v[54:55], v21 offset:46080
    v_mfma_f32_32x32x16_bf16 v[112:127], v[60:63], v[44:47], v[112:127]
    s_waitcnt lgkmcnt(6)
    v_dot2_f32_bf16 v128, v196, s29, v128
    v_dot2_f32_bf16 v130, v196, v196, v130
    v_dot2_f32_bf16 v132, v208, s29, v132
    v_dot2_f32_bf16 v128, v197, s29, v128
    v_dot2_f32_bf16 v130, v197, v197, v130
    v_dot2_f32_bf16 v132, v209, s29, v132
    v_dot2_f32_bf16 v128, v198, s29, v128
    v_dot2_f32_bf16 v130, v198, v198, v130
    v_dot2_f32_bf16 v132, v210, s29, v132
    v_dot2_f32_bf16 v128, v199, s29, v128
    v_dot2_f32_bf16 v130, v199, v199, v130
    v_dot2_f32_bf16 v132, v211, s29, v132
    v_mfma_f32_32x32x16_bf16 v[64:79], v[204:207], v[196:199], v[64:79]
    s_barrier
    ds_read_b128 v[40:43], v4 offset:0
    ds_read_b128 v[44:47], v4 offset:4096
    v_mfma_f32_32x32x16_bf16 v[80:95], v[208:211], v[196:199], v[80:95]
    ds_read_b64_tr_b16 v[56:57], v8 offset:0
    ds_read_b64_tr_b16 v[58:59], v8 offset:1024
    v_mfma_f32_32x32x16_bf16 v[96:111], v[204:207], v[200:203], v[96:111]
    ds_read_b64_tr_b16 v[60:61], v9 offset:0
    ds_read_b64_tr_b16 v[62:63], v9 offset:1024
    v_mfma_f32_32x32x16_bf16 v[112:127], v[208:211], v[200:203], v[112:127]
    s_waitcnt lgkmcnt(6)
    v_dot2_f32_bf16 v128, v32, s29, v128
    v_dot2_f32_bf16 v130, v32, v32, v130
    v_dot2_f32_bf16 v132, v52, s29, v132
    v_dot2_f32_bf16 v128, v33, s29, v128
    v_dot2_f32_bf16 v130, v33, v33, v130
    v_dot2_f32_bf16 v132, v53, s29, v132
    v_dot2_f32_bf16 v128, v34, s29, v128
    v_dot2_f32_bf16 v130, v34, v34, v130
    v_dot2_f32_bf16 v132, v54, s29, v132
    v_dot2_f32_bf16 v128, v35, s29, v128
    v_dot2_f32_bf16 v130, v35, v35, v130
    v_dot2_f32_bf16 v132, v55, s29, v132
    v_mfma_f32_32x32x16_bf16 v[64:79], v[48:51], v[32:35], v[64:79]
    ds_read_b128 v[196:199], v5 offset:0
    ds_read_b128 v[200:203], v5 offset:4096
    v_mfma_f32_32x32x16_bf16 v[80:95], v[52:55], v[32:35], v[80:95]
    ds_read_b64_tr_b16 v[204:205], v8 offset:4096
    ds_read_b64_tr_b16 v[206:207], v8 offset:5120
    v_mfma_f32_32x32x16_bf16 v[96:111], v[48:51], v[36:39], v[96:111]
    ds_read_b64_tr_b16 v[208:209], v9 offset:4096
    ds_read_b64_tr_b16 v[210:211], v9 offset:5120
    v_mfma_f32_32x32x16_bf16 v[112:127], v[52:55], v[36:39], v[112:127]
    s_waitcnt lgkmcnt(6)
    v_dot2_f32_bf16 v128, v40, s29, v128
    v_dot2_f32_bf16 v130, v40, v40, v130
    v_dot2_f32_bf16 v132, v60, s29, v132
    v_dot2_f32_bf16 v128, v41, s29, v128
    v_dot2_f32_bf16 v130, v41, v41, v130
    v_dot2_f32_bf16 v132, v61, s29, v132
    v_dot2_f32_bf16 v128, v42, s29, v128
    v_dot2_f32_bf16 v130, v42, v42, v130
    v_dot2_f32_bf16 v132, v62, s29, v132
    v_dot2_f32_bf16 v128, v43, s29, v128
    v_dot2_f32_bf16 v130, v43, v43, v130
    v_dot2_f32_bf16 v132, v63, s29, v132
    v_mfma_f32_32x32x16_bf16 v[64:79], v[56:59], v[40:43], v[64:79]
    ds_read_b128 v[32:35], v6 offset:0
    ds_read_b128 v[36:39], v6 offset:4096
    v_mfma_f32_32x32x16_bf16 v[80:95], v[60:63], v[40:43], v[80:95]
    ds_read_b64_tr_b16 v[48:49], v8 offset:8192
    ds_read_b64_tr_b16 v[50:51], v8 offset:9216
    v_mfma_f32_32x32x16_bf16 v[96:111], v[56:59], v[44:47], v[96:111]
    ds_read_b64_tr_b16 v[52:53], v9 offset:8192
    ds_read_b64_tr_b16 v[54:55], v9 offset:9216
    v_mfma_f32_32x32x16_bf16 v[112:127], v[60:63], v[44:47], v[112:127]
    s_waitcnt lgkmcnt(6)
    v_dot2_f32_bf16 v128, v196, s29, v128
    v_dot2_f32_bf16 v130, v196, v196, v130
    v_dot2_f32_bf16 v132, v208, s29, v132
    v_dot2_f32_bf16 v128, v197, s29, v128
    v_dot2_f32_bf16 v130, v197, v197, v130
    v_dot2_f32_bf16 v132, v209, s29, v132
    v_dot2_f32_bf16 v128, v198, s29, v128
    v_dot2_f32_bf16 v130, v198, v198, v130
    v_dot2_f32_bf16 v132, v210, s29, v132
    v_dot2_f32_bf16 v128, v199, s29, v128
    v_dot2_f32_bf16 v130, v199, v199, v130
    v_dot2_f32_bf16 v132, v211, s29, v132
    v_mfma_f32_32x32x16_bf16 v[64:79], v[204:207], v[196:199], v[64:79]
    ds_read_b128 v[40:43], v7 offset:0
    ds_read_b128 v[44:47], v7 offset:4096
    v_mfma_f32_32x32x16_bf16 v[80:95], v[208:211], v[196:199], v[80:95]
    ds_read_b64_tr_b16 v[56:57], v8 offset:12288
    ds_read_b64_tr_b16 v[58:59], v8 offset:13312
    v_mfma_f32_32x32x16_bf16 v[96:111], v[204:207], v[200:203], v[96:111]
    ds_read_b64_tr_b16 v[60:61], v9 offset:12288
    ds_read_b64_tr_b16 v[62:63], v9 offset:13312
    v_mfma_f32_32x32x16_bf16 v[112:127], v[208:211], v[200:203], v[112:127]
    s_waitcnt lgkmcnt(6)
    v_dot2_f32_bf16 v128, v32, s29, v128
    v_dot2_f32_bf16 v130, v32, v32, v130
    v_dot2_f32_bf16 v132, v52, s29, v132
    v_dot2_f32_bf16 v128, v33, s29, v128
    v_dot2_f32_bf16 v130, v33, v33, v130
    v_dot2_f32_bf16 v132, v53, s29, v132
    v_dot2_f32_bf16 v128, v34, s29, v128
    v_dot2_f32_bf16 v130, v34, v34, v130
    v_dot2_f32_bf16 v132, v54, s29, v132
    v_dot2_f32_bf16 v128, v35, s29, v128
    v_dot2_f32_bf16 v130, v35, v35, v130
    v_dot2_f32_bf16 v132, v55, s29, v132
    v_mfma_f32_32x32x16_bf16 v[64:79], v[48:51], v[32:35], v[64:79]
    v_mfma_f32_32x32x16_bf16 v[80:95], v[52:55], v[32:35], v[80:95]
    v_mfma_f32_32x32x16_bf16 v[96:111], v[48:51], v[36:39], v[96:111]
    v_mfma_f32_32x32x16_bf16 v[112:127], v[52:55], v[36:39], v[112:127]
    s_waitcnt lgkmcnt(0)
    v_dot2_f32_bf16 v128, v40, s29, v128
    v_dot2_f32_bf16 v130, v40, v40, v130
    v_dot2_f32_bf16 v132, v60, s29, v132
    v_dot2_f32_bf16 v128, v41, s29, v128
    v_dot2_f32_bf16 v130, v41, v41, v130
    v_dot2_f32_bf16 v132, v61, s29, v132
    v_dot2_f32_bf16 v128, v42, s29, v128
    v_dot2_f32_bf16 v130, v42, v42, v130
    v_dot2_f32_bf16 v132, v62, s29, v132
    v_dot2_f32_bf16 v128, v43, s29, v128
    v_dot2_f32_bf16 v130, v43, v43, v130
    v_dot2_f32_bf16 v132, v63, s29, v132
    v_mfma_f32_32x32x16_bf16 v[64:79], v[56:59], v[40:43], v[64:79]
    v_mfma_f32_32x32x16_bf16 v[80:95], v[60:63], v[40:43], v[80:95]
    v_mfma_f32_32x32x16_bf16 v[96:111], v[56:59], v[44:47], v[96:111]
    v_mfma_f32_32x32x16_bf16 v[112:127], v[60:63], v[44:47], v[112:127]
    s_branch qkv_a_kernel_qe
qkv_a_kernel_q3:
    v_mov_b32 v64, 0
    v_mov_b32 v65, 0
    v_mov_b32 v66, 0
    v_mov_b32 v67, 0
    v_mov_b32 v68, 0
    v_mov_b32 v69, 0
    v_mov_b32 v70, 0
    v_mov_b32 v71, 0
    v_mov_b32 v72, 0
    v_mov_b32 v73, 0
    v_mov_b32 v74, 0
    v_mov_b32 v75, 0
    v_mov_b32 v76, 0
    v_mov_b32 v77, 0
    v_mov_b32 v78, 0
    v_mov_b32 v79, 0
    v_mov_b32 v80, 0
    v_mov_b32 v81, 0
    v_mov_b32 v82, 0
    v_mov_b32 v83, 0
    v_mov_b32 v84, 0
    v_mov_b32 v85, 0
    v_mov_b32 v86, 0
    v_mov_b32 v87, 0
    v_mov_b32 v88, 0
    v_mov_b32 v89, 0
    v_mov_b32 v90, 0
    v_mov_b32 v91, 0
    v_mov_b32 v92, 0
    v_mov_b32 v93, 0
    v_mov_b32 v94, 0
    v_mov_b32 v95, 0
    v_mov_b32 v96, 0
    v_mov_b32 v97, 0
    v_mov_b32 v98, 0
    v_mov_b32 v99, 0
    v_mov_b32 v100, 0
    v_mov_b32 v101, 0
    v_mov_b32 v102, 0
    v_mov_b32 v103, 0
    v_mov_b32 v104, 0
    v_mov_b32 v105, 0
    v_mov_b32 v106, 0
    v_mov_b32 v107, 0
    v_mov_b32 v108, 0
    v_mov_b32 v109, 0
    v_mov_b32 v110, 0
    v_mov_b32 v111, 0
    v_mov_b32 v112, 0
    v_mov_b32 v113, 0
    v_mov_b32 v114, 0
    v_mov_b32 v115, 0
    v_mov_b32 v116, 0
    v_mov_b32 v117, 0
    v_mov_b32 v118, 0
    v_mov_b32 v119, 0
    v_mov_b32 v120, 0
    v_mov_b32 v121, 0
    v_mov_b32 v122, 0
    v_mov_b32 v123, 0
    v_mov_b32 v124, 0
    v_mov_b32 v125, 0
    v_mov_b32 v126, 0
    v_mov_b32 v127, 0
    v_mov_b32 v128, 0
    v_mov_b32 v129, 0
    v_mov_b32 v130, 0
    v_mov_b32 v131, 0
    v_mov_b32 v132, 0
    v_mov_b32 v133, 0
    s_barrier
    ds_read_b128 v[32:35], v16 offset:0
    ds_read_b128 v[36:39], v16 offset:4096
    ds_read_b64_tr_b16 v[48:49], v20 offset:0
    ds_read_b64_tr_b16 v[50:51], v20 offset:1024
    ds_read_b64_tr_b16 v[52:53], v21 offset:0
    ds_read_b64_tr_b16 v[54:55], v21 offset:1024
    ds_read_b128 v[40:43], v17 offset:0
    ds_read_b128 v[44:47], v17 offset:4096
    ds_read_b64_tr_b16 v[56:57], v20 offset:4096
    ds_read_b64_tr_b16 v[58:59], v20 offset:5120
    ds_read_b64_tr_b16 v[60:61], v21 offset:4096
    ds_read_b64_tr_b16 v[62:63], v21 offset:5120
    s_waitcnt lgkmcnt(6)
    v_dot2_f32_bf16 v128, v36, s29, v128
    v_dot2_f32_bf16 v130, v36, v36, v130
    v_dot2_f32_bf16 v132, v52, s29, v132
    v_dot2_f32_bf16 v128, v37, s29, v128
    v_dot2_f32_bf16 v130, v37, v37, v130
    v_dot2_f32_bf16 v132, v53, s29, v132
    v_dot2_f32_bf16 v128, v38, s29, v128
    v_dot2_f32_bf16 v130, v38, v38, v130
    v_dot2_f32_bf16 v132, v54, s29, v132
    v_dot2_f32_bf16 v128, v39, s29, v128
    v_dot2_f32_bf16 v130, v39, v39, v130
    v_dot2_f32_bf16 v132, v55, s29, v132
    v_mfma_f32_32x32x16_bf16 v[64:79], v[48:51], v[32:35], v[64:79]
    ds_read_b128 v[196:199], v18 offset:0
    ds_read_b128 v[200:203], v18 offset:4096
    v_mfma_f32_32x32x16_bf16 v[80:95], v[52:55], v[32:35], v[80:95]
    ds_read_b64_tr_b16 v[204:205], v20 offset:8192
    ds_read_b64_tr_b16 v[206:207], v20 offset:9216
    v_mfma_f32_32x32x16_bf16 v[96:111], v[48:51], v[36:39], v[96:111]
    ds_read_b64_tr_b16 v[208:209], v21 offset:8192
    ds_read_b64_tr_b16 v[210:211], v21 offset:9216
    v_mfma_f32_32x32x16_bf16 v[112:127], v[52:55], v[36:39], v[112:127]
    s_waitcnt lgkmcnt(6)
    v_dot2_f32_bf16 v128, v44, s29, v128
    v_dot2_f32_bf16 v130, v44, v44, v130
    v_dot2_f32_bf16 v132, v60, s29, v132
    v_dot2_f32_bf16 v128, v45, s29, v128
    v_dot2_f32_bf16 v130, v45, v45, v130
    v_dot2_f32_bf16 v132, v61, s29, v132
    v_dot2_f32_bf16 v128, v46, s29, v128
    v_dot2_f32_bf16 v130, v46, v46, v130
    v_dot2_f32_bf16 v132, v62, s29, v132
    v_dot2_f32_bf16 v128, v47, s29, v128
    v_dot2_f32_bf16 v130, v47, v47, v130
    v_dot2_f32_bf16 v132, v63, s29, v132
    v_mfma_f32_32x32x16_bf16 v[64:79], v[56:59], v[40:43], v[64:79]
    ds_read_b128 v[32:35], v19 offset:0
    ds_read_b128 v[36:39], v19 offset:4096
    v_mfma_f32_32x32x16_bf16 v[80:95], v[60:63], v[40:43], v[80:95]
    ds_read_b64_tr_b16 v[48:49], v20 offset:12288
    ds_read_b64_tr_b16 v[50:51], v20 offset:13312
    v_mfma_f32_32x32x16_bf16 v[96:111], v[56:59], v[44:47], v[96:111]
    ds_read_b64_tr_b16 v[52:53], v21 offset:12288
    ds_read_b64_tr_b16 v[54:55], v21 offset:13312
    v_mfma_f32_32x32x16_bf16 v[112:127], v[60:63], v[44:47], v[112:127]
    s_waitcnt lgkmcnt(6)
    v_dot2_f32_bf16 v128, v200, s29, v128
    v_dot2_f32_bf16 v130, v200, v200, v130
    v_dot2_f32_bf16 v132, v208, s29, v132
    v_dot2_f32_bf16 v128, v201, s29, v128
    v_dot2_f32_bf16 v130, v201, v201, v130
    v_dot2_f32_bf16 v132, v209, s29, v132
    v_dot2_f32_bf16 v128, v202, s29, v128
    v_dot2_f32_bf16 v130, v202, v202, v130
    v_dot2_f32_bf16 v132, v210, s29, v132
    v_dot2_f32_bf16 v128, v203, s29, v128
    v_dot2_f32_bf16 v130, v203, v203, v130
    v_dot2_f32_bf16 v132, v211, s29, v132
    v_mfma_f32_32x32x16_bf16 v[64:79], v[204:207], v[196:199], v[64:79]
    s_barrier
    ds_read_b128 v[40:43], v16 offset:32768
    ds_read_b128 v[44:47], v16 offset:36864
    v_mfma_f32_32x32x16_bf16 v[80:95], v[208:211], v[196:199], v[80:95]
    ds_read_b64_tr_b16 v[56:57], v20 offset:32768
    ds_read_b64_tr_b16 v[58:59], v20 offset:33792
    v_mfma_f32_32x32x16_bf16 v[96:111], v[204:207], v[200:203], v[96:111]
    ds_read_b64_tr_b16 v[60:61], v21 offset:32768
    ds_read_b64_tr_b16 v[62:63], v21 offset:33792
    v_mfma_f32_32x32x16_bf16 v[112:127], v[208:211], v[200:203], v[112:127]
    s_waitcnt lgkmcnt(6)
    v_dot2_f32_bf16 v128, v36, s29, v128
    v_dot2_f32_bf16 v130, v36, v36, v130
    v_dot2_f32_bf16 v132, v52, s29, v132
    v_dot2_f32_bf16 v128, v37, s29, v128
    v_dot2_f32_bf16 v130, v37, v37, v130
    v_dot2_f32_bf16 v132, v53, s29, v132
    v_dot2_f32_bf16 v128, v38, s29, v128
    v_dot2_f32_bf16 v130, v38, v38, v130
    v_dot2_f32_bf16 v132, v54, s29, v132
    v_dot2_f32_bf16 v128, v39, s29, v128
    v_dot2_f32_bf16 v130, v39, v39, v130
    v_dot2_f32_bf16 v132, v55, s29, v132
    v_mfma_f32_32x32x16_bf16 v[64:79], v[48:51], v[32:35], v[64:79]
    ds_read_b128 v[196:199], v17 offset:32768
    ds_read_b128 v[200:203], v17 offset:36864
    v_mfma_f32_32x32x16_bf16 v[80:95], v[52:55], v[32:35], v[80:95]
    ds_read_b64_tr_b16 v[204:205], v20 offset:36864
    ds_read_b64_tr_b16 v[206:207], v20 offset:37888
    v_mfma_f32_32x32x16_bf16 v[96:111], v[48:51], v[36:39], v[96:111]
    ds_read_b64_tr_b16 v[208:209], v21 offset:36864
    ds_read_b64_tr_b16 v[210:211], v21 offset:37888
    v_mfma_f32_32x32x16_bf16 v[112:127], v[52:55], v[36:39], v[112:127]
    s_waitcnt lgkmcnt(6)
    v_dot2_f32_bf16 v128, v44, s29, v128
    v_dot2_f32_bf16 v130, v44, v44, v130
    v_dot2_f32_bf16 v132, v60, s29, v132
    v_dot2_f32_bf16 v128, v45, s29, v128
    v_dot2_f32_bf16 v130, v45, v45, v130
    v_dot2_f32_bf16 v132, v61, s29, v132
    v_dot2_f32_bf16 v128, v46, s29, v128
    v_dot2_f32_bf16 v130, v46, v46, v130
    v_dot2_f32_bf16 v132, v62, s29, v132
    v_dot2_f32_bf16 v128, v47, s29, v128
    v_dot2_f32_bf16 v130, v47, v47, v130
    v_dot2_f32_bf16 v132, v63, s29, v132
    v_mfma_f32_32x32x16_bf16 v[64:79], v[56:59], v[40:43], v[64:79]
    ds_read_b128 v[32:35], v18 offset:32768
    ds_read_b128 v[36:39], v18 offset:36864
    v_mfma_f32_32x32x16_bf16 v[80:95], v[60:63], v[40:43], v[80:95]
    ds_read_b64_tr_b16 v[48:49], v20 offset:40960
    ds_read_b64_tr_b16 v[50:51], v20 offset:41984
    v_mfma_f32_32x32x16_bf16 v[96:111], v[56:59], v[44:47], v[96:111]
    ds_read_b64_tr_b16 v[52:53], v21 offset:40960
    ds_read_b64_tr_b16 v[54:55], v21 offset:41984
    v_mfma_f32_32x32x16_bf16 v[112:127], v[60:63], v[44:47], v[112:127]
    s_waitcnt lgkmcnt(6)
    v_dot2_f32_bf16 v128, v200, s29, v128
    v_dot2_f32_bf16 v130, v200, v200, v130
    v_dot2_f32_bf16 v132, v208, s29, v132
    v_dot2_f32_bf16 v128, v201, s29, v128
    v_dot2_f32_bf16 v130, v201, v201, v130
    v_dot2_f32_bf16 v132, v209, s29, v132
    v_dot2_f32_bf16 v128, v202, s29, v128
    v_dot2_f32_bf16 v130, v202, v202, v130
    v_dot2_f32_bf16 v132, v210, s29, v132
    v_dot2_f32_bf16 v128, v203, s29, v128
    v_dot2_f32_bf16 v130, v203, v203, v130
    v_dot2_f32_bf16 v132, v211, s29, v132
    v_mfma_f32_32x32x16_bf16 v[64:79], v[204:207], v[196:199], v[64:79]
    ds_read_b128 v[40:43], v19 offset:32768
    ds_read_b128 v[44:47], v19 offset:36864
    v_mfma_f32_32x32x16_bf16 v[80:95], v[208:211], v[196:199], v[80:95]
    ds_read_b64_tr_b16 v[56:57], v20 offset:45056
    ds_read_b64_tr_b16 v[58:59], v20 offset:46080
    v_mfma_f32_32x32x16_bf16 v[96:111], v[204:207], v[200:203], v[96:111]
    ds_read_b64_tr_b16 v[60:61], v21 offset:45056
    ds_read_b64_tr_b16 v[62:63], v21 offset:46080
    v_mfma_f32_32x32x16_bf16 v[112:127], v[208:211], v[200:203], v[112:127]
    s_waitcnt lgkmcnt(6)
    v_dot2_f32_bf16 v128, v36, s29, v128
    v_dot2_f32_bf16 v130, v36, v36, v130
    v_dot2_f32_bf16 v132, v52, s29, v132
    v_dot2_f32_bf16 v128, v37, s29, v128
    v_dot2_f32_bf16 v130, v37, v37, v130
    v_dot2_f32_bf16 v132, v53, s29, v132
    v_dot2_f32_bf16 v128, v38, s29, v128
    v_dot2_f32_bf16 v130, v38, v38, v130
    v_dot2_f32_bf16 v132, v54, s29, v132
    v_dot2_f32_bf16 v128, v39, s29, v128
    v_dot2_f32_bf16 v130, v39, v39, v130
    v_dot2_f32_bf16 v132, v55, s29, v132
    v_mfma_f32_32x32x16_bf16 v[64:79], v[48:51], v[32:35], v[64:79]
    s_barrier
    ds_read_b128 v[196:199], v4 offset:0
    ds_read_b128 v[200:203], v4 offset:4096
    v_mfma_f32_32x32x16_bf16 v[80:95], v[52:55], v[32:35], v[80:95]
    ds_read_b64_tr_b16 v[204:205], v8 offset:0
    ds_read_b64_tr_b16 v[206:207], v8 offset:1024
    v_mfma_f32_32x32x16_bf16 v[96:111], v[48:51], v[36:39], v[96:111]
    ds_read_b64_tr_b16 v[208:209], v9 offset:0
    ds_read_b64_tr_b16 v[210:211], v9 offset:1024
    v_mfma_f32_32x32x16_bf16 v[112:127], v[52:55], v[36:39], v[112:127]
    s_waitcnt lgkmcnt(6)
    v_dot2_f32_bf16 v128, v44, s29, v128
    v_dot2_f32_bf16 v130, v44, v44, v130
    v_dot2_f32_bf16 v132, v60, s29, v132
    v_dot2_f32_bf16 v128, v45, s29, v128
    v_dot2_f32_bf16 v130, v45, v45, v130
    v_dot2_f32_bf16 v132, v61, s29, v132
    v_dot2_f32_bf16 v128, v46, s29, v128
    v_dot2_f32_bf16 v130, v46, v46, v130
    v_dot2_f32_bf16 v132, v62, s29, v132
    v_dot2_f32_bf16 v128, v47, s29, v128
    v_dot2_f32_bf16 v130, v47, v47, v130
    v_dot2_f32_bf16 v132, v63, s29, v132
    v_mfma_f32_32x32x16_bf16 v[64:79], v[56:59], v[40:43], v[64:79]
    ds_read_b128 v[32:35], v5 offset:0
    ds_read_b128 v[36:39], v5 offset:4096
    v_mfma_f32_32x32x16_bf16 v[80:95], v[60:63], v[40:43], v[80:95]
    ds_read_b64_tr_b16 v[48:49], v8 offset:4096
    ds_read_b64_tr_b16 v[50:51], v8 offset:5120
    v_mfma_f32_32x32x16_bf16 v[96:111], v[56:59], v[44:47], v[96:111]
    ds_read_b64_tr_b16 v[52:53], v9 offset:4096
    ds_read_b64_tr_b16 v[54:55], v9 offset:5120
    v_mfma_f32_32x32x16_bf16 v[112:127], v[60:63], v[44:47], v[112:127]
    s_waitcnt lgkmcnt(6)
    v_dot2_f32_bf16 v128, v200, s29, v128
    v_dot2_f32_bf16 v130, v200, v200, v130
    v_dot2_f32_bf16 v132, v208, s29, v132
    v_dot2_f32_bf16 v128, v201, s29, v128
    v_dot2_f32_bf16 v130, v201, v201, v130
    v_dot2_f32_bf16 v132, v209, s29, v132
    v_dot2_f32_bf16 v128, v202, s29, v128
    v_dot2_f32_bf16 v130, v202, v202, v130
    v_dot2_f32_bf16 v132, v210, s29, v132
    v_dot2_f32_bf16 v128, v203, s29, v128
    v_dot2_f32_bf16 v130, v203, v203, v130
    v_dot2_f32_bf16 v132, v211, s29, v132
    v_mfma_f32_32x32x16_bf16 v[64:79], v[204:207], v[196:199], v[64:79]
    ds_read_b128 v[40:43], v6 offset:0
    ds_read_b128 v[44:47], v6 offset:4096
    v_mfma_f32_32x32x16_bf16 v[80:95], v[208:211], v[196:199], v[80:95]
    ds_read_b64_tr_b16 v[56:57], v8 offset:8192
    ds_read_b64_tr_b16 v[58:59], v8 offset:9216
    v_mfma_f32_32x32x16_bf16 v[96:111], v[204:207], v[200:203], v[96:111]
    ds_read_b64_tr_b16 v[60:61], v9 offset:8192
    ds_read_b64_tr_b16 v[62:63], v9 offset:9216
    v_mfma_f32_32x32x16_bf16 v[112:127], v[208:211], v[200:203], v[112:127]
    s_waitcnt lgkmcnt(6)
    v_dot2_f32_bf16 v128, v36, s29, v128
    v_dot2_f32_bf16 v130, v36, v36, v130
    v_dot2_f32_bf16 v132, v52, s29, v132
    v_dot2_f32_bf16 v128, v37, s29, v128
    v_dot2_f32_bf16 v130, v37, v37, v130
    v_dot2_f32_bf16 v132, v53, s29, v132
    v_dot2_f32_bf16 v128, v38, s29, v128
    v_dot2_f32_bf16 v130, v38, v38, v130
    v_dot2_f32_bf16 v132, v54, s29, v132
    v_dot2_f32_bf16 v128, v39, s29, v128
    v_dot2_f32_bf16 v130, v39, v39, v130
    v_dot2_f32_bf16 v132, v55, s29, v132
    v_mfma_f32_32x32x16_bf16 v[64:79], v[48:51], v[32:35], v[64:79]
    ds_read_b128 v[196:199], v7 offset:0
    ds_read_b128 v[200:203], v7 offset:4096
    v_mfma_f32_32x32x16_bf16 v[80:95], v[52:55], v[32:35], v[80:95]
    ds_read_b64_tr_b16 v[204:205], v8 offset:12288
    ds_read_b64_tr_b16 v[206:207], v8 offset:13312
    v_mfma_f32_32x32x16_bf16 v[96:111], v[48:51], v[36:39], v[96:111]
    ds_read_b64_tr_b16 v[208:209], v9 offset:12288
    ds_read_b64_tr_b16 v[210:211], v9 offset:13312
    v_mfma_f32_32x32x16_bf16 v[112:127], v[52:55], v[36:39], v[112:127]
    s_waitcnt lgkmcnt(6)
    v_dot2_f32_bf16 v128, v44, s29, v128
    v_dot2_f32_bf16 v130, v44, v44, v130
    v_dot2_f32_bf16 v132, v60, s29, v132
    v_dot2_f32_bf16 v128, v45, s29, v128
    v_dot2_f32_bf16 v130, v45, v45, v130
    v_dot2_f32_bf16 v132, v61, s29, v132
    v_dot2_f32_bf16 v128, v46, s29, v128
    v_dot2_f32_bf16 v130, v46, v46, v130
    v_dot2_f32_bf16 v132, v62, s29, v132
    v_dot2_f32_bf16 v128, v47, s29, v128
    v_dot2_f32_bf16 v130, v47, v47, v130
    v_dot2_f32_bf16 v132, v63, s29, v132
    v_mfma_f32_32x32x16_bf16 v[64:79], v[56:59], v[40:43], v[64:79]
    s_barrier
    ds_read_b128 v[32:35], v4 offset:32768
    ds_read_b128 v[36:39], v4 offset:36864
    v_mfma_f32_32x32x16_bf16 v[80:95], v[60:63], v[40:43], v[80:95]
    ds_read_b64_tr_b16 v[48:49], v8 offset:32768
    ds_read_b64_tr_b16 v[50:51], v8 offset:33792
    v_mfma_f32_32x32x16_bf16 v[96:111], v[56:59], v[44:47], v[96:111]
    ds_read_b64_tr_b16 v[52:53], v9 offset:32768
    ds_read_b64_tr_b16 v[54:55], v9 offset:33792
    v_mfma_f32_32x32x16_bf16 v[112:127], v[60:63], v[44:47], v[112:127]
    s_waitcnt lgkmcnt(6)
    v_dot2_f32_bf16 v128, v200, s29, v128
    v_dot2_f32_bf16 v130, v200, v200, v130
    v_dot2_f32_bf16 v132, v208, s29, v132
    v_dot2_f32_bf16 v128, v201, s29, v128
    v_dot2_f32_bf16 v130, v201, v201, v130
    v_dot2_f32_bf16 v132, v209, s29, v132
    v_dot2_f32_bf16 v128, v202, s29, v128
    v_dot2_f32_bf16 v130, v202, v202, v130
    v_dot2_f32_bf16 v132, v210, s29, v132
    v_dot2_f32_bf16 v128, v203, s29, v128
    v_dot2_f32_bf16 v130, v203, v203, v130
    v_dot2_f32_bf16 v132, v211, s29, v132
    v_mfma_f32_32x32x16_bf16 v[64:79], v[204:207], v[196:199], v[64:79]
    ds_read_b128 v[40:43], v5 offset:32768
    ds_read_b128 v[44:47], v5 offset:36864
    v_mfma_f32_32x32x16_bf16 v[80:95], v[208:211], v[196:199], v[80:95]
    ds_read_b64_tr_b16 v[56:57], v8 offset:36864
    ds_read_b64_tr_b16 v[58:59], v8 offset:37888
    v_mfma_f32_32x32x16_bf16 v[96:111], v[204:207], v[200:203], v[96:111]
    ds_read_b64_tr_b16 v[60:61], v9 offset:36864
    ds_read_b64_tr_b16 v[62:63], v9 offset:37888
    v_mfma_f32_32x32x16_bf16 v[112:127], v[208:211], v[200:203], v[112:127]
    s_waitcnt lgkmcnt(6)
    v_dot2_f32_bf16 v128, v36, s29, v128
    v_dot2_f32_bf16 v130, v36, v36, v130
    v_dot2_f32_bf16 v132, v52, s29, v132
    v_dot2_f32_bf16 v128, v37, s29, v128
    v_dot2_f32_bf16 v130, v37, v37, v130
    v_dot2_f32_bf16 v132, v53, s29, v132
    v_dot2_f32_bf16 v128, v38, s29, v128
    v_dot2_f32_bf16 v130, v38, v38, v130
    v_dot2_f32_bf16 v132, v54, s29, v132
    v_dot2_f32_bf16 v128, v39, s29, v128
    v_dot2_f32_bf16 v130, v39, v39, v130
    v_dot2_f32_bf16 v132, v55, s29, v132
    v_mfma_f32_32x32x16_bf16 v[64:79], v[48:51], v[32:35], v[64:79]
    ds_read_b128 v[196:199], v6 offset:32768
    ds_read_b128 v[200:203], v6 offset:36864
    v_mfma_f32_32x32x16_bf16 v[80:95], v[52:55], v[32:35], v[80:95]
    ds_read_b64_tr_b16 v[204:205], v8 offset:40960
    ds_read_b64_tr_b16 v[206:207], v8 offset:41984
    v_mfma_f32_32x32x16_bf16 v[96:111], v[48:51], v[36:39], v[96:111]
    ds_read_b64_tr_b16 v[208:209], v9 offset:40960
    ds_read_b64_tr_b16 v[210:211], v9 offset:41984
    v_mfma_f32_32x32x16_bf16 v[112:127], v[52:55], v[36:39], v[112:127]
    s_waitcnt lgkmcnt(6)
    v_dot2_f32_bf16 v128, v44, s29, v128
    v_dot2_f32_bf16 v130, v44, v44, v130
    v_dot2_f32_bf16 v132, v60, s29, v132
    v_dot2_f32_bf16 v128, v45, s29, v128
    v_dot2_f32_bf16 v130, v45, v45, v130
    v_dot2_f32_bf16 v132, v61, s29, v132
    v_dot2_f32_bf16 v128, v46, s29, v128
    v_dot2_f32_bf16 v130, v46, v46, v130
    v_dot2_f32_bf16 v132, v62, s29, v132
    v_dot2_f32_bf16 v128, v47, s29, v128
    v_dot2_f32_bf16 v130, v47, v47, v130
    v_dot2_f32_bf16 v132, v63, s29, v132
    v_mfma_f32_32x32x16_bf16 v[64:79], v[56:59], v[40:43], v[64:79]
    ds_read_b128 v[32:35], v7 offset:32768
    ds_read_b128 v[36:39], v7 offset:36864
    v_mfma_f32_32x32x16_bf16 v[80:95], v[60:63], v[40:43], v[80:95]
    ds_read_b64_tr_b16 v[48:49], v8 offset:45056
    ds_read_b64_tr_b16 v[50:51], v8 offset:46080
    v_mfma_f32_32x32x16_bf16 v[96:111], v[56:59], v[44:47], v[96:111]
    ds_read_b64_tr_b16 v[52:53], v9 offset:45056
    ds_read_b64_tr_b16 v[54:55], v9 offset:46080
    v_mfma_f32_32x32x16_bf16 v[112:127], v[60:63], v[44:47], v[112:127]
    s_waitcnt lgkmcnt(6)
    v_dot2_f32_bf16 v128, v200, s29, v128
    v_dot2_f32_bf16 v130, v200, v200, v130
    v_dot2_f32_bf16 v132, v208, s29, v132
    v_dot2_f32_bf16 v128, v201, s29, v128
    v_dot2_f32_bf16 v130, v201, v201, v130
    v_dot2_f32_bf16 v132, v209, s29, v132
    v_dot2_f32_bf16 v128, v202, s29, v128
    v_dot2_f32_bf16 v130, v202, v202, v130
    v_dot2_f32_bf16 v132, v210, s29, v132
    v_dot2_f32_bf16 v128, v203, s29, v128
    v_dot2_f32_bf16 v130, v203, v203, v130
    v_dot2_f32_bf16 v132, v211, s29, v132
    v_mfma_f32_32x32x16_bf16 v[64:79], v[204:207], v[196:199], v[64:79]
    s_barrier
    ds_read_b128 v[40:43], v10 offset:0
    ds_read_b128 v[44:47], v10 offset:4096
    v_mfma_f32_32x32x16_bf16 v[80:95], v[208:211], v[196:199], v[80:95]
    ds_read_b64_tr_b16 v[56:57], v14 offset:0
    ds_read_b64_tr_b16 v[58:59], v14 offset:1024
    v_mfma_f32_32x32x16_bf16 v[96:111], v[204:207], v[200:203], v[96:111]
    ds_read_b64_tr_b16 v[60:61], v15 offset:0
    ds_read_b64_tr_b16 v[62:63], v15 offset:1024
    v_mfma_f32_32x32x16_bf16 v[112:127], v[208:211], v[200:203], v[112:127]
    s_waitcnt lgkmcnt(6)
    v_dot2_f32_bf16 v128, v36, s29, v128
    v_dot2_f32_bf16 v130, v36, v36, v130
    v_dot2_f32_bf16 v132, v52, s29, v132
    v_dot2_f32_bf16 v128, v37, s29, v128
    v_dot2_f32_bf16 v130, v37, v37, v130
    v_dot2_f32_bf16 v132, v53, s29, v132
    v_dot2_f32_bf16 v128, v38, s29, v128
    v_dot2_f32_bf16 v130, v38, v38, v130
    v_dot2_f32_bf16 v132, v54, s29, v132
    v_dot2_f32_bf16 v128, v39, s29, v128
    v_dot2_f32_bf16 v130, v39, v39, v130
    v_dot2_f32_bf16 v132, v55, s29, v132
    v_mfma_f32_32x32x16_bf16 v[64:79], v[48:51], v[32:35], v[64:79]
    ds_read_b128 v[196:199], v11 offset:0
    ds_read_b128 v[200:203], v11 offset:4096
    v_mfma_f32_32x32x16_bf16 v[80:95], v[52:55], v[32:35], v[80:95]
    ds_read_b64_tr_b16 v[204:205], v14 offset:4096
    ds_read_b64_tr_b16 v[206:207], v14 offset:5120
    v_mfma_f32_32x32x16_bf16 v[96:111], v[48:51], v[36:39], v[96:111]
    ds_read_b64_tr_b16 v[208:209], v15 offset:4096
    ds_read_b64_tr_b16 v[210:211], v15 offset:5120
    v_mfma_f32_32x32x16_bf16 v[112:127], v[52:55], v[36:39], v[112:127]
    s_waitcnt lgkmcnt(6)
    v_dot2_f32_bf16 v128, v44, s29, v128
    v_dot2_f32_bf16 v130, v44, v44, v130
    v_dot2_f32_bf16 v132, v60, s29, v132
    v_dot2_f32_bf16 v128, v45, s29, v128
    v_dot2_f32_bf16 v130, v45, v45, v130
    v_dot2_f32_bf16 v132, v61, s29, v132
    v_dot2_f32_bf16 v128, v46, s29, v128
    v_dot2_f32_bf16 v130, v46, v46, v130
    v_dot2_f32_bf16 v132, v62, s29, v132
    v_dot2_f32_bf16 v128, v47, s29, v128
    v_dot2_f32_bf16 v130, v47, v47, v130
    v_dot2_f32_bf16 v132, v63, s29, v132
    v_mfma_f32_32x32x16_bf16 v[64:79], v[56:59], v[40:43], v[64:79]
    ds_read_b128 v[32:35], v12 offset:0
    ds_read_b128 v[36:39], v12 offset:4096
    v_mfma_f32_32x32x16_bf16 v[80:95], v[60:63], v[40:43], v[80:95]
    ds_read_b64_tr_b16 v[48:49], v14 offset:8192
    ds_read_b64_tr_b16 v[50:51], v14 offset:9216
    v_mfma_f32_32x32x16_bf16 v[96:111], v[56:59], v[44:47], v[96:111]
    ds_read_b64_tr_b16 v[52:53], v15 offset:8192
    ds_read_b64_tr_b16 v[54:55], v15 offset:9216
    v_mfma_f32_32x32x16_bf16 v[112:127], v[60:63], v[44:47], v[112:127]
    s_waitcnt lgkmcnt(6)
    v_dot2_f32_bf16 v128, v200, s29, v128
    v_dot2_f32_bf16 v130, v200, v200, v130
    v_dot2_f32_bf16 v132, v208, s29, v132
    v_dot2_f32_bf16 v128, v201, s29, v128
    v_dot2_f32_bf16 v130, v201, v201, v130
    v_dot2_f32_bf16 v132, v209, s29, v132
    v_dot2_f32_bf16 v128, v202, s29, v128
    v_dot2_f32_bf16 v130, v202, v202, v130
    v_dot2_f32_bf16 v132, v210, s29, v132
    v_dot2_f32_bf16 v128, v203, s29, v128
    v_dot2_f32_bf16 v130, v203, v203, v130
    v_dot2_f32_bf16 v132, v211, s29, v132
    v_mfma_f32_32x32x16_bf16 v[64:79], v[204:207], v[196:199], v[64:79]
    ds_read_b128 v[40:43], v13 offset:0
    ds_read_b128 v[44:47], v13 offset:4096
    v_mfma_f32_32x32x16_bf16 v[80:95], v[208:211], v[196:199], v[80:95]
    ds_read_b64_tr_b16 v[56:57], v14 offset:12288
    ds_read_b64_tr_b16 v[58:59], v14 offset:13312
    v_mfma_f32_32x32x16_bf16 v[96:111], v[204:207], v[200:203], v[96:111]
    ds_read_b64_tr_b16 v[60:61], v15 offset:12288
    ds_read_b64_tr_b16 v[62:63], v15 offset:13312
    v_mfma_f32_32x32x16_bf16 v[112:127], v[208:211], v[200:203], v[112:127]
    s_waitcnt lgkmcnt(6)
    v_dot2_f32_bf16 v128, v36, s29, v128
    v_dot2_f32_bf16 v130, v36, v36, v130
    v_dot2_f32_bf16 v132, v52, s29, v132
    v_dot2_f32_bf16 v128, v37, s29, v128
    v_dot2_f32_bf16 v130, v37, v37, v130
    v_dot2_f32_bf16 v132, v53, s29, v132
    v_dot2_f32_bf16 v128, v38, s29, v128
    v_dot2_f32_bf16 v130, v38, v38, v130
    v_dot2_f32_bf16 v132, v54, s29, v132
    v_dot2_f32_bf16 v128, v39, s29, v128
    v_dot2_f32_bf16 v130, v39, v39, v130
    v_dot2_f32_bf16 v132, v55, s29, v132
    v_mfma_f32_32x32x16_bf16 v[64:79], v[48:51], v[32:35], v[64:79]
    s_barrier
    ds_read_b128 v[196:199], v16 offset:0
    ds_read_b128 v[200:203], v16 offset:4096
    v_mfma_f32_32x32x16_bf16 v[80:95], v[52:55], v[32:35], v[80:95]
    ds_read_b64_tr_b16 v[204:205], v20 offset:0
    ds_read_b64_tr_b16 v[206:207], v20 offset:1024
    v_mfma_f32_32x32x16_bf16 v[96:111], v[48:51], v[36:39], v[96:111]
    ds_read_b64_tr_b16 v[208:209], v21 offset:0
    ds_read_b64_tr_b16 v[210:211], v21 offset:1024
    v_mfma_f32_32x32x16_bf16 v[112:127], v[52:55], v[36:39], v[112:127]
    s_waitcnt lgkmcnt(6)
    v_dot2_f32_bf16 v128, v44, s29, v128
    v_dot2_f32_bf16 v130, v44, v44, v130
    v_dot2_f32_bf16 v132, v60, s29, v132
    v_dot2_f32_bf16 v128, v45, s29, v128
    v_dot2_f32_bf16 v130, v45, v45, v130
    v_dot2_f32_bf16 v132, v61, s29, v132
    v_dot2_f32_bf16 v128, v46, s29, v128
    v_dot2_f32_bf16 v130, v46, v46, v130
    v_dot2_f32_bf16 v132, v62, s29, v132
    v_dot2_f32_bf16 v128, v47, s29, v128
    v_dot2_f32_bf16 v130, v47, v47, v130
    v_dot2_f32_bf16 v132, v63, s29, v132
    v_mfma_f32_32x32x16_bf16 v[64:79], v[56:59], v[40:43], v[64:79]
    ds_read_b128 v[32:35], v17 offset:0
    ds_read_b128 v[36:39], v17 offset:4096
    v_mfma_f32_32x32x16_bf16 v[80:95], v[60:63], v[40:43], v[80:95]
    ds_read_b64_tr_b16 v[48:49], v20 offset:4096
    ds_read_b64_tr_b16 v[50:51], v20 offset:5120
    v_mfma_f32_32x32x16_bf16 v[96:111], v[56:59], v[44:47], v[96:111]
    ds_read_b64_tr_b16 v[52:53], v21 offset:4096
    ds_read_b64_tr_b16 v[54:55], v21 offset:5120
    v_mfma_f32_32x32x16_bf16 v[112:127], v[60:63], v[44:47], v[112:127]
    s_waitcnt lgkmcnt(6)
    v_dot2_f32_bf16 v128, v200, s29, v128
    v_dot2_f32_bf16 v130, v200, v200, v130
    v_dot2_f32_bf16 v132, v208, s29, v132
    v_dot2_f32_bf16 v128, v201, s29, v128
    v_dot2_f32_bf16 v130, v201, v201, v130
    v_dot2_f32_bf16 v132, v209, s29, v132
    v_dot2_f32_bf16 v128, v202, s29, v128
    v_dot2_f32_bf16 v130, v202, v202, v130
    v_dot2_f32_bf16 v132, v210, s29, v132
    v_dot2_f32_bf16 v128, v203, s29, v128
    v_dot2_f32_bf16 v130, v203, v203, v130
    v_dot2_f32_bf16 v132, v211, s29, v132
    v_mfma_f32_32x32x16_bf16 v[64:79], v[204:207], v[196:199], v[64:79]
    ds_read_b128 v[40:43], v18 offset:0
    ds_read_b128 v[44:47], v18 offset:4096
    v_mfma_f32_32x32x16_bf16 v[80:95], v[208:211], v[196:199], v[80:95]
    ds_read_b64_tr_b16 v[56:57], v20 offset:8192
    ds_read_b64_tr_b16 v[58:59], v20 offset:9216
    v_mfma_f32_32x32x16_bf16 v[96:111], v[204:207], v[200:203], v[96:111]
    ds_read_b64_tr_b16 v[60:61], v21 offset:8192
    ds_read_b64_tr_b16 v[62:63], v21 offset:9216
    v_mfma_f32_32x32x16_bf16 v[112:127], v[208:211], v[200:203], v[112:127]
    s_waitcnt lgkmcnt(6)
    v_dot2_f32_bf16 v128, v36, s29, v128
    v_dot2_f32_bf16 v130, v36, v36, v130
    v_dot2_f32_bf16 v132, v52, s29, v132
    v_dot2_f32_bf16 v128, v37, s29, v128
    v_dot2_f32_bf16 v130, v37, v37, v130
    v_dot2_f32_bf16 v132, v53, s29, v132
    v_dot2_f32_bf16 v128, v38, s29, v128
    v_dot2_f32_bf16 v130, v38, v38, v130
    v_dot2_f32_bf16 v132, v54, s29, v132
    v_dot2_f32_bf16 v128, v39, s29, v128
    v_dot2_f32_bf16 v130, v39, v39, v130
    v_dot2_f32_bf16 v132, v55, s29, v132
    v_mfma_f32_32x32x16_bf16 v[64:79], v[48:51], v[32:35], v[64:79]
    ds_read_b128 v[196:199], v19 offset:0
    ds_read_b128 v[200:203], v19 offset:4096
    v_mfma_f32_32x32x16_bf16 v[80:95], v[52:55], v[32:35], v[80:95]
    ds_read_b64_tr_b16 v[204:205], v20 offset:12288
    ds_read_b64_tr_b16 v[206:207], v20 offset:13312
    v_mfma_f32_32x32x16_bf16 v[96:111], v[48:51], v[36:39], v[96:111]
    ds_read_b64_tr_b16 v[208:209], v21 offset:12288
    ds_read_b64_tr_b16 v[210:211], v21 offset:13312
    v_mfma_f32_32x32x16_bf16 v[112:127], v[52:55], v[36:39], v[112:127]
    s_waitcnt lgkmcnt(6)
    v_dot2_f32_bf16 v128, v44, s29, v128
    v_dot2_f32_bf16 v130, v44, v44, v130
    v_dot2_f32_bf16 v132, v60, s29, v132
    v_dot2_f32_bf16 v128, v45, s29, v128
    v_dot2_f32_bf16 v130, v45, v45, v130
    v_dot2_f32_bf16 v132, v61, s29, v132
    v_dot2_f32_bf16 v128, v46, s29, v128
    v_dot2_f32_bf16 v130, v46, v46, v130
    v_dot2_f32_bf16 v132, v62, s29, v132
    v_dot2_f32_bf16 v128, v47, s29, v128
    v_dot2_f32_bf16 v130, v47, v47, v130
    v_dot2_f32_bf16 v132, v63, s29, v132
    v_mfma_f32_32x32x16_bf16 v[64:79], v[56:59], v[40:43], v[64:79]
    s_barrier
    ds_read_b128 v[32:35], v16 offset:32768
    ds_read_b128 v[36:39], v16 offset:36864
    v_mfma_f32_32x32x16_bf16 v[80:95], v[60:63], v[40:43], v[80:95]
    ds_read_b64_tr_b16 v[48:49], v20 offset:32768
    ds_read_b64_tr_b16 v[50:51], v20 offset:33792
    v_mfma_f32_32x32x16_bf16 v[96:111], v[56:59], v[44:47], v[96:111]
    ds_read_b64_tr_b16 v[52:53], v21 offset:32768
    ds_read_b64_tr_b16 v[54:55], v21 offset:33792
    v_mfma_f32_32x32x16_bf16 v[112:127], v[60:63], v[44:47], v[112:127]
    s_waitcnt lgkmcnt(6)
    v_dot2_f32_bf16 v128, v200, s29, v128
    v_dot2_f32_bf16 v130, v200, v200, v130
    v_dot2_f32_bf16 v132, v208, s29, v132
    v_dot2_f32_bf16 v128, v201, s29, v128
    v_dot2_f32_bf16 v130, v201, v201, v130
    v_dot2_f32_bf16 v132, v209, s29, v132
    v_dot2_f32_bf16 v128, v202, s29, v128
    v_dot2_f32_bf16 v130, v202, v202, v130
    v_dot2_f32_bf16 v132, v210, s29, v132
    v_dot2_f32_bf16 v128, v203, s29, v128
    v_dot2_f32_bf16 v130, v203, v203, v130
    v_dot2_f32_bf16 v132, v211, s29, v132
    v_mfma_f32_32x32x16_bf16 v[64:79], v[204:207], v[196:199], v[64:79]
    ds_read_b128 v[40:43], v17 offset:32768
    ds_read_b128 v[44:47], v17 offset:36864
    v_mfma_f32_32x32x16_bf16 v[80:95], v[208:211], v[196:199], v[80:95]
    ds_read_b64_tr_b16 v[56:57], v20 offset:36864
    ds_read_b64_tr_b16 v[58:59], v20 offset:37888
    v_mfma_f32_32x32x16_bf16 v[96:111], v[204:207], v[200:203], v[96:111]
    ds_read_b64_tr_b16 v[60:61], v21 offset:36864
    ds_read_b64_tr_b16 v[62:63], v21 offset:37888
    v_mfma_f32_32x32x16_bf16 v[112:127], v[208:211], v[200:203], v[112:127]
    s_waitcnt lgkmcnt(6)
    v_dot2_f32_bf16 v128, v36, s29, v128
    v_dot2_f32_bf16 v130, v36, v36, v130
    v_dot2_f32_bf16 v132, v52, s29, v132
    v_dot2_f32_bf16 v128, v37, s29, v128
    v_dot2_f32_bf16 v130, v37, v37, v130
    v_dot2_f32_bf16 v132, v53, s29, v132
    v_dot2_f32_bf16 v128, v38, s29, v128
    v_dot2_f32_bf16 v130, v38, v38, v130
    v_dot2_f32_bf16 v132, v54, s29, v132
    v_dot2_f32_bf16 v128, v39, s29, v128
    v_dot2_f32_bf16 v130, v39, v39, v130
    v_dot2_f32_bf16 v132, v55, s29, v132
    v_mfma_f32_32x32x16_bf16 v[64:79], v[48:51], v[32:35], v[64:79]
    ds_read_b128 v[196:199], v18 offset:32768
    ds_read_b128 v[200:203], v18 offset:36864
    v_mfma_f32_32x32x16_bf16 v[80:95], v[52:55], v[32:35], v[80:95]
    ds_read_b64_tr_b16 v[204:205], v20 offset:40960
    ds_read_b64_tr_b16 v[206:207], v20 offset:41984
    v_mfma_f32_32x32x16_bf16 v[96:111], v[48:51], v[36:39], v[96:111]
    ds_read_b64_tr_b16 v[208:209], v21 offset:40960
    ds_read_b64_tr_b16 v[210:211], v21 offset:41984
    v_mfma_f32_32x32x16_bf16 v[112:127], v[52:55], v[36:39], v[112:127]
    s_waitcnt lgkmcnt(6)
    v_dot2_f32_bf16 v128, v44, s29, v128
    v_dot2_f32_bf16 v130, v44, v44, v130
    v_dot2_f32_bf16 v132, v60, s29, v132
    v_dot2_f32_bf16 v128, v45, s29, v128
    v_dot2_f32_bf16 v130, v45, v45, v130
    v_dot2_f32_bf16 v132, v61, s29, v132
    v_dot2_f32_bf16 v128, v46, s29, v128
    v_dot2_f32_bf16 v130, v46, v46, v130
    v_dot2_f32_bf16 v132, v62, s29, v132
    v_dot2_f32_bf16 v128, v47, s29, v128
    v_dot2_f32_bf16 v130, v47, v47, v130
    v_dot2_f32_bf16 v132, v63, s29, v132
    v_mfma_f32_32x32x16_bf16 v[64:79], v[56:59], v[40:43], v[64:79]
    ds_read_b128 v[32:35], v19 offset:32768
    ds_read_b128 v[36:39], v19 offset:36864
    v_mfma_f32_32x32x16_bf16 v[80:95], v[60:63], v[40:43], v[80:95]
    ds_read_b64_tr_b16 v[48:49], v20 offset:45056
    ds_read_b64_tr_b16 v[50:51], v20 offset:46080
    v_mfma_f32_32x32x16_bf16 v[96:111], v[56:59], v[44:47], v[96:111]
    ds_read_b64_tr_b16 v[52:53], v21 offset:45056
    ds_read_b64_tr_b16 v[54:55], v21 offset:46080
    v_mfma_f32_32x32x16_bf16 v[112:127], v[60:63], v[44:47], v[112:127]
    s_waitcnt lgkmcnt(6)
    v_dot2_f32_bf16 v128, v200, s29, v128
    v_dot2_f32_bf16 v130, v200, v200, v130
    v_dot2_f32_bf16 v132, v208, s29, v132
    v_dot2_f32_bf16 v128, v201, s29, v128
    v_dot2_f32_bf16 v130, v201, v201, v130
    v_dot2_f32_bf16 v132, v209, s29, v132
    v_dot2_f32_bf16 v128, v202, s29, v128
    v_dot2_f32_bf16 v130, v202, v202, v130
    v_dot2_f32_bf16 v132, v210, s29, v132
    v_dot2_f32_bf16 v128, v203, s29, v128
    v_dot2_f32_bf16 v130, v203, v203, v130
    v_dot2_f32_bf16 v132, v211, s29, v132
    v_mfma_f32_32x32x16_bf16 v[64:79], v[204:207], v[196:199], v[64:79]
    s_barrier
    ds_read_b128 v[40:43], v4 offset:0
    ds_read_b128 v[44:47], v4 offset:4096
    v_mfma_f32_32x32x16_bf16 v[80:95], v[208:211], v[196:199], v[80:95]
    ds_read_b64_tr_b16 v[56:57], v8 offset:0
    ds_read_b64_tr_b16 v[58:59], v8 offset:1024
    v_mfma_f32_32x32x16_bf16 v[96:111], v[204:207], v[200:203], v[96:111]
    ds_read_b64_tr_b16 v[60:61], v9 offset:0
    ds_read_b64_tr_b16 v[62:63], v9 offset:1024
    v_mfma_f32_32x32x16_bf16 v[112:127], v[208:211], v[200:203], v[112:127]
    s_waitcnt lgkmcnt(6)
    v_dot2_f32_bf16 v128, v36, s29, v128
    v_dot2_f32_bf16 v130, v36, v36, v130
    v_dot2_f32_bf16 v132, v52, s29, v132
    v_dot2_f32_bf16 v128, v37, s29, v128
    v_dot2_f32_bf16 v130, v37, v37, v130
    v_dot2_f32_bf16 v132, v53, s29, v132
    v_dot2_f32_bf16 v128, v38, s29, v128
    v_dot2_f32_bf16 v130, v38, v38, v130
    v_dot2_f32_bf16 v132, v54, s29, v132
    v_dot2_f32_bf16 v128, v39, s29, v128
    v_dot2_f32_bf16 v130, v39, v39, v130
    v_dot2_f32_bf16 v132, v55, s29, v132
    v_mfma_f32_32x32x16_bf16 v[64:79], v[48:51], v[32:35], v[64:79]
    ds_read_b128 v[196:199], v5 offset:0
    ds_read_b128 v[200:203], v5 offset:4096
    v_mfma_f32_32x32x16_bf16 v[80:95], v[52:55], v[32:35], v[80:95]
    ds_read_b64_tr_b16 v[204:205], v8 offset:4096
    ds_read_b64_tr_b16 v[206:207], v8 offset:5120
    v_mfma_f32_32x32x16_bf16 v[96:111], v[48:51], v[36:39], v[96:111]
    ds_read_b64_tr_b16 v[208:209], v9 offset:4096
    ds_read_b64_tr_b16 v[210:211], v9 offset:5120
    v_mfma_f32_32x32x16_bf16 v[112:127], v[52:55], v[36:39], v[112:127]
    s_waitcnt lgkmcnt(6)
    v_dot2_f32_bf16 v128, v44, s29, v128
    v_dot2_f32_bf16 v130, v44, v44, v130
    v_dot2_f32_bf16 v132, v60, s29, v132
    v_dot2_f32_bf16 v128, v45, s29, v128
    v_dot2_f32_bf16 v130, v45, v45, v130
    v_dot2_f32_bf16 v132, v61, s29, v132
    v_dot2_f32_bf16 v128, v46, s29, v128
    v_dot2_f32_bf16 v130, v46, v46, v130
    v_dot2_f32_bf16 v132, v62, s29, v132
    v_dot2_f32_bf16 v128, v47, s29, v128
    v_dot2_f32_bf16 v130, v47, v47, v130
    v_dot2_f32_bf16 v132, v63, s29, v132
    v_mfma_f32_32x32x16_bf16 v[64:79], v[56:59], v[40:43], v[64:79]
    ds_read_b128 v[32:35], v6 offset:0
    ds_read_b128 v[36:39], v6 offset:4096
    v_mfma_f32_32x32x16_bf16 v[80:95], v[60:63], v[40:43], v[80:95]
    ds_read_b64_tr_b16 v[48:49], v8 offset:8192
    ds_read_b64_tr_b16 v[50:51], v8 offset:9216
    v_mfma_f32_32x32x16_bf16 v[96:111], v[56:59], v[44:47], v[96:111]
    ds_read_b64_tr_b16 v[52:53], v9 offset:8192
    ds_read_b64_tr_b16 v[54:55], v9 offset:9216
    v_mfma_f32_32x32x16_bf16 v[112:127], v[60:63], v[44:47], v[112:127]
    s_waitcnt lgkmcnt(6)
    v_dot2_f32_bf16 v128, v200, s29, v128
    v_dot2_f32_bf16 v130, v200, v200, v130
    v_dot2_f32_bf16 v132, v208, s29, v132
    v_dot2_f32_bf16 v128, v201, s29, v128
    v_dot2_f32_bf16 v130, v201, v201, v130
    v_dot2_f32_bf16 v132, v209, s29, v132
    v_dot2_f32_bf16 v128, v202, s29, v128
    v_dot2_f32_bf16 v130, v202, v202, v130
    v_dot2_f32_bf16 v132, v210, s29, v132
    v_dot2_f32_bf16 v128, v203, s29, v128
    v_dot2_f32_bf16 v130, v203, v203, v130
    v_dot2_f32_bf16 v132, v211, s29, v132
    v_mfma_f32_32x32x16_bf16 v[64:79], v[204:207], v[196:199], v[64:79]
    ds_read_b128 v[40:43], v7 offset:0
    ds_read_b128 v[44:47], v7 offset:4096
    v_mfma_f32_32x32x16_bf16 v[80:95], v[208:211], v[196:199], v[80:95]
    ds_read_b64_tr_b16 v[56:57], v8 offset:12288
    ds_read_b64_tr_b16 v[58:59], v8 offset:13312
    v_mfma_f32_32x32x16_bf16 v[96:111], v[204:207], v[200:203], v[96:111]
    ds_read_b64_tr_b16 v[60:61], v9 offset:12288
    ds_read_b64_tr_b16 v[62:63], v9 offset:13312
    v_mfma_f32_32x32x16_bf16 v[112:127], v[208:211], v[200:203], v[112:127]
    s_waitcnt lgkmcnt(6)
    v_dot2_f32_bf16 v128, v36, s29, v128
    v_dot2_f32_bf16 v130, v36, v36, v130
    v_dot2_f32_bf16 v132, v52, s29, v132
    v_dot2_f32_bf16 v128, v37, s29, v128
    v_dot2_f32_bf16 v130, v37, v37, v130
    v_dot2_f32_bf16 v132, v53, s29, v132
    v_dot2_f32_bf16 v128, v38, s29, v128
    v_dot2_f32_bf16 v130, v38, v38, v130
    v_dot2_f32_bf16 v132, v54, s29, v132
    v_dot2_f32_bf16 v128, v39, s29, v128
    v_dot2_f32_bf16 v130, v39, v39, v130
    v_dot2_f32_bf16 v132, v55, s29, v132
    v_mfma_f32_32x32x16_bf16 v[64:79], v[48:51], v[32:35], v[64:79]
    v_mfma_f32_32x32x16_bf16 v[80:95], v[52:55], v[32:35], v[80:95]
    v_mfma_f32_32x32x16_bf16 v[96:111], v[48:51], v[36:39], v[96:111]
    v_mfma_f32_32x32x16_bf16 v[112:127], v[52:55], v[36:39], v[112:127]
    s_waitcnt lgkmcnt(0)
    v_dot2_f32_bf16 v128, v44, s29, v128
    v_dot2_f32_bf16 v130, v44, v44, v130
    v_dot2_f32_bf16 v132, v60, s29, v132
    v_dot2_f32_bf16 v128, v45, s29, v128
    v_dot2_f32_bf16 v130, v45, v45, v130
    v_dot2_f32_bf16 v132, v61, s29, v132
    v_dot2_f32_bf16 v128, v46, s29, v128
    v_dot2_f32_bf16 v130, v46, v46, v130
    v_dot2_f32_bf16 v132, v62, s29, v132
    v_dot2_f32_bf16 v128, v47, s29, v128
    v_dot2_f32_bf16 v130, v47, v47, v130
    v_dot2_f32_bf16 v132, v63, s29, v132
    v_mfma_f32_32x32x16_bf16 v[64:79], v[56:59], v[40:43], v[64:79]
    v_mfma_f32_32x32x16_bf16 v[80:95], v[60:63], v[40:43], v[80:95]
    v_mfma_f32_32x32x16_bf16 v[96:111], v[56:59], v[44:47], v[96:111]
    v_mfma_f32_32x32x16_bf16 v[112:127], v[60:63], v[44:47], v[112:127]
qkv_a_kernel_qe:
    s_barrier
    s_lshl_b32 s3, s26, 10
    v_lshlrev_b32 v12, 2, v2
    v_add_u32 v12, s3, v12
    ds_write_b32 v12, v128
    ds_write_b32 v12, v130 offset:256
    ds_write_b32 v12, v132 offset:512
    s_waitcnt lgkmcnt(0)
    s_barrier
    s_lshl_b32 s3, s27, 11
    v_lshlrev_b32 v12, 2, v2
    v_add_u32 v13, s3, v12
    s_lshl_b32 s3, s28, 10
    v_add_u32 v12, s3, v12
    ds_read_b32 v128, v13
    ds_read_b32 v129, v13 offset:1024
    ds_read_b32 v130, v13 offset:256
    ds_read_b32 v131, v13 offset:1280
    ds_read_b32 v132, v12 offset:512
    ds_read_b32 v133, v12 offset:2560
    s_waitcnt lgkmcnt(0)
    v_mov_b32 v144, v128
    s_nop 1
    v_permlane32_swap_b32 v128, v144
    s_nop 1
    v_add_f32 v128, v128, v144
    v_mov_b32 v144, v130
    s_nop 1
    v_permlane32_swap_b32 v130, v144
    s_nop 1
    v_add_f32 v130, v130, v144
    v_mul_f32 v128, 0xbb000000, v128
    v_mul_f32 v130, 0x3b000000, v130
    v_fma_f32 v130, -v128, v128, v130
    v_add_f32 v130, 0x3727c5ac, v130
    v_rsq_f32 v130, v130
    v_cvt_pk_bf16_f32 v32, v128, v128
    v_and_b32 v144, 0xffff0000, v32
    v_sub_f32 v144, v128, v144
    v_cvt_pk_bf16_f32 v33, v144, v144
    v_mov_b32 v34, 0
    v_mov_b32 v35, 0
    v_mov_b32 v144, v129
    s_nop 1
    v_permlane32_swap_b32 v129, v144
    s_nop 1
    v_add_f32 v129, v129, v144
    v_mov_b32 v144, v131
    s_nop 1
    v_permlane32_swap_b32 v131, v144
    s_nop 1
    v_add_f32 v131, v131, v144
    v_mul_f32 v129, 0xbb000000, v129
    v_mul_f32 v131, 0x3b000000, v131
    v_fma_f32 v131, -v129, v129, v131
    v_add_f32 v131, 0x3727c5ac, v131
    v_rsq_f32 v131, v131
    v_cvt_pk_bf16_f32 v36, v129, v129
    v_and_b32 v144, 0xffff0000, v36
    v_sub_f32 v144, v129, v144
    v_cvt_pk_bf16_f32 v37, v144, v144
    v_mov_b32 v38, 0
    v_mov_b32 v39, 0
    v_cvt_pk_bf16_f32 v48, v132, v132
    v_and_b32 v144, 0xffff0000, v48
    v_sub_f32 v144, v132, v144
    v_cvt_pk_bf16_f32 v48, v132, v144
    v_mov_b32 v49, v48
    v_mov_b32 v50, 0
    v_mov_b32 v51, 0
    v_cvt_pk_bf16_f32 v52, v133, v133
    v_and_b32 v144, 0xffff0000, v52
    v_sub_f32 v144, v133, v144
    v_cvt_pk_bf16_f32 v52, v133, v144
    v_mov_b32 v53, v52
    v_mov_b32 v54, 0
    v_mov_b32 v55, 0
    s_nop 1
    v_mfma_f32_32x32x16_bf16 v[64:79], v[48:51], v[32:35], v[64:79]
    v_mfma_f32_32x32x16_bf16 v[80:95], v[52:55], v[32:35], v[80:95]
    v_mfma_f32_32x32x16_bf16 v[96:111], v[48:51], v[36:39], v[96:111]
    v_mfma_f32_32x32x16_bf16 v[112:127], v[52:55], v[36:39], v[112:127]
    s_mov_b32 s3, 0x3eb8aa3b
    s_cmp_lt_u32 s25, 4
    s_cselect_b32 s3, s3, 1.0
    v_mul_f32 v130, s3, v130
    v_mul_f32 v131, s3, v131
    s_lshl_b32 s33, s25, 3
    s_lshl_b32 s34, s28, 2
    s_add_u32 s33, s33, s34
    s_lshl_b32 s33, s33, 16
    s_lshl_b32 s34, s24, 2
    s_lshl_b32 s35, s27, 1
    s_add_u32 s34, s34, s35
    s_lshl_b32 s34, s34, 10
    s_add_u32 s33, s33, s34
    s_nop 7
    v_pk_mul_f32 v[64:65], v[64:65], v[130:131] op_sel:[0,0] op_sel_hi:[1,0]
    v_pk_mul_f32 v[66:67], v[66:67], v[130:131] op_sel:[0,0] op_sel_hi:[1,0]
    v_pk_mul_f32 v[68:69], v[68:69], v[130:131] op_sel:[0,0] op_sel_hi:[1,0]
    v_pk_mul_f32 v[70:71], v[70:71], v[130:131] op_sel:[0,0] op_sel_hi:[1,0]
    v_pk_mul_f32 v[72:73], v[72:73], v[130:131] op_sel:[0,0] op_sel_hi:[1,0]
    v_pk_mul_f32 v[74:75], v[74:75], v[130:131] op_sel:[0,0] op_sel_hi:[1,0]
    v_pk_mul_f32 v[76:77], v[76:77], v[130:131] op_sel:[0,0] op_sel_hi:[1,0]
    v_pk_mul_f32 v[78:79], v[78:79], v[130:131] op_sel:[0,0] op_sel_hi:[1,0]
    v_cvt_pk_bf16_f32 v148, v64, v65
    v_cvt_pk_bf16_f32 v149, v66, v67
    v_cvt_pk_bf16_f32 v150, v68, v69
    v_cvt_pk_bf16_f32 v151, v70, v71
    s_add_u32 s3, s33, 0
    buffer_store_dwordx4 v[148:151], v3, s[16:19], s3 offen sc0 sc1
    v_cvt_pk_bf16_f32 v152, v72, v73
    v_cvt_pk_bf16_f32 v153, v74, v75
    v_cvt_pk_bf16_f32 v154, v76, v77
    v_cvt_pk_bf16_f32 v155, v78, v79
    s_add_u32 s3, s33, 65536
    buffer_store_dwordx4 v[152:155], v3, s[16:19], s3 offen sc0 sc1
    v_pk_mul_f32 v[80:81], v[80:81], v[130:131] op_sel:[0,0] op_sel_hi:[1,0]
    v_pk_mul_f32 v[82:83], v[82:83], v[130:131] op_sel:[0,0] op_sel_hi:[1,0]
    v_pk_mul_f32 v[84:85], v[84:85], v[130:131] op_sel:[0,0] op_sel_hi:[1,0]
    v_pk_mul_f32 v[86:87], v[86:87], v[130:131] op_sel:[0,0] op_sel_hi:[1,0]
    v_pk_mul_f32 v[88:89], v[88:89], v[130:131] op_sel:[0,0] op_sel_hi:[1,0]
    v_pk_mul_f32 v[90:91], v[90:91], v[130:131] op_sel:[0,0] op_sel_hi:[1,0]
    v_pk_mul_f32 v[92:93], v[92:93], v[130:131] op_sel:[0,0] op_sel_hi:[1,0]
    v_pk_mul_f32 v[94:95], v[94:95], v[130:131] op_sel:[0,0] op_sel_hi:[1,0]
    v_cvt_pk_bf16_f32 v156, v80, v81
    v_cvt_pk_bf16_f32 v157, v82, v83
    v_cvt_pk_bf16_f32 v158, v84, v85
    v_cvt_pk_bf16_f32 v159, v86, v87
    s_add_u32 s3, s33, 131072
    buffer_store_dwordx4 v[156:159], v3, s[16:19], s3 offen sc0 sc1
    v_cvt_pk_bf16_f32 v148, v88, v89
    v_cvt_pk_bf16_f32 v149, v90, v91
    v_cvt_pk_bf16_f32 v150, v92, v93
    v_cvt_pk_bf16_f32 v151, v94, v95
    s_add_u32 s3, s33, 196608
    buffer_store_dwordx4 v[148:151], v3, s[16:19], s3 offen sc0 sc1
    v_pk_mul_f32 v[96:97], v[96:97], v[130:131] op_sel:[0,1] op_sel_hi:[1,1]
    v_pk_mul_f32 v[98:99], v[98:99], v[130:131] op_sel:[0,1] op_sel_hi:[1,1]
    v_pk_mul_f32 v[100:101], v[100:101], v[130:131] op_sel:[0,1] op_sel_hi:[1,1]
    v_pk_mul_f32 v[102:103], v[102:103], v[130:131] op_sel:[0,1] op_sel_hi:[1,1]
    v_pk_mul_f32 v[104:105], v[104:105], v[130:131] op_sel:[0,1] op_sel_hi:[1,1]
    v_pk_mul_f32 v[106:107], v[106:107], v[130:131] op_sel:[0,1] op_sel_hi:[1,1]
    v_pk_mul_f32 v[108:109], v[108:109], v[130:131] op_sel:[0,1] op_sel_hi:[1,1]
    v_pk_mul_f32 v[110:111], v[110:111], v[130:131] op_sel:[0,1] op_sel_hi:[1,1]
    v_cvt_pk_bf16_f32 v152, v96, v97
    v_cvt_pk_bf16_f32 v153, v98, v99
    v_cvt_pk_bf16_f32 v154, v100, v101
    v_cvt_pk_bf16_f32 v155, v102, v103
    s_add_u32 s3, s33, 1024
    buffer_store_dwordx4 v[152:155], v3, s[16:19], s3 offen sc0 sc1
    v_cvt_pk_bf16_f32 v156, v104, v105
    v_cvt_pk_bf16_f32 v157, v106, v107
    v_cvt_pk_bf16_f32 v158, v108, v109
    v_cvt_pk_bf16_f32 v159, v110, v111
    s_add_u32 s3, s33, 66560
    buffer_store_dwordx4 v[156:159], v3, s[16:19], s3 offen sc0 sc1
    v_pk_mul_f32 v[112:113], v[112:113], v[130:131] op_sel:[0,1] op_sel_hi:[1,1]
    v_pk_mul_f32 v[114:115], v[114:115], v[130:131] op_sel:[0,1] op_sel_hi:[1,1]
    v_pk_mul_f32 v[116:117], v[116:117], v[130:131] op_sel:[0,1] op_sel_hi:[1,1]
    v_pk_mul_f32 v[118:119], v[118:119], v[130:131] op_sel:[0,1] op_sel_hi:[1,1]
    v_pk_mul_f32 v[120:121], v[120:121], v[130:131] op_sel:[0,1] op_sel_hi:[1,1]
    v_pk_mul_f32 v[122:123], v[122:123], v[130:131] op_sel:[0,1] op_sel_hi:[1,1]
    v_pk_mul_f32 v[124:125], v[124:125], v[130:131] op_sel:[0,1] op_sel_hi:[1,1]
    v_pk_mul_f32 v[126:127], v[126:127], v[130:131] op_sel:[0,1] op_sel_hi:[1,1]
    v_cvt_pk_bf16_f32 v148, v112, v113
    v_cvt_pk_bf16_f32 v149, v114, v115
    v_cvt_pk_bf16_f32 v150, v116, v117
    v_cvt_pk_bf16_f32 v151, v118, v119
    s_add_u32 s3, s33, 132096
    buffer_store_dwordx4 v[148:151], v3, s[16:19], s3 offen sc0 sc1
    v_cvt_pk_bf16_f32 v152, v120, v121
    v_cvt_pk_bf16_f32 v153, v122, v123
    v_cvt_pk_bf16_f32 v154, v124, v125
    v_cvt_pk_bf16_f32 v155, v126, v127
    s_add_u32 s3, s33, 197632
    buffer_store_dwordx4 v[152:155], v3, s[16:19], s3 offen sc0 sc1
    s_branch qkv_a_kernel_fin
qkv_a_kernel_v:
    s_cmp_lg_u32 s26, 0
    s_cbranch_scc1 qkv_a_kernel_v1
    v_mov_b32 v64, 0
    v_mov_b32 v65, 0
    v_mov_b32 v66, 0
    v_mov_b32 v67, 0
    v_mov_b32 v68, 0
    v_mov_b32 v69, 0
    v_mov_b32 v70, 0
    v_mov_b32 v71, 0
    v_mov_b32 v72, 0
    v_mov_b32 v73, 0
    v_mov_b32 v74, 0
    v_mov_b32 v75, 0
    v_mov_b32 v76, 0
    v_mov_b32 v77, 0
    v_mov_b32 v78, 0
    v_mov_b32 v79, 0
    v_mov_b32 v80, 0
    v_mov_b32 v81, 0
    v_mov_b32 v82, 0
    v_mov_b32 v83, 0
    v_mov_b32 v84, 0
    v_mov_b32 v85, 0
    v_mov_b32 v86, 0
    v_mov_b32 v87, 0
    v_mov_b32 v88, 0
    v_mov_b32 v89, 0
    v_mov_b32 v90, 0
    v_mov_b32 v91, 0
    v_mov_b32 v92, 0
    v_mov_b32 v93, 0
    v_mov_b32 v94, 0
    v_mov_b32 v95, 0
    v_mov_b32 v96, 0
    v_mov_b32 v97, 0
    v_mov_b32 v98, 0
    v_mov_b32 v99, 0
    v_mov_b32 v100, 0
    v_mov_b32 v101, 0
    v_mov_b32 v102, 0
    v_mov_b32 v103, 0
    v_mov_b32 v104, 0
    v_mov_b32 v105, 0
    v_mov_b32 v106, 0
    v_mov_b32 v107, 0
    v_mov_b32 v108, 0
    v_mov_b32 v109, 0
    v_mov_b32 v110, 0
    v_mov_b32 v111, 0
    v_mov_b32 v112, 0
    v_mov_b32 v113, 0
    v_mov_b32 v114, 0
    v_mov_b32 v115, 0
    v_mov_b32 v116, 0
    v_mov_b32 v117, 0
    v_mov_b32 v118, 0
    v_mov_b32 v119, 0
    v_mov_b32 v120, 0
    v_mov_b32 v121, 0
    v_mov_b32 v122, 0
    v_mov_b32 v123, 0
    v_mov_b32 v124, 0
    v_mov_b32 v125, 0
    v_mov_b32 v126, 0
    v_mov_b32 v127, 0
    v_mov_b32 v128, 0
    v_mov_b32 v129, 0
    v_mov_b32 v130, 0
    v_mov_b32 v131, 0
    v_mov_b32 v132, 0
    v_mov_b32 v133, 0
    s_barrier
    ds_read_b128 v[32:35], v16 offset:0
    ds_read_b128 v[36:39], v16 offset:4096
    ds_read_b64_tr_b16 v[48:49], v20 offset:0
    ds_read_b64_tr_b16 v[50:51], v20 offset:1024
    ds_read_b64_tr_b16 v[52:53], v21 offset:0
    ds_read_b64_tr_b16 v[54:55], v21 offset:1024
    ds_read_b128 v[40:43], v17 offset:0
    ds_read_b128 v[44:47], v17 offset:4096
    ds_read_b64_tr_b16 v[56:57], v20 offset:4096
    ds_read_b64_tr_b16 v[58:59], v20 offset:5120
    ds_read_b64_tr_b16 v[60:61], v21 offset:4096
    ds_read_b64_tr_b16 v[62:63], v21 offset:5120
    s_waitcnt lgkmcnt(6)
    v_dot2_f32_bf16 v128, v32, s29, v128
    v_dot2_f32_bf16 v130, v32, v32, v130
    v_dot2_f32_bf16 v132, v48, s29, v132
    v_dot2_f32_bf16 v128, v33, s29, v128
    v_dot2_f32_bf16 v130, v33, v33, v130
    v_dot2_f32_bf16 v132, v49, s29, v132
    v_dot2_f32_bf16 v128, v34, s29, v128
    v_dot2_f32_bf16 v130, v34, v34, v130
    v_dot2_f32_bf16 v132, v50, s29, v132
    v_dot2_f32_bf16 v128, v35, s29, v128
    v_dot2_f32_bf16 v130, v35, v35, v130
    v_dot2_f32_bf16 v132, v51, s29, v132
    v_mfma_f32_32x32x16_bf16 v[64:79], v[32:35], v[48:51], v[64:79]
    ds_read_b128 v[196:199], v18 offset:0
    ds_read_b128 v[200:203], v18 offset:4096
    v_mfma_f32_32x32x16_bf16 v[80:95], v[32:35], v[52:55], v[80:95]
    ds_read_b64_tr_b16 v[204:205], v20 offset:8192
    ds_read_b64_tr_b16 v[206:207], v20 offset:9216
    v_mfma_f32_32x32x16_bf16 v[96:111], v[36:39], v[48:51], v[96:111]
    ds_read_b64_tr_b16 v[208:209], v21 offset:8192
    ds_read_b64_tr_b16 v[210:211], v21 offset:9216
    v_mfma_f32_32x32x16_bf16 v[112:127], v[36:39], v[52:55], v[112:127]
    s_waitcnt lgkmcnt(6)
    v_dot2_f32_bf16 v128, v40, s29, v128
    v_dot2_f32_bf16 v130, v40, v40, v130
    v_dot2_f32_bf16 v132, v56, s29, v132
    v_dot2_f32_bf16 v128, v41, s29, v128
    v_dot2_f32_bf16 v130, v41, v41, v130
    v_dot2_f32_bf16 v132, v57, s29, v132
    v_dot2_f32_bf16 v128, v42, s29, v128
    v_dot2_f32_bf16 v130, v42, v42, v130
    v_dot2_f32_bf16 v132, v58, s29, v132
    v_dot2_f32_bf16 v128, v43, s29, v128
    v_dot2_f32_bf16 v130, v43, v43, v130
    v_dot2_f32_bf16 v132, v59, s29, v132
    v_mfma_f32_32x32x16_bf16 v[64:79], v[40:43], v[56:59], v[64:79]
    ds_read_b128 v[32:35], v19 offset:0
    ds_read_b128 v[36:39], v19 offset:4096
    v_mfma_f32_32x32x16_bf16 v[80:95], v[40:43], v[60:63], v[80:95]
    ds_read_b64_tr_b16 v[48:49], v20 offset:12288
    ds_read_b64_tr_b16 v[50:51], v20 offset:13312
    v_mfma_f32_32x32x16_bf16 v[96:111], v[44:47], v[56:59], v[96:111]
    ds_read_b64_tr_b16 v[52:53], v21 offset:12288
    ds_read_b64_tr_b16 v[54:55], v21 offset:13312
    v_mfma_f32_32x32x16_bf16 v[112:127], v[44:47], v[60:63], v[112:127]
    s_waitcnt lgkmcnt(6)
    v_dot2_f32_bf16 v128, v196, s29, v128
    v_dot2_f32_bf16 v130, v196, v196, v130
    v_dot2_f32_bf16 v132, v204, s29, v132
    v_dot2_f32_bf16 v128, v197, s29, v128
    v_dot2_f32_bf16 v130, v197, v197, v130
    v_dot2_f32_bf16 v132, v205, s29, v132
    v_dot2_f32_bf16 v128, v198, s29, v128
    v_dot2_f32_bf16 v130, v198, v198, v130
    v_dot2_f32_bf16 v132, v206, s29, v132
    v_dot2_f32_bf16 v128, v199, s29, v128
    v_dot2_f32_bf16 v130, v199, v199, v130
    v_dot2_f32_bf16 v132, v207, s29, v132
    v_mfma_f32_32x32x16_bf16 v[64:79], v[196:199], v[204:207], v[64:79]
    s_barrier
    ds_read_b128 v[40:43], v16 offset:32768
    ds_read_b128 v[44:47], v16 offset:36864
    v_mfma_f32_32x32x16_bf16 v[80:95], v[196:199], v[208:211], v[80:95]
    ds_read_b64_tr_b16 v[56:57], v20 offset:32768
    ds_read_b64_tr_b16 v[58:59], v20 offset:33792
    v_mfma_f32_32x32x16_bf16 v[96:111], v[200:203], v[204:207], v[96:111]
    ds_read_b64_tr_b16 v[60:61], v21 offset:32768
    ds_read_b64_tr_b16 v[62:63], v21 offset:33792
    v_mfma_f32_32x32x16_bf16 v[112:127], v[200:203], v[208:211], v[112:127]
    s_waitcnt lgkmcnt(6)
    v_dot2_f32_bf16 v128, v32, s29, v128
    v_dot2_f32_bf16 v130, v32, v32, v130
    v_dot2_f32_bf16 v132, v48, s29, v132
    v_dot2_f32_bf16 v128, v33, s29, v128
    v_dot2_f32_bf16 v130, v33, v33, v130
    v_dot2_f32_bf16 v132, v49, s29, v132
    v_dot2_f32_bf16 v128, v34, s29, v128
    v_dot2_f32_bf16 v130, v34, v34, v130
    v_dot2_f32_bf16 v132, v50, s29, v132
    v_dot2_f32_bf16 v128, v35, s29, v128
    v_dot2_f32_bf16 v130, v35, v35, v130
    v_dot2_f32_bf16 v132, v51, s29, v132
    v_mfma_f32_32x32x16_bf16 v[64:79], v[32:35], v[48:51], v[64:79]
    ds_read_b128 v[196:199], v17 offset:32768
    ds_read_b128 v[200:203], v17 offset:36864
    v_mfma_f32_32x32x16_bf16 v[80:95], v[32:35], v[52:55], v[80:95]
    ds_read_b64_tr_b16 v[204:205], v20 offset:36864
    ds_read_b64_tr_b16 v[206:207], v20 offset:37888
    v_mfma_f32_32x32x16_bf16 v[96:111], v[36:39], v[48:51], v[96:111]
    ds_read_b64_tr_b16 v[208:209], v21 offset:36864
    ds_read_b64_tr_b16 v[210:211], v21 offset:37888
    v_mfma_f32_32x32x16_bf16 v[112:127], v[36:39], v[52:55], v[112:127]
    s_waitcnt lgkmcnt(6)
    v_dot2_f32_bf16 v128, v40, s29, v128
    v_dot2_f32_bf16 v130, v40, v40, v130
    v_dot2_f32_bf16 v132, v56, s29, v132
    v_dot2_f32_bf16 v128, v41, s29, v128
    v_dot2_f32_bf16 v130, v41, v41, v130
    v_dot2_f32_bf16 v132, v57, s29, v132
    v_dot2_f32_bf16 v128, v42, s29, v128
    v_dot2_f32_bf16 v130, v42, v42, v130
    v_dot2_f32_bf16 v132, v58, s29, v132
    v_dot2_f32_bf16 v128, v43, s29, v128
    v_dot2_f32_bf16 v130, v43, v43, v130
    v_dot2_f32_bf16 v132, v59, s29, v132
    v_mfma_f32_32x32x16_bf16 v[64:79], v[40:43], v[56:59], v[64:79]
    ds_read_b128 v[32:35], v18 offset:32768
    ds_read_b128 v[36:39], v18 offset:36864
    v_mfma_f32_32x32x16_bf16 v[80:95], v[40:43], v[60:63], v[80:95]
    ds_read_b64_tr_b16 v[48:49], v20 offset:40960
    ds_read_b64_tr_b16 v[50:51], v20 offset:41984
    v_mfma_f32_32x32x16_bf16 v[96:111], v[44:47], v[56:59], v[96:111]
    ds_read_b64_tr_b16 v[52:53], v21 offset:40960
    ds_read_b64_tr_b16 v[54:55], v21 offset:41984
    v_mfma_f32_32x32x16_bf16 v[112:127], v[44:47], v[60:63], v[112:127]
    s_waitcnt lgkmcnt(6)
    v_dot2_f32_bf16 v128, v196, s29, v128
    v_dot2_f32_bf16 v130, v196, v196, v130
    v_dot2_f32_bf16 v132, v204, s29, v132
    v_dot2_f32_bf16 v128, v197, s29, v128
    v_dot2_f32_bf16 v130, v197, v197, v130
    v_dot2_f32_bf16 v132, v205, s29, v132
    v_dot2_f32_bf16 v128, v198, s29, v128
    v_dot2_f32_bf16 v130, v198, v198, v130
    v_dot2_f32_bf16 v132, v206, s29, v132
    v_dot2_f32_bf16 v128, v199, s29, v128
    v_dot2_f32_bf16 v130, v199, v199, v130
    v_dot2_f32_bf16 v132, v207, s29, v132
    v_mfma_f32_32x32x16_bf16 v[64:79], v[196:199], v[204:207], v[64:79]
    ds_read_b128 v[40:43], v19 offset:32768
    ds_read_b128 v[44:47], v19 offset:36864
    v_mfma_f32_32x32x16_bf16 v[80:95], v[196:199], v[208:211], v[80:95]
    ds_read_b64_tr_b16 v[56:57], v20 offset:45056
    ds_read_b64_tr_b16 v[58:59], v20 offset:46080
    v_mfma_f32_32x32x16_bf16 v[96:111], v[200:203], v[204:207], v[96:111]
    ds_read_b64_tr_b16 v[60:61], v21 offset:45056
    ds_read_b64_tr_b16 v[62:63], v21 offset:46080
    v_mfma_f32_32x32x16_bf16 v[112:127], v[200:203], v[208:211], v[112:127]
    s_waitcnt lgkmcnt(6)
    v_dot2_f32_bf16 v128, v32, s29, v128
    v_dot2_f32_bf16 v130, v32, v32, v130
    v_dot2_f32_bf16 v132, v48, s29, v132
    v_dot2_f32_bf16 v128, v33, s29, v128
    v_dot2_f32_bf16 v130, v33, v33, v130
    v_dot2_f32_bf16 v132, v49, s29, v132
    v_dot2_f32_bf16 v128, v34, s29, v128
    v_dot2_f32_bf16 v130, v34, v34, v130
    v_dot2_f32_bf16 v132, v50, s29, v132
    v_dot2_f32_bf16 v128, v35, s29, v128
    v_dot2_f32_bf16 v130, v35, v35, v130
    v_dot2_f32_bf16 v132, v51, s29, v132
    v_mfma_f32_32x32x16_bf16 v[64:79], v[32:35], v[48:51], v[64:79]
    s_barrier
    ds_read_b128 v[196:199], v4 offset:0
    ds_read_b128 v[200:203], v4 offset:4096
    v_mfma_f32_32x32x16_bf16 v[80:95], v[32:35], v[52:55], v[80:95]
    ds_read_b64_tr_b16 v[204:205], v8 offset:0
    ds_read_b64_tr_b16 v[206:207], v8 offset:1024
    v_mfma_f32_32x32x16_bf16 v[96:111], v[36:39], v[48:51], v[96:111]
    ds_read_b64_tr_b16 v[208:209], v9 offset:0
    ds_read_b64_tr_b16 v[210:211], v9 offset:1024
    v_mfma_f32_32x32x16_bf16 v[112:127], v[36:39], v[52:55], v[112:127]
    s_waitcnt lgkmcnt(6)
    v_dot2_f32_bf16 v128, v40, s29, v128
    v_dot2_f32_bf16 v130, v40, v40, v130
    v_dot2_f32_bf16 v132, v56, s29, v132
    v_dot2_f32_bf16 v128, v41, s29, v128
    v_dot2_f32_bf16 v130, v41, v41, v130
    v_dot2_f32_bf16 v132, v57, s29, v132
    v_dot2_f32_bf16 v128, v42, s29, v128
    v_dot2_f32_bf16 v130, v42, v42, v130
    v_dot2_f32_bf16 v132, v58, s29, v132
    v_dot2_f32_bf16 v128, v43, s29, v128
    v_dot2_f32_bf16 v130, v43, v43, v130
    v_dot2_f32_bf16 v132, v59, s29, v132
    v_mfma_f32_32x32x16_bf16 v[64:79], v[40:43], v[56:59], v[64:79]
    ds_read_b128 v[32:35], v5 offset:0
    ds_read_b128 v[36:39], v5 offset:4096
    v_mfma_f32_32x32x16_bf16 v[80:95], v[40:43], v[60:63], v[80:95]
    ds_read_b64_tr_b16 v[48:49], v8 offset:4096
    ds_read_b64_tr_b16 v[50:51], v8 offset:5120
    v_mfma_f32_32x32x16_bf16 v[96:111], v[44:47], v[56:59], v[96:111]
    ds_read_b64_tr_b16 v[52:53], v9 offset:4096
    ds_read_b64_tr_b16 v[54:55], v9 offset:5120
    v_mfma_f32_32x32x16_bf16 v[112:127], v[44:47], v[60:63], v[112:127]
    s_waitcnt lgkmcnt(6)
    v_dot2_f32_bf16 v128, v196, s29, v128
    v_dot2_f32_bf16 v130, v196, v196, v130
    v_dot2_f32_bf16 v132, v204, s29, v132
    v_dot2_f32_bf16 v128, v197, s29, v128
    v_dot2_f32_bf16 v130, v197, v197, v130
    v_dot2_f32_bf16 v132, v205, s29, v132
    v_dot2_f32_bf16 v128, v198, s29, v128
    v_dot2_f32_bf16 v130, v198, v198, v130
    v_dot2_f32_bf16 v132, v206, s29, v132
    v_dot2_f32_bf16 v128, v199, s29, v128
    v_dot2_f32_bf16 v130, v199, v199, v130
    v_dot2_f32_bf16 v132, v207, s29, v132
    v_mfma_f32_32x32x16_bf16 v[64:79], v[196:199], v[204:207], v[64:79]
    ds_read_b128 v[40:43], v6 offset:0
    ds_read_b128 v[44:47], v6 offset:4096
    v_mfma_f32_32x32x16_bf16 v[80:95], v[196:199], v[208:211], v[80:95]
    ds_read_b64_tr_b16 v[56:57], v8 offset:8192
    ds_read_b64_tr_b16 v[58:59], v8 offset:9216
    v_mfma_f32_32x32x16_bf16 v[96:111], v[200:203], v[204:207], v[96:111]
    ds_read_b64_tr_b16 v[60:61], v9 offset:8192
    ds_read_b64_tr_b16 v[62:63], v9 offset:9216
    v_mfma_f32_32x32x16_bf16 v[112:127], v[200:203], v[208:211], v[112:127]
    s_waitcnt lgkmcnt(6)
    v_dot2_f32_bf16 v128, v32, s29, v128
    v_dot2_f32_bf16 v130, v32, v32, v130
    v_dot2_f32_bf16 v132, v48, s29, v132
    v_dot2_f32_bf16 v128, v33, s29, v128
    v_dot2_f32_bf16 v130, v33, v33, v130
    v_dot2_f32_bf16 v132, v49, s29, v132
    v_dot2_f32_bf16 v128, v34, s29, v128
    v_dot2_f32_bf16 v130, v34, v34, v130
    v_dot2_f32_bf16 v132, v50, s29, v132
    v_dot2_f32_bf16 v128, v35, s29, v128
    v_dot2_f32_bf16 v130, v35, v35, v130
    v_dot2_f32_bf16 v132, v51, s29, v132
    v_mfma_f32_32x32x16_bf16 v[64:79], v[32:35], v[48:51], v[64:79]
    ds_read_b128 v[196:199], v7 offset:0
    ds_read_b128 v[200:203], v7 offset:4096
    v_mfma_f32_32x32x16_bf16 v[80:95], v[32:35], v[52:55], v[80:95]
    ds_read_b64_tr_b16 v[204:205], v8 offset:12288
    ds_read_b64_tr_b16 v[206:207], v8 offset:13312
    v_mfma_f32_32x32x16_bf16 v[96:111], v[36:39], v[48:51], v[96:111]
    ds_read_b64_tr_b16 v[208:209], v9 offset:12288
    ds_read_b64_tr_b16 v[210:211], v9 offset:13312
    v_mfma_f32_32x32x16_bf16 v[112:127], v[36:39], v[52:55], v[112:127]
    s_waitcnt lgkmcnt(6)
    v_dot2_f32_bf16 v128, v40, s29, v128
    v_dot2_f32_bf16 v130, v40, v40, v130
    v_dot2_f32_bf16 v132, v56, s29, v132
    v_dot2_f32_bf16 v128, v41, s29, v128
    v_dot2_f32_bf16 v130, v41, v41, v130
    v_dot2_f32_bf16 v132, v57, s29, v132
    v_dot2_f32_bf16 v128, v42, s29, v128
    v_dot2_f32_bf16 v130, v42, v42, v130
    v_dot2_f32_bf16 v132, v58, s29, v132
    v_dot2_f32_bf16 v128, v43, s29, v128
    v_dot2_f32_bf16 v130, v43, v43, v130
    v_dot2_f32_bf16 v132, v59, s29, v132
    v_mfma_f32_32x32x16_bf16 v[64:79], v[40:43], v[56:59], v[64:79]
    s_barrier
    ds_read_b128 v[32:35], v4 offset:32768
    ds_read_b128 v[36:39], v4 offset:36864
    v_mfma_f32_32x32x16_bf16 v[80:95], v[40:43], v[60:63], v[80:95]
    ds_read_b64_tr_b16 v[48:49], v8 offset:32768
    ds_read_b64_tr_b16 v[50:51], v8 offset:33792
    v_mfma_f32_32x32x16_bf16 v[96:111], v[44:47], v[56:59], v[96:111]
    ds_read_b64_tr_b16 v[52:53], v9 offset:32768
    ds_read_b64_tr_b16 v[54:55], v9 offset:33792
    v_mfma_f32_32x32x16_bf16 v[112:127], v[44:47], v[60:63], v[112:127]
    s_waitcnt lgkmcnt(6)
    v_dot2_f32_bf16 v128, v196, s29, v128
    v_dot2_f32_bf16 v130, v196, v196, v130
    v_dot2_f32_bf16 v132, v204, s29, v132
    v_dot2_f32_bf16 v128, v197, s29, v128
    v_dot2_f32_bf16 v130, v197, v197, v130
    v_dot2_f32_bf16 v132, v205, s29, v132
    v_dot2_f32_bf16 v128, v198, s29, v128
    v_dot2_f32_bf16 v130, v198, v198, v130
    v_dot2_f32_bf16 v132, v206, s29, v132
    v_dot2_f32_bf16 v128, v199, s29, v128
    v_dot2_f32_bf16 v130, v199, v199, v130
    v_dot2_f32_bf16 v132, v207, s29, v132
    v_mfma_f32_32x32x16_bf16 v[64:79], v[196:199], v[204:207], v[64:79]
    ds_read_b128 v[40:43], v5 offset:32768
    ds_read_b128 v[44:47], v5 offset:36864
    v_mfma_f32_32x32x16_bf16 v[80:95], v[196:199], v[208:211], v[80:95]
    ds_read_b64_tr_b16 v[56:57], v8 offset:36864
    ds_read_b64_tr_b16 v[58:59], v8 offset:37888
    v_mfma_f32_32x32x16_bf16 v[96:111], v[200:203], v[204:207], v[96:111]
    ds_read_b64_tr_b16 v[60:61], v9 offset:36864
    ds_read_b64_tr_b16 v[62:63], v9 offset:37888
    v_mfma_f32_32x32x16_bf16 v[112:127], v[200:203], v[208:211], v[112:127]
    s_waitcnt lgkmcnt(6)
    v_dot2_f32_bf16 v128, v32, s29, v128
    v_dot2_f32_bf16 v130, v32, v32, v130
    v_dot2_f32_bf16 v132, v48, s29, v132
    v_dot2_f32_bf16 v128, v33, s29, v128
    v_dot2_f32_bf16 v130, v33, v33, v130
    v_dot2_f32_bf16 v132, v49, s29, v132
    v_dot2_f32_bf16 v128, v34, s29, v128
    v_dot2_f32_bf16 v130, v34, v34, v130
    v_dot2_f32_bf16 v132, v50, s29, v132
    v_dot2_f32_bf16 v128, v35, s29, v128
    v_dot2_f32_bf16 v130, v35, v35, v130
    v_dot2_f32_bf16 v132, v51, s29, v132
    v_mfma_f32_32x32x16_bf16 v[64:79], v[32:35], v[48:51], v[64:79]
    ds_read_b128 v[196:199], v6 offset:32768
    ds_read_b128 v[200:203], v6 offset:36864
    v_mfma_f32_32x32x16_bf16 v[80:95], v[32:35], v[52:55], v[80:95]
    ds_read_b64_tr_b16 v[204:205], v8 offset:40960
    ds_read_b64_tr_b16 v[206:207], v8 offset:41984
    v_mfma_f32_32x32x16_bf16 v[96:111], v[36:39], v[48:51], v[96:111]
    ds_read_b64_tr_b16 v[208:209], v9 offset:40960
    ds_read_b64_tr_b16 v[210:211], v9 offset:41984
    v_mfma_f32_32x32x16_bf16 v[112:127], v[36:39], v[52:55], v[112:127]
    s_waitcnt lgkmcnt(6)
    v_dot2_f32_bf16 v128, v40, s29, v128
    v_dot2_f32_bf16 v130, v40, v40, v130
    v_dot2_f32_bf16 v132, v56, s29, v132
    v_dot2_f32_bf16 v128, v41, s29, v128
    v_dot2_f32_bf16 v130, v41, v41, v130
    v_dot2_f32_bf16 v132, v57, s29, v132
    v_dot2_f32_bf16 v128, v42, s29, v128
    v_dot2_f32_bf16 v130, v42, v42, v130
    v_dot2_f32_bf16 v132, v58, s29, v132
    v_dot2_f32_bf16 v128, v43, s29, v128
    v_dot2_f32_bf16 v130, v43, v43, v130
    v_dot2_f32_bf16 v132, v59, s29, v132
    v_mfma_f32_32x32x16_bf16 v[64:79], v[40:43], v[56:59], v[64:79]
    ds_read_b128 v[32:35], v7 offset:32768
    ds_read_b128 v[36:39], v7 offset:36864
    v_mfma_f32_32x32x16_bf16 v[80:95], v[40:43], v[60:63], v[80:95]
    ds_read_b64_tr_b16 v[48:49], v8 offset:45056
    ds_read_b64_tr_b16 v[50:51], v8 offset:46080
    v_mfma_f32_32x32x16_bf16 v[96:111], v[44:47], v[56:59], v[96:111]
    ds_read_b64_tr_b16 v[52:53], v9 offset:45056
    ds_read_b64_tr_b16 v[54:55], v9 offset:46080
    v_mfma_f32_32x32x16_bf16 v[112:127], v[44:47], v[60:63], v[112:127]
    s_waitcnt lgkmcnt(6)
    v_dot2_f32_bf16 v128, v196, s29, v128
    v_dot2_f32_bf16 v130, v196, v196, v130
    v_dot2_f32_bf16 v132, v204, s29, v132
    v_dot2_f32_bf16 v128, v197, s29, v128
    v_dot2_f32_bf16 v130, v197, v197, v130
    v_dot2_f32_bf16 v132, v205, s29, v132
    v_dot2_f32_bf16 v128, v198, s29, v128
    v_dot2_f32_bf16 v130, v198, v198, v130
    v_dot2_f32_bf16 v132, v206, s29, v132
    v_dot2_f32_bf16 v128, v199, s29, v128
    v_dot2_f32_bf16 v130, v199, v199, v130
    v_dot2_f32_bf16 v132, v207, s29, v132
    v_mfma_f32_32x32x16_bf16 v[64:79], v[196:199], v[204:207], v[64:79]
    s_barrier
    ds_read_b128 v[40:43], v10 offset:0
    ds_read_b128 v[44:47], v10 offset:4096
    v_mfma_f32_32x32x16_bf16 v[80:95], v[196:199], v[208:211], v[80:95]
    ds_read_b64_tr_b16 v[56:57], v14 offset:0
    ds_read_b64_tr_b16 v[58:59], v14 offset:1024
    v_mfma_f32_32x32x16_bf16 v[96:111], v[200:203], v[204:207], v[96:111]
    ds_read_b64_tr_b16 v[60:61], v15 offset:0
    ds_read_b64_tr_b16 v[62:63], v15 offset:1024
    v_mfma_f32_32x32x16_bf16 v[112:127], v[200:203], v[208:211], v[112:127]
    s_waitcnt lgkmcnt(6)
    v_dot2_f32_bf16 v128, v32, s29, v128
    v_dot2_f32_bf16 v130, v32, v32, v130
    v_dot2_f32_bf16 v132, v48, s29, v132
    v_dot2_f32_bf16 v128, v33, s29, v128
    v_dot2_f32_bf16 v130, v33, v33, v130
    v_dot2_f32_bf16 v132, v49, s29, v132
    v_dot2_f32_bf16 v128, v34, s29, v128
    v_dot2_f32_bf16 v130, v34, v34, v130
    v_dot2_f32_bf16 v132, v50, s29, v132
    v_dot2_f32_bf16 v128, v35, s29, v128
    v_dot2_f32_bf16 v130, v35, v35, v130
    v_dot2_f32_bf16 v132, v51, s29, v132
    v_mfma_f32_32x32x16_bf16 v[64:79], v[32:35], v[48:51], v[64:79]
    ds_read_b128 v[196:199], v11 offset:0
    ds_read_b128 v[200:203], v11 offset:4096
    v_mfma_f32_32x32x16_bf16 v[80:95], v[32:35], v[52:55], v[80:95]
    ds_read_b64_tr_b16 v[204:205], v14 offset:4096
    ds_read_b64_tr_b16 v[206:207], v14 offset:5120
    v_mfma_f32_32x32x16_bf16 v[96:111], v[36:39], v[48:51], v[96:111]
    ds_read_b64_tr_b16 v[208:209], v15 offset:4096
    ds_read_b64_tr_b16 v[210:211], v15 offset:5120
    v_mfma_f32_32x32x16_bf16 v[112:127], v[36:39], v[52:55], v[112:127]
    s_waitcnt lgkmcnt(6)
    v_dot2_f32_bf16 v128, v40, s29, v128
    v_dot2_f32_bf16 v130, v40, v40, v130
    v_dot2_f32_bf16 v132, v56, s29, v132
    v_dot2_f32_bf16 v128, v41, s29, v128
    v_dot2_f32_bf16 v130, v41, v41, v130
    v_dot2_f32_bf16 v132, v57, s29, v132
    v_dot2_f32_bf16 v128, v42, s29, v128
    v_dot2_f32_bf16 v130, v42, v42, v130
    v_dot2_f32_bf16 v132, v58, s29, v132
    v_dot2_f32_bf16 v128, v43, s29, v128
    v_dot2_f32_bf16 v130, v43, v43, v130
    v_dot2_f32_bf16 v132, v59, s29, v132
    v_mfma_f32_32x32x16_bf16 v[64:79], v[40:43], v[56:59], v[64:79]
    ds_read_b128 v[32:35], v12 offset:0
    ds_read_b128 v[36:39], v12 offset:4096
    v_mfma_f32_32x32x16_bf16 v[80:95], v[40:43], v[60:63], v[80:95]
    ds_read_b64_tr_b16 v[48:49], v14 offset:8192
    ds_read_b64_tr_b16 v[50:51], v14 offset:9216
    v_mfma_f32_32x32x16_bf16 v[96:111], v[44:47], v[56:59], v[96:111]
    ds_read_b64_tr_b16 v[52:53], v15 offset:8192
    ds_read_b64_tr_b16 v[54:55], v15 offset:9216
    v_mfma_f32_32x32x16_bf16 v[112:127], v[44:47], v[60:63], v[112:127]
    s_waitcnt lgkmcnt(6)
    v_dot2_f32_bf16 v128, v196, s29, v128
    v_dot2_f32_bf16 v130, v196, v196, v130
    v_dot2_f32_bf16 v132, v204, s29, v132
    v_dot2_f32_bf16 v128, v197, s29, v128
    v_dot2_f32_bf16 v130, v197, v197, v130
    v_dot2_f32_bf16 v132, v205, s29, v132
    v_dot2_f32_bf16 v128, v198, s29, v128
    v_dot2_f32_bf16 v130, v198, v198, v130
    v_dot2_f32_bf16 v132, v206, s29, v132
    v_dot2_f32_bf16 v128, v199, s29, v128
    v_dot2_f32_bf16 v130, v199, v199, v130
    v_dot2_f32_bf16 v132, v207, s29, v132
    v_mfma_f32_32x32x16_bf16 v[64:79], v[196:199], v[204:207], v[64:79]
    ds_read_b128 v[40:43], v13 offset:0
    ds_read_b128 v[44:47], v13 offset:4096
    v_mfma_f32_32x32x16_bf16 v[80:95], v[196:199], v[208:211], v[80:95]
    ds_read_b64_tr_b16 v[56:57], v14 offset:12288
    ds_read_b64_tr_b16 v[58:59], v14 offset:13312
    v_mfma_f32_32x32x16_bf16 v[96:111], v[200:203], v[204:207], v[96:111]
    ds_read_b64_tr_b16 v[60:61], v15 offset:12288
    ds_read_b64_tr_b16 v[62:63], v15 offset:13312
    v_mfma_f32_32x32x16_bf16 v[112:127], v[200:203], v[208:211], v[112:127]
    s_waitcnt lgkmcnt(6)
    v_dot2_f32_bf16 v128, v32, s29, v128
    v_dot2_f32_bf16 v130, v32, v32, v130
    v_dot2_f32_bf16 v132, v48, s29, v132
    v_dot2_f32_bf16 v128, v33, s29, v128
    v_dot2_f32_bf16 v130, v33, v33, v130
    v_dot2_f32_bf16 v132, v49, s29, v132
    v_dot2_f32_bf16 v128, v34, s29, v128
    v_dot2_f32_bf16 v130, v34, v34, v130
    v_dot2_f32_bf16 v132, v50, s29, v132
    v_dot2_f32_bf16 v128, v35, s29, v128
    v_dot2_f32_bf16 v130, v35, v35, v130
    v_dot2_f32_bf16 v132, v51, s29, v132
    v_mfma_f32_32x32x16_bf16 v[64:79], v[32:35], v[48:51], v[64:79]
    s_barrier
    ds_read_b128 v[196:199], v16 offset:0
    ds_read_b128 v[200:203], v16 offset:4096
    v_mfma_f32_32x32x16_bf16 v[80:95], v[32:35], v[52:55], v[80:95]
    ds_read_b64_tr_b16 v[204:205], v20 offset:0
    ds_read_b64_tr_b16 v[206:207], v20 offset:1024
    v_mfma_f32_32x32x16_bf16 v[96:111], v[36:39], v[48:51], v[96:111]
    ds_read_b64_tr_b16 v[208:209], v21 offset:0
    ds_read_b64_tr_b16 v[210:211], v21 offset:1024
    v_mfma_f32_32x32x16_bf16 v[112:127], v[36:39], v[52:55], v[112:127]
    s_waitcnt lgkmcnt(6)
    v_dot2_f32_bf16 v128, v40, s29, v128
    v_dot2_f32_bf16 v130, v40, v40, v130
    v_dot2_f32_bf16 v132, v56, s29, v132
    v_dot2_f32_bf16 v128, v41, s29, v128
    v_dot2_f32_bf16 v130, v41, v41, v130
    v_dot2_f32_bf16 v132, v57, s29, v132
    v_dot2_f32_bf16 v128, v42, s29, v128
    v_dot2_f32_bf16 v130, v42, v42, v130
    v_dot2_f32_bf16 v132, v58, s29, v132
    v_dot2_f32_bf16 v128, v43, s29, v128
    v_dot2_f32_bf16 v130, v43, v43, v130
    v_dot2_f32_bf16 v132, v59, s29, v132
    v_mfma_f32_32x32x16_bf16 v[64:79], v[40:43], v[56:59], v[64:79]
    ds_read_b128 v[32:35], v17 offset:0
    ds_read_b128 v[36:39], v17 offset:4096
    v_mfma_f32_32x32x16_bf16 v[80:95], v[40:43], v[60:63], v[80:95]
    ds_read_b64_tr_b16 v[48:49], v20 offset:4096
    ds_read_b64_tr_b16 v[50:51], v20 offset:5120
    v_mfma_f32_32x32x16_bf16 v[96:111], v[44:47], v[56:59], v[96:111]
    ds_read_b64_tr_b16 v[52:53], v21 offset:4096
    ds_read_b64_tr_b16 v[54:55], v21 offset:5120
    v_mfma_f32_32x32x16_bf16 v[112:127], v[44:47], v[60:63], v[112:127]
    s_waitcnt lgkmcnt(6)
    v_dot2_f32_bf16 v128, v196, s29, v128
    v_dot2_f32_bf16 v130, v196, v196, v130
    v_dot2_f32_bf16 v132, v204, s29, v132
    v_dot2_f32_bf16 v128, v197, s29, v128
    v_dot2_f32_bf16 v130, v197, v197, v130
    v_dot2_f32_bf16 v132, v205, s29, v132
    v_dot2_f32_bf16 v128, v198, s29, v128
    v_dot2_f32_bf16 v130, v198, v198, v130
    v_dot2_f32_bf16 v132, v206, s29, v132
    v_dot2_f32_bf16 v128, v199, s29, v128
    v_dot2_f32_bf16 v130, v199, v199, v130
    v_dot2_f32_bf16 v132, v207, s29, v132
    v_mfma_f32_32x32x16_bf16 v[64:79], v[196:199], v[204:207], v[64:79]
    ds_read_b128 v[40:43], v18 offset:0
    ds_read_b128 v[44:47], v18 offset:4096
    v_mfma_f32_32x32x16_bf16 v[80:95], v[196:199], v[208:211], v[80:95]
    ds_read_b64_tr_b16 v[56:57], v20 offset:8192
    ds_read_b64_tr_b16 v[58:59], v20 offset:9216
    v_mfma_f32_32x32x16_bf16 v[96:111], v[200:203], v[204:207], v[96:111]
    ds_read_b64_tr_b16 v[60:61], v21 offset:8192
    ds_read_b64_tr_b16 v[62:63], v21 offset:9216
    v_mfma_f32_32x32x16_bf16 v[112:127], v[200:203], v[208:211], v[112:127]
    s_waitcnt lgkmcnt(6)
    v_dot2_f32_bf16 v128, v32, s29, v128
    v_dot2_f32_bf16 v130, v32, v32, v130
    v_dot2_f32_bf16 v132, v48, s29, v132
    v_dot2_f32_bf16 v128, v33, s29, v128
    v_dot2_f32_bf16 v130, v33, v33, v130
    v_dot2_f32_bf16 v132, v49, s29, v132
    v_dot2_f32_bf16 v128, v34, s29, v128
    v_dot2_f32_bf16 v130, v34, v34, v130
    v_dot2_f32_bf16 v132, v50, s29, v132
    v_dot2_f32_bf16 v128, v35, s29, v128
    v_dot2_f32_bf16 v130, v35, v35, v130
    v_dot2_f32_bf16 v132, v51, s29, v132
    v_mfma_f32_32x32x16_bf16 v[64:79], v[32:35], v[48:51], v[64:79]
    ds_read_b128 v[196:199], v19 offset:0
    ds_read_b128 v[200:203], v19 offset:4096
    v_mfma_f32_32x32x16_bf16 v[80:95], v[32:35], v[52:55], v[80:95]
    ds_read_b64_tr_b16 v[204:205], v20 offset:12288
    ds_read_b64_tr_b16 v[206:207], v20 offset:13312
    v_mfma_f32_32x32x16_bf16 v[96:111], v[36:39], v[48:51], v[96:111]
    ds_read_b64_tr_b16 v[208:209], v21 offset:12288
    ds_read_b64_tr_b16 v[210:211], v21 offset:13312
    v_mfma_f32_32x32x16_bf16 v[112:127], v[36:39], v[52:55], v[112:127]
    s_waitcnt lgkmcnt(6)
    v_dot2_f32_bf16 v128, v40, s29, v128
    v_dot2_f32_bf16 v130, v40, v40, v130
    v_dot2_f32_bf16 v132, v56, s29, v132
    v_dot2_f32_bf16 v128, v41, s29, v128
    v_dot2_f32_bf16 v130, v41, v41, v130
    v_dot2_f32_bf16 v132, v57, s29, v132
    v_dot2_f32_bf16 v128, v42, s29, v128
    v_dot2_f32_bf16 v130, v42, v42, v130
    v_dot2_f32_bf16 v132, v58, s29, v132
    v_dot2_f32_bf16 v128, v43, s29, v128
    v_dot2_f32_bf16 v130, v43, v43, v130
    v_dot2_f32_bf16 v132, v59, s29, v132
    v_mfma_f32_32x32x16_bf16 v[64:79], v[40:43], v[56:59], v[64:79]
    s_barrier
    ds_read_b128 v[32:35], v16 offset:32768
    ds_read_b128 v[36:39], v16 offset:36864
    v_mfma_f32_32x32x16_bf16 v[80:95], v[40:43], v[60:63], v[80:95]
    ds_read_b64_tr_b16 v[48:49], v20 offset:32768
    ds_read_b64_tr_b16 v[50:51], v20 offset:33792
    v_mfma_f32_32x32x16_bf16 v[96:111], v[44:47], v[56:59], v[96:111]
    ds_read_b64_tr_b16 v[52:53], v21 offset:32768
    ds_read_b64_tr_b16 v[54:55], v21 offset:33792
    v_mfma_f32_32x32x16_bf16 v[112:127], v[44:47], v[60:63], v[112:127]
    s_waitcnt lgkmcnt(6)
    v_dot2_f32_bf16 v128, v196, s29, v128
    v_dot2_f32_bf16 v130, v196, v196, v130
    v_dot2_f32_bf16 v132, v204, s29, v132
    v_dot2_f32_bf16 v128, v197, s29, v128
    v_dot2_f32_bf16 v130, v197, v197, v130
    v_dot2_f32_bf16 v132, v205, s29, v132
    v_dot2_f32_bf16 v128, v198, s29, v128
    v_dot2_f32_bf16 v130, v198, v198, v130
    v_dot2_f32_bf16 v132, v206, s29, v132
    v_dot2_f32_bf16 v128, v199, s29, v128
    v_dot2_f32_bf16 v130, v199, v199, v130
    v_dot2_f32_bf16 v132, v207, s29, v132
    v_mfma_f32_32x32x16_bf16 v[64:79], v[196:199], v[204:207], v[64:79]
    ds_read_b128 v[40:43], v17 offset:32768
    ds_read_b128 v[44:47], v17 offset:36864
    v_mfma_f32_32x32x16_bf16 v[80:95], v[196:199], v[208:211], v[80:95]
    ds_read_b64_tr_b16 v[56:57], v20 offset:36864
    ds_read_b64_tr_b16 v[58:59], v20 offset:37888
    v_mfma_f32_32x32x16_bf16 v[96:111], v[200:203], v[204:207], v[96:111]
    ds_read_b64_tr_b16 v[60:61], v21 offset:36864
    ds_read_b64_tr_b16 v[62:63], v21 offset:37888
    v_mfma_f32_32x32x16_bf16 v[112:127], v[200:203], v[208:211], v[112:127]
    s_waitcnt lgkmcnt(6)
    v_dot2_f32_bf16 v128, v32, s29, v128
    v_dot2_f32_bf16 v130, v32, v32, v130
    v_dot2_f32_bf16 v132, v48, s29, v132
    v_dot2_f32_bf16 v128, v33, s29, v128
    v_dot2_f32_bf16 v130, v33, v33, v130
    v_dot2_f32_bf16 v132, v49, s29, v132
    v_dot2_f32_bf16 v128, v34, s29, v128
    v_dot2_f32_bf16 v130, v34, v34, v130
    v_dot2_f32_bf16 v132, v50, s29, v132
    v_dot2_f32_bf16 v128, v35, s29, v128
    v_dot2_f32_bf16 v130, v35, v35, v130
    v_dot2_f32_bf16 v132, v51, s29, v132
    v_mfma_f32_32x32x16_bf16 v[64:79], v[32:35], v[48:51], v[64:79]
    ds_read_b128 v[196:199], v18 offset:32768
    ds_read_b128 v[200:203], v18 offset:36864
    v_mfma_f32_32x32x16_bf16 v[80:95], v[32:35], v[52:55], v[80:95]
    ds_read_b64_tr_b16 v[204:205], v20 offset:40960
    ds_read_b64_tr_b16 v[206:207], v20 offset:41984
    v_mfma_f32_32x32x16_bf16 v[96:111], v[36:39], v[48:51], v[96:111]
    ds_read_b64_tr_b16 v[208:209], v21 offset:40960
    ds_read_b64_tr_b16 v[210:211], v21 offset:41984
    v_mfma_f32_32x32x16_bf16 v[112:127], v[36:39], v[52:55], v[112:127]
    s_waitcnt lgkmcnt(6)
    v_dot2_f32_bf16 v128, v40, s29, v128
    v_dot2_f32_bf16 v130, v40, v40, v130
    v_dot2_f32_bf16 v132, v56, s29, v132
    v_dot2_f32_bf16 v128, v41, s29, v128
    v_dot2_f32_bf16 v130, v41, v41, v130
    v_dot2_f32_bf16 v132, v57, s29, v132
    v_dot2_f32_bf16 v128, v42, s29, v128
    v_dot2_f32_bf16 v130, v42, v42, v130
    v_dot2_f32_bf16 v132, v58, s29, v132
    v_dot2_f32_bf16 v128, v43, s29, v128
    v_dot2_f32_bf16 v130, v43, v43, v130
    v_dot2_f32_bf16 v132, v59, s29, v132
    v_mfma_f32_32x32x16_bf16 v[64:79], v[40:43], v[56:59], v[64:79]
    ds_read_b128 v[32:35], v19 offset:32768
    ds_read_b128 v[36:39], v19 offset:36864
    v_mfma_f32_32x32x16_bf16 v[80:95], v[40:43], v[60:63], v[80:95]
    ds_read_b64_tr_b16 v[48:49], v20 offset:45056
    ds_read_b64_tr_b16 v[50:51], v20 offset:46080
    v_mfma_f32_32x32x16_bf16 v[96:111], v[44:47], v[56:59], v[96:111]
    ds_read_b64_tr_b16 v[52:53], v21 offset:45056
    ds_read_b64_tr_b16 v[54:55], v21 offset:46080
    v_mfma_f32_32x32x16_bf16 v[112:127], v[44:47], v[60:63], v[112:127]
    s_waitcnt lgkmcnt(6)
    v_dot2_f32_bf16 v128, v196, s29, v128
    v_dot2_f32_bf16 v130, v196, v196, v130
    v_dot2_f32_bf16 v132, v204, s29, v132
    v_dot2_f32_bf16 v128, v197, s29, v128
    v_dot2_f32_bf16 v130, v197, v197, v130
    v_dot2_f32_bf16 v132, v205, s29, v132
    v_dot2_f32_bf16 v128, v198, s29, v128
    v_dot2_f32_bf16 v130, v198, v198, v130
    v_dot2_f32_bf16 v132, v206, s29, v132
    v_dot2_f32_bf16 v128, v199, s29, v128
    v_dot2_f32_bf16 v130, v199, v199, v130
    v_dot2_f32_bf16 v132, v207, s29, v132
    v_mfma_f32_32x32x16_bf16 v[64:79], v[196:199], v[204:207], v[64:79]
    s_barrier
    ds_read_b128 v[40:43], v4 offset:0
    ds_read_b128 v[44:47], v4 offset:4096
    v_mfma_f32_32x32x16_bf16 v[80:95], v[196:199], v[208:211], v[80:95]
    ds_read_b64_tr_b16 v[56:57], v8 offset:0
    ds_read_b64_tr_b16 v[58:59], v8 offset:1024
    v_mfma_f32_32x32x16_bf16 v[96:111], v[200:203], v[204:207], v[96:111]
    ds_read_b64_tr_b16 v[60:61], v9 offset:0
    ds_read_b64_tr_b16 v[62:63], v9 offset:1024
    v_mfma_f32_32x32x16_bf16 v[112:127], v[200:203], v[208:211], v[112:127]
    s_waitcnt lgkmcnt(6)
    v_dot2_f32_bf16 v128, v32, s29, v128
    v_dot2_f32_bf16 v130, v32, v32, v130
    v_dot2_f32_bf16 v132, v48, s29, v132
    v_dot2_f32_bf16 v128, v33, s29, v128
    v_dot2_f32_bf16 v130, v33, v33, v130
    v_dot2_f32_bf16 v132, v49, s29, v132
    v_dot2_f32_bf16 v128, v34, s29, v128
    v_dot2_f32_bf16 v130, v34, v34, v130
    v_dot2_f32_bf16 v132, v50, s29, v132
    v_dot2_f32_bf16 v128, v35, s29, v128
    v_dot2_f32_bf16 v130, v35, v35, v130
    v_dot2_f32_bf16 v132, v51, s29, v132
    v_mfma_f32_32x32x16_bf16 v[64:79], v[32:35], v[48:51], v[64:79]
    ds_read_b128 v[196:199], v5 offset:0
    ds_read_b128 v[200:203], v5 offset:4096
    v_mfma_f32_32x32x16_bf16 v[80:95], v[32:35], v[52:55], v[80:95]
    ds_read_b64_tr_b16 v[204:205], v8 offset:4096
    ds_read_b64_tr_b16 v[206:207], v8 offset:5120
    v_mfma_f32_32x32x16_bf16 v[96:111], v[36:39], v[48:51], v[96:111]
    ds_read_b64_tr_b16 v[208:209], v9 offset:4096
    ds_read_b64_tr_b16 v[210:211], v9 offset:5120
    v_mfma_f32_32x32x16_bf16 v[112:127], v[36:39], v[52:55], v[112:127]
    s_waitcnt lgkmcnt(6)
    v_dot2_f32_bf16 v128, v40, s29, v128
    v_dot2_f32_bf16 v130, v40, v40, v130
    v_dot2_f32_bf16 v132, v56, s29, v132
    v_dot2_f32_bf16 v128, v41, s29, v128
    v_dot2_f32_bf16 v130, v41, v41, v130
    v_dot2_f32_bf16 v132, v57, s29, v132
    v_dot2_f32_bf16 v128, v42, s29, v128
    v_dot2_f32_bf16 v130, v42, v42, v130
    v_dot2_f32_bf16 v132, v58, s29, v132
    v_dot2_f32_bf16 v128, v43, s29, v128
    v_dot2_f32_bf16 v130, v43, v43, v130
    v_dot2_f32_bf16 v132, v59, s29, v132
    v_mfma_f32_32x32x16_bf16 v[64:79], v[40:43], v[56:59], v[64:79]
    ds_read_b128 v[32:35], v6 offset:0
    ds_read_b128 v[36:39], v6 offset:4096
    v_mfma_f32_32x32x16_bf16 v[80:95], v[40:43], v[60:63], v[80:95]
    ds_read_b64_tr_b16 v[48:49], v8 offset:8192
    ds_read_b64_tr_b16 v[50:51], v8 offset:9216
    v_mfma_f32_32x32x16_bf16 v[96:111], v[44:47], v[56:59], v[96:111]
    ds_read_b64_tr_b16 v[52:53], v9 offset:8192
    ds_read_b64_tr_b16 v[54:55], v9 offset:9216
    v_mfma_f32_32x32x16_bf16 v[112:127], v[44:47], v[60:63], v[112:127]
    s_waitcnt lgkmcnt(6)
    v_dot2_f32_bf16 v128, v196, s29, v128
    v_dot2_f32_bf16 v130, v196, v196, v130
    v_dot2_f32_bf16 v132, v204, s29, v132
    v_dot2_f32_bf16 v128, v197, s29, v128
    v_dot2_f32_bf16 v130, v197, v197, v130
    v_dot2_f32_bf16 v132, v205, s29, v132
    v_dot2_f32_bf16 v128, v198, s29, v128
    v_dot2_f32_bf16 v130, v198, v198, v130
    v_dot2_f32_bf16 v132, v206, s29, v132
    v_dot2_f32_bf16 v128, v199, s29, v128
    v_dot2_f32_bf16 v130, v199, v199, v130
    v_dot2_f32_bf16 v132, v207, s29, v132
    v_mfma_f32_32x32x16_bf16 v[64:79], v[196:199], v[204:207], v[64:79]
    ds_read_b128 v[40:43], v7 offset:0
    ds_read_b128 v[44:47], v7 offset:4096
    v_mfma_f32_32x32x16_bf16 v[80:95], v[196:199], v[208:211], v[80:95]
    ds_read_b64_tr_b16 v[56:57], v8 offset:12288
    ds_read_b64_tr_b16 v[58:59], v8 offset:13312
    v_mfma_f32_32x32x16_bf16 v[96:111], v[200:203], v[204:207], v[96:111]
    ds_read_b64_tr_b16 v[60:61], v9 offset:12288
    ds_read_b64_tr_b16 v[62:63], v9 offset:13312
    v_mfma_f32_32x32x16_bf16 v[112:127], v[200:203], v[208:211], v[112:127]
    s_waitcnt lgkmcnt(6)
    v_dot2_f32_bf16 v128, v32, s29, v128
    v_dot2_f32_bf16 v130, v32, v32, v130
    v_dot2_f32_bf16 v132, v48, s29, v132
    v_dot2_f32_bf16 v128, v33, s29, v128
    v_dot2_f32_bf16 v130, v33, v33, v130
    v_dot2_f32_bf16 v132, v49, s29, v132
    v_dot2_f32_bf16 v128, v34, s29, v128
    v_dot2_f32_bf16 v130, v34, v34, v130
    v_dot2_f32_bf16 v132, v50, s29, v132
    v_dot2_f32_bf16 v128, v35, s29, v128
    v_dot2_f32_bf16 v130, v35, v35, v130
    v_dot2_f32_bf16 v132, v51, s29, v132
    v_mfma_f32_32x32x16_bf16 v[64:79], v[32:35], v[48:51], v[64:79]
    v_mfma_f32_32x32x16_bf16 v[80:95], v[32:35], v[52:55], v[80:95]
    v_mfma_f32_32x32x16_bf16 v[96:111], v[36:39], v[48:51], v[96:111]
    v_mfma_f32_32x32x16_bf16 v[112:127], v[36:39], v[52:55], v[112:127]
    s_waitcnt lgkmcnt(0)
    v_dot2_f32_bf16 v128, v40, s29, v128
    v_dot2_f32_bf16 v130, v40, v40, v130
    v_dot2_f32_bf16 v132, v56, s29, v132
    v_dot2_f32_bf16 v128, v41, s29, v128
    v_dot2_f32_bf16 v130, v41, v41, v130
    v_dot2_f32_bf16 v132, v57, s29, v132
    v_dot2_f32_bf16 v128, v42, s29, v128
    v_dot2_f32_bf16 v130, v42, v42, v130
    v_dot2_f32_bf16 v132, v58, s29, v132
    v_dot2_f32_bf16 v128, v43, s29, v128
    v_dot2_f32_bf16 v130, v43, v43, v130
    v_dot2_f32_bf16 v132, v59, s29, v132
    v_mfma_f32_32x32x16_bf16 v[64:79], v[40:43], v[56:59], v[64:79]
    v_mfma_f32_32x32x16_bf16 v[80:95], v[40:43], v[60:63], v[80:95]
    v_mfma_f32_32x32x16_bf16 v[96:111], v[44:47], v[56:59], v[96:111]
    v_mfma_f32_32x32x16_bf16 v[112:127], v[44:47], v[60:63], v[112:127]
    s_branch qkv_a_kernel_ve
qkv_a_kernel_v1:
    s_cmp_lg_u32 s26, 1
    s_cbranch_scc1 qkv_a_kernel_v2
    v_mov_b32 v64, 0
    v_mov_b32 v65, 0
    v_mov_b32 v66, 0
    v_mov_b32 v67, 0
    v_mov_b32 v68, 0
    v_mov_b32 v69, 0
    v_mov_b32 v70, 0
    v_mov_b32 v71, 0
    v_mov_b32 v72, 0
    v_mov_b32 v73, 0
    v_mov_b32 v74, 0
    v_mov_b32 v75, 0
    v_mov_b32 v76, 0
    v_mov_b32 v77, 0
    v_mov_b32 v78, 0
    v_mov_b32 v79, 0
    v_mov_b32 v80, 0
    v_mov_b32 v81, 0
    v_mov_b32 v82, 0
    v_mov_b32 v83, 0
    v_mov_b32 v84, 0
    v_mov_b32 v85, 0
    v_mov_b32 v86, 0
    v_mov_b32 v87, 0
    v_mov_b32 v88, 0
    v_mov_b32 v89, 0
    v_mov_b32 v90, 0
    v_mov_b32 v91, 0
    v_mov_b32 v92, 0
    v_mov_b32 v93, 0
    v_mov_b32 v94, 0
    v_mov_b32 v95, 0
    v_mov_b32 v96, 0
    v_mov_b32 v97, 0
    v_mov_b32 v98, 0
    v_mov_b32 v99, 0
    v_mov_b32 v100, 0
    v_mov_b32 v101, 0
    v_mov_b32 v102, 0
    v_mov_b32 v103, 0
    v_mov_b32 v104, 0
    v_mov_b32 v105, 0
    v_mov_b32 v106, 0
    v_mov_b32 v107, 0
    v_mov_b32 v108, 0
    v_mov_b32 v109, 0
    v_mov_b32 v110, 0
    v_mov_b32 v111, 0
    v_mov_b32 v112, 0
    v_mov_b32 v113, 0
    v_mov_b32 v114, 0
    v_mov_b32 v115, 0
    v_mov_b32 v116, 0
    v_mov_b32 v117, 0
    v_mov_b32 v118, 0
    v_mov_b32 v119, 0
    v_mov_b32 v120, 0
    v_mov_b32 v121, 0
    v_mov_b32 v122, 0
    v_mov_b32 v123, 0
    v_mov_b32 v124, 0
    v_mov_b32 v125, 0
    v_mov_b32 v126, 0
    v_mov_b32 v127, 0
    v_mov_b32 v128, 0
    v_mov_b32 v129, 0
    v_mov_b32 v130, 0
    v_mov_b32 v131, 0
    v_mov_b32 v132, 0
    v_mov_b32 v133, 0
    s_barrier
    ds_read_b128 v[32:35], v16 offset:0
    ds_read_b128 v[36:39], v16 offset:4096
    ds_read_b64_tr_b16 v[48:49], v20 offset:0
    ds_read_b64_tr_b16 v[50:51], v20 offset:1024
    ds_read_b64_tr_b16 v[52:53], v21 offset:0
    ds_read_b64_tr_b16 v[54:55], v21 offset:1024
    ds_read_b128 v[40:43], v17 offset:0
    ds_read_b128 v[44:47], v17 offset:4096
    ds_read_b64_tr_b16 v[56:57], v20 offset:4096
    ds_read_b64_tr_b16 v[58:59], v20 offset:5120
    ds_read_b64_tr_b16 v[60:61], v21 offset:4096
    ds_read_b64_tr_b16 v[62:63], v21 offset:5120
    s_waitcnt lgkmcnt(6)
    v_dot2_f32_bf16 v128, v36, s29, v128
    v_dot2_f32_bf16 v130, v36, v36, v130
    v_dot2_f32_bf16 v132, v48, s29, v132
    v_dot2_f32_bf16 v128, v37, s29, v128
    v_dot2_f32_bf16 v130, v37, v37, v130
    v_dot2_f32_bf16 v132, v49, s29, v132
    v_dot2_f32_bf16 v128, v38, s29, v128
    v_dot2_f32_bf16 v130, v38, v38, v130
    v_dot2_f32_bf16 v132, v50, s29, v132
    v_dot2_f32_bf16 v128, v39, s29, v128
    v_dot2_f32_bf16 v130, v39, v39, v130
    v_dot2_f32_bf16 v132, v51, s29, v132
    v_mfma_f32_32x32x16_bf16 v[64:79], v[32:35], v[48:51], v[64:79]
    ds_read_b128 v[196:199], v18 offset:0
    ds_read_b128 v[200:203], v18 offset:4096
    v_mfma_f32_32x32x16_bf16 v[80:95], v[32:35], v[52:55], v[80:95]
    ds_read_b64_tr_b16 v[204:205], v20 offset:8192
    ds_read_b64_tr_b16 v[206:207], v20 offset:9216
    v_mfma_f32_32x32x16_bf16 v[96:111], v[36:39], v[48:51], v[96:111]
    ds_read_b64_tr_b16 v[208:209], v21 offset:8192
    ds_read_b64_tr_b16 v[210:211], v21 offset:9216
    v_mfma_f32_32x32x16_bf16 v[112:127], v[36:39], v[52:55], v[112:127]
    s_waitcnt lgkmcnt(6)
    v_dot2_f32_bf16 v128, v44, s29, v128
    v_dot2_f32_bf16 v130, v44, v44, v130
    v_dot2_f32_bf16 v132, v56, s29, v132
    v_dot2_f32_bf16 v128, v45, s29, v128
    v_dot2_f32_bf16 v130, v45, v45, v130
    v_dot2_f32_bf16 v132, v57, s29, v132
    v_dot2_f32_bf16 v128, v46, s29, v128
    v_dot2_f32_bf16 v130, v46, v46, v130
    v_dot2_f32_bf16 v132, v58, s29, v132
    v_dot2_f32_bf16 v128, v47, s29, v128
    v_dot2_f32_bf16 v130, v47, v47, v130
    v_dot2_f32_bf16 v132, v59, s29, v132
    v_mfma_f32_32x32x16_bf16 v[64:79], v[40:43], v[56:59], v[64:79]
    ds_read_b128 v[32:35], v19 offset:0
    ds_read_b128 v[36:39], v19 offset:4096
    v_mfma_f32_32x32x16_bf16 v[80:95], v[40:43], v[60:63], v[80:95]
    ds_read_b64_tr_b16 v[48:49], v20 offset:12288
    ds_read_b64_tr_b16 v[50:51], v20 offset:13312
    v_mfma_f32_32x32x16_bf16 v[96:111], v[44:47], v[56:59], v[96:111]
    ds_read_b64_tr_b16 v[52:53], v21 offset:12288
    ds_read_b64_tr_b16 v[54:55], v21 offset:13312
    v_mfma_f32_32x32x16_bf16 v[112:127], v[44:47], v[60:63], v[112:127]
    s_waitcnt lgkmcnt(6)
    v_dot2_f32_bf16 v128, v200, s29, v128
    v_dot2_f32_bf16 v130, v200, v200, v130
    v_dot2_f32_bf16 v132, v204, s29, v132
    v_dot2_f32_bf16 v128, v201, s29, v128
    v_dot2_f32_bf16 v130, v201, v201, v130
    v_dot2_f32_bf16 v132, v205, s29, v132
    v_dot2_f32_bf16 v128, v202, s29, v128
    v_dot2_f32_bf16 v130, v202, v202, v130
    v_dot2_f32_bf16 v132, v206, s29, v132
    v_dot2_f32_bf16 v128, v203, s29, v128
    v_dot2_f32_bf16 v130, v203, v203, v130
    v_dot2_f32_bf16 v132, v207, s29, v132
    v_mfma_f32_32x32x16_bf16 v[64:79], v[196:199], v[204:207], v[64:79]
    s_barrier
    ds_read_b128 v[40:43], v16 offset:32768
    ds_read_b128 v[44:47], v16 offset:36864
    v_mfma_f32_32x32x16_bf16 v[80:95], v[196:199], v[208:211], v[80:95]
    ds_read_b64_tr_b16 v[56:57], v20 offset:32768
    ds_read_b64_tr_b16 v[58:59], v20 offset:33792
    v_mfma_f32_32x32x16_bf16 v[96:111], v[200:203], v[204:207], v[96:111]
    ds_read_b64_tr_b16 v[60:61], v21 offset:32768
    ds_read_b64_tr_b16 v[62:63], v21 offset:33792
    v_mfma_f32_32x32x16_bf16 v[112:127], v[200:203], v[208:211], v[112:127]
    s_waitcnt lgkmcnt(6)
    v_dot2_f32_bf16 v128, v36, s29, v128
    v_dot2_f32_bf16 v130, v36, v36, v130
    v_dot2_f32_bf16 v132, v48, s29, v132
    v_dot2_f32_bf16 v128, v37, s29, v128
    v_dot2_f32_bf16 v130, v37, v37, v130
    v_dot2_f32_bf16 v132, v49, s29, v132
    v_dot2_f32_bf16 v128, v38, s29, v128
    v_dot2_f32_bf16 v130, v38, v38, v130
    v_dot2_f32_bf16 v132, v50, s29, v132
    v_dot2_f32_bf16 v128, v39, s29, v128
    v_dot2_f32_bf16 v130, v39, v39, v130
    v_dot2_f32_bf16 v132, v51, s29, v132
    v_mfma_f32_32x32x16_bf16 v[64:79], v[32:35], v[48:51], v[64:79]
    ds_read_b128 v[196:199], v17 offset:32768
    ds_read_b128 v[200:203], v17 offset:36864
    v_mfma_f32_32x32x16_bf16 v[80:95], v[32:35], v[52:55], v[80:95]
    ds_read_b64_tr_b16 v[204:205], v20 offset:36864
    ds_read_b64_tr_b16 v[206:207], v20 offset:37888
    v_mfma_f32_32x32x16_bf16 v[96:111], v[36:39], v[48:51], v[96:111]
    ds_read_b64_tr_b16 v[208:209], v21 offset:36864
    ds_read_b64_tr_b16 v[210:211], v21 offset:37888
    v_mfma_f32_32x32x16_bf16 v[112:127], v[36:39], v[52:55], v[112:127]
    s_waitcnt lgkmcnt(6)
    v_dot2_f32_bf16 v128, v44, s29, v128
    v_dot2_f32_bf16 v130, v44, v44, v130
    v_dot2_f32_bf16 v132, v56, s29, v132
    v_dot2_f32_bf16 v128, v45, s29, v128
    v_dot2_f32_bf16 v130, v45, v45, v130
    v_dot2_f32_bf16 v132, v57, s29, v132
    v_dot2_f32_bf16 v128, v46, s29, v128
    v_dot2_f32_bf16 v130, v46, v46, v130
    v_dot2_f32_bf16 v132, v58, s29, v132
    v_dot2_f32_bf16 v128, v47, s29, v128
    v_dot2_f32_bf16 v130, v47, v47, v130
    v_dot2_f32_bf16 v132, v59, s29, v132
    v_mfma_f32_32x32x16_bf16 v[64:79], v[40:43], v[56:59], v[64:79]
    ds_read_b128 v[32:35], v18 offset:32768
    ds_read_b128 v[36:39], v18 offset:36864
    v_mfma_f32_32x32x16_bf16 v[80:95], v[40:43], v[60:63], v[80:95]
    ds_read_b64_tr_b16 v[48:49], v20 offset:40960
    ds_read_b64_tr_b16 v[50:51], v20 offset:41984
    v_mfma_f32_32x32x16_bf16 v[96:111], v[44:47], v[56:59], v[96:111]
    ds_read_b64_tr_b16 v[52:53], v21 offset:40960
    ds_read_b64_tr_b16 v[54:55], v21 offset:41984
    v_mfma_f32_32x32x16_bf16 v[112:127], v[44:47], v[60:63], v[112:127]
    s_waitcnt lgkmcnt(6)
    v_dot2_f32_bf16 v128, v200, s29, v128
    v_dot2_f32_bf16 v130, v200, v200, v130
    v_dot2_f32_bf16 v132, v204, s29, v132
    v_dot2_f32_bf16 v128, v201, s29, v128
    v_dot2_f32_bf16 v130, v201, v201, v130
    v_dot2_f32_bf16 v132, v205, s29, v132
    v_dot2_f32_bf16 v128, v202, s29, v128
    v_dot2_f32_bf16 v130, v202, v202, v130
    v_dot2_f32_bf16 v132, v206, s29, v132
    v_dot2_f32_bf16 v128, v203, s29, v128
    v_dot2_f32_bf16 v130, v203, v203, v130
    v_dot2_f32_bf16 v132, v207, s29, v132
    v_mfma_f32_32x32x16_bf16 v[64:79], v[196:199], v[204:207], v[64:79]
    ds_read_b128 v[40:43], v19 offset:32768
    ds_read_b128 v[44:47], v19 offset:36864
    v_mfma_f32_32x32x16_bf16 v[80:95], v[196:199], v[208:211], v[80:95]
    ds_read_b64_tr_b16 v[56:57], v20 offset:45056
    ds_read_b64_tr_b16 v[58:59], v20 offset:46080
    v_mfma_f32_32x32x16_bf16 v[96:111], v[200:203], v[204:207], v[96:111]
    ds_read_b64_tr_b16 v[60:61], v21 offset:45056
    ds_read_b64_tr_b16 v[62:63], v21 offset:46080
    v_mfma_f32_32x32x16_bf16 v[112:127], v[200:203], v[208:211], v[112:127]
    s_waitcnt lgkmcnt(6)
    v_dot2_f32_bf16 v128, v36, s29, v128
    v_dot2_f32_bf16 v130, v36, v36, v130
    v_dot2_f32_bf16 v132, v48, s29, v132
    v_dot2_f32_bf16 v128, v37, s29, v128
    v_dot2_f32_bf16 v130, v37, v37, v130
    v_dot2_f32_bf16 v132, v49, s29, v132
    v_dot2_f32_bf16 v128, v38, s29, v128
    v_dot2_f32_bf16 v130, v38, v38, v130
    v_dot2_f32_bf16 v132, v50, s29, v132
    v_dot2_f32_bf16 v128, v39, s29, v128
    v_dot2_f32_bf16 v130, v39, v39, v130
    v_dot2_f32_bf16 v132, v51, s29, v132
    v_mfma_f32_32x32x16_bf16 v[64:79], v[32:35], v[48:51], v[64:79]
    s_barrier
    ds_read_b128 v[196:199], v4 offset:0
    ds_read_b128 v[200:203], v4 offset:4096
    v_mfma_f32_32x32x16_bf16 v[80:95], v[32:35], v[52:55], v[80:95]
    ds_read_b64_tr_b16 v[204:205], v8 offset:0
    ds_read_b64_tr_b16 v[206:207], v8 offset:1024
    v_mfma_f32_32x32x16_bf16 v[96:111], v[36:39], v[48:51], v[96:111]
    ds_read_b64_tr_b16 v[208:209], v9 offset:0
    ds_read_b64_tr_b16 v[210:211], v9 offset:1024
    v_mfma_f32_32x32x16_bf16 v[112:127], v[36:39], v[52:55], v[112:127]
    s_waitcnt lgkmcnt(6)
    v_dot2_f32_bf16 v128, v44, s29, v128
    v_dot2_f32_bf16 v130, v44, v44, v130
    v_dot2_f32_bf16 v132, v56, s29, v132
    v_dot2_f32_bf16 v128, v45, s29, v128
    v_dot2_f32_bf16 v130, v45, v45, v130
    v_dot2_f32_bf16 v132, v57, s29, v132
    v_dot2_f32_bf16 v128, v46, s29, v128
    v_dot2_f32_bf16 v130, v46, v46, v130
    v_dot2_f32_bf16 v132, v58, s29, v132
    v_dot2_f32_bf16 v128, v47, s29, v128
    v_dot2_f32_bf16 v130, v47, v47, v130
    v_dot2_f32_bf16 v132, v59, s29, v132
    v_mfma_f32_32x32x16_bf16 v[64:79], v[40:43], v[56:59], v[64:79]
    ds_read_b128 v[32:35], v5 offset:0
    ds_read_b128 v[36:39], v5 offset:4096
    v_mfma_f32_32x32x16_bf16 v[80:95], v[40:43], v[60:63], v[80:95]
    ds_read_b64_tr_b16 v[48:49], v8 offset:4096
    ds_read_b64_tr_b16 v[50:51], v8 offset:5120
    v_mfma_f32_32x32x16_bf16 v[96:111], v[44:47], v[56:59], v[96:111]
    ds_read_b64_tr_b16 v[52:53], v9 offset:4096
    ds_read_b64_tr_b16 v[54:55], v9 offset:5120
    v_mfma_f32_32x32x16_bf16 v[112:127], v[44:47], v[60:63], v[112:127]
    s_waitcnt lgkmcnt(6)
    v_dot2_f32_bf16 v128, v200, s29, v128
    v_dot2_f32_bf16 v130, v200, v200, v130
    v_dot2_f32_bf16 v132, v204, s29, v132
    v_dot2_f32_bf16 v128, v201, s29, v128
    v_dot2_f32_bf16 v130, v201, v201, v130
    v_dot2_f32_bf16 v132, v205, s29, v132
    v_dot2_f32_bf16 v128, v202, s29, v128
    v_dot2_f32_bf16 v130, v202, v202, v130
    v_dot2_f32_bf16 v132, v206, s29, v132
    v_dot2_f32_bf16 v128, v203, s29, v128
    v_dot2_f32_bf16 v130, v203, v203, v130
    v_dot2_f32_bf16 v132, v207, s29, v132
    v_mfma_f32_32x32x16_bf16 v[64:79], v[196:199], v[204:207], v[64:79]
    ds_read_b128 v[40:43], v6 offset:0
    ds_read_b128 v[44:47], v6 offset:4096
    v_mfma_f32_32x32x16_bf16 v[80:95], v[196:199], v[208:211], v[80:95]
    ds_read_b64_tr_b16 v[56:57], v8 offset:8192
    ds_read_b64_tr_b16 v[58:59], v8 offset:9216
    v_mfma_f32_32x32x16_bf16 v[96:111], v[200:203], v[204:207], v[96:111]
    ds_read_b64_tr_b16 v[60:61], v9 offset:8192
    ds_read_b64_tr_b16 v[62:63], v9 offset:9216
    v_mfma_f32_32x32x16_bf16 v[112:127], v[200:203], v[208:211], v[112:127]
    s_waitcnt lgkmcnt(6)
    v_dot2_f32_bf16 v128, v36, s29, v128
    v_dot2_f32_bf16 v130, v36, v36, v130
    v_dot2_f32_bf16 v132, v48, s29, v132
    v_dot2_f32_bf16 v128, v37, s29, v128
    v_dot2_f32_bf16 v130, v37, v37, v130
    v_dot2_f32_bf16 v132, v49, s29, v132
    v_dot2_f32_bf16 v128, v38, s29, v128
    v_dot2_f32_bf16 v130, v38, v38, v130
    v_dot2_f32_bf16 v132, v50, s29, v132
    v_dot2_f32_bf16 v128, v39, s29, v128
    v_dot2_f32_bf16 v130, v39, v39, v130
    v_dot2_f32_bf16 v132, v51, s29, v132
    v_mfma_f32_32x32x16_bf16 v[64:79], v[32:35], v[48:51], v[64:79]
    ds_read_b128 v[196:199], v7 offset:0
    ds_read_b128 v[200:203], v7 offset:4096
    v_mfma_f32_32x32x16_bf16 v[80:95], v[32:35], v[52:55], v[80:95]
    ds_read_b64_tr_b16 v[204:205], v8 offset:12288
    ds_read_b64_tr_b16 v[206:207], v8 offset:13312
    v_mfma_f32_32x32x16_bf16 v[96:111], v[36:39], v[48:51], v[96:111]
    ds_read_b64_tr_b16 v[208:209], v9 offset:12288
    ds_read_b64_tr_b16 v[210:211], v9 offset:13312
    v_mfma_f32_32x32x16_bf16 v[112:127], v[36:39], v[52:55], v[112:127]
    s_waitcnt lgkmcnt(6)
    v_dot2_f32_bf16 v128, v44, s29, v128
    v_dot2_f32_bf16 v130, v44, v44, v130
    v_dot2_f32_bf16 v132, v56, s29, v132
    v_dot2_f32_bf16 v128, v45, s29, v128
    v_dot2_f32_bf16 v130, v45, v45, v130
    v_dot2_f32_bf16 v132, v57, s29, v132
    v_dot2_f32_bf16 v128, v46, s29, v128
    v_dot2_f32_bf16 v130, v46, v46, v130
    v_dot2_f32_bf16 v132, v58, s29, v132
    v_dot2_f32_bf16 v128, v47, s29, v128
    v_dot2_f32_bf16 v130, v47, v47, v130
    v_dot2_f32_bf16 v132, v59, s29, v132
    v_mfma_f32_32x32x16_bf16 v[64:79], v[40:43], v[56:59], v[64:79]
    s_barrier
    ds_read_b128 v[32:35], v4 offset:32768
    ds_read_b128 v[36:39], v4 offset:36864
    v_mfma_f32_32x32x16_bf16 v[80:95], v[40:43], v[60:63], v[80:95]
    ds_read_b64_tr_b16 v[48:49], v8 offset:32768
    ds_read_b64_tr_b16 v[50:51], v8 offset:33792
    v_mfma_f32_32x32x16_bf16 v[96:111], v[44:47], v[56:59], v[96:111]
    ds_read_b64_tr_b16 v[52:53], v9 offset:32768
    ds_read_b64_tr_b16 v[54:55], v9 offset:33792
    v_mfma_f32_32x32x16_bf16 v[112:127], v[44:47], v[60:63], v[112:127]
    s_waitcnt lgkmcnt(6)
    v_dot2_f32_bf16 v128, v200, s29, v128
    v_dot2_f32_bf16 v130, v200, v200, v130
    v_dot2_f32_bf16 v132, v204, s29, v132
    v_dot2_f32_bf16 v128, v201, s29, v128
    v_dot2_f32_bf16 v130, v201, v201, v130
    v_dot2_f32_bf16 v132, v205, s29, v132
    v_dot2_f32_bf16 v128, v202, s29, v128
    v_dot2_f32_bf16 v130, v202, v202, v130
    v_dot2_f32_bf16 v132, v206, s29, v132
    v_dot2_f32_bf16 v128, v203, s29, v128
    v_dot2_f32_bf16 v130, v203, v203, v130
    v_dot2_f32_bf16 v132, v207, s29, v132
    v_mfma_f32_32x32x16_bf16 v[64:79], v[196:199], v[204:207], v[64:79]
    ds_read_b128 v[40:43], v5 offset:32768
    ds_read_b128 v[44:47], v5 offset:36864
    v_mfma_f32_32x32x16_bf16 v[80:95], v[196:199], v[208:211], v[80:95]
    ds_read_b64_tr_b16 v[56:57], v8 offset:36864
    ds_read_b64_tr_b16 v[58:59], v8 offset:37888
    v_mfma_f32_32x32x16_bf16 v[96:111], v[200:203], v[204:207], v[96:111]
    ds_read_b64_tr_b16 v[60:61], v9 offset:36864
    ds_read_b64_tr_b16 v[62:63], v9 offset:37888
    v_mfma_f32_32x32x16_bf16 v[112:127], v[200:203], v[208:211], v[112:127]
    s_waitcnt lgkmcnt(6)
    v_dot2_f32_bf16 v128, v36, s29, v128
    v_dot2_f32_bf16 v130, v36, v36, v130
    v_dot2_f32_bf16 v132, v48, s29, v132
    v_dot2_f32_bf16 v128, v37, s29, v128
    v_dot2_f32_bf16 v130, v37, v37, v130
    v_dot2_f32_bf16 v132, v49, s29, v132
    v_dot2_f32_bf16 v128, v38, s29, v128
    v_dot2_f32_bf16 v130, v38, v38, v130
    v_dot2_f32_bf16 v132, v50, s29, v132
    v_dot2_f32_bf16 v128, v39, s29, v128
    v_dot2_f32_bf16 v130, v39, v39, v130
    v_dot2_f32_bf16 v132, v51, s29, v132
    v_mfma_f32_32x32x16_bf16 v[64:79], v[32:35], v[48:51], v[64:79]
    ds_read_b128 v[196:199], v6 offset:32768
    ds_read_b128 v[200:203], v6 offset:36864
    v_mfma_f32_32x32x16_bf16 v[80:95], v[32:35], v[52:55], v[80:95]
    ds_read_b64_tr_b16 v[204:205], v8 offset:40960
    ds_read_b64_tr_b16 v[206:207], v8 offset:41984
    v_mfma_f32_32x32x16_bf16 v[96:111], v[36:39], v[48:51], v[96:111]
    ds_read_b64_tr_b16 v[208:209], v9 offset:40960
    ds_read_b64_tr_b16 v[210:211], v9 offset:41984
    v_mfma_f32_32x32x16_bf16 v[112:127], v[36:39], v[52:55], v[112:127]
    s_waitcnt lgkmcnt(6)
    v_dot2_f32_bf16 v128, v44, s29, v128
    v_dot2_f32_bf16 v130, v44, v44, v130
    v_dot2_f32_bf16 v132, v56, s29, v132
    v_dot2_f32_bf16 v128, v45, s29, v128
    v_dot2_f32_bf16 v130, v45, v45, v130
    v_dot2_f32_bf16 v132, v57, s29, v132
    v_dot2_f32_bf16 v128, v46, s29, v128
    v_dot2_f32_bf16 v130, v46, v46, v130
    v_dot2_f32_bf16 v132, v58, s29, v132
    v_dot2_f32_bf16 v128, v47, s29, v128
    v_dot2_f32_bf16 v130, v47, v47, v130
    v_dot2_f32_bf16 v132, v59, s29, v132
    v_mfma_f32_32x32x16_bf16 v[64:79], v[40:43], v[56:59], v[64:79]
    ds_read_b128 v[32:35], v7 offset:32768
    ds_read_b128 v[36:39], v7 offset:36864
    v_mfma_f32_32x32x16_bf16 v[80:95], v[40:43], v[60:63], v[80:95]
    ds_read_b64_tr_b16 v[48:49], v8 offset:45056
    ds_read_b64_tr_b16 v[50:51], v8 offset:46080
    v_mfma_f32_32x32x16_bf16 v[96:111], v[44:47], v[56:59], v[96:111]
    ds_read_b64_tr_b16 v[52:53], v9 offset:45056
    ds_read_b64_tr_b16 v[54:55], v9 offset:46080
    v_mfma_f32_32x32x16_bf16 v[112:127], v[44:47], v[60:63], v[112:127]
    s_waitcnt lgkmcnt(6)
    v_dot2_f32_bf16 v128, v200, s29, v128
    v_dot2_f32_bf16 v130, v200, v200, v130
    v_dot2_f32_bf16 v132, v204, s29, v132
    v_dot2_f32_bf16 v128, v201, s29, v128
    v_dot2_f32_bf16 v130, v201, v201, v130
    v_dot2_f32_bf16 v132, v205, s29, v132
    v_dot2_f32_bf16 v128, v202, s29, v128
    v_dot2_f32_bf16 v130, v202, v202, v130
    v_dot2_f32_bf16 v132, v206, s29, v132
    v_dot2_f32_bf16 v128, v203, s29, v128
    v_dot2_f32_bf16 v130, v203, v203, v130
    v_dot2_f32_bf16 v132, v207, s29, v132
    v_mfma_f32_32x32x16_bf16 v[64:79], v[196:199], v[204:207], v[64:79]
    s_barrier
    ds_read_b128 v[40:43], v10 offset:0
    ds_read_b128 v[44:47], v10 offset:4096
    v_mfma_f32_32x32x16_bf16 v[80:95], v[196:199], v[208:211], v[80:95]
    ds_read_b64_tr_b16 v[56:57], v14 offset:0
    ds_read_b64_tr_b16 v[58:59], v14 offset:1024
    v_mfma_f32_32x32x16_bf16 v[96:111], v[200:203], v[204:207], v[96:111]
    ds_read_b64_tr_b16 v[60:61], v15 offset:0
    ds_read_b64_tr_b16 v[62:63], v15 offset:1024
    v_mfma_f32_32x32x16_bf16 v[112:127], v[200:203], v[208:211], v[112:127]
    s_waitcnt lgkmcnt(6)
    v_dot2_f32_bf16 v128, v36, s29, v128
    v_dot2_f32_bf16 v130, v36, v36, v130
    v_dot2_f32_bf16 v132, v48, s29, v132
    v_dot2_f32_bf16 v128, v37, s29, v128
    v_dot2_f32_bf16 v130, v37, v37, v130
    v_dot2_f32_bf16 v132, v49, s29, v132
    v_dot2_f32_bf16 v128, v38, s29, v128
    v_dot2_f32_bf16 v130, v38, v38, v130
    v_dot2_f32_bf16 v132, v50, s29, v132
    v_dot2_f32_bf16 v128, v39, s29, v128
    v_dot2_f32_bf16 v130, v39, v39, v130
    v_dot2_f32_bf16 v132, v51, s29, v132
    v_mfma_f32_32x32x16_bf16 v[64:79], v[32:35], v[48:51], v[64:79]
    ds_read_b128 v[196:199], v11 offset:0
    ds_read_b128 v[200:203], v11 offset:4096
    v_mfma_f32_32x32x16_bf16 v[80:95], v[32:35], v[52:55], v[80:95]
    ds_read_b64_tr_b16 v[204:205], v14 offset:4096
    ds_read_b64_tr_b16 v[206:207], v14 offset:5120
    v_mfma_f32_32x32x16_bf16 v[96:111], v[36:39], v[48:51], v[96:111]
    ds_read_b64_tr_b16 v[208:209], v15 offset:4096
    ds_read_b64_tr_b16 v[210:211], v15 offset:5120
    v_mfma_f32_32x32x16_bf16 v[112:127], v[36:39], v[52:55], v[112:127]
    s_waitcnt lgkmcnt(6)
    v_dot2_f32_bf16 v128, v44, s29, v128
    v_dot2_f32_bf16 v130, v44, v44, v130
    v_dot2_f32_bf16 v132, v56, s29, v132
    v_dot2_f32_bf16 v128, v45, s29, v128
    v_dot2_f32_bf16 v130, v45, v45, v130
    v_dot2_f32_bf16 v132, v57, s29, v132
    v_dot2_f32_bf16 v128, v46, s29, v128
    v_dot2_f32_bf16 v130, v46, v46, v130
    v_dot2_f32_bf16 v132, v58, s29, v132
    v_dot2_f32_bf16 v128, v47, s29, v128
    v_dot2_f32_bf16 v130, v47, v47, v130
    v_dot2_f32_bf16 v132, v59, s29, v132
    v_mfma_f32_32x32x16_bf16 v[64:79], v[40:43], v[56:59], v[64:79]
    ds_read_b128 v[32:35], v12 offset:0
    ds_read_b128 v[36:39], v12 offset:4096
    v_mfma_f32_32x32x16_bf16 v[80:95], v[40:43], v[60:63], v[80:95]
    ds_read_b64_tr_b16 v[48:49], v14 offset:8192
    ds_read_b64_tr_b16 v[50:51], v14 offset:9216
    v_mfma_f32_32x32x16_bf16 v[96:111], v[44:47], v[56:59], v[96:111]
    ds_read_b64_tr_b16 v[52:53], v15 offset:8192
    ds_read_b64_tr_b16 v[54:55], v15 offset:9216
    v_mfma_f32_32x32x16_bf16 v[112:127], v[44:47], v[60:63], v[112:127]
    s_waitcnt lgkmcnt(6)
    v_dot2_f32_bf16 v128, v200, s29, v128
    v_dot2_f32_bf16 v130, v200, v200, v130
    v_dot2_f32_bf16 v132, v204, s29, v132
    v_dot2_f32_bf16 v128, v201, s29, v128
    v_dot2_f32_bf16 v130, v201, v201, v130
    v_dot2_f32_bf16 v132, v205, s29, v132
    v_dot2_f32_bf16 v128, v202, s29, v128
    v_dot2_f32_bf16 v130, v202, v202, v130
    v_dot2_f32_bf16 v132, v206, s29, v132
    v_dot2_f32_bf16 v128, v203, s29, v128
    v_dot2_f32_bf16 v130, v203, v203, v130
    v_dot2_f32_bf16 v132, v207, s29, v132
    v_mfma_f32_32x32x16_bf16 v[64:79], v[196:199], v[204:207], v[64:79]
    ds_read_b128 v[40:43], v13 offset:0
    ds_read_b128 v[44:47], v13 offset:4096
    v_mfma_f32_32x32x16_bf16 v[80:95], v[196:199], v[208:211], v[80:95]
    ds_read_b64_tr_b16 v[56:57], v14 offset:12288
    ds_read_b64_tr_b16 v[58:59], v14 offset:13312
    v_mfma_f32_32x32x16_bf16 v[96:111], v[200:203], v[204:207], v[96:111]
    ds_read_b64_tr_b16 v[60:61], v15 offset:12288
    ds_read_b64_tr_b16 v[62:63], v15 offset:13312
    v_mfma_f32_32x32x16_bf16 v[112:127], v[200:203], v[208:211], v[112:127]
    s_waitcnt lgkmcnt(6)
    v_dot2_f32_bf16 v128, v36, s29, v128
    v_dot2_f32_bf16 v130, v36, v36, v130
    v_dot2_f32_bf16 v132, v48, s29, v132
    v_dot2_f32_bf16 v128, v37, s29, v128
    v_dot2_f32_bf16 v130, v37, v37, v130
    v_dot2_f32_bf16 v132, v49, s29, v132
    v_dot2_f32_bf16 v128, v38, s29, v128
    v_dot2_f32_bf16 v130, v38, v38, v130
    v_dot2_f32_bf16 v132, v50, s29, v132
    v_dot2_f32_bf16 v128, v39, s29, v128
    v_dot2_f32_bf16 v130, v39, v39, v130
    v_dot2_f32_bf16 v132, v51, s29, v132
    v_mfma_f32_32x32x16_bf16 v[64:79], v[32:35], v[48:51], v[64:79]
    s_barrier
    ds_read_b128 v[196:199], v16 offset:0
    ds_read_b128 v[200:203], v16 offset:4096
    v_mfma_f32_32x32x16_bf16 v[80:95], v[32:35], v[52:55], v[80:95]
    ds_read_b64_tr_b16 v[204:205], v20 offset:0
    ds_read_b64_tr_b16 v[206:207], v20 offset:1024
    v_mfma_f32_32x32x16_bf16 v[96:111], v[36:39], v[48:51], v[96:111]
    ds_read_b64_tr_b16 v[208:209], v21 offset:0
    ds_read_b64_tr_b16 v[210:211], v21 offset:1024
    v_mfma_f32_32x32x16_bf16 v[112:127], v[36:39], v[52:55], v[112:127]
    s_waitcnt lgkmcnt(6)
    v_dot2_f32_bf16 v128, v44, s29, v128
    v_dot2_f32_bf16 v130, v44, v44, v130
    v_dot2_f32_bf16 v132, v56, s29, v132
    v_dot2_f32_bf16 v128, v45, s29, v128
    v_dot2_f32_bf16 v130, v45, v45, v130
    v_dot2_f32_bf16 v132, v57, s29, v132
    v_dot2_f32_bf16 v128, v46, s29, v128
    v_dot2_f32_bf16 v130, v46, v46, v130
    v_dot2_f32_bf16 v132, v58, s29, v132
    v_dot2_f32_bf16 v128, v47, s29, v128
    v_dot2_f32_bf16 v130, v47, v47, v130
    v_dot2_f32_bf16 v132, v59, s29, v132
    v_mfma_f32_32x32x16_bf16 v[64:79], v[40:43], v[56:59], v[64:79]
    ds_read_b128 v[32:35], v17 offset:0
    ds_read_b128 v[36:39], v17 offset:4096
    v_mfma_f32_32x32x16_bf16 v[80:95], v[40:43], v[60:63], v[80:95]
    ds_read_b64_tr_b16 v[48:49], v20 offset:4096
    ds_read_b64_tr_b16 v[50:51], v20 offset:5120
    v_mfma_f32_32x32x16_bf16 v[96:111], v[44:47], v[56:59], v[96:111]
    ds_read_b64_tr_b16 v[52:53], v21 offset:4096
    ds_read_b64_tr_b16 v[54:55], v21 offset:5120
    v_mfma_f32_32x32x16_bf16 v[112:127], v[44:47], v[60:63], v[112:127]
    s_waitcnt lgkmcnt(6)
    v_dot2_f32_bf16 v128, v200, s29, v128
    v_dot2_f32_bf16 v130, v200, v200, v130
    v_dot2_f32_bf16 v132, v204, s29, v132
    v_dot2_f32_bf16 v128, v201, s29, v128
    v_dot2_f32_bf16 v130, v201, v201, v130
    v_dot2_f32_bf16 v132, v205, s29, v132
    v_dot2_f32_bf16 v128, v202, s29, v128
    v_dot2_f32_bf16 v130, v202, v202, v130
    v_dot2_f32_bf16 v132, v206, s29, v132
    v_dot2_f32_bf16 v128, v203, s29, v128
    v_dot2_f32_bf16 v130, v203, v203, v130
    v_dot2_f32_bf16 v132, v207, s29, v132
    v_mfma_f32_32x32x16_bf16 v[64:79], v[196:199], v[204:207], v[64:79]
    ds_read_b128 v[40:43], v18 offset:0
    ds_read_b128 v[44:47], v18 offset:4096
    v_mfma_f32_32x32x16_bf16 v[80:95], v[196:199], v[208:211], v[80:95]
    ds_read_b64_tr_b16 v[56:57], v20 offset:8192
    ds_read_b64_tr_b16 v[58:59], v20 offset:9216
    v_mfma_f32_32x32x16_bf16 v[96:111], v[200:203], v[204:207], v[96:111]
    ds_read_b64_tr_b16 v[60:61], v21 offset:8192
    ds_read_b64_tr_b16 v[62:63], v21 offset:9216
    v_mfma_f32_32x32x16_bf16 v[112:127], v[200:203], v[208:211], v[112:127]
    s_waitcnt lgkmcnt(6)
    v_dot2_f32_bf16 v128, v36, s29, v128
    v_dot2_f32_bf16 v130, v36, v36, v130
    v_dot2_f32_bf16 v132, v48, s29, v132
    v_dot2_f32_bf16 v128, v37, s29, v128
    v_dot2_f32_bf16 v130, v37, v37, v130
    v_dot2_f32_bf16 v132, v49, s29, v132
    v_dot2_f32_bf16 v128, v38, s29, v128
    v_dot2_f32_bf16 v130, v38, v38, v130
    v_dot2_f32_bf16 v132, v50, s29, v132
    v_dot2_f32_bf16 v128, v39, s29, v128
    v_dot2_f32_bf16 v130, v39, v39, v130
    v_dot2_f32_bf16 v132, v51, s29, v132
    v_mfma_f32_32x32x16_bf16 v[64:79], v[32:35], v[48:51], v[64:79]
    ds_read_b128 v[196:199], v19 offset:0
    ds_read_b128 v[200:203], v19 offset:4096
    v_mfma_f32_32x32x16_bf16 v[80:95], v[32:35], v[52:55], v[80:95]
    ds_read_b64_tr_b16 v[204:205], v20 offset:12288
    ds_read_b64_tr_b16 v[206:207], v20 offset:13312
    v_mfma_f32_32x32x16_bf16 v[96:111], v[36:39], v[48:51], v[96:111]
    ds_read_b64_tr_b16 v[208:209], v21 offset:12288
    ds_read_b64_tr_b16 v[210:211], v21 offset:13312
    v_mfma_f32_32x32x16_bf16 v[112:127], v[36:39], v[52:55], v[112:127]
    s_waitcnt lgkmcnt(6)
    v_dot2_f32_bf16 v128, v44, s29, v128
    v_dot2_f32_bf16 v130, v44, v44, v130
    v_dot2_f32_bf16 v132, v56, s29, v132
    v_dot2_f32_bf16 v128, v45, s29, v128
    v_dot2_f32_bf16 v130, v45, v45, v130
    v_dot2_f32_bf16 v132, v57, s29, v132
    v_dot2_f32_bf16 v128, v46, s29, v128
    v_dot2_f32_bf16 v130, v46, v46, v130
    v_dot2_f32_bf16 v132, v58, s29, v132
    v_dot2_f32_bf16 v128, v47, s29, v128
    v_dot2_f32_bf16 v130, v47, v47, v130
    v_dot2_f32_bf16 v132, v59, s29, v132
    v_mfma_f32_32x32x16_bf16 v[64:79], v[40:43], v[56:59], v[64:79]
    s_barrier
    ds_read_b128 v[32:35], v16 offset:32768
    ds_read_b128 v[36:39], v16 offset:36864
    v_mfma_f32_32x32x16_bf16 v[80:95], v[40:43], v[60:63], v[80:95]
    ds_read_b64_tr_b16 v[48:49], v20 offset:32768
    ds_read_b64_tr_b16 v[50:51], v20 offset:33792
    v_mfma_f32_32x32x16_bf16 v[96:111], v[44:47], v[56:59], v[96:111]
    ds_read_b64_tr_b16 v[52:53], v21 offset:32768
    ds_read_b64_tr_b16 v[54:55], v21 offset:33792
    v_mfma_f32_32x32x16_bf16 v[112:127], v[44:47], v[60:63], v[112:127]
    s_waitcnt lgkmcnt(6)
    v_dot2_f32_bf16 v128, v200, s29, v128
    v_dot2_f32_bf16 v130, v200, v200, v130
    v_dot2_f32_bf16 v132, v204, s29, v132
    v_dot2_f32_bf16 v128, v201, s29, v128
    v_dot2_f32_bf16 v130, v201, v201, v130
    v_dot2_f32_bf16 v132, v205, s29, v132
    v_dot2_f32_bf16 v128, v202, s29, v128
    v_dot2_f32_bf16 v130, v202, v202, v130
    v_dot2_f32_bf16 v132, v206, s29, v132
    v_dot2_f32_bf16 v128, v203, s29, v128
    v_dot2_f32_bf16 v130, v203, v203, v130
    v_dot2_f32_bf16 v132, v207, s29, v132
    v_mfma_f32_32x32x16_bf16 v[64:79], v[196:199], v[204:207], v[64:79]
    ds_read_b128 v[40:43], v17 offset:32768
    ds_read_b128 v[44:47], v17 offset:36864
    v_mfma_f32_32x32x16_bf16 v[80:95], v[196:199], v[208:211], v[80:95]
    ds_read_b64_tr_b16 v[56:57], v20 offset:36864
    ds_read_b64_tr_b16 v[58:59], v20 offset:37888
    v_mfma_f32_32x32x16_bf16 v[96:111], v[200:203], v[204:207], v[96:111]
    ds_read_b64_tr_b16 v[60:61], v21 offset:36864
    ds_read_b64_tr_b16 v[62:63], v21 offset:37888
    v_mfma_f32_32x32x16_bf16 v[112:127], v[200:203], v[208:211], v[112:127]
    s_waitcnt lgkmcnt(6)
    v_dot2_f32_bf16 v128, v36, s29, v128
    v_dot2_f32_bf16 v130, v36, v36, v130
    v_dot2_f32_bf16 v132, v48, s29, v132
    v_dot2_f32_bf16 v128, v37, s29, v128
    v_dot2_f32_bf16 v130, v37, v37, v130
    v_dot2_f32_bf16 v132, v49, s29, v132
    v_dot2_f32_bf16 v128, v38, s29, v128
    v_dot2_f32_bf16 v130, v38, v38, v130
    v_dot2_f32_bf16 v132, v50, s29, v132
    v_dot2_f32_bf16 v128, v39, s29, v128
    v_dot2_f32_bf16 v130, v39, v39, v130
    v_dot2_f32_bf16 v132, v51, s29, v132
    v_mfma_f32_32x32x16_bf16 v[64:79], v[32:35], v[48:51], v[64:79]
    ds_read_b128 v[196:199], v18 offset:32768
    ds_read_b128 v[200:203], v18 offset:36864
    v_mfma_f32_32x32x16_bf16 v[80:95], v[32:35], v[52:55], v[80:95]
    ds_read_b64_tr_b16 v[204:205], v20 offset:40960
    ds_read_b64_tr_b16 v[206:207], v20 offset:41984
    v_mfma_f32_32x32x16_bf16 v[96:111], v[36:39], v[48:51], v[96:111]
    ds_read_b64_tr_b16 v[208:209], v21 offset:40960
    ds_read_b64_tr_b16 v[210:211], v21 offset:41984
    v_mfma_f32_32x32x16_bf16 v[112:127], v[36:39], v[52:55], v[112:127]
    s_waitcnt lgkmcnt(6)
    v_dot2_f32_bf16 v128, v44, s29, v128
    v_dot2_f32_bf16 v130, v44, v44, v130
    v_dot2_f32_bf16 v132, v56, s29, v132
    v_dot2_f32_bf16 v128, v45, s29, v128
    v_dot2_f32_bf16 v130, v45, v45, v130
    v_dot2_f32_bf16 v132, v57, s29, v132
    v_dot2_f32_bf16 v128, v46, s29, v128
    v_dot2_f32_bf16 v130, v46, v46, v130
    v_dot2_f32_bf16 v132, v58, s29, v132
    v_dot2_f32_bf16 v128, v47, s29, v128
    v_dot2_f32_bf16 v130, v47, v47, v130
    v_dot2_f32_bf16 v132, v59, s29, v132
    v_mfma_f32_32x32x16_bf16 v[64:79], v[40:43], v[56:59], v[64:79]
    ds_read_b128 v[32:35], v19 offset:32768
    ds_read_b128 v[36:39], v19 offset:36864
    v_mfma_f32_32x32x16_bf16 v[80:95], v[40:43], v[60:63], v[80:95]
    ds_read_b64_tr_b16 v[48:49], v20 offset:45056
    ds_read_b64_tr_b16 v[50:51], v20 offset:46080
    v_mfma_f32_32x32x16_bf16 v[96:111], v[44:47], v[56:59], v[96:111]
    ds_read_b64_tr_b16 v[52:53], v21 offset:45056
    ds_read_b64_tr_b16 v[54:55], v21 offset:46080
    v_mfma_f32_32x32x16_bf16 v[112:127], v[44:47], v[60:63], v[112:127]
    s_waitcnt lgkmcnt(6)
    v_dot2_f32_bf16 v128, v200, s29, v128
    v_dot2_f32_bf16 v130, v200, v200, v130
    v_dot2_f32_bf16 v132, v204, s29, v132
    v_dot2_f32_bf16 v128, v201, s29, v128
    v_dot2_f32_bf16 v130, v201, v201, v130
    v_dot2_f32_bf16 v132, v205, s29, v132
    v_dot2_f32_bf16 v128, v202, s29, v128
    v_dot2_f32_bf16 v130, v202, v202, v130
    v_dot2_f32_bf16 v132, v206, s29, v132
    v_dot2_f32_bf16 v128, v203, s29, v128
    v_dot2_f32_bf16 v130, v203, v203, v130
    v_dot2_f32_bf16 v132, v207, s29, v132
    v_mfma_f32_32x32x16_bf16 v[64:79], v[196:199], v[204:207], v[64:79]
    s_barrier
    ds_read_b128 v[40:43], v4 offset:0
    ds_read_b128 v[44:47], v4 offset:4096
    v_mfma_f32_32x32x16_bf16 v[80:95], v[196:199], v[208:211], v[80:95]
    ds_read_b64_tr_b16 v[56:57], v8 offset:0
    ds_read_b64_tr_b16 v[58:59], v8 offset:1024
    v_mfma_f32_32x32x16_bf16 v[96:111], v[200:203], v[204:207], v[96:111]
    ds_read_b64_tr_b16 v[60:61], v9 offset:0
    ds_read_b64_tr_b16 v[62:63], v9 offset:1024
    v_mfma_f32_32x32x16_bf16 v[112:127], v[200:203], v[208:211], v[112:127]
    s_waitcnt lgkmcnt(6)
    v_dot2_f32_bf16 v128, v36, s29, v128
    v_dot2_f32_bf16 v130, v36, v36, v130
    v_dot2_f32_bf16 v132, v48, s29, v132
    v_dot2_f32_bf16 v128, v37, s29, v128
    v_dot2_f32_bf16 v130, v37, v37, v130
    v_dot2_f32_bf16 v132, v49, s29, v132
    v_dot2_f32_bf16 v128, v38, s29, v128
    v_dot2_f32_bf16 v130, v38, v38, v130
    v_dot2_f32_bf16 v132, v50, s29, v132
    v_dot2_f32_bf16 v128, v39, s29, v128
    v_dot2_f32_bf16 v130, v39, v39, v130
    v_dot2_f32_bf16 v132, v51, s29, v132
    v_mfma_f32_32x32x16_bf16 v[64:79], v[32:35], v[48:51], v[64:79]
    ds_read_b128 v[196:199], v5 offset:0
    ds_read_b128 v[200:203], v5 offset:4096
    v_mfma_f32_32x32x16_bf16 v[80:95], v[32:35], v[52:55], v[80:95]
    ds_read_b64_tr_b16 v[204:205], v8 offset:4096
    ds_read_b64_tr_b16 v[206:207], v8 offset:5120
    v_mfma_f32_32x32x16_bf16 v[96:111], v[36:39], v[48:51], v[96:111]
    ds_read_b64_tr_b16 v[208:209], v9 offset:4096
    ds_read_b64_tr_b16 v[210:211], v9 offset:5120
    v_mfma_f32_32x32x16_bf16 v[112:127], v[36:39], v[52:55], v[112:127]
    s_waitcnt lgkmcnt(6)
    v_dot2_f32_bf16 v128, v44, s29, v128
    v_dot2_f32_bf16 v130, v44, v44, v130
    v_dot2_f32_bf16 v132, v56, s29, v132
    v_dot2_f32_bf16 v128, v45, s29, v128
    v_dot2_f32_bf16 v130, v45, v45, v130
    v_dot2_f32_bf16 v132, v57, s29, v132
    v_dot2_f32_bf16 v128, v46, s29, v128
    v_dot2_f32_bf16 v130, v46, v46, v130
    v_dot2_f32_bf16 v132, v58, s29, v132
    v_dot2_f32_bf16 v128, v47, s29, v128
    v_dot2_f32_bf16 v130, v47, v47, v130
    v_dot2_f32_bf16 v132, v59, s29, v132
    v_mfma_f32_32x32x16_bf16 v[64:79], v[40:43], v[56:59], v[64:79]
    ds_read_b128 v[32:35], v6 offset:0
    ds_read_b128 v[36:39], v6 offset:4096
    v_mfma_f32_32x32x16_bf16 v[80:95], v[40:43], v[60:63], v[80:95]
    ds_read_b64_tr_b16 v[48:49], v8 offset:8192
    ds_read_b64_tr_b16 v[50:51], v8 offset:9216
    v_mfma_f32_32x32x16_bf16 v[96:111], v[44:47], v[56:59], v[96:111]
    ds_read_b64_tr_b16 v[52:53], v9 offset:8192
    ds_read_b64_tr_b16 v[54:55], v9 offset:9216
    v_mfma_f32_32x32x16_bf16 v[112:127], v[44:47], v[60:63], v[112:127]
    s_waitcnt lgkmcnt(6)
    v_dot2_f32_bf16 v128, v200, s29, v128
    v_dot2_f32_bf16 v130, v200, v200, v130
    v_dot2_f32_bf16 v132, v204, s29, v132
    v_dot2_f32_bf16 v128, v201, s29, v128
    v_dot2_f32_bf16 v130, v201, v201, v130
    v_dot2_f32_bf16 v132, v205, s29, v132
    v_dot2_f32_bf16 v128, v202, s29, v128
    v_dot2_f32_bf16 v130, v202, v202, v130
    v_dot2_f32_bf16 v132, v206, s29, v132
    v_dot2_f32_bf16 v128, v203, s29, v128
    v_dot2_f32_bf16 v130, v203, v203, v130
    v_dot2_f32_bf16 v132, v207, s29, v132
    v_mfma_f32_32x32x16_bf16 v[64:79], v[196:199], v[204:207], v[64:79]
    ds_read_b128 v[40:43], v7 offset:0
    ds_read_b128 v[44:47], v7 offset:4096
    v_mfma_f32_32x32x16_bf16 v[80:95], v[196:199], v[208:211], v[80:95]
    ds_read_b64_tr_b16 v[56:57], v8 offset:12288
    ds_read_b64_tr_b16 v[58:59], v8 offset:13312
    v_mfma_f32_32x32x16_bf16 v[96:111], v[200:203], v[204:207], v[96:111]
    ds_read_b64_tr_b16 v[60:61], v9 offset:12288
    ds_read_b64_tr_b16 v[62:63], v9 offset:13312
    v_mfma_f32_32x32x16_bf16 v[112:127], v[200:203], v[208:211], v[112:127]
    s_waitcnt lgkmcnt(6)
    v_dot2_f32_bf16 v128, v36, s29, v128
    v_dot2_f32_bf16 v130, v36, v36, v130
    v_dot2_f32_bf16 v132, v48, s29, v132
    v_dot2_f32_bf16 v128, v37, s29, v128
    v_dot2_f32_bf16 v130, v37, v37, v130
    v_dot2_f32_bf16 v132, v49, s29, v132
    v_dot2_f32_bf16 v128, v38, s29, v128
    v_dot2_f32_bf16 v130, v38, v38, v130
    v_dot2_f32_bf16 v132, v50, s29, v132
    v_dot2_f32_bf16 v128, v39, s29, v128
    v_dot2_f32_bf16 v130, v39, v39, v130
    v_dot2_f32_bf16 v132, v51, s29, v132
    v_mfma_f32_32x32x16_bf16 v[64:79], v[32:35], v[48:51], v[64:79]
    v_mfma_f32_32x32x16_bf16 v[80:95], v[32:35], v[52:55], v[80:95]
    v_mfma_f32_32x32x16_bf16 v[96:111], v[36:39], v[48:51], v[96:111]
    v_mfma_f32_32x32x16_bf16 v[112:127], v[36:39], v[52:55], v[112:127]
    s_waitcnt lgkmcnt(0)
    v_dot2_f32_bf16 v128, v44, s29, v128
    v_dot2_f32_bf16 v130, v44, v44, v130
    v_dot2_f32_bf16 v132, v56, s29, v132
    v_dot2_f32_bf16 v128, v45, s29, v128
    v_dot2_f32_bf16 v130, v45, v45, v130
    v_dot2_f32_bf16 v132, v57, s29, v132
    v_dot2_f32_bf16 v128, v46, s29, v128
    v_dot2_f32_bf16 v130, v46, v46, v130
    v_dot2_f32_bf16 v132, v58, s29, v132
    v_dot2_f32_bf16 v128, v47, s29, v128
    v_dot2_f32_bf16 v130, v47, v47, v130
    v_dot2_f32_bf16 v132, v59, s29, v132
    v_mfma_f32_32x32x16_bf16 v[64:79], v[40:43], v[56:59], v[64:79]
    v_mfma_f32_32x32x16_bf16 v[80:95], v[40:43], v[60:63], v[80:95]
    v_mfma_f32_32x32x16_bf16 v[96:111], v[44:47], v[56:59], v[96:111]
    v_mfma_f32_32x32x16_bf16 v[112:127], v[44:47], v[60:63], v[112:127]
    s_branch qkv_a_kernel_ve
qkv_a_kernel_v2:
    s_cmp_lg_u32 s26, 2
    s_cbranch_scc1 qkv_a_kernel_v3
    v_mov_b32 v64, 0
    v_mov_b32 v65, 0
    v_mov_b32 v66, 0
    v_mov_b32 v67, 0
    v_mov_b32 v68, 0
    v_mov_b32 v69, 0
    v_mov_b32 v70, 0
    v_mov_b32 v71, 0
    v_mov_b32 v72, 0
    v_mov_b32 v73, 0
    v_mov_b32 v74, 0
    v_mov_b32 v75, 0
    v_mov_b32 v76, 0
    v_mov_b32 v77, 0
    v_mov_b32 v78, 0
    v_mov_b32 v79, 0
    v_mov_b32 v80, 0
    v_mov_b32 v81, 0
    v_mov_b32 v82, 0
    v_mov_b32 v83, 0
    v_mov_b32 v84, 0
    v_mov_b32 v85, 0
    v_mov_b32 v86, 0
    v_mov_b32 v87, 0
    v_mov_b32 v88, 0
    v_mov_b32 v89, 0
    v_mov_b32 v90, 0
    v_mov_b32 v91, 0
    v_mov_b32 v92, 0
    v_mov_b32 v93, 0
    v_mov_b32 v94, 0
    v_mov_b32 v95, 0
    v_mov_b32 v96, 0
    v_mov_b32 v97, 0
    v_mov_b32 v98, 0
    v_mov_b32 v99, 0
    v_mov_b32 v100, 0
    v_mov_b32 v101, 0
    v_mov_b32 v102, 0
    v_mov_b32 v103, 0
    v_mov_b32 v104, 0
    v_mov_b32 v105, 0
    v_mov_b32 v106, 0
    v_mov_b32 v107, 0
    v_mov_b32 v108, 0
    v_mov_b32 v109, 0
    v_mov_b32 v110, 0
    v_mov_b32 v111, 0
    v_mov_b32 v112, 0
    v_mov_b32 v113, 0
    v_mov_b32 v114, 0
    v_mov_b32 v115, 0
    v_mov_b32 v116, 0
    v_mov_b32 v117, 0
    v_mov_b32 v118, 0
    v_mov_b32 v119, 0
    v_mov_b32 v120, 0
    v_mov_b32 v121, 0
    v_mov_b32 v122, 0
    v_mov_b32 v123, 0
    v_mov_b32 v124, 0
    v_mov_b32 v125, 0
    v_mov_b32 v126, 0
    v_mov_b32 v127, 0
    v_mov_b32 v128, 0
    v_mov_b32 v129, 0
    v_mov_b32 v130, 0
    v_mov_b32 v131, 0
    v_mov_b32 v132, 0
    v_mov_b32 v133, 0
    s_barrier
    ds_read_b128 v[32:35], v16 offset:0
    ds_read_b128 v[36:39], v16 offset:4096
    ds_read_b64_tr_b16 v[48:49], v20 offset:0
    ds_read_b64_tr_b16 v[50:51], v20 offset:1024
    ds_read_b64_tr_b16 v[52:53], v21 offset:0
    ds_read_b64_tr_b16 v[54:55], v21 offset:1024
    ds_read_b128 v[40:43], v17 offset:0
    ds_read_b128 v[44:47], v17 offset:4096
    ds_read_b64_tr_b16 v[56:57], v20 offset:4096
    ds_read_b64_tr_b16 v[58:59], v20 offset:5120
    ds_read_b64_tr_b16 v[60:61], v21 offset:4096
    ds_read_b64_tr_b16 v[62:63], v21 offset:5120
    s_waitcnt lgkmcnt(6)
    v_dot2_f32_bf16 v128, v32, s29, v128
    v_dot2_f32_bf16 v130, v32, v32, v130
    v_dot2_f32_bf16 v132, v52, s29, v132
    v_dot2_f32_bf16 v128, v33, s29, v128
    v_dot2_f32_bf16 v130, v33, v33, v130
    v_dot2_f32_bf16 v132, v53, s29, v132
    v_dot2_f32_bf16 v128, v34, s29, v128
    v_dot2_f32_bf16 v130, v34, v34, v130
    v_dot2_f32_bf16 v132, v54, s29, v132
    v_dot2_f32_bf16 v128, v35, s29, v128
    v_dot2_f32_bf16 v130, v35, v35, v130
    v_dot2_f32_bf16 v132, v55, s29, v132
    v_mfma_f32_32x32x16_bf16 v[64:79], v[32:35], v[48:51], v[64:79]
    ds_read_b128 v[196:199], v18 offset:0
    ds_read_b128 v[200:203], v18 offset:4096
    v_mfma_f32_32x32x16_bf16 v[80:95], v[32:35], v[52:55], v[80:95]
    ds_read_b64_tr_b16 v[204:205], v20 offset:8192
    ds_read_b64_tr_b16 v[206:207], v20 offset:9216
    v_mfma_f32_32x32x16_bf16 v[96:111], v[36:39], v[48:51], v[96:111]
    ds_read_b64_tr_b16 v[208:209], v21 offset:8192
    ds_read_b64_tr_b16 v[210:211], v21 offset:9216
    v_mfma_f32_32x32x16_bf16 v[112:127], v[36:39], v[52:55], v[112:127]
    s_waitcnt lgkmcnt(6)
    v_dot2_f32_bf16 v128, v40, s29, v128
    v_dot2_f32_bf16 v130, v40, v40, v130
    v_dot2_f32_bf16 v132, v60, s29, v132
    v_dot2_f32_bf16 v128, v41, s29, v128
    v_dot2_f32_bf16 v130, v41, v41, v130
    v_dot2_f32_bf16 v132, v61, s29, v132
    v_dot2_f32_bf16 v128, v42, s29, v128
    v_dot2_f32_bf16 v130, v42, v42, v130
    v_dot2_f32_bf16 v132, v62, s29, v132
    v_dot2_f32_bf16 v128, v43, s29, v128
    v_dot2_f32_bf16 v130, v43, v43, v130
    v_dot2_f32_bf16 v132, v63, s29, v132
    v_mfma_f32_32x32x16_bf16 v[64:79], v[40:43], v[56:59], v[64:79]
    ds_read_b128 v[32:35], v19 offset:0
    ds_read_b128 v[36:39], v19 offset:4096
    v_mfma_f32_32x32x16_bf16 v[80:95], v[40:43], v[60:63], v[80:95]
    ds_read_b64_tr_b16 v[48:49], v20 offset:12288
    ds_read_b64_tr_b16 v[50:51], v20 offset:13312
    v_mfma_f32_32x32x16_bf16 v[96:111], v[44:47], v[56:59], v[96:111]
    ds_read_b64_tr_b16 v[52:53], v21 offset:12288
    ds_read_b64_tr_b16 v[54:55], v21 offset:13312
    v_mfma_f32_32x32x16_bf16 v[112:127], v[44:47], v[60:63], v[112:127]
    s_waitcnt lgkmcnt(6)
    v_dot2_f32_bf16 v128, v196, s29, v128
    v_dot2_f32_bf16 v130, v196, v196, v130
    v_dot2_f32_bf16 v132, v208, s29, v132
    v_dot2_f32_bf16 v128, v197, s29, v128
    v_dot2_f32_bf16 v130, v197, v197, v130
    v_dot2_f32_bf16 v132, v209, s29, v132
    v_dot2_f32_bf16 v128, v198, s29, v128
    v_dot2_f32_bf16 v130, v198, v198, v130
    v_dot2_f32_bf16 v132, v210, s29, v132
    v_dot2_f32_bf16 v128, v199, s29, v128
    v_dot2_f32_bf16 v130, v199, v199, v130
    v_dot2_f32_bf16 v132, v211, s29, v132
    v_mfma_f32_32x32x16_bf16 v[64:79], v[196:199], v[204:207], v[64:79]
    s_barrier
    ds_read_b128 v[40:43], v16 offset:32768
    ds_read_b128 v[44:47], v16 offset:36864
    v_mfma_f32_32x32x16_bf16 v[80:95], v[196:199], v[208:211], v[80:95]
    ds_read_b64_tr_b16 v[56:57], v20 offset:32768
    ds_read_b64_tr_b16 v[58:59], v20 offset:33792
    v_mfma_f32_32x32x16_bf16 v[96:111], v[200:203], v[204:207], v[96:111]
    ds_read_b64_tr_b16 v[60:61], v21 offset:32768
    ds_read_b64_tr_b16 v[62:63], v21 offset:33792
    v_mfma_f32_32x32x16_bf16 v[112:127], v[200:203], v[208:211], v[112:127]
    s_waitcnt lgkmcnt(6)
    v_dot2_f32_bf16 v128, v32, s29, v128
    v_dot2_f32_bf16 v130, v32, v32, v130
    v_dot2_f32_bf16 v132, v52, s29, v132
    v_dot2_f32_bf16 v128, v33, s29, v128
    v_dot2_f32_bf16 v130, v33, v33, v130
    v_dot2_f32_bf16 v132, v53, s29, v132
    v_dot2_f32_bf16 v128, v34, s29, v128
    v_dot2_f32_bf16 v130, v34, v34, v130
    v_dot2_f32_bf16 v132, v54, s29, v132
    v_dot2_f32_bf16 v128, v35, s29, v128
    v_dot2_f32_bf16 v130, v35, v35, v130
    v_dot2_f32_bf16 v132, v55, s29, v132
    v_mfma_f32_32x32x16_bf16 v[64:79], v[32:35], v[48:51], v[64:79]
    ds_read_b128 v[196:199], v17 offset:32768
    ds_read_b128 v[200:203], v17 offset:36864
    v_mfma_f32_32x32x16_bf16 v[80:95], v[32:35], v[52:55], v[80:95]
    ds_read_b64_tr_b16 v[204:205], v20 offset:36864
    ds_read_b64_tr_b16 v[206:207], v20 offset:37888
    v_mfma_f32_32x32x16_bf16 v[96:111], v[36:39], v[48:51], v[96:111]
    ds_read_b64_tr_b16 v[208:209], v21 offset:36864
    ds_read_b64_tr_b16 v[210:211], v21 offset:37888
    v_mfma_f32_32x32x16_bf16 v[112:127], v[36:39], v[52:55], v[112:127]
    s_waitcnt lgkmcnt(6)
    v_dot2_f32_bf16 v128, v40, s29, v128
    v_dot2_f32_bf16 v130, v40, v40, v130
    v_dot2_f32_bf16 v132, v60, s29, v132
    v_dot2_f32_bf16 v128, v41, s29, v128
    v_dot2_f32_bf16 v130, v41, v41, v130
    v_dot2_f32_bf16 v132, v61, s29, v132
    v_dot2_f32_bf16 v128, v42, s29, v128
    v_dot2_f32_bf16 v130, v42, v42, v130
    v_dot2_f32_bf16 v132, v62, s29, v132
    v_dot2_f32_bf16 v128, v43, s29, v128
    v_dot2_f32_bf16 v130, v43, v43, v130
    v_dot2_f32_bf16 v132, v63, s29, v132
    v_mfma_f32_32x32x16_bf16 v[64:79], v[40:43], v[56:59], v[64:79]
    ds_read_b128 v[32:35], v18 offset:32768
    ds_read_b128 v[36:39], v18 offset:36864
    v_mfma_f32_32x32x16_bf16 v[80:95], v[40:43], v[60:63], v[80:95]
    ds_read_b64_tr_b16 v[48:49], v20 offset:40960
    ds_read_b64_tr_b16 v[50:51], v20 offset:41984
    v_mfma_f32_32x32x16_bf16 v[96:111], v[44:47], v[56:59], v[96:111]
    ds_read_b64_tr_b16 v[52:53], v21 offset:40960
    ds_read_b64_tr_b16 v[54:55], v21 offset:41984
    v_mfma_f32_32x32x16_bf16 v[112:127], v[44:47], v[60:63], v[112:127]
    s_waitcnt lgkmcnt(6)
    v_dot2_f32_bf16 v128, v196, s29, v128
    v_dot2_f32_bf16 v130, v196, v196, v130
    v_dot2_f32_bf16 v132, v208, s29, v132
    v_dot2_f32_bf16 v128, v197, s29, v128
    v_dot2_f32_bf16 v130, v197, v197, v130
    v_dot2_f32_bf16 v132, v209, s29, v132
    v_dot2_f32_bf16 v128, v198, s29, v128
    v_dot2_f32_bf16 v130, v198, v198, v130
    v_dot2_f32_bf16 v132, v210, s29, v132
    v_dot2_f32_bf16 v128, v199, s29, v128
    v_dot2_f32_bf16 v130, v199, v199, v130
    v_dot2_f32_bf16 v132, v211, s29, v132
    v_mfma_f32_32x32x16_bf16 v[64:79], v[196:199], v[204:207], v[64:79]
    ds_read_b128 v[40:43], v19 offset:32768
    ds_read_b128 v[44:47], v19 offset:36864
    v_mfma_f32_32x32x16_bf16 v[80:95], v[196:199], v[208:211], v[80:95]
    ds_read_b64_tr_b16 v[56:57], v20 offset:45056
    ds_read_b64_tr_b16 v[58:59], v20 offset:46080
    v_mfma_f32_32x32x16_bf16 v[96:111], v[200:203], v[204:207], v[96:111]
    ds_read_b64_tr_b16 v[60:61], v21 offset:45056
    ds_read_b64_tr_b16 v[62:63], v21 offset:46080
    v_mfma_f32_32x32x16_bf16 v[112:127], v[200:203], v[208:211], v[112:127]
    s_waitcnt lgkmcnt(6)
    v_dot2_f32_bf16 v128, v32, s29, v128
    v_dot2_f32_bf16 v130, v32, v32, v130
    v_dot2_f32_bf16 v132, v52, s29, v132
    v_dot2_f32_bf16 v128, v33, s29, v128
    v_dot2_f32_bf16 v130, v33, v33, v130
    v_dot2_f32_bf16 v132, v53, s29, v132
    v_dot2_f32_bf16 v128, v34, s29, v128
    v_dot2_f32_bf16 v130, v34, v34, v130
    v_dot2_f32_bf16 v132, v54, s29, v132
    v_dot2_f32_bf16 v128, v35, s29, v128
    v_dot2_f32_bf16 v130, v35, v35, v130
    v_dot2_f32_bf16 v132, v55, s29, v132
    v_mfma_f32_32x32x16_bf16 v[64:79], v[32:35], v[48:51], v[64:79]
    s_barrier
    ds_read_b128 v[196:199], v4 offset:0
    ds_read_b128 v[200:203], v4 offset:4096
    v_mfma_f32_32x32x16_bf16 v[80:95], v[32:35], v[52:55], v[80:95]
    ds_read_b64_tr_b16 v[204:205], v8 offset:0
    ds_read_b64_tr_b16 v[206:207], v8 offset:1024
    v_mfma_f32_32x32x16_bf16 v[96:111], v[36:39], v[48:51], v[96:111]
    ds_read_b64_tr_b16 v[208:209], v9 offset:0
    ds_read_b64_tr_b16 v[210:211], v9 offset:1024
    v_mfma_f32_32x32x16_bf16 v[112:127], v[36:39], v[52:55], v[112:127]
    s_waitcnt lgkmcnt(6)
    v_dot2_f32_bf16 v128, v40, s29, v128
    v_dot2_f32_bf16 v130, v40, v40, v130
    v_dot2_f32_bf16 v132, v60, s29, v132
    v_dot2_f32_bf16 v128, v41, s29, v128
    v_dot2_f32_bf16 v130, v41, v41, v130
    v_dot2_f32_bf16 v132, v61, s29, v132
    v_dot2_f32_bf16 v128, v42, s29, v128
    v_dot2_f32_bf16 v130, v42, v42, v130
    v_dot2_f32_bf16 v132, v62, s29, v132
    v_dot2_f32_bf16 v128, v43, s29, v128
    v_dot2_f32_bf16 v130, v43, v43, v130
    v_dot2_f32_bf16 v132, v63, s29, v132
    v_mfma_f32_32x32x16_bf16 v[64:79], v[40:43], v[56:59], v[64:79]
    ds_read_b128 v[32:35], v5 offset:0
    ds_read_b128 v[36:39], v5 offset:4096
    v_mfma_f32_32x32x16_bf16 v[80:95], v[40:43], v[60:63], v[80:95]
    ds_read_b64_tr_b16 v[48:49], v8 offset:4096
    ds_read_b64_tr_b16 v[50:51], v8 offset:5120
    v_mfma_f32_32x32x16_bf16 v[96:111], v[44:47], v[56:59], v[96:111]
    ds_read_b64_tr_b16 v[52:53], v9 offset:4096
    ds_read_b64_tr_b16 v[54:55], v9 offset:5120
    v_mfma_f32_32x32x16_bf16 v[112:127], v[44:47], v[60:63], v[112:127]
    s_waitcnt lgkmcnt(6)
    v_dot2_f32_bf16 v128, v196, s29, v128
    v_dot2_f32_bf16 v130, v196, v196, v130
    v_dot2_f32_bf16 v132, v208, s29, v132
    v_dot2_f32_bf16 v128, v197, s29, v128
    v_dot2_f32_bf16 v130, v197, v197, v130
    v_dot2_f32_bf16 v132, v209, s29, v132
    v_dot2_f32_bf16 v128, v198, s29, v128
    v_dot2_f32_bf16 v130, v198, v198, v130
    v_dot2_f32_bf16 v132, v210, s29, v132
    v_dot2_f32_bf16 v128, v199, s29, v128
    v_dot2_f32_bf16 v130, v199, v199, v130
    v_dot2_f32_bf16 v132, v211, s29, v132
    v_mfma_f32_32x32x16_bf16 v[64:79], v[196:199], v[204:207], v[64:79]
    ds_read_b128 v[40:43], v6 offset:0
    ds_read_b128 v[44:47], v6 offset:4096
    v_mfma_f32_32x32x16_bf16 v[80:95], v[196:199], v[208:211], v[80:95]
    ds_read_b64_tr_b16 v[56:57], v8 offset:8192
    ds_read_b64_tr_b16 v[58:59], v8 offset:9216
    v_mfma_f32_32x32x16_bf16 v[96:111], v[200:203], v[204:207], v[96:111]
    ds_read_b64_tr_b16 v[60:61], v9 offset:8192
    ds_read_b64_tr_b16 v[62:63], v9 offset:9216
    v_mfma_f32_32x32x16_bf16 v[112:127], v[200:203], v[208:211], v[112:127]
    s_waitcnt lgkmcnt(6)
    v_dot2_f32_bf16 v128, v32, s29, v128
    v_dot2_f32_bf16 v130, v32, v32, v130
    v_dot2_f32_bf16 v132, v52, s29, v132
    v_dot2_f32_bf16 v128, v33, s29, v128
    v_dot2_f32_bf16 v130, v33, v33, v130
    v_dot2_f32_bf16 v132, v53, s29, v132
    v_dot2_f32_bf16 v128, v34, s29, v128
    v_dot2_f32_bf16 v130, v34, v34, v130
    v_dot2_f32_bf16 v132, v54, s29, v132
    v_dot2_f32_bf16 v128, v35, s29, v128
    v_dot2_f32_bf16 v130, v35, v35, v130
    v_dot2_f32_bf16 v132, v55, s29, v132
    v_mfma_f32_32x32x16_bf16 v[64:79], v[32:35], v[48:51], v[64:79]
    ds_read_b128 v[196:199], v7 offset:0
    ds_read_b128 v[200:203], v7 offset:4096
    v_mfma_f32_32x32x16_bf16 v[80:95], v[32:35], v[52:55], v[80:95]
    ds_read_b64_tr_b16 v[204:205], v8 offset:12288
    ds_read_b64_tr_b16 v[206:207], v8 offset:13312
    v_mfma_f32_32x32x16_bf16 v[96:111], v[36:39], v[48:51], v[96:111]
    ds_read_b64_tr_b16 v[208:209], v9 offset:12288
    ds_read_b64_tr_b16 v[210:211], v9 offset:13312
    v_mfma_f32_32x32x16_bf16 v[112:127], v[36:39], v[52:55], v[112:127]
    s_waitcnt lgkmcnt(6)
    v_dot2_f32_bf16 v128, v40, s29, v128
    v_dot2_f32_bf16 v130, v40, v40, v130
    v_dot2_f32_bf16 v132, v60, s29, v132
    v_dot2_f32_bf16 v128, v41, s29, v128
    v_dot2_f32_bf16 v130, v41, v41, v130
    v_dot2_f32_bf16 v132, v61, s29, v132
    v_dot2_f32_bf16 v128, v42, s29, v128
    v_dot2_f32_bf16 v130, v42, v42, v130
    v_dot2_f32_bf16 v132, v62, s29, v132
    v_dot2_f32_bf16 v128, v43, s29, v128
    v_dot2_f32_bf16 v130, v43, v43, v130
    v_dot2_f32_bf16 v132, v63, s29, v132
    v_mfma_f32_32x32x16_bf16 v[64:79], v[40:43], v[56:59], v[64:79]
    s_barrier
    ds_read_b128 v[32:35], v4 offset:32768
    ds_read_b128 v[36:39], v4 offset:36864
    v_mfma_f32_32x32x16_bf16 v[80:95], v[40:43], v[60:63], v[80:95]
    ds_read_b64_tr_b16 v[48:49], v8 offset:32768
    ds_read_b64_tr_b16 v[50:51], v8 offset:33792
    v_mfma_f32_32x32x16_bf16 v[96:111], v[44:47], v[56:59], v[96:111]
    ds_read_b64_tr_b16 v[52:53], v9 offset:32768
    ds_read_b64_tr_b16 v[54:55], v9 offset:33792
    v_mfma_f32_32x32x16_bf16 v[112:127], v[44:47], v[60:63], v[112:127]
    s_waitcnt lgkmcnt(6)
    v_dot2_f32_bf16 v128, v196, s29, v128
    v_dot2_f32_bf16 v130, v196, v196, v130
    v_dot2_f32_bf16 v132, v208, s29, v132
    v_dot2_f32_bf16 v128, v197, s29, v128
    v_dot2_f32_bf16 v130, v197, v197, v130
    v_dot2_f32_bf16 v132, v209, s29, v132
    v_dot2_f32_bf16 v128, v198, s29, v128
    v_dot2_f32_bf16 v130, v198, v198, v130
    v_dot2_f32_bf16 v132, v210, s29, v132
    v_dot2_f32_bf16 v128, v199, s29, v128
    v_dot2_f32_bf16 v130, v199, v199, v130
    v_dot2_f32_bf16 v132, v211, s29, v132
    v_mfma_f32_32x32x16_bf16 v[64:79], v[196:199], v[204:207], v[64:79]
    ds_read_b128 v[40:43], v5 offset:32768
    ds_read_b128 v[44:47], v5 offset:36864
    v_mfma_f32_32x32x16_bf16 v[80:95], v[196:199], v[208:211], v[80:95]
    ds_read_b64_tr_b16 v[56:57], v8 offset:36864
    ds_read_b64_tr_b16 v[58:59], v8 offset:37888
    v_mfma_f32_32x32x16_bf16 v[96:111], v[200:203], v[204:207], v[96:111]
    ds_read_b64_tr_b16 v[60:61], v9 offset:36864
    ds_read_b64_tr_b16 v[62:63], v9 offset:37888
    v_mfma_f32_32x32x16_bf16 v[112:127], v[200:203], v[208:211], v[112:127]
    s_waitcnt lgkmcnt(6)
    v_dot2_f32_bf16 v128, v32, s29, v128
    v_dot2_f32_bf16 v130, v32, v32, v130
    v_dot2_f32_bf16 v132, v52, s29, v132
    v_dot2_f32_bf16 v128, v33, s29, v128
    v_dot2_f32_bf16 v130, v33, v33, v130
    v_dot2_f32_bf16 v132, v53, s29, v132
    v_dot2_f32_bf16 v128, v34, s29, v128
    v_dot2_f32_bf16 v130, v34, v34, v130
    v_dot2_f32_bf16 v132, v54, s29, v132
    v_dot2_f32_bf16 v128, v35, s29, v128
    v_dot2_f32_bf16 v130, v35, v35, v130
    v_dot2_f32_bf16 v132, v55, s29, v132
    v_mfma_f32_32x32x16_bf16 v[64:79], v[32:35], v[48:51], v[64:79]
    ds_read_b128 v[196:199], v6 offset:32768
    ds_read_b128 v[200:203], v6 offset:36864
    v_mfma_f32_32x32x16_bf16 v[80:95], v[32:35], v[52:55], v[80:95]
    ds_read_b64_tr_b16 v[204:205], v8 offset:40960
    ds_read_b64_tr_b16 v[206:207], v8 offset:41984
    v_mfma_f32_32x32x16_bf16 v[96:111], v[36:39], v[48:51], v[96:111]
    ds_read_b64_tr_b16 v[208:209], v9 offset:40960
    ds_read_b64_tr_b16 v[210:211], v9 offset:41984
    v_mfma_f32_32x32x16_bf16 v[112:127], v[36:39], v[52:55], v[112:127]
    s_waitcnt lgkmcnt(6)
    v_dot2_f32_bf16 v128, v40, s29, v128
    v_dot2_f32_bf16 v130, v40, v40, v130
    v_dot2_f32_bf16 v132, v60, s29, v132
    v_dot2_f32_bf16 v128, v41, s29, v128
    v_dot2_f32_bf16 v130, v41, v41, v130
    v_dot2_f32_bf16 v132, v61, s29, v132
    v_dot2_f32_bf16 v128, v42, s29, v128
    v_dot2_f32_bf16 v130, v42, v42, v130
    v_dot2_f32_bf16 v132, v62, s29, v132
    v_dot2_f32_bf16 v128, v43, s29, v128
    v_dot2_f32_bf16 v130, v43, v43, v130
    v_dot2_f32_bf16 v132, v63, s29, v132
    v_mfma_f32_32x32x16_bf16 v[64:79], v[40:43], v[56:59], v[64:79]
    ds_read_b128 v[32:35], v7 offset:32768
    ds_read_b128 v[36:39], v7 offset:36864
    v_mfma_f32_32x32x16_bf16 v[80:95], v[40:43], v[60:63], v[80:95]
    ds_read_b64_tr_b16 v[48:49], v8 offset:45056
    ds_read_b64_tr_b16 v[50:51], v8 offset:46080
    v_mfma_f32_32x32x16_bf16 v[96:111], v[44:47], v[56:59], v[96:111]
    ds_read_b64_tr_b16 v[52:53], v9 offset:45056
    ds_read_b64_tr_b16 v[54:55], v9 offset:46080
    v_mfma_f32_32x32x16_bf16 v[112:127], v[44:47], v[60:63], v[112:127]
    s_waitcnt lgkmcnt(6)
    v_dot2_f32_bf16 v128, v196, s29, v128
    v_dot2_f32_bf16 v130, v196, v196, v130
    v_dot2_f32_bf16 v132, v208, s29, v132
    v_dot2_f32_bf16 v128, v197, s29, v128
    v_dot2_f32_bf16 v130, v197, v197, v130
    v_dot2_f32_bf16 v132, v209, s29, v132
    v_dot2_f32_bf16 v128, v198, s29, v128
    v_dot2_f32_bf16 v130, v198, v198, v130
    v_dot2_f32_bf16 v132, v210, s29, v132
    v_dot2_f32_bf16 v128, v199, s29, v128
    v_dot2_f32_bf16 v130, v199, v199, v130
    v_dot2_f32_bf16 v132, v211, s29, v132
    v_mfma_f32_32x32x16_bf16 v[64:79], v[196:199], v[204:207], v[64:79]
    s_barrier
    ds_read_b128 v[40:43], v10 offset:0
    ds_read_b128 v[44:47], v10 offset:4096
    v_mfma_f32_32x32x16_bf16 v[80:95], v[196:199], v[208:211], v[80:95]
    ds_read_b64_tr_b16 v[56:57], v14 offset:0
    ds_read_b64_tr_b16 v[58:59], v14 offset:1024
    v_mfma_f32_32x32x16_bf16 v[96:111], v[200:203], v[204:207], v[96:111]
    ds_read_b64_tr_b16 v[60:61], v15 offset:0
    ds_read_b64_tr_b16 v[62:63], v15 offset:1024
    v_mfma_f32_32x32x16_bf16 v[112:127], v[200:203], v[208:211], v[112:127]
    s_waitcnt lgkmcnt(6)
    v_dot2_f32_bf16 v128, v32, s29, v128
    v_dot2_f32_bf16 v130, v32, v32, v130
    v_dot2_f32_bf16 v132, v52, s29, v132
    v_dot2_f32_bf16 v128, v33, s29, v128
    v_dot2_f32_bf16 v130, v33, v33, v130
    v_dot2_f32_bf16 v132, v53, s29, v132
    v_dot2_f32_bf16 v128, v34, s29, v128
    v_dot2_f32_bf16 v130, v34, v34, v130
    v_dot2_f32_bf16 v132, v54, s29, v132
    v_dot2_f32_bf16 v128, v35, s29, v128
    v_dot2_f32_bf16 v130, v35, v35, v130
    v_dot2_f32_bf16 v132, v55, s29, v132
    v_mfma_f32_32x32x16_bf16 v[64:79], v[32:35], v[48:51], v[64:79]
    ds_read_b128 v[196:199], v11 offset:0
    ds_read_b128 v[200:203], v11 offset:4096
    v_mfma_f32_32x32x16_bf16 v[80:95], v[32:35], v[52:55], v[80:95]
    ds_read_b64_tr_b16 v[204:205], v14 offset:4096
    ds_read_b64_tr_b16 v[206:207], v14 offset:5120
    v_mfma_f32_32x32x16_bf16 v[96:111], v[36:39], v[48:51], v[96:111]
    ds_read_b64_tr_b16 v[208:209], v15 offset:4096
    ds_read_b64_tr_b16 v[210:211], v15 offset:5120
    v_mfma_f32_32x32x16_bf16 v[112:127], v[36:39], v[52:55], v[112:127]
    s_waitcnt lgkmcnt(6)
    v_dot2_f32_bf16 v128, v40, s29, v128
    v_dot2_f32_bf16 v130, v40, v40, v130
    v_dot2_f32_bf16 v132, v60, s29, v132
    v_dot2_f32_bf16 v128, v41, s29, v128
    v_dot2_f32_bf16 v130, v41, v41, v130
    v_dot2_f32_bf16 v132, v61, s29, v132
    v_dot2_f32_bf16 v128, v42, s29, v128
    v_dot2_f32_bf16 v130, v42, v42, v130
    v_dot2_f32_bf16 v132, v62, s29, v132
    v_dot2_f32_bf16 v128, v43, s29, v128
    v_dot2_f32_bf16 v130, v43, v43, v130
    v_dot2_f32_bf16 v132, v63, s29, v132
    v_mfma_f32_32x32x16_bf16 v[64:79], v[40:43], v[56:59], v[64:79]
    ds_read_b128 v[32:35], v12 offset:0
    ds_read_b128 v[36:39], v12 offset:4096
    v_mfma_f32_32x32x16_bf16 v[80:95], v[40:43], v[60:63], v[80:95]
    ds_read_b64_tr_b16 v[48:49], v14 offset:8192
    ds_read_b64_tr_b16 v[50:51], v14 offset:9216
    v_mfma_f32_32x32x16_bf16 v[96:111], v[44:47], v[56:59], v[96:111]
    ds_read_b64_tr_b16 v[52:53], v15 offset:8192
    ds_read_b64_tr_b16 v[54:55], v15 offset:9216
    v_mfma_f32_32x32x16_bf16 v[112:127], v[44:47], v[60:63], v[112:127]
    s_waitcnt lgkmcnt(6)
    v_dot2_f32_bf16 v128, v196, s29, v128
    v_dot2_f32_bf16 v130, v196, v196, v130
    v_dot2_f32_bf16 v132, v208, s29, v132
    v_dot2_f32_bf16 v128, v197, s29, v128
    v_dot2_f32_bf16 v130, v197, v197, v130
    v_dot2_f32_bf16 v132, v209, s29, v132
    v_dot2_f32_bf16 v128, v198, s29, v128
    v_dot2_f32_bf16 v130, v198, v198, v130
    v_dot2_f32_bf16 v132, v210, s29, v132
    v_dot2_f32_bf16 v128, v199, s29, v128
    v_dot2_f32_bf16 v130, v199, v199, v130
    v_dot2_f32_bf16 v132, v211, s29, v132
    v_mfma_f32_32x32x16_bf16 v[64:79], v[196:199], v[204:207], v[64:79]
    ds_read_b128 v[40:43], v13 offset:0
    ds_read_b128 v[44:47], v13 offset:4096
    v_mfma_f32_32x32x16_bf16 v[80:95], v[196:199], v[208:211], v[80:95]
    ds_read_b64_tr_b16 v[56:57], v14 offset:12288
    ds_read_b64_tr_b16 v[58:59], v14 offset:13312
    v_mfma_f32_32x32x16_bf16 v[96:111], v[200:203], v[204:207], v[96:111]
    ds_read_b64_tr_b16 v[60:61], v15 offset:12288
    ds_read_b64_tr_b16 v[62:63], v15 offset:13312
    v_mfma_f32_32x32x16_bf16 v[112:127], v[200:203], v[208:211], v[112:127]
    s_waitcnt lgkmcnt(6)
    v_dot2_f32_bf16 v128, v32, s29, v128
    v_dot2_f32_bf16 v130, v32, v32, v130
    v_dot2_f32_bf16 v132, v52, s29, v132
    v_dot2_f32_bf16 v128, v33, s29, v128
    v_dot2_f32_bf16 v130, v33, v33, v130
    v_dot2_f32_bf16 v132, v53, s29, v132
    v_dot2_f32_bf16 v128, v34, s29, v128
    v_dot2_f32_bf16 v130, v34, v34, v130
    v_dot2_f32_bf16 v132, v54, s29, v132
    v_dot2_f32_bf16 v128, v35, s29, v128
    v_dot2_f32_bf16 v130, v35, v35, v130
    v_dot2_f32_bf16 v132, v55, s29, v132
    v_mfma_f32_32x32x16_bf16 v[64:79], v[32:35], v[48:51], v[64:79]
    s_barrier
    ds_read_b128 v[196:199], v16 offset:0
    ds_read_b128 v[200:203], v16 offset:4096
    v_mfma_f32_32x32x16_bf16 v[80:95], v[32:35], v[52:55], v[80:95]
    ds_read_b64_tr_b16 v[204:205], v20 offset:0
    ds_read_b64_tr_b16 v[206:207], v20 offset:1024
    v_mfma_f32_32x32x16_bf16 v[96:111], v[36:39], v[48:51], v[96:111]
    ds_read_b64_tr_b16 v[208:209], v21 offset:0
    ds_read_b64_tr_b16 v[210:211], v21 offset:1024
    v_mfma_f32_32x32x16_bf16 v[112:127], v[36:39], v[52:55], v[112:127]
    s_waitcnt lgkmcnt(6)
    v_dot2_f32_bf16 v128, v40, s29, v128
    v_dot2_f32_bf16 v130, v40, v40, v130
    v_dot2_f32_bf16 v132, v60, s29, v132
    v_dot2_f32_bf16 v128, v41, s29, v128
    v_dot2_f32_bf16 v130, v41, v41, v130
    v_dot2_f32_bf16 v132, v61, s29, v132
    v_dot2_f32_bf16 v128, v42, s29, v128
    v_dot2_f32_bf16 v130, v42, v42, v130
    v_dot2_f32_bf16 v132, v62, s29, v132
    v_dot2_f32_bf16 v128, v43, s29, v128
    v_dot2_f32_bf16 v130, v43, v43, v130
    v_dot2_f32_bf16 v132, v63, s29, v132
    v_mfma_f32_32x32x16_bf16 v[64:79], v[40:43], v[56:59], v[64:79]
    ds_read_b128 v[32:35], v17 offset:0
    ds_read_b128 v[36:39], v17 offset:4096
    v_mfma_f32_32x32x16_bf16 v[80:95], v[40:43], v[60:63], v[80:95]
    ds_read_b64_tr_b16 v[48:49], v20 offset:4096
    ds_read_b64_tr_b16 v[50:51], v20 offset:5120
    v_mfma_f32_32x32x16_bf16 v[96:111], v[44:47], v[56:59], v[96:111]
    ds_read_b64_tr_b16 v[52:53], v21 offset:4096
    ds_read_b64_tr_b16 v[54:55], v21 offset:5120
    v_mfma_f32_32x32x16_bf16 v[112:127], v[44:47], v[60:63], v[112:127]
    s_waitcnt lgkmcnt(6)
    v_dot2_f32_bf16 v128, v196, s29, v128
    v_dot2_f32_bf16 v130, v196, v196, v130
    v_dot2_f32_bf16 v132, v208, s29, v132
    v_dot2_f32_bf16 v128, v197, s29, v128
    v_dot2_f32_bf16 v130, v197, v197, v130
    v_dot2_f32_bf16 v132, v209, s29, v132
    v_dot2_f32_bf16 v128, v198, s29, v128
    v_dot2_f32_bf16 v130, v198, v198, v130
    v_dot2_f32_bf16 v132, v210, s29, v132
    v_dot2_f32_bf16 v128, v199, s29, v128
    v_dot2_f32_bf16 v130, v199, v199, v130
    v_dot2_f32_bf16 v132, v211, s29, v132
    v_mfma_f32_32x32x16_bf16 v[64:79], v[196:199], v[204:207], v[64:79]
    ds_read_b128 v[40:43], v18 offset:0
    ds_read_b128 v[44:47], v18 offset:4096
    v_mfma_f32_32x32x16_bf16 v[80:95], v[196:199], v[208:211], v[80:95]
    ds_read_b64_tr_b16 v[56:57], v20 offset:8192
    ds_read_b64_tr_b16 v[58:59], v20 offset:9216
    v_mfma_f32_32x32x16_bf16 v[96:111], v[200:203], v[204:207], v[96:111]
    ds_read_b64_tr_b16 v[60:61], v21 offset:8192
    ds_read_b64_tr_b16 v[62:63], v21 offset:9216
    v_mfma_f32_32x32x16_bf16 v[112:127], v[200:203], v[208:211], v[112:127]
    s_waitcnt lgkmcnt(6)
    v_dot2_f32_bf16 v128, v32, s29, v128
    v_dot2_f32_bf16 v130, v32, v32, v130
    v_dot2_f32_bf16 v132, v52, s29, v132
    v_dot2_f32_bf16 v128, v33, s29, v128
    v_dot2_f32_bf16 v130, v33, v33, v130
    v_dot2_f32_bf16 v132, v53, s29, v132
    v_dot2_f32_bf16 v128, v34, s29, v128
    v_dot2_f32_bf16 v130, v34, v34, v130
    v_dot2_f32_bf16 v132, v54, s29, v132
    v_dot2_f32_bf16 v128, v35, s29, v128
    v_dot2_f32_bf16 v130, v35, v35, v130
    v_dot2_f32_bf16 v132, v55, s29, v132
    v_mfma_f32_32x32x16_bf16 v[64:79], v[32:35], v[48:51], v[64:79]
    ds_read_b128 v[196:199], v19 offset:0
    ds_read_b128 v[200:203], v19 offset:4096
    v_mfma_f32_32x32x16_bf16 v[80:95], v[32:35], v[52:55], v[80:95]
    ds_read_b64_tr_b16 v[204:205], v20 offset:12288
    ds_read_b64_tr_b16 v[206:207], v20 offset:13312
    v_mfma_f32_32x32x16_bf16 v[96:111], v[36:39], v[48:51], v[96:111]
    ds_read_b64_tr_b16 v[208:209], v21 offset:12288
    ds_read_b64_tr_b16 v[210:211], v21 offset:13312
    v_mfma_f32_32x32x16_bf16 v[112:127], v[36:39], v[52:55], v[112:127]
    s_waitcnt lgkmcnt(6)
    v_dot2_f32_bf16 v128, v40, s29, v128
    v_dot2_f32_bf16 v130, v40, v40, v130
    v_dot2_f32_bf16 v132, v60, s29, v132
    v_dot2_f32_bf16 v128, v41, s29, v128
    v_dot2_f32_bf16 v130, v41, v41, v130
    v_dot2_f32_bf16 v132, v61, s29, v132
    v_dot2_f32_bf16 v128, v42, s29, v128
    v_dot2_f32_bf16 v130, v42, v42, v130
    v_dot2_f32_bf16 v132, v62, s29, v132
    v_dot2_f32_bf16 v128, v43, s29, v128
    v_dot2_f32_bf16 v130, v43, v43, v130
    v_dot2_f32_bf16 v132, v63, s29, v132
    v_mfma_f32_32x32x16_bf16 v[64:79], v[40:43], v[56:59], v[64:79]
    s_barrier
    ds_read_b128 v[32:35], v16 offset:32768
    ds_read_b128 v[36:39], v16 offset:36864
    v_mfma_f32_32x32x16_bf16 v[80:95], v[40:43], v[60:63], v[80:95]
    ds_read_b64_tr_b16 v[48:49], v20 offset:32768
    ds_read_b64_tr_b16 v[50:51], v20 offset:33792
    v_mfma_f32_32x32x16_bf16 v[96:111], v[44:47], v[56:59], v[96:111]
    ds_read_b64_tr_b16 v[52:53], v21 offset:32768
    ds_read_b64_tr_b16 v[54:55], v21 offset:33792
    v_mfma_f32_32x32x16_bf16 v[112:127], v[44:47], v[60:63], v[112:127]
    s_waitcnt lgkmcnt(6)
    v_dot2_f32_bf16 v128, v196, s29, v128
    v_dot2_f32_bf16 v130, v196, v196, v130
    v_dot2_f32_bf16 v132, v208, s29, v132
    v_dot2_f32_bf16 v128, v197, s29, v128
    v_dot2_f32_bf16 v130, v197, v197, v130
    v_dot2_f32_bf16 v132, v209, s29, v132
    v_dot2_f32_bf16 v128, v198, s29, v128
    v_dot2_f32_bf16 v130, v198, v198, v130
    v_dot2_f32_bf16 v132, v210, s29, v132
    v_dot2_f32_bf16 v128, v199, s29, v128
    v_dot2_f32_bf16 v130, v199, v199, v130
    v_dot2_f32_bf16 v132, v211, s29, v132
    v_mfma_f32_32x32x16_bf16 v[64:79], v[196:199], v[204:207], v[64:79]
    ds_read_b128 v[40:43], v17 offset:32768
    ds_read_b128 v[44:47], v17 offset:36864
    v_mfma_f32_32x32x16_bf16 v[80:95], v[196:199], v[208:211], v[80:95]
    ds_read_b64_tr_b16 v[56:57], v20 offset:36864
    ds_read_b64_tr_b16 v[58:59], v20 offset:37888
    v_mfma_f32_32x32x16_bf16 v[96:111], v[200:203], v[204:207], v[96:111]
    ds_read_b64_tr_b16 v[60:61], v21 offset:36864
    ds_read_b64_tr_b16 v[62:63], v21 offset:37888
    v_mfma_f32_32x32x16_bf16 v[112:127], v[200:203], v[208:211], v[112:127]
    s_waitcnt lgkmcnt(6)
    v_dot2_f32_bf16 v128, v32, s29, v128
    v_dot2_f32_bf16 v130, v32, v32, v130
    v_dot2_f32_bf16 v132, v52, s29, v132
    v_dot2_f32_bf16 v128, v33, s29, v128
    v_dot2_f32_bf16 v130, v33, v33, v130
    v_dot2_f32_bf16 v132, v53, s29, v132
    v_dot2_f32_bf16 v128, v34, s29, v128
    v_dot2_f32_bf16 v130, v34, v34, v130
    v_dot2_f32_bf16 v132, v54, s29, v132
    v_dot2_f32_bf16 v128, v35, s29, v128
    v_dot2_f32_bf16 v130, v35, v35, v130
    v_dot2_f32_bf16 v132, v55, s29, v132
    v_mfma_f32_32x32x16_bf16 v[64:79], v[32:35], v[48:51], v[64:79]
    ds_read_b128 v[196:199], v18 offset:32768
    ds_read_b128 v[200:203], v18 offset:36864
    v_mfma_f32_32x32x16_bf16 v[80:95], v[32:35], v[52:55], v[80:95]
    ds_read_b64_tr_b16 v[204:205], v20 offset:40960
    ds_read_b64_tr_b16 v[206:207], v20 offset:41984
    v_mfma_f32_32x32x16_bf16 v[96:111], v[36:39], v[48:51], v[96:111]
    ds_read_b64_tr_b16 v[208:209], v21 offset:40960
    ds_read_b64_tr_b16 v[210:211], v21 offset:41984
    v_mfma_f32_32x32x16_bf16 v[112:127], v[36:39], v[52:55], v[112:127]
    s_waitcnt lgkmcnt(6)
    v_dot2_f32_bf16 v128, v40, s29, v128
    v_dot2_f32_bf16 v130, v40, v40, v130
    v_dot2_f32_bf16 v132, v60, s29, v132
    v_dot2_f32_bf16 v128, v41, s29, v128
    v_dot2_f32_bf16 v130, v41, v41, v130
    v_dot2_f32_bf16 v132, v61, s29, v132
    v_dot2_f32_bf16 v128, v42, s29, v128
    v_dot2_f32_bf16 v130, v42, v42, v130
    v_dot2_f32_bf16 v132, v62, s29, v132
    v_dot2_f32_bf16 v128, v43, s29, v128
    v_dot2_f32_bf16 v130, v43, v43, v130
    v_dot2_f32_bf16 v132, v63, s29, v132
    v_mfma_f32_32x32x16_bf16 v[64:79], v[40:43], v[56:59], v[64:79]
    ds_read_b128 v[32:35], v19 offset:32768
    ds_read_b128 v[36:39], v19 offset:36864
    v_mfma_f32_32x32x16_bf16 v[80:95], v[40:43], v[60:63], v[80:95]
    ds_read_b64_tr_b16 v[48:49], v20 offset:45056
    ds_read_b64_tr_b16 v[50:51], v20 offset:46080
    v_mfma_f32_32x32x16_bf16 v[96:111], v[44:47], v[56:59], v[96:111]
    ds_read_b64_tr_b16 v[52:53], v21 offset:45056
    ds_read_b64_tr_b16 v[54:55], v21 offset:46080
    v_mfma_f32_32x32x16_bf16 v[112:127], v[44:47], v[60:63], v[112:127]
    s_waitcnt lgkmcnt(6)
    v_dot2_f32_bf16 v128, v196, s29, v128
    v_dot2_f32_bf16 v130, v196, v196, v130
    v_dot2_f32_bf16 v132, v208, s29, v132
    v_dot2_f32_bf16 v128, v197, s29, v128
    v_dot2_f32_bf16 v130, v197, v197, v130
    v_dot2_f32_bf16 v132, v209, s29, v132
    v_dot2_f32_bf16 v128, v198, s29, v128
    v_dot2_f32_bf16 v130, v198, v198, v130
    v_dot2_f32_bf16 v132, v210, s29, v132
    v_dot2_f32_bf16 v128, v199, s29, v128
    v_dot2_f32_bf16 v130, v199, v199, v130
    v_dot2_f32_bf16 v132, v211, s29, v132
    v_mfma_f32_32x32x16_bf16 v[64:79], v[196:199], v[204:207], v[64:79]
    s_barrier
    ds_read_b128 v[40:43], v4 offset:0
    ds_read_b128 v[44:47], v4 offset:4096
    v_mfma_f32_32x32x16_bf16 v[80:95], v[196:199], v[208:211], v[80:95]
    ds_read_b64_tr_b16 v[56:57], v8 offset:0
    ds_read_b64_tr_b16 v[58:59], v8 offset:1024
    v_mfma_f32_32x32x16_bf16 v[96:111], v[200:203], v[204:207], v[96:111]
    ds_read_b64_tr_b16 v[60:61], v9 offset:0
    ds_read_b64_tr_b16 v[62:63], v9 offset:1024
    v_mfma_f32_32x32x16_bf16 v[112:127], v[200:203], v[208:211], v[112:127]
    s_waitcnt lgkmcnt(6)
    v_dot2_f32_bf16 v128, v32, s29, v128
    v_dot2_f32_bf16 v130, v32, v32, v130
    v_dot2_f32_bf16 v132, v52, s29, v132
    v_dot2_f32_bf16 v128, v33, s29, v128
    v_dot2_f32_bf16 v130, v33, v33, v130
    v_dot2_f32_bf16 v132, v53, s29, v132
    v_dot2_f32_bf16 v128, v34, s29, v128
    v_dot2_f32_bf16 v130, v34, v34, v130
    v_dot2_f32_bf16 v132, v54, s29, v132
    v_dot2_f32_bf16 v128, v35, s29, v128
    v_dot2_f32_bf16 v130, v35, v35, v130
    v_dot2_f32_bf16 v132, v55, s29, v132
    v_mfma_f32_32x32x16_bf16 v[64:79], v[32:35], v[48:51], v[64:79]
    ds_read_b128 v[196:199], v5 offset:0
    ds_read_b128 v[200:203], v5 offset:4096
    v_mfma_f32_32x32x16_bf16 v[80:95], v[32:35], v[52:55], v[80:95]
    ds_read_b64_tr_b16 v[204:205], v8 offset:4096
    ds_read_b64_tr_b16 v[206:207], v8 offset:5120
    v_mfma_f32_32x32x16_bf16 v[96:111], v[36:39], v[48:51], v[96:111]
    ds_read_b64_tr_b16 v[208:209], v9 offset:4096
    ds_read_b64_tr_b16 v[210:211], v9 offset:5120
    v_mfma_f32_32x32x16_bf16 v[112:127], v[36:39], v[52:55], v[112:127]
    s_waitcnt lgkmcnt(6)
    v_dot2_f32_bf16 v128, v40, s29, v128
    v_dot2_f32_bf16 v130, v40, v40, v130
    v_dot2_f32_bf16 v132, v60, s29, v132
    v_dot2_f32_bf16 v128, v41, s29, v128
    v_dot2_f32_bf16 v130, v41, v41, v130
    v_dot2_f32_bf16 v132, v61, s29, v132
    v_dot2_f32_bf16 v128, v42, s29, v128
    v_dot2_f32_bf16 v130, v42, v42, v130
    v_dot2_f32_bf16 v132, v62, s29, v132
    v_dot2_f32_bf16 v128, v43, s29, v128
    v_dot2_f32_bf16 v130, v43, v43, v130
    v_dot2_f32_bf16 v132, v63, s29, v132
    v_mfma_f32_32x32x16_bf16 v[64:79], v[40:43], v[56:59], v[64:79]
    ds_read_b128 v[32:35], v6 offset:0
    ds_read_b128 v[36:39], v6 offset:4096
    v_mfma_f32_32x32x16_bf16 v[80:95], v[40:43], v[60:63], v[80:95]
    ds_read_b64_tr_b16 v[48:49], v8 offset:8192
    ds_read_b64_tr_b16 v[50:51], v8 offset:9216
    v_mfma_f32_32x32x16_bf16 v[96:111], v[44:47], v[56:59], v[96:111]
    ds_read_b64_tr_b16 v[52:53], v9 offset:8192
    ds_read_b64_tr_b16 v[54:55], v9 offset:9216
    v_mfma_f32_32x32x16_bf16 v[112:127], v[44:47], v[60:63], v[112:127]
    s_waitcnt lgkmcnt(6)
    v_dot2_f32_bf16 v128, v196, s29, v128
    v_dot2_f32_bf16 v130, v196, v196, v130
    v_dot2_f32_bf16 v132, v208, s29, v132
    v_dot2_f32_bf16 v128, v197, s29, v128
    v_dot2_f32_bf16 v130, v197, v197, v130
    v_dot2_f32_bf16 v132, v209, s29, v132
    v_dot2_f32_bf16 v128, v198, s29, v128
    v_dot2_f32_bf16 v130, v198, v198, v130
    v_dot2_f32_bf16 v132, v210, s29, v132
    v_dot2_f32_bf16 v128, v199, s29, v128
    v_dot2_f32_bf16 v130, v199, v199, v130
    v_dot2_f32_bf16 v132, v211, s29, v132
    v_mfma_f32_32x32x16_bf16 v[64:79], v[196:199], v[204:207], v[64:79]
    ds_read_b128 v[40:43], v7 offset:0
    ds_read_b128 v[44:47], v7 offset:4096
    v_mfma_f32_32x32x16_bf16 v[80:95], v[196:199], v[208:211], v[80:95]
    ds_read_b64_tr_b16 v[56:57], v8 offset:12288
    ds_read_b64_tr_b16 v[58:59], v8 offset:13312
    v_mfma_f32_32x32x16_bf16 v[96:111], v[200:203], v[204:207], v[96:111]
    ds_read_b64_tr_b16 v[60:61], v9 offset:12288
    ds_read_b64_tr_b16 v[62:63], v9 offset:13312
    v_mfma_f32_32x32x16_bf16 v[112:127], v[200:203], v[208:211], v[112:127]
    s_waitcnt lgkmcnt(6)
    v_dot2_f32_bf16 v128, v32, s29, v128
    v_dot2_f32_bf16 v130, v32, v32, v130
    v_dot2_f32_bf16 v132, v52, s29, v132
    v_dot2_f32_bf16 v128, v33, s29, v128
    v_dot2_f32_bf16 v130, v33, v33, v130
    v_dot2_f32_bf16 v132, v53, s29, v132
    v_dot2_f32_bf16 v128, v34, s29, v128
    v_dot2_f32_bf16 v130, v34, v34, v130
    v_dot2_f32_bf16 v132, v54, s29, v132
    v_dot2_f32_bf16 v128, v35, s29, v128
    v_dot2_f32_bf16 v130, v35, v35, v130
    v_dot2_f32_bf16 v132, v55, s29, v132
    v_mfma_f32_32x32x16_bf16 v[64:79], v[32:35], v[48:51], v[64:79]
    v_mfma_f32_32x32x16_bf16 v[80:95], v[32:35], v[52:55], v[80:95]
    v_mfma_f32_32x32x16_bf16 v[96:111], v[36:39], v[48:51], v[96:111]
    v_mfma_f32_32x32x16_bf16 v[112:127], v[36:39], v[52:55], v[112:127]
    s_waitcnt lgkmcnt(0)
    v_dot2_f32_bf16 v128, v40, s29, v128
    v_dot2_f32_bf16 v130, v40, v40, v130
    v_dot2_f32_bf16 v132, v60, s29, v132
    v_dot2_f32_bf16 v128, v41, s29, v128
    v_dot2_f32_bf16 v130, v41, v41, v130
    v_dot2_f32_bf16 v132, v61, s29, v132
    v_dot2_f32_bf16 v128, v42, s29, v128
    v_dot2_f32_bf16 v130, v42, v42, v130
    v_dot2_f32_bf16 v132, v62, s29, v132
    v_dot2_f32_bf16 v128, v43, s29, v128
    v_dot2_f32_bf16 v130, v43, v43, v130
    v_dot2_f32_bf16 v132, v63, s29, v132
    v_mfma_f32_32x32x16_bf16 v[64:79], v[40:43], v[56:59], v[64:79]
    v_mfma_f32_32x32x16_bf16 v[80:95], v[40:43], v[60:63], v[80:95]
    v_mfma_f32_32x32x16_bf16 v[96:111], v[44:47], v[56:59], v[96:111]
    v_mfma_f32_32x32x16_bf16 v[112:127], v[44:47], v[60:63], v[112:127]
    s_branch qkv_a_kernel_ve
qkv_a_kernel_v3:
    v_mov_b32 v64, 0
    v_mov_b32 v65, 0
    v_mov_b32 v66, 0
    v_mov_b32 v67, 0
    v_mov_b32 v68, 0
    v_mov_b32 v69, 0
    v_mov_b32 v70, 0
    v_mov_b32 v71, 0
    v_mov_b32 v72, 0
    v_mov_b32 v73, 0
    v_mov_b32 v74, 0
    v_mov_b32 v75, 0
    v_mov_b32 v76, 0
    v_mov_b32 v77, 0
    v_mov_b32 v78, 0
    v_mov_b32 v79, 0
    v_mov_b32 v80, 0
    v_mov_b32 v81, 0
    v_mov_b32 v82, 0
    v_mov_b32 v83, 0
    v_mov_b32 v84, 0
    v_mov_b32 v85, 0
    v_mov_b32 v86, 0
    v_mov_b32 v87, 0
    v_mov_b32 v88, 0
    v_mov_b32 v89, 0
    v_mov_b32 v90, 0
    v_mov_b32 v91, 0
    v_mov_b32 v92, 0
    v_mov_b32 v93, 0
    v_mov_b32 v94, 0
    v_mov_b32 v95, 0
    v_mov_b32 v96, 0
    v_mov_b32 v97, 0
    v_mov_b32 v98, 0
    v_mov_b32 v99, 0
    v_mov_b32 v100, 0
    v_mov_b32 v101, 0
    v_mov_b32 v102, 0
    v_mov_b32 v103, 0
    v_mov_b32 v104, 0
    v_mov_b32 v105, 0
    v_mov_b32 v106, 0
    v_mov_b32 v107, 0
    v_mov_b32 v108, 0
    v_mov_b32 v109, 0
    v_mov_b32 v110, 0
    v_mov_b32 v111, 0
    v_mov_b32 v112, 0
    v_mov_b32 v113, 0
    v_mov_b32 v114, 0
    v_mov_b32 v115, 0
    v_mov_b32 v116, 0
    v_mov_b32 v117, 0
    v_mov_b32 v118, 0
    v_mov_b32 v119, 0
    v_mov_b32 v120, 0
    v_mov_b32 v121, 0
    v_mov_b32 v122, 0
    v_mov_b32 v123, 0
    v_mov_b32 v124, 0
    v_mov_b32 v125, 0
    v_mov_b32 v126, 0
    v_mov_b32 v127, 0
    v_mov_b32 v128, 0
    v_mov_b32 v129, 0
    v_mov_b32 v130, 0
    v_mov_b32 v131, 0
    v_mov_b32 v132, 0
    v_mov_b32 v133, 0
    s_barrier
    ds_read_b128 v[32:35], v16 offset:0
    ds_read_b128 v[36:39], v16 offset:4096
    ds_read_b64_tr_b16 v[48:49], v20 offset:0
    ds_read_b64_tr_b16 v[50:51], v20 offset:1024
    ds_read_b64_tr_b16 v[52:53], v21 offset:0
    ds_read_b64_tr_b16 v[54:55], v21 offset:1024
    ds_read_b128 v[40:43], v17 offset:0
    ds_read_b128 v[44:47], v17 offset:4096
    ds_read_b64_tr_b16 v[56:57], v20 offset:4096
    ds_read_b64_tr_b16 v[58:59], v20 offset:5120
    ds_read_b64_tr_b16 v[60:61], v21 offset:4096
    ds_read_b64_tr_b16 v[62:63], v21 offset:5120
    s_waitcnt lgkmcnt(6)
    v_dot2_f32_bf16 v128, v36, s29, v128
    v_dot2_f32_bf16 v130, v36, v36, v130
    v_dot2_f32_bf16 v132, v52, s29, v132
    v_dot2_f32_bf16 v128, v37, s29, v128
    v_dot2_f32_bf16 v130, v37, v37, v130
    v_dot2_f32_bf16 v132, v53, s29, v132
    v_dot2_f32_bf16 v128, v38, s29, v128
    v_dot2_f32_bf16 v130, v38, v38, v130
    v_dot2_f32_bf16 v132, v54, s29, v132
    v_dot2_f32_bf16 v128, v39, s29, v128
    v_dot2_f32_bf16 v130, v39, v39, v130
    v_dot2_f32_bf16 v132, v55, s29, v132
    v_mfma_f32_32x32x16_bf16 v[64:79], v[32:35], v[48:51], v[64:79]
    ds_read_b128 v[196:199], v18 offset:0
    ds_read_b128 v[200:203], v18 offset:4096
    v_mfma_f32_32x32x16_bf16 v[80:95], v[32:35], v[52:55], v[80:95]
    ds_read_b64_tr_b16 v[204:205], v20 offset:8192
    ds_read_b64_tr_b16 v[206:207], v20 offset:9216
    v_mfma_f32_32x32x16_bf16 v[96:111], v[36:39], v[48:51], v[96:111]
    ds_read_b64_tr_b16 v[208:209], v21 offset:8192
    ds_read_b64_tr_b16 v[210:211], v21 offset:9216
    v_mfma_f32_32x32x16_bf16 v[112:127], v[36:39], v[52:55], v[112:127]
    s_waitcnt lgkmcnt(6)
    v_dot2_f32_bf16 v128, v44, s29, v128
    v_dot2_f32_bf16 v130, v44, v44, v130
    v_dot2_f32_bf16 v132, v60, s29, v132
    v_dot2_f32_bf16 v128, v45, s29, v128
    v_dot2_f32_bf16 v130, v45, v45, v130
    v_dot2_f32_bf16 v132, v61, s29, v132
    v_dot2_f32_bf16 v128, v46, s29, v128
    v_dot2_f32_bf16 v130, v46, v46, v130
    v_dot2_f32_bf16 v132, v62, s29, v132
    v_dot2_f32_bf16 v128, v47, s29, v128
    v_dot2_f32_bf16 v130, v47, v47, v130
    v_dot2_f32_bf16 v132, v63, s29, v132
    v_mfma_f32_32x32x16_bf16 v[64:79], v[40:43], v[56:59], v[64:79]
    ds_read_b128 v[32:35], v19 offset:0
    ds_read_b128 v[36:39], v19 offset:4096
    v_mfma_f32_32x32x16_bf16 v[80:95], v[40:43], v[60:63], v[80:95]
    ds_read_b64_tr_b16 v[48:49], v20 offset:12288
    ds_read_b64_tr_b16 v[50:51], v20 offset:13312
    v_mfma_f32_32x32x16_bf16 v[96:111], v[44:47], v[56:59], v[96:111]
    ds_read_b64_tr_b16 v[52:53], v21 offset:12288
    ds_read_b64_tr_b16 v[54:55], v21 offset:13312
    v_mfma_f32_32x32x16_bf16 v[112:127], v[44:47], v[60:63], v[112:127]
    s_waitcnt lgkmcnt(6)
    v_dot2_f32_bf16 v128, v200, s29, v128
    v_dot2_f32_bf16 v130, v200, v200, v130
    v_dot2_f32_bf16 v132, v208, s29, v132
    v_dot2_f32_bf16 v128, v201, s29, v128
    v_dot2_f32_bf16 v130, v201, v201, v130
    v_dot2_f32_bf16 v132, v209, s29, v132
    v_dot2_f32_bf16 v128, v202, s29, v128
    v_dot2_f32_bf16 v130, v202, v202, v130
    v_dot2_f32_bf16 v132, v210, s29, v132
    v_dot2_f32_bf16 v128, v203, s29, v128
    v_dot2_f32_bf16 v130, v203, v203, v130
    v_dot2_f32_bf16 v132, v211, s29, v132
    v_mfma_f32_32x32x16_bf16 v[64:79], v[196:199], v[204:207], v[64:79]
    s_barrier
    ds_read_b128 v[40:43], v16 offset:32768
    ds_read_b128 v[44:47], v16 offset:36864
    v_mfma_f32_32x32x16_bf16 v[80:95], v[196:199], v[208:211], v[80:95]
    ds_read_b64_tr_b16 v[56:57], v20 offset:32768
    ds_read_b64_tr_b16 v[58:59], v20 offset:33792
    v_mfma_f32_32x32x16_bf16 v[96:111], v[200:203], v[204:207], v[96:111]
    ds_read_b64_tr_b16 v[60:61], v21 offset:32768
    ds_read_b64_tr_b16 v[62:63], v21 offset:33792
    v_mfma_f32_32x32x16_bf16 v[112:127], v[200:203], v[208:211], v[112:127]
    s_waitcnt lgkmcnt(6)
    v_dot2_f32_bf16 v128, v36, s29, v128
    v_dot2_f32_bf16 v130, v36, v36, v130
    v_dot2_f32_bf16 v132, v52, s29, v132
    v_dot2_f32_bf16 v128, v37, s29, v128
    v_dot2_f32_bf16 v130, v37, v37, v130
    v_dot2_f32_bf16 v132, v53, s29, v132
    v_dot2_f32_bf16 v128, v38, s29, v128
    v_dot2_f32_bf16 v130, v38, v38, v130
    v_dot2_f32_bf16 v132, v54, s29, v132
    v_dot2_f32_bf16 v128, v39, s29, v128
    v_dot2_f32_bf16 v130, v39, v39, v130
    v_dot2_f32_bf16 v132, v55, s29, v132
    v_mfma_f32_32x32x16_bf16 v[64:79], v[32:35], v[48:51], v[64:79]
    ds_read_b128 v[196:199], v17 offset:32768
    ds_read_b128 v[200:203], v17 offset:36864
    v_mfma_f32_32x32x16_bf16 v[80:95], v[32:35], v[52:55], v[80:95]
    ds_read_b64_tr_b16 v[204:205], v20 offset:36864
    ds_read_b64_tr_b16 v[206:207], v20 offset:37888
    v_mfma_f32_32x32x16_bf16 v[96:111], v[36:39], v[48:51], v[96:111]
    ds_read_b64_tr_b16 v[208:209], v21 offset:36864
    ds_read_b64_tr_b16 v[210:211], v21 offset:37888
    v_mfma_f32_32x32x16_bf16 v[112:127], v[36:39], v[52:55], v[112:127]
    s_waitcnt lgkmcnt(6)
    v_dot2_f32_bf16 v128, v44, s29, v128
    v_dot2_f32_bf16 v130, v44, v44, v130
    v_dot2_f32_bf16 v132, v60, s29, v132
    v_dot2_f32_bf16 v128, v45, s29, v128
    v_dot2_f32_bf16 v130, v45, v45, v130
    v_dot2_f32_bf16 v132, v61, s29, v132
    v_dot2_f32_bf16 v128, v46, s29, v128
    v_dot2_f32_bf16 v130, v46, v46, v130
    v_dot2_f32_bf16 v132, v62, s29, v132
    v_dot2_f32_bf16 v128, v47, s29, v128
    v_dot2_f32_bf16 v130, v47, v47, v130
    v_dot2_f32_bf16 v132, v63, s29, v132
    v_mfma_f32_32x32x16_bf16 v[64:79], v[40:43], v[56:59], v[64:79]
    ds_read_b128 v[32:35], v18 offset:32768
    ds_read_b128 v[36:39], v18 offset:36864
    v_mfma_f32_32x32x16_bf16 v[80:95], v[40:43], v[60:63], v[80:95]
    ds_read_b64_tr_b16 v[48:49], v20 offset:40960
    ds_read_b64_tr_b16 v[50:51], v20 offset:41984
    v_mfma_f32_32x32x16_bf16 v[96:111], v[44:47], v[56:59], v[96:111]
    ds_read_b64_tr_b16 v[52:53], v21 offset:40960
    ds_read_b64_tr_b16 v[54:55], v21 offset:41984
    v_mfma_f32_32x32x16_bf16 v[112:127], v[44:47], v[60:63], v[112:127]
    s_waitcnt lgkmcnt(6)
    v_dot2_f32_bf16 v128, v200, s29, v128
    v_dot2_f32_bf16 v130, v200, v200, v130
    v_dot2_f32_bf16 v132, v208, s29, v132
    v_dot2_f32_bf16 v128, v201, s29, v128
    v_dot2_f32_bf16 v130, v201, v201, v130
    v_dot2_f32_bf16 v132, v209, s29, v132
    v_dot2_f32_bf16 v128, v202, s29, v128
    v_dot2_f32_bf16 v130, v202, v202, v130
    v_dot2_f32_bf16 v132, v210, s29, v132
    v_dot2_f32_bf16 v128, v203, s29, v128
    v_dot2_f32_bf16 v130, v203, v203, v130
    v_dot2_f32_bf16 v132, v211, s29, v132
    v_mfma_f32_32x32x16_bf16 v[64:79], v[196:199], v[204:207], v[64:79]
    ds_read_b128 v[40:43], v19 offset:32768
    ds_read_b128 v[44:47], v19 offset:36864
    v_mfma_f32_32x32x16_bf16 v[80:95], v[196:199], v[208:211], v[80:95]
    ds_read_b64_tr_b16 v[56:57], v20 offset:45056
    ds_read_b64_tr_b16 v[58:59], v20 offset:46080
    v_mfma_f32_32x32x16_bf16 v[96:111], v[200:203], v[204:207], v[96:111]
    ds_read_b64_tr_b16 v[60:61], v21 offset:45056
    ds_read_b64_tr_b16 v[62:63], v21 offset:46080
    v_mfma_f32_32x32x16_bf16 v[112:127], v[200:203], v[208:211], v[112:127]
    s_waitcnt lgkmcnt(6)
    v_dot2_f32_bf16 v128, v36, s29, v128
    v_dot2_f32_bf16 v130, v36, v36, v130
    v_dot2_f32_bf16 v132, v52, s29, v132
    v_dot2_f32_bf16 v128, v37, s29, v128
    v_dot2_f32_bf16 v130, v37, v37, v130
    v_dot2_f32_bf16 v132, v53, s29, v132
    v_dot2_f32_bf16 v128, v38, s29, v128
    v_dot2_f32_bf16 v130, v38, v38, v130
    v_dot2_f32_bf16 v132, v54, s29, v132
    v_dot2_f32_bf16 v128, v39, s29, v128
    v_dot2_f32_bf16 v130, v39, v39, v130
    v_dot2_f32_bf16 v132, v55, s29, v132
    v_mfma_f32_32x32x16_bf16 v[64:79], v[32:35], v[48:51], v[64:79]
    s_barrier
    ds_read_b128 v[196:199], v4 offset:0
    ds_read_b128 v[200:203], v4 offset:4096
    v_mfma_f32_32x32x16_bf16 v[80:95], v[32:35], v[52:55], v[80:95]
    ds_read_b64_tr_b16 v[204:205], v8 offset:0
    ds_read_b64_tr_b16 v[206:207], v8 offset:1024
    v_mfma_f32_32x32x16_bf16 v[96:111], v[36:39], v[48:51], v[96:111]
    ds_read_b64_tr_b16 v[208:209], v9 offset:0
    ds_read_b64_tr_b16 v[210:211], v9 offset:1024
    v_mfma_f32_32x32x16_bf16 v[112:127], v[36:39], v[52:55], v[112:127]
    s_waitcnt lgkmcnt(6)
    v_dot2_f32_bf16 v128, v44, s29, v128
    v_dot2_f32_bf16 v130, v44, v44, v130
    v_dot2_f32_bf16 v132, v60, s29, v132
    v_dot2_f32_bf16 v128, v45, s29, v128
    v_dot2_f32_bf16 v130, v45, v45, v130
    v_dot2_f32_bf16 v132, v61, s29, v132
    v_dot2_f32_bf16 v128, v46, s29, v128
    v_dot2_f32_bf16 v130, v46, v46, v130
    v_dot2_f32_bf16 v132, v62, s29, v132
    v_dot2_f32_bf16 v128, v47, s29, v128
    v_dot2_f32_bf16 v130, v47, v47, v130
    v_dot2_f32_bf16 v132, v63, s29, v132
    v_mfma_f32_32x32x16_bf16 v[64:79], v[40:43], v[56:59], v[64:79]
    ds_read_b128 v[32:35], v5 offset:0
    ds_read_b128 v[36:39], v5 offset:4096
    v_mfma_f32_32x32x16_bf16 v[80:95], v[40:43], v[60:63], v[80:95]
    ds_read_b64_tr_b16 v[48:49], v8 offset:4096
    ds_read_b64_tr_b16 v[50:51], v8 offset:5120
    v_mfma_f32_32x32x16_bf16 v[96:111], v[44:47], v[56:59], v[96:111]
    ds_read_b64_tr_b16 v[52:53], v9 offset:4096
    ds_read_b64_tr_b16 v[54:55], v9 offset:5120
    v_mfma_f32_32x32x16_bf16 v[112:127], v[44:47], v[60:63], v[112:127]
    s_waitcnt lgkmcnt(6)
    v_dot2_f32_bf16 v128, v200, s29, v128
    v_dot2_f32_bf16 v130, v200, v200, v130
    v_dot2_f32_bf16 v132, v208, s29, v132
    v_dot2_f32_bf16 v128, v201, s29, v128
    v_dot2_f32_bf16 v130, v201, v201, v130
    v_dot2_f32_bf16 v132, v209, s29, v132
    v_dot2_f32_bf16 v128, v202, s29, v128
    v_dot2_f32_bf16 v130, v202, v202, v130
    v_dot2_f32_bf16 v132, v210, s29, v132
    v_dot2_f32_bf16 v128, v203, s29, v128
    v_dot2_f32_bf16 v130, v203, v203, v130
    v_dot2_f32_bf16 v132, v211, s29, v132
    v_mfma_f32_32x32x16_bf16 v[64:79], v[196:199], v[204:207], v[64:79]
    ds_read_b128 v[40:43], v6 offset:0
    ds_read_b128 v[44:47], v6 offset:4096
    v_mfma_f32_32x32x16_bf16 v[80:95], v[196:199], v[208:211], v[80:95]
    ds_read_b64_tr_b16 v[56:57], v8 offset:8192
    ds_read_b64_tr_b16 v[58:59], v8 offset:9216
    v_mfma_f32_32x32x16_bf16 v[96:111], v[200:203], v[204:207], v[96:111]
    ds_read_b64_tr_b16 v[60:61], v9 offset:8192
    ds_read_b64_tr_b16 v[62:63], v9 offset:9216
    v_mfma_f32_32x32x16_bf16 v[112:127], v[200:203], v[208:211], v[112:127]
    s_waitcnt lgkmcnt(6)
    v_dot2_f32_bf16 v128, v36, s29, v128
    v_dot2_f32_bf16 v130, v36, v36, v130
    v_dot2_f32_bf16 v132, v52, s29, v132
    v_dot2_f32_bf16 v128, v37, s29, v128
    v_dot2_f32_bf16 v130, v37, v37, v130
    v_dot2_f32_bf16 v132, v53, s29, v132
    v_dot2_f32_bf16 v128, v38, s29, v128
    v_dot2_f32_bf16 v130, v38, v38, v130
    v_dot2_f32_bf16 v132, v54, s29, v132
    v_dot2_f32_bf16 v128, v39, s29, v128
    v_dot2_f32_bf16 v130, v39, v39, v130
    v_dot2_f32_bf16 v132, v55, s29, v132
    v_mfma_f32_32x32x16_bf16 v[64:79], v[32:35], v[48:51], v[64:79]
    ds_read_b128 v[196:199], v7 offset:0
    ds_read_b128 v[200:203], v7 offset:4096
    v_mfma_f32_32x32x16_bf16 v[80:95], v[32:35], v[52:55], v[80:95]
    ds_read_b64_tr_b16 v[204:205], v8 offset:12288
    ds_read_b64_tr_b16 v[206:207], v8 offset:13312
    v_mfma_f32_32x32x16_bf16 v[96:111], v[36:39], v[48:51], v[96:111]
    ds_read_b64_tr_b16 v[208:209], v9 offset:12288
    ds_read_b64_tr_b16 v[210:211], v9 offset:13312
    v_mfma_f32_32x32x16_bf16 v[112:127], v[36:39], v[52:55], v[112:127]
    s_waitcnt lgkmcnt(6)
    v_dot2_f32_bf16 v128, v44, s29, v128
    v_dot2_f32_bf16 v130, v44, v44, v130
    v_dot2_f32_bf16 v132, v60, s29, v132
    v_dot2_f32_bf16 v128, v45, s29, v128
    v_dot2_f32_bf16 v130, v45, v45, v130
    v_dot2_f32_bf16 v132, v61, s29, v132
    v_dot2_f32_bf16 v128, v46, s29, v128
    v_dot2_f32_bf16 v130, v46, v46, v130
    v_dot2_f32_bf16 v132, v62, s29, v132
    v_dot2_f32_bf16 v128, v47, s29, v128
    v_dot2_f32_bf16 v130, v47, v47, v130
    v_dot2_f32_bf16 v132, v63, s29, v132
    v_mfma_f32_32x32x16_bf16 v[64:79], v[40:43], v[56:59], v[64:79]
    s_barrier
    ds_read_b128 v[32:35], v4 offset:32768
    ds_read_b128 v[36:39], v4 offset:36864
    v_mfma_f32_32x32x16_bf16 v[80:95], v[40:43], v[60:63], v[80:95]
    ds_read_b64_tr_b16 v[48:49], v8 offset:32768
    ds_read_b64_tr_b16 v[50:51], v8 offset:33792
    v_mfma_f32_32x32x16_bf16 v[96:111], v[44:47], v[56:59], v[96:111]
    ds_read_b64_tr_b16 v[52:53], v9 offset:32768
    ds_read_b64_tr_b16 v[54:55], v9 offset:33792
    v_mfma_f32_32x32x16_bf16 v[112:127], v[44:47], v[60:63], v[112:127]
    s_waitcnt lgkmcnt(6)
    v_dot2_f32_bf16 v128, v200, s29, v128
    v_dot2_f32_bf16 v130, v200, v200, v130
    v_dot2_f32_bf16 v132, v208, s29, v132
    v_dot2_f32_bf16 v128, v201, s29, v128
    v_dot2_f32_bf16 v130, v201, v201, v130
    v_dot2_f32_bf16 v132, v209, s29, v132
    v_dot2_f32_bf16 v128, v202, s29, v128
    v_dot2_f32_bf16 v130, v202, v202, v130
    v_dot2_f32_bf16 v132, v210, s29, v132
    v_dot2_f32_bf16 v128, v203, s29, v128
    v_dot2_f32_bf16 v130, v203, v203, v130
    v_dot2_f32_bf16 v132, v211, s29, v132
    v_mfma_f32_32x32x16_bf16 v[64:79], v[196:199], v[204:207], v[64:79]
    ds_read_b128 v[40:43], v5 offset:32768
    ds_read_b128 v[44:47], v5 offset:36864
    v_mfma_f32_32x32x16_bf16 v[80:95], v[196:199], v[208:211], v[80:95]
    ds_read_b64_tr_b16 v[56:57], v8 offset:36864
    ds_read_b64_tr_b16 v[58:59], v8 offset:37888
    v_mfma_f32_32x32x16_bf16 v[96:111], v[200:203], v[204:207], v[96:111]
    ds_read_b64_tr_b16 v[60:61], v9 offset:36864
    ds_read_b64_tr_b16 v[62:63], v9 offset:37888
    v_mfma_f32_32x32x16_bf16 v[112:127], v[200:203], v[208:211], v[112:127]
    s_waitcnt lgkmcnt(6)
    v_dot2_f32_bf16 v128, v36, s29, v128
    v_dot2_f32_bf16 v130, v36, v36, v130
    v_dot2_f32_bf16 v132, v52, s29, v132
    v_dot2_f32_bf16 v128, v37, s29, v128
    v_dot2_f32_bf16 v130, v37, v37, v130
    v_dot2_f32_bf16 v132, v53, s29, v132
    v_dot2_f32_bf16 v128, v38, s29, v128
    v_dot2_f32_bf16 v130, v38, v38, v130
    v_dot2_f32_bf16 v132, v54, s29, v132
    v_dot2_f32_bf16 v128, v39, s29, v128
    v_dot2_f32_bf16 v130, v39, v39, v130
    v_dot2_f32_bf16 v132, v55, s29, v132
    v_mfma_f32_32x32x16_bf16 v[64:79], v[32:35], v[48:51], v[64:79]
    ds_read_b128 v[196:199], v6 offset:32768
    ds_read_b128 v[200:203], v6 offset:36864
    v_mfma_f32_32x32x16_bf16 v[80:95], v[32:35], v[52:55], v[80:95]
    ds_read_b64_tr_b16 v[204:205], v8 offset:40960
    ds_read_b64_tr_b16 v[206:207], v8 offset:41984
    v_mfma_f32_32x32x16_bf16 v[96:111], v[36:39], v[48:51], v[96:111]
    ds_read_b64_tr_b16 v[208:209], v9 offset:40960
    ds_read_b64_tr_b16 v[210:211], v9 offset:41984
    v_mfma_f32_32x32x16_bf16 v[112:127], v[36:39], v[52:55], v[112:127]
    s_waitcnt lgkmcnt(6)
    v_dot2_f32_bf16 v128, v44, s29, v128
    v_dot2_f32_bf16 v130, v44, v44, v130
    v_dot2_f32_bf16 v132, v60, s29, v132
    v_dot2_f32_bf16 v128, v45, s29, v128
    v_dot2_f32_bf16 v130, v45, v45, v130
    v_dot2_f32_bf16 v132, v61, s29, v132
    v_dot2_f32_bf16 v128, v46, s29, v128
    v_dot2_f32_bf16 v130, v46, v46, v130
    v_dot2_f32_bf16 v132, v62, s29, v132
    v_dot2_f32_bf16 v128, v47, s29, v128
    v_dot2_f32_bf16 v130, v47, v47, v130
    v_dot2_f32_bf16 v132, v63, s29, v132
    v_mfma_f32_32x32x16_bf16 v[64:79], v[40:43], v[56:59], v[64:79]
    ds_read_b128 v[32:35], v7 offset:32768
    ds_read_b128 v[36:39], v7 offset:36864
    v_mfma_f32_32x32x16_bf16 v[80:95], v[40:43], v[60:63], v[80:95]
    ds_read_b64_tr_b16 v[48:49], v8 offset:45056
    ds_read_b64_tr_b16 v[50:51], v8 offset:46080
    v_mfma_f32_32x32x16_bf16 v[96:111], v[44:47], v[56:59], v[96:111]
    ds_read_b64_tr_b16 v[52:53], v9 offset:45056
    ds_read_b64_tr_b16 v[54:55], v9 offset:46080
    v_mfma_f32_32x32x16_bf16 v[112:127], v[44:47], v[60:63], v[112:127]
    s_waitcnt lgkmcnt(6)
    v_dot2_f32_bf16 v128, v200, s29, v128
    v_dot2_f32_bf16 v130, v200, v200, v130
    v_dot2_f32_bf16 v132, v208, s29, v132
    v_dot2_f32_bf16 v128, v201, s29, v128
    v_dot2_f32_bf16 v130, v201, v201, v130
    v_dot2_f32_bf16 v132, v209, s29, v132
    v_dot2_f32_bf16 v128, v202, s29, v128
    v_dot2_f32_bf16 v130, v202, v202, v130
    v_dot2_f32_bf16 v132, v210, s29, v132
    v_dot2_f32_bf16 v128, v203, s29, v128
    v_dot2_f32_bf16 v130, v203, v203, v130
    v_dot2_f32_bf16 v132, v211, s29, v132
    v_mfma_f32_32x32x16_bf16 v[64:79], v[196:199], v[204:207], v[64:79]
    s_barrier
    ds_read_b128 v[40:43], v10 offset:0
    ds_read_b128 v[44:47], v10 offset:4096
    v_mfma_f32_32x32x16_bf16 v[80:95], v[196:199], v[208:211], v[80:95]
    ds_read_b64_tr_b16 v[56:57], v14 offset:0
    ds_read_b64_tr_b16 v[58:59], v14 offset:1024
    v_mfma_f32_32x32x16_bf16 v[96:111], v[200:203], v[204:207], v[96:111]
    ds_read_b64_tr_b16 v[60:61], v15 offset:0
    ds_read_b64_tr_b16 v[62:63], v15 offset:1024
    v_mfma_f32_32x32x16_bf16 v[112:127], v[200:203], v[208:211], v[112:127]
    s_waitcnt lgkmcnt(6)
    v_dot2_f32_bf16 v128, v36, s29, v128
    v_dot2_f32_bf16 v130, v36, v36, v130
    v_dot2_f32_bf16 v132, v52, s29, v132
    v_dot2_f32_bf16 v128, v37, s29, v128
    v_dot2_f32_bf16 v130, v37, v37, v130
    v_dot2_f32_bf16 v132, v53, s29, v132
    v_dot2_f32_bf16 v128, v38, s29, v128
    v_dot2_f32_bf16 v130, v38, v38, v130
    v_dot2_f32_bf16 v132, v54, s29, v132
    v_dot2_f32_bf16 v128, v39, s29, v128
    v_dot2_f32_bf16 v130, v39, v39, v130
    v_dot2_f32_bf16 v132, v55, s29, v132
    v_mfma_f32_32x32x16_bf16 v[64:79], v[32:35], v[48:51], v[64:79]
    ds_read_b128 v[196:199], v11 offset:0
    ds_read_b128 v[200:203], v11 offset:4096
    v_mfma_f32_32x32x16_bf16 v[80:95], v[32:35], v[52:55], v[80:95]
    ds_read_b64_tr_b16 v[204:205], v14 offset:4096
    ds_read_b64_tr_b16 v[206:207], v14 offset:5120
    v_mfma_f32_32x32x16_bf16 v[96:111], v[36:39], v[48:51], v[96:111]
    ds_read_b64_tr_b16 v[208:209], v15 offset:4096
    ds_read_b64_tr_b16 v[210:211], v15 offset:5120
    v_mfma_f32_32x32x16_bf16 v[112:127], v[36:39], v[52:55], v[112:127]
    s_waitcnt lgkmcnt(6)
    v_dot2_f32_bf16 v128, v44, s29, v128
    v_dot2_f32_bf16 v130, v44, v44, v130
    v_dot2_f32_bf16 v132, v60, s29, v132
    v_dot2_f32_bf16 v128, v45, s29, v128
    v_dot2_f32_bf16 v130, v45, v45, v130
    v_dot2_f32_bf16 v132, v61, s29, v132
    v_dot2_f32_bf16 v128, v46, s29, v128
    v_dot2_f32_bf16 v130, v46, v46, v130
    v_dot2_f32_bf16 v132, v62, s29, v132
    v_dot2_f32_bf16 v128, v47, s29, v128
    v_dot2_f32_bf16 v130, v47, v47, v130
    v_dot2_f32_bf16 v132, v63, s29, v132
    v_mfma_f32_32x32x16_bf16 v[64:79], v[40:43], v[56:59], v[64:79]
    ds_read_b128 v[32:35], v12 offset:0
    ds_read_b128 v[36:39], v12 offset:4096
    v_mfma_f32_32x32x16_bf16 v[80:95], v[40:43], v[60:63], v[80:95]
    ds_read_b64_tr_b16 v[48:49], v14 offset:8192
    ds_read_b64_tr_b16 v[50:51], v14 offset:9216
    v_mfma_f32_32x32x16_bf16 v[96:111], v[44:47], v[56:59], v[96:111]
    ds_read_b64_tr_b16 v[52:53], v15 offset:8192
    ds_read_b64_tr_b16 v[54:55], v15 offset:9216
    v_mfma_f32_32x32x16_bf16 v[112:127], v[44:47], v[60:63], v[112:127]
    s_waitcnt lgkmcnt(6)
    v_dot2_f32_bf16 v128, v200, s29, v128
    v_dot2_f32_bf16 v130, v200, v200, v130
    v_dot2_f32_bf16 v132, v208, s29, v132
    v_dot2_f32_bf16 v128, v201, s29, v128
    v_dot2_f32_bf16 v130, v201, v201, v130
    v_dot2_f32_bf16 v132, v209, s29, v132
    v_dot2_f32_bf16 v128, v202, s29, v128
    v_dot2_f32_bf16 v130, v202, v202, v130
    v_dot2_f32_bf16 v132, v210, s29, v132
    v_dot2_f32_bf16 v128, v203, s29, v128
    v_dot2_f32_bf16 v130, v203, v203, v130
    v_dot2_f32_bf16 v132, v211, s29, v132
    v_mfma_f32_32x32x16_bf16 v[64:79], v[196:199], v[204:207], v[64:79]
    ds_read_b128 v[40:43], v13 offset:0
    ds_read_b128 v[44:47], v13 offset:4096
    v_mfma_f32_32x32x16_bf16 v[80:95], v[196:199], v[208:211], v[80:95]
    ds_read_b64_tr_b16 v[56:57], v14 offset:12288
    ds_read_b64_tr_b16 v[58:59], v14 offset:13312
    v_mfma_f32_32x32x16_bf16 v[96:111], v[200:203], v[204:207], v[96:111]
    ds_read_b64_tr_b16 v[60:61], v15 offset:12288
    ds_read_b64_tr_b16 v[62:63], v15 offset:13312
    v_mfma_f32_32x32x16_bf16 v[112:127], v[200:203], v[208:211], v[112:127]
    s_waitcnt lgkmcnt(6)
    v_dot2_f32_bf16 v128, v36, s29, v128
    v_dot2_f32_bf16 v130, v36, v36, v130
    v_dot2_f32_bf16 v132, v52, s29, v132
    v_dot2_f32_bf16 v128, v37, s29, v128
    v_dot2_f32_bf16 v130, v37, v37, v130
    v_dot2_f32_bf16 v132, v53, s29, v132
    v_dot2_f32_bf16 v128, v38, s29, v128
    v_dot2_f32_bf16 v130, v38, v38, v130
    v_dot2_f32_bf16 v132, v54, s29, v132
    v_dot2_f32_bf16 v128, v39, s29, v128
    v_dot2_f32_bf16 v130, v39, v39, v130
    v_dot2_f32_bf16 v132, v55, s29, v132
    v_mfma_f32_32x32x16_bf16 v[64:79], v[32:35], v[48:51], v[64:79]
    s_barrier
    ds_read_b128 v[196:199], v16 offset:0
    ds_read_b128 v[200:203], v16 offset:4096
    v_mfma_f32_32x32x16_bf16 v[80:95], v[32:35], v[52:55], v[80:95]
    ds_read_b64_tr_b16 v[204:205], v20 offset:0
    ds_read_b64_tr_b16 v[206:207], v20 offset:1024
    v_mfma_f32_32x32x16_bf16 v[96:111], v[36:39], v[48:51], v[96:111]
    ds_read_b64_tr_b16 v[208:209], v21 offset:0
    ds_read_b64_tr_b16 v[210:211], v21 offset:1024
    v_mfma_f32_32x32x16_bf16 v[112:127], v[36:39], v[52:55], v[112:127]
    s_waitcnt lgkmcnt(6)
    v_dot2_f32_bf16 v128, v44, s29, v128
    v_dot2_f32_bf16 v130, v44, v44, v130
    v_dot2_f32_bf16 v132, v60, s29, v132
    v_dot2_f32_bf16 v128, v45, s29, v128
    v_dot2_f32_bf16 v130, v45, v45, v130
    v_dot2_f32_bf16 v132, v61, s29, v132
    v_dot2_f32_bf16 v128, v46, s29, v128
    v_dot2_f32_bf16 v130, v46, v46, v130
    v_dot2_f32_bf16 v132, v62, s29, v132
    v_dot2_f32_bf16 v128, v47, s29, v128
    v_dot2_f32_bf16 v130, v47, v47, v130
    v_dot2_f32_bf16 v132, v63, s29, v132
    v_mfma_f32_32x32x16_bf16 v[64:79], v[40:43], v[56:59], v[64:79]
    ds_read_b128 v[32:35], v17 offset:0
    ds_read_b128 v[36:39], v17 offset:4096
    v_mfma_f32_32x32x16_bf16 v[80:95], v[40:43], v[60:63], v[80:95]
    ds_read_b64_tr_b16 v[48:49], v20 offset:4096
    ds_read_b64_tr_b16 v[50:51], v20 offset:5120
    v_mfma_f32_32x32x16_bf16 v[96:111], v[44:47], v[56:59], v[96:111]
    ds_read_b64_tr_b16 v[52:53], v21 offset:4096
    ds_read_b64_tr_b16 v[54:55], v21 offset:5120
    v_mfma_f32_32x32x16_bf16 v[112:127], v[44:47], v[60:63], v[112:127]
    s_waitcnt lgkmcnt(6)
    v_dot2_f32_bf16 v128, v200, s29, v128
    v_dot2_f32_bf16 v130, v200, v200, v130
    v_dot2_f32_bf16 v132, v208, s29, v132
    v_dot2_f32_bf16 v128, v201, s29, v128
    v_dot2_f32_bf16 v130, v201, v201, v130
    v_dot2_f32_bf16 v132, v209, s29, v132
    v_dot2_f32_bf16 v128, v202, s29, v128
    v_dot2_f32_bf16 v130, v202, v202, v130
    v_dot2_f32_bf16 v132, v210, s29, v132
    v_dot2_f32_bf16 v128, v203, s29, v128
    v_dot2_f32_bf16 v130, v203, v203, v130
    v_dot2_f32_bf16 v132, v211, s29, v132
    v_mfma_f32_32x32x16_bf16 v[64:79], v[196:199], v[204:207], v[64:79]
    ds_read_b128 v[40:43], v18 offset:0
    ds_read_b128 v[44:47], v18 offset:4096
    v_mfma_f32_32x32x16_bf16 v[80:95], v[196:199], v[208:211], v[80:95]
    ds_read_b64_tr_b16 v[56:57], v20 offset:8192
    ds_read_b64_tr_b16 v[58:59], v20 offset:9216
    v_mfma_f32_32x32x16_bf16 v[96:111], v[200:203], v[204:207], v[96:111]
    ds_read_b64_tr_b16 v[60:61], v21 offset:8192
    ds_read_b64_tr_b16 v[62:63], v21 offset:9216
    v_mfma_f32_32x32x16_bf16 v[112:127], v[200:203], v[208:211], v[112:127]
    s_waitcnt lgkmcnt(6)
    v_dot2_f32_bf16 v128, v36, s29, v128
    v_dot2_f32_bf16 v130, v36, v36, v130
    v_dot2_f32_bf16 v132, v52, s29, v132
    v_dot2_f32_bf16 v128, v37, s29, v128
    v_dot2_f32_bf16 v130, v37, v37, v130
    v_dot2_f32_bf16 v132, v53, s29, v132
    v_dot2_f32_bf16 v128, v38, s29, v128
    v_dot2_f32_bf16 v130, v38, v38, v130
    v_dot2_f32_bf16 v132, v54, s29, v132
    v_dot2_f32_bf16 v128, v39, s29, v128
    v_dot2_f32_bf16 v130, v39, v39, v130
    v_dot2_f32_bf16 v132, v55, s29, v132
    v_mfma_f32_32x32x16_bf16 v[64:79], v[32:35], v[48:51], v[64:79]
    ds_read_b128 v[196:199], v19 offset:0
    ds_read_b128 v[200:203], v19 offset:4096
    v_mfma_f32_32x32x16_bf16 v[80:95], v[32:35], v[52:55], v[80:95]
    ds_read_b64_tr_b16 v[204:205], v20 offset:12288
    ds_read_b64_tr_b16 v[206:207], v20 offset:13312
    v_mfma_f32_32x32x16_bf16 v[96:111], v[36:39], v[48:51], v[96:111]
    ds_read_b64_tr_b16 v[208:209], v21 offset:12288
    ds_read_b64_tr_b16 v[210:211], v21 offset:13312
    v_mfma_f32_32x32x16_bf16 v[112:127], v[36:39], v[52:55], v[112:127]
    s_waitcnt lgkmcnt(6)
    v_dot2_f32_bf16 v128, v44, s29, v128
    v_dot2_f32_bf16 v130, v44, v44, v130
    v_dot2_f32_bf16 v132, v60, s29, v132
    v_dot2_f32_bf16 v128, v45, s29, v128
    v_dot2_f32_bf16 v130, v45, v45, v130
    v_dot2_f32_bf16 v132, v61, s29, v132
    v_dot2_f32_bf16 v128, v46, s29, v128
    v_dot2_f32_bf16 v130, v46, v46, v130
    v_dot2_f32_bf16 v132, v62, s29, v132
    v_dot2_f32_bf16 v128, v47, s29, v128
    v_dot2_f32_bf16 v130, v47, v47, v130
    v_dot2_f32_bf16 v132, v63, s29, v132
    v_mfma_f32_32x32x16_bf16 v[64:79], v[40:43], v[56:59], v[64:79]
    s_barrier
    ds_read_b128 v[32:35], v16 offset:32768
    ds_read_b128 v[36:39], v16 offset:36864
    v_mfma_f32_32x32x16_bf16 v[80:95], v[40:43], v[60:63], v[80:95]
    ds_read_b64_tr_b16 v[48:49], v20 offset:32768
    ds_read_b64_tr_b16 v[50:51], v20 offset:33792
    v_mfma_f32_32x32x16_bf16 v[96:111], v[44:47], v[56:59], v[96:111]
    ds_read_b64_tr_b16 v[52:53], v21 offset:32768
    ds_read_b64_tr_b16 v[54:55], v21 offset:33792
    v_mfma_f32_32x32x16_bf16 v[112:127], v[44:47], v[60:63], v[112:127]
    s_waitcnt lgkmcnt(6)
    v_dot2_f32_bf16 v128, v200, s29, v128
    v_dot2_f32_bf16 v130, v200, v200, v130
    v_dot2_f32_bf16 v132, v208, s29, v132
    v_dot2_f32_bf16 v128, v201, s29, v128
    v_dot2_f32_bf16 v130, v201, v201, v130
    v_dot2_f32_bf16 v132, v209, s29, v132
    v_dot2_f32_bf16 v128, v202, s29, v128
    v_dot2_f32_bf16 v130, v202, v202, v130
    v_dot2_f32_bf16 v132, v210, s29, v132
    v_dot2_f32_bf16 v128, v203, s29, v128
    v_dot2_f32_bf16 v130, v203, v203, v130
    v_dot2_f32_bf16 v132, v211, s29, v132
    v_mfma_f32_32x32x16_bf16 v[64:79], v[196:199], v[204:207], v[64:79]
    ds_read_b128 v[40:43], v17 offset:32768
    ds_read_b128 v[44:47], v17 offset:36864
    v_mfma_f32_32x32x16_bf16 v[80:95], v[196:199], v[208:211], v[80:95]
    ds_read_b64_tr_b16 v[56:57], v20 offset:36864
    ds_read_b64_tr_b16 v[58:59], v20 offset:37888
    v_mfma_f32_32x32x16_bf16 v[96:111], v[200:203], v[204:207], v[96:111]
    ds_read_b64_tr_b16 v[60:61], v21 offset:36864
    ds_read_b64_tr_b16 v[62:63], v21 offset:37888
    v_mfma_f32_32x32x16_bf16 v[112:127], v[200:203], v[208:211], v[112:127]
    s_waitcnt lgkmcnt(6)
    v_dot2_f32_bf16 v128, v36, s29, v128
    v_dot2_f32_bf16 v130, v36, v36, v130
    v_dot2_f32_bf16 v132, v52, s29, v132
    v_dot2_f32_bf16 v128, v37, s29, v128
    v_dot2_f32_bf16 v130, v37, v37, v130
    v_dot2_f32_bf16 v132, v53, s29, v132
    v_dot2_f32_bf16 v128, v38, s29, v128
    v_dot2_f32_bf16 v130, v38, v38, v130
    v_dot2_f32_bf16 v132, v54, s29, v132
    v_dot2_f32_bf16 v128, v39, s29, v128
    v_dot2_f32_bf16 v130, v39, v39, v130
    v_dot2_f32_bf16 v132, v55, s29, v132
    v_mfma_f32_32x32x16_bf16 v[64:79], v[32:35], v[48:51], v[64:79]
    ds_read_b128 v[196:199], v18 offset:32768
    ds_read_b128 v[200:203], v18 offset:36864
    v_mfma_f32_32x32x16_bf16 v[80:95], v[32:35], v[52:55], v[80:95]
    ds_read_b64_tr_b16 v[204:205], v20 offset:40960
    ds_read_b64_tr_b16 v[206:207], v20 offset:41984
    v_mfma_f32_32x32x16_bf16 v[96:111], v[36:39], v[48:51], v[96:111]
    ds_read_b64_tr_b16 v[208:209], v21 offset:40960
    ds_read_b64_tr_b16 v[210:211], v21 offset:41984
    v_mfma_f32_32x32x16_bf16 v[112:127], v[36:39], v[52:55], v[112:127]
    s_waitcnt lgkmcnt(6)
    v_dot2_f32_bf16 v128, v44, s29, v128
    v_dot2_f32_bf16 v130, v44, v44, v130
    v_dot2_f32_bf16 v132, v60, s29, v132
    v_dot2_f32_bf16 v128, v45, s29, v128
    v_dot2_f32_bf16 v130, v45, v45, v130
    v_dot2_f32_bf16 v132, v61, s29, v132
    v_dot2_f32_bf16 v128, v46, s29, v128
    v_dot2_f32_bf16 v130, v46, v46, v130
    v_dot2_f32_bf16 v132, v62, s29, v132
    v_dot2_f32_bf16 v128, v47, s29, v128
    v_dot2_f32_bf16 v130, v47, v47, v130
    v_dot2_f32_bf16 v132, v63, s29, v132
    v_mfma_f32_32x32x16_bf16 v[64:79], v[40:43], v[56:59], v[64:79]
    ds_read_b128 v[32:35], v19 offset:32768
    ds_read_b128 v[36:39], v19 offset:36864
    v_mfma_f32_32x32x16_bf16 v[80:95], v[40:43], v[60:63], v[80:95]
    ds_read_b64_tr_b16 v[48:49], v20 offset:45056
    ds_read_b64_tr_b16 v[50:51], v20 offset:46080
    v_mfma_f32_32x32x16_bf16 v[96:111], v[44:47], v[56:59], v[96:111]
    ds_read_b64_tr_b16 v[52:53], v21 offset:45056
    ds_read_b64_tr_b16 v[54:55], v21 offset:46080
    v_mfma_f32_32x32x16_bf16 v[112:127], v[44:47], v[60:63], v[112:127]
    s_waitcnt lgkmcnt(6)
    v_dot2_f32_bf16 v128, v200, s29, v128
    v_dot2_f32_bf16 v130, v200, v200, v130
    v_dot2_f32_bf16 v132, v208, s29, v132
    v_dot2_f32_bf16 v128, v201, s29, v128
    v_dot2_f32_bf16 v130, v201, v201, v130
    v_dot2_f32_bf16 v132, v209, s29, v132
    v_dot2_f32_bf16 v128, v202, s29, v128
    v_dot2_f32_bf16 v130, v202, v202, v130
    v_dot2_f32_bf16 v132, v210, s29, v132
    v_dot2_f32_bf16 v128, v203, s29, v128
    v_dot2_f32_bf16 v130, v203, v203, v130
    v_dot2_f32_bf16 v132, v211, s29, v132
    v_mfma_f32_32x32x16_bf16 v[64:79], v[196:199], v[204:207], v[64:79]
    s_barrier
    ds_read_b128 v[40:43], v4 offset:0
    ds_read_b128 v[44:47], v4 offset:4096
    v_mfma_f32_32x32x16_bf16 v[80:95], v[196:199], v[208:211], v[80:95]
    ds_read_b64_tr_b16 v[56:57], v8 offset:0
    ds_read_b64_tr_b16 v[58:59], v8 offset:1024
    v_mfma_f32_32x32x16_bf16 v[96:111], v[200:203], v[204:207], v[96:111]
    ds_read_b64_tr_b16 v[60:61], v9 offset:0
    ds_read_b64_tr_b16 v[62:63], v9 offset:1024
    v_mfma_f32_32x32x16_bf16 v[112:127], v[200:203], v[208:211], v[112:127]
    s_waitcnt lgkmcnt(6)
    v_dot2_f32_bf16 v128, v36, s29, v128
    v_dot2_f32_bf16 v130, v36, v36, v130
    v_dot2_f32_bf16 v132, v52, s29, v132
    v_dot2_f32_bf16 v128, v37, s29, v128
    v_dot2_f32_bf16 v130, v37, v37, v130
    v_dot2_f32_bf16 v132, v53, s29, v132
    v_dot2_f32_bf16 v128, v38, s29, v128
    v_dot2_f32_bf16 v130, v38, v38, v130
    v_dot2_f32_bf16 v132, v54, s29, v132
    v_dot2_f32_bf16 v128, v39, s29, v128
    v_dot2_f32_bf16 v130, v39, v39, v130
    v_dot2_f32_bf16 v132, v55, s29, v132
    v_mfma_f32_32x32x16_bf16 v[64:79], v[32:35], v[48:51], v[64:79]
    ds_read_b128 v[196:199], v5 offset:0
    ds_read_b128 v[200:203], v5 offset:4096
    v_mfma_f32_32x32x16_bf16 v[80:95], v[32:35], v[52:55], v[80:95]
    ds_read_b64_tr_b16 v[204:205], v8 offset:4096
    ds_read_b64_tr_b16 v[206:207], v8 offset:5120
    v_mfma_f32_32x32x16_bf16 v[96:111], v[36:39], v[48:51], v[96:111]
    ds_read_b64_tr_b16 v[208:209], v9 offset:4096
    ds_read_b64_tr_b16 v[210:211], v9 offset:5120
    v_mfma_f32_32x32x16_bf16 v[112:127], v[36:39], v[52:55], v[112:127]
    s_waitcnt lgkmcnt(6)
    v_dot2_f32_bf16 v128, v44, s29, v128
    v_dot2_f32_bf16 v130, v44, v44, v130
    v_dot2_f32_bf16 v132, v60, s29, v132
    v_dot2_f32_bf16 v128, v45, s29, v128
    v_dot2_f32_bf16 v130, v45, v45, v130
    v_dot2_f32_bf16 v132, v61, s29, v132
    v_dot2_f32_bf16 v128, v46, s29, v128
    v_dot2_f32_bf16 v130, v46, v46, v130
    v_dot2_f32_bf16 v132, v62, s29, v132
    v_dot2_f32_bf16 v128, v47, s29, v128
    v_dot2_f32_bf16 v130, v47, v47, v130
    v_dot2_f32_bf16 v132, v63, s29, v132
    v_mfma_f32_32x32x16_bf16 v[64:79], v[40:43], v[56:59], v[64:79]
    ds_read_b128 v[32:35], v6 offset:0
    ds_read_b128 v[36:39], v6 offset:4096
    v_mfma_f32_32x32x16_bf16 v[80:95], v[40:43], v[60:63], v[80:95]
    ds_read_b64_tr_b16 v[48:49], v8 offset:8192
    ds_read_b64_tr_b16 v[50:51], v8 offset:9216
    v_mfma_f32_32x32x16_bf16 v[96:111], v[44:47], v[56:59], v[96:111]
    ds_read_b64_tr_b16 v[52:53], v9 offset:8192
    ds_read_b64_tr_b16 v[54:55], v9 offset:9216
    v_mfma_f32_32x32x16_bf16 v[112:127], v[44:47], v[60:63], v[112:127]
    s_waitcnt lgkmcnt(6)
    v_dot2_f32_bf16 v128, v200, s29, v128
    v_dot2_f32_bf16 v130, v200, v200, v130
    v_dot2_f32_bf16 v132, v208, s29, v132
    v_dot2_f32_bf16 v128, v201, s29, v128
    v_dot2_f32_bf16 v130, v201, v201, v130
    v_dot2_f32_bf16 v132, v209, s29, v132
    v_dot2_f32_bf16 v128, v202, s29, v128
    v_dot2_f32_bf16 v130, v202, v202, v130
    v_dot2_f32_bf16 v132, v210, s29, v132
    v_dot2_f32_bf16 v128, v203, s29, v128
    v_dot2_f32_bf16 v130, v203, v203, v130
    v_dot2_f32_bf16 v132, v211, s29, v132
    v_mfma_f32_32x32x16_bf16 v[64:79], v[196:199], v[204:207], v[64:79]
    ds_read_b128 v[40:43], v7 offset:0
    ds_read_b128 v[44:47], v7 offset:4096
    v_mfma_f32_32x32x16_bf16 v[80:95], v[196:199], v[208:211], v[80:95]
    ds_read_b64_tr_b16 v[56:57], v8 offset:12288
    ds_read_b64_tr_b16 v[58:59], v8 offset:13312
    v_mfma_f32_32x32x16_bf16 v[96:111], v[200:203], v[204:207], v[96:111]
    ds_read_b64_tr_b16 v[60:61], v9 offset:12288
    ds_read_b64_tr_b16 v[62:63], v9 offset:13312
    v_mfma_f32_32x32x16_bf16 v[112:127], v[200:203], v[208:211], v[112:127]
    s_waitcnt lgkmcnt(6)
    v_dot2_f32_bf16 v128, v36, s29, v128
    v_dot2_f32_bf16 v130, v36, v36, v130
    v_dot2_f32_bf16 v132, v52, s29, v132
    v_dot2_f32_bf16 v128, v37, s29, v128
    v_dot2_f32_bf16 v130, v37, v37, v130
    v_dot2_f32_bf16 v132, v53, s29, v132
    v_dot2_f32_bf16 v128, v38, s29, v128
    v_dot2_f32_bf16 v130, v38, v38, v130
    v_dot2_f32_bf16 v132, v54, s29, v132
    v_dot2_f32_bf16 v128, v39, s29, v128
    v_dot2_f32_bf16 v130, v39, v39, v130
    v_dot2_f32_bf16 v132, v55, s29, v132
    v_mfma_f32_32x32x16_bf16 v[64:79], v[32:35], v[48:51], v[64:79]
    v_mfma_f32_32x32x16_bf16 v[80:95], v[32:35], v[52:55], v[80:95]
    v_mfma_f32_32x32x16_bf16 v[96:111], v[36:39], v[48:51], v[96:111]
    v_mfma_f32_32x32x16_bf16 v[112:127], v[36:39], v[52:55], v[112:127]
    s_waitcnt lgkmcnt(0)
    v_dot2_f32_bf16 v128, v44, s29, v128
    v_dot2_f32_bf16 v130, v44, v44, v130
    v_dot2_f32_bf16 v132, v60, s29, v132
    v_dot2_f32_bf16 v128, v45, s29, v128
    v_dot2_f32_bf16 v130, v45, v45, v130
    v_dot2_f32_bf16 v132, v61, s29, v132
    v_dot2_f32_bf16 v128, v46, s29, v128
    v_dot2_f32_bf16 v130, v46, v46, v130
    v_dot2_f32_bf16 v132, v62, s29, v132
    v_dot2_f32_bf16 v128, v47, s29, v128
    v_dot2_f32_bf16 v130, v47, v47, v130
    v_dot2_f32_bf16 v132, v63, s29, v132
    v_mfma_f32_32x32x16_bf16 v[64:79], v[40:43], v[56:59], v[64:79]
    v_mfma_f32_32x32x16_bf16 v[80:95], v[40:43], v[60:63], v[80:95]
    v_mfma_f32_32x32x16_bf16 v[96:111], v[44:47], v[56:59], v[96:111]
    v_mfma_f32_32x32x16_bf16 v[112:127], v[44:47], v[60:63], v[112:127]
qkv_a_kernel_ve:
    s_barrier
    s_lshl_b32 s3, s26, 10
    v_lshlrev_b32 v12, 2, v2
    v_add_u32 v12, s3, v12
    ds_write_b32 v12, v128
    ds_write_b32 v12, v130 offset:256
    ds_write_b32 v12, v132 offset:512
    s_waitcnt lgkmcnt(0)
    s_barrier
    s_lshl_b32 s3, s27, 11
    v_lshlrev_b32 v12, 2, v2
    v_add_u32 v13, s3, v12
    s_lshl_b32 s3, s28, 10
    v_add_u32 v12, s3, v12
    ds_read_b32 v128, v13
    ds_read_b32 v129, v13 offset:1024
    ds_read_b32 v130, v13 offset:256
    ds_read_b32 v131, v13 offset:1280
    ds_read_b32 v132, v12 offset:512
    ds_read_b32 v133, v12 offset:2560
    s_waitcnt lgkmcnt(0)
    v_mov_b32 v144, v128
    s_nop 1
    v_permlane32_swap_b32 v128, v144
    s_nop 1
    v_add_f32 v128, v128, v144
    v_mov_b32 v144, v130
    s_nop 1
    v_permlane32_swap_b32 v130, v144
    s_nop 1
    v_add_f32 v130, v130, v144
    v_mul_f32 v128, 0xbb000000, v128
    v_mul_f32 v130, 0x3b000000, v130
    v_fma_f32 v130, -v128, v128, v130
    v_add_f32 v130, 0x3727c5ac, v130
    v_rsq_f32 v130, v130
    v_cvt_pk_bf16_f32 v32, v128, v128
    v_and_b32 v144, 0xffff0000, v32
    v_sub_f32 v144, v128, v144
    v_cvt_pk_bf16_f32 v33, v144, v144
    v_mov_b32 v34, 0
    v_mov_b32 v35, 0
    v_mov_b32 v144, v129
    s_nop 1
    v_permlane32_swap_b32 v129, v144
    s_nop 1
    v_add_f32 v129, v129, v144
    v_mov_b32 v144, v131
    s_nop 1
    v_permlane32_swap_b32 v131, v144
    s_nop 1
    v_add_f32 v131, v131, v144
    v_mul_f32 v129, 0xbb000000, v129
    v_mul_f32 v131, 0x3b000000, v131
    v_fma_f32 v131, -v129, v129, v131
    v_add_f32 v131, 0x3727c5ac, v131
    v_rsq_f32 v131, v131
    v_cvt_pk_bf16_f32 v36, v129, v129
    v_and_b32 v144, 0xffff0000, v36
    v_sub_f32 v144, v129, v144
    v_cvt_pk_bf16_f32 v37, v144, v144
    v_mov_b32 v38, 0
    v_mov_b32 v39, 0
    v_cvt_pk_bf16_f32 v48, v132, v132
    v_and_b32 v144, 0xffff0000, v48
    v_sub_f32 v144, v132, v144
    v_cvt_pk_bf16_f32 v48, v132, v144
    v_mov_b32 v49, v48
    v_mov_b32 v50, 0
    v_mov_b32 v51, 0
    v_cvt_pk_bf16_f32 v52, v133, v133
    v_and_b32 v144, 0xffff0000, v52
    v_sub_f32 v144, v133, v144
    v_cvt_pk_bf16_f32 v52, v133, v144
    v_mov_b32 v53, v52
    v_mov_b32 v54, 0
    v_mov_b32 v55, 0
    s_nop 1
    v_mfma_f32_32x32x16_bf16 v[64:79], v[32:35], v[48:51], v[64:79]
    v_mfma_f32_32x32x16_bf16 v[80:95], v[32:35], v[52:55], v[80:95]
    v_mfma_f32_32x32x16_bf16 v[96:111], v[36:39], v[48:51], v[96:111]
    v_mfma_f32_32x32x16_bf16 v[112:127], v[36:39], v[52:55], v[112:127]
    s_barrier
    v_and_b32 v12, 31, v2
    v_lshlrev_b32 v12, 2, v12
    s_lshl_b32 s3, s26, 8
    s_add_u32 s3, s3, 8192
    v_add_u32 v12, s3, v12
    ds_write_b32 v12, v130
    ds_write_b32 v12, v131 offset:128
    v_lshrrev_b32 v13, 5, v2
    v_lshlrev_b32 v13, 4, v13
    v_add_u32 v13, s3, v13
    s_waitcnt lgkmcnt(0)
    s_nop 15
    ds_read_b128 v[32:35], v13 offset:0
    ds_read_b128 v[36:39], v13 offset:32
    ds_read_b128 v[40:43], v13 offset:64
    ds_read_b128 v[44:47], v13 offset:96
    ds_read_b128 v[48:51], v13 offset:128
    ds_read_b128 v[52:55], v13 offset:160
    ds_read_b128 v[56:59], v13 offset:192
    ds_read_b128 v[60:63], v13 offset:224
    s_lshl_b32 s33, s25, 3
    s_lshl_b32 s34, s28, 2
    s_add_u32 s33, s33, s34
    s_lshl_b32 s33, s33, 16
    s_lshl_b32 s34, s24, 2
    s_lshl_b32 s35, s27, 1
    s_add_u32 s34, s34, s35
    s_lshl_b32 s34, s34, 10
    s_add_u32 s33, s33, s34
    v_bfe_u32 v12, v2, 4, 1
    v_lshlrev_b32 v12, 16, v12
    v_lshrrev_b32 v13, 5, v2
    v_lshlrev_b32 v13, 8, v13
    v_and_b32 v14, 15, v2
    v_lshlrev_b32 v14, 4, v14
    v_add3_u32 v12, v12, v13, v14
    s_waitcnt lgkmcnt(0)
    v_pk_mul_f32 v[64:65], v[64:65], v[32:33]
    v_pk_mul_f32 v[66:67], v[66:67], v[34:35]
    v_pk_mul_f32 v[68:69], v[68:69], v[36:37]
    v_pk_mul_f32 v[70:71], v[70:71], v[38:39]
    v_pk_mul_f32 v[72:73], v[72:73], v[40:41]
    v_pk_mul_f32 v[74:75], v[74:75], v[42:43]
    v_pk_mul_f32 v[76:77], v[76:77], v[44:45]
    v_pk_mul_f32 v[78:79], v[78:79], v[46:47]
    v_cvt_pk_bf16_f32 v148, v64, v65
    v_cvt_pk_bf16_f32 v149, v66, v67
    v_cvt_pk_bf16_f32 v150, v68, v69
    v_cvt_pk_bf16_f32 v151, v70, v71
    s_add_u32 s3, s33, 0
    buffer_store_dwordx4 v[148:151], v12, s[16:19], s3 offen sc0 sc1
    v_cvt_pk_bf16_f32 v152, v72, v73
    v_cvt_pk_bf16_f32 v153, v74, v75
    v_cvt_pk_bf16_f32 v154, v76, v77
    v_cvt_pk_bf16_f32 v155, v78, v79
    s_add_u32 s3, s33, 512
    buffer_store_dwordx4 v[152:155], v12, s[16:19], s3 offen sc0 sc1
    v_pk_mul_f32 v[80:81], v[80:81], v[32:33]
    v_pk_mul_f32 v[82:83], v[82:83], v[34:35]
    v_pk_mul_f32 v[84:85], v[84:85], v[36:37]
    v_pk_mul_f32 v[86:87], v[86:87], v[38:39]
    v_pk_mul_f32 v[88:89], v[88:89], v[40:41]
    v_pk_mul_f32 v[90:91], v[90:91], v[42:43]
    v_pk_mul_f32 v[92:93], v[92:93], v[44:45]
    v_pk_mul_f32 v[94:95], v[94:95], v[46:47]
    v_cvt_pk_bf16_f32 v156, v80, v81
    v_cvt_pk_bf16_f32 v157, v82, v83
    v_cvt_pk_bf16_f32 v158, v84, v85
    v_cvt_pk_bf16_f32 v159, v86, v87
    s_add_u32 s3, s33, 131072
    buffer_store_dwordx4 v[156:159], v12, s[16:19], s3 offen sc0 sc1
    v_cvt_pk_bf16_f32 v148, v88, v89
    v_cvt_pk_bf16_f32 v149, v90, v91
    v_cvt_pk_bf16_f32 v150, v92, v93
    v_cvt_pk_bf16_f32 v151, v94, v95
    s_add_u32 s3, s33, 131584
    buffer_store_dwordx4 v[148:151], v12, s[16:19], s3 offen sc0 sc1
    v_pk_mul_f32 v[96:97], v[96:97], v[48:49]
    v_pk_mul_f32 v[98:99], v[98:99], v[50:51]
    v_pk_mul_f32 v[100:101], v[100:101], v[52:53]
    v_pk_mul_f32 v[102:103], v[102:103], v[54:55]
    v_pk_mul_f32 v[104:105], v[104:105], v[56:57]
    v_pk_mul_f32 v[106:107], v[106:107], v[58:59]
    v_pk_mul_f32 v[108:109], v[108:109], v[60:61]
    v_pk_mul_f32 v[110:111], v[110:111], v[62:63]
    v_cvt_pk_bf16_f32 v152, v96, v97
    v_cvt_pk_bf16_f32 v153, v98, v99
    v_cvt_pk_bf16_f32 v154, v100, v101
    v_cvt_pk_bf16_f32 v155, v102, v103
    s_add_u32 s3, s33, 1024
    buffer_store_dwordx4 v[152:155], v12, s[16:19], s3 offen sc0 sc1
    v_cvt_pk_bf16_f32 v156, v104, v105
    v_cvt_pk_bf16_f32 v157, v106, v107
    v_cvt_pk_bf16_f32 v158, v108, v109
    v_cvt_pk_bf16_f32 v159, v110, v111
    s_add_u32 s3, s33, 1536
    buffer_store_dwordx4 v[156:159], v12, s[16:19], s3 offen sc0 sc1
    v_pk_mul_f32 v[112:113], v[112:113], v[48:49]
    v_pk_mul_f32 v[114:115], v[114:115], v[50:51]
    v_pk_mul_f32 v[116:117], v[116:117], v[52:53]
    v_pk_mul_f32 v[118:119], v[118:119], v[54:55]
    v_pk_mul_f32 v[120:121], v[120:121], v[56:57]
    v_pk_mul_f32 v[122:123], v[122:123], v[58:59]
    v_pk_mul_f32 v[124:125], v[124:125], v[60:61]
    v_pk_mul_f32 v[126:127], v[126:127], v[62:63]
    v_cvt_pk_bf16_f32 v148, v112, v113
    v_cvt_pk_bf16_f32 v149, v114, v115
    v_cvt_pk_bf16_f32 v150, v116, v117
    v_cvt_pk_bf16_f32 v151, v118, v119
    s_add_u32 s3, s33, 132096
    buffer_store_dwordx4 v[148:151], v12, s[16:19], s3 offen sc0 sc1
    v_cvt_pk_bf16_f32 v152, v120, v121
    v_cvt_pk_bf16_f32 v153, v122, v123
    v_cvt_pk_bf16_f32 v154, v124, v125
    v_cvt_pk_bf16_f32 v155, v126, v127
    s_add_u32 s3, s33, 132608
    buffer_store_dwordx4 v[152:155], v12, s[16:19], s3 offen sc0 sc1
qkv_a_kernel_fin:
qkv_a_kernel_done:
    s_endpgm
.section .rodata,"a"
.p2align 6
.amdhsa_kernel qkv_a_kernel
  .amdhsa_next_free_vgpr 212
  .amdhsa_next_free_sgpr 96
  .amdhsa_accum_offset 212
  .amdhsa_group_segment_fixed_size 0
  .amdhsa_kernarg_size 72
  .amdhsa_user_sgpr_count 2
  .amdhsa_user_sgpr_kernarg_segment_ptr 1
  .amdhsa_system_sgpr_workgroup_id_x 1
  .amdhsa_float_denorm_mode_32 3
.end_amdhsa_kernel
.text
.globl qkv_b_kernel
.p2align 8
.type qkv_b_kernel,@function
qkv_b_kernel:
    s_cmp_ge_u32 s2, 192
    s_cbranch_scc1 qkv_b_kernel_done
    s_load_dwordx2 s[8:9], s[0:1], 64
    s_load_dwordx2 s[12:13], s[0:1], 8
    v_lshrrev_b32 v1, 6, v0
    v_and_b32 v2, 63, v0
    s_and_b32 s3, s2, 7
    s_lshr_b32 s4, s2, 3
    v_readfirstlane_b32 s26, v1
    s_and_b32 s5, s3, 3
    s_lshr_b32 s3, s3, 2
    s_lshl_b32 s5, s5, 2
    s_and_b32 s24, s4, 3
    s_add_u32 s24, s24, s5
    s_lshr_b32 s4, s4, 2
    s_mul_i32 s3, s3, 6
    s_add_u32 s25, s3, s4
    v_lshlrev_b32 v3, 4, v2
    s_cmp_lt_u32 s26, 4
    s_cbranch_scc1 qkv_b_kernel_cw
    s_sub_u32 s26, s26, 4
    s_lshr_b32 s27, s26, 1
    s_and_b32 s28, s26, 1
    s_lshl_b32 s30, s26, 12
    v_lshrrev_b32 v12, 4, v2
    v_bfe_u32 v13, v2, 2, 2
    v_xor_b32 v13, v13, v12
    v_lshlrev_b32 v13, 6, v13
    v_and_b32 v14, 3, v2
    v_lshlrev_b32 v14, 4, v14
    v_mul_u32_u24 v12, 3072, v12
    v_add3_u32 v8, v12, v13, v14
    v_add_u32 v9, 11264, v8
    v_add_u32 v10, 22528, v8
    v_add_u32 v11, 33792, v8
    s_lshl_b32 s31, s24, 2
    s_add_u32 s31, s31, s26
    s_lshl_b32 s31, s31, 15
    s_mul_i32 s32, s26, 49152
    s_lshl_b32 s3, s25, 8
    s_add_u32 s32, s32, s3
    s_waitcnt lgkmcnt(0)
    s_mov_b32 s10, 0x200000
    s_mov_b32 s11, 0x00020000
    s_mov_b32 s14, 0x180000
    s_mov_b32 s15, 0x00020000
    s_add_u32 m0, s30, 16384
    s_add_u32 s3, s32, 0
    buffer_load_dwordx4 v8, s[12:15], s3 offen offset:0 lds
    buffer_load_dwordx4 v9, s[12:15], s3 offen offset:1024 lds
    buffer_load_dwordx4 v10, s[12:15], s3 offen offset:2048 lds
    buffer_load_dwordx4 v11, s[12:15], s3 offen offset:3072 lds
    s_add_u32 m0, s30, 0
    s_add_u32 s3, s31, 0
    buffer_load_dwordx4 v3, s[8:11], s3 offen offset:0 lds
    buffer_load_dwordx4 v3, s[8:11], s3 offen offset:1024 lds
    buffer_load_dwordx4 v3, s[8:11], s3 offen offset:2048 lds
    buffer_load_dwordx4 v3, s[8:11], s3 offen offset:3072 lds
    s_add_u32 m0, s30, 49152
    s_add_u32 s3, s32, 196608
    buffer_load_dwordx4 v8, s[12:15], s3 offen offset:0 lds
    buffer_load_dwordx4 v9, s[12:15], s3 offen offset:1024 lds
    buffer_load_dwordx4 v10, s[12:15], s3 offen offset:2048 lds
    buffer_load_dwordx4 v11, s[12:15], s3 offen offset:3072 lds
    s_add_u32 m0, s30, 32768
    s_add_u32 s3, s31, 4096
    buffer_load_dwordx4 v3, s[8:11], s3 offen offset:0 lds
    buffer_load_dwordx4 v3, s[8:11], s3 offen offset:1024 lds
    buffer_load_dwordx4 v3, s[8:11], s3 offen offset:2048 lds
    buffer_load_dwordx4 v3, s[8:11], s3 offen offset:3072 lds
    s_waitcnt vmcnt(8)
    s_barrier
    s_add_u32 m0, s30, 81920
    s_add_u32 s3, s32, 393216
    buffer_load_dwordx4 v8, s[12:15], s3 offen offset:0 lds
    buffer_load_dwordx4 v9, s[12:15], s3 offen offset:1024 lds
    buffer_load_dwordx4 v10, s[12:15], s3 offen offset:2048 lds
    buffer_load_dwordx4 v11, s[12:15], s3 offen offset:3072 lds
    s_add_u32 m0, s30, 65536
    s_add_u32 s3, s31, 8192
    buffer_load_dwordx4 v3, s[8:11], s3 offen offset:0 lds
    buffer_load_dwordx4 v3, s[8:11], s3 offen offset:1024 lds
    buffer_load_dwordx4 v3, s[8:11], s3 offen offset:2048 lds
    buffer_load_dwordx4 v3, s[8:11], s3 offen offset:3072 lds
    s_waitcnt vmcnt(8)
    s_barrier
    s_add_u32 m0, s30, 114688
    s_add_u32 s3, s32, 589824
    buffer_load_dwordx4 v8, s[12:15], s3 offen offset:0 lds
    buffer_load_dwordx4 v9, s[12:15], s3 offen offset:1024 lds
    buffer_load_dwordx4 v10, s[12:15], s3 offen offset:2048 lds
    buffer_load_dwordx4 v11, s[12:15], s3 offen offset:3072 lds
    s_add_u32 m0, s30, 98304
    s_add_u32 s3, s31, 12288
    buffer_load_dwordx4 v3, s[8:11], s3 offen offset:0 lds
    buffer_load_dwordx4 v3, s[8:11], s3 offen offset:1024 lds
    buffer_load_dwordx4 v3, s[8:11], s3 offen offset:2048 lds
    buffer_load_dwordx4 v3, s[8:11], s3 offen offset:3072 lds
    s_waitcnt vmcnt(8)
    s_barrier
    s_add_u32 m0, s30, 147456
    s_add_u32 s3, s32, 786432
    buffer_load_dwordx4 v8, s[12:15], s3 offen offset:0 lds
    buffer_load_dwordx4 v9, s[12:15], s3 offen offset:1024 lds
    buffer_load_dwordx4 v10, s[12:15], s3 offen offset:2048 lds
    buffer_load_dwordx4 v11, s[12:15], s3 offen offset:3072 lds
    s_add_u32 m0, s30, 131072
    s_add_u32 s3, s31, 16384
    buffer_load_dwordx4 v3, s[8:11], s3 offen offset:0 lds
    buffer_load_dwordx4 v3, s[8:11], s3 offen offset:1024 lds
    buffer_load_dwordx4 v3, s[8:11], s3 offen offset:2048 lds
    buffer_load_dwordx4 v3, s[8:11], s3 offen offset:3072 lds
    s_waitcnt vmcnt(8)
    s_barrier
    s_add_u32 m0, s30, 16384
    s_add_u32 s3, s32, 983040
    buffer_load_dwordx4 v8, s[12:15], s3 offen offset:0 lds
    buffer_load_dwordx4 v9, s[12:15], s3 offen offset:1024 lds
    buffer_load_dwordx4 v10, s[12:15], s3 offen offset:2048 lds
    buffer_load_dwordx4 v11, s[12:15], s3 offen offset:3072 lds
    s_add_u32 m0, s30, 0
    s_add_u32 s3, s31, 20480
    buffer_load_dwordx4 v3, s[8:11], s3 offen offset:0 lds
    buffer_load_dwordx4 v3, s[8:11], s3 offen offset:1024 lds
    buffer_load_dwordx4 v3, s[8:11], s3 offen offset:2048 lds
    buffer_load_dwordx4 v3, s[8:11], s3 offen offset:3072 lds
    s_waitcnt vmcnt(8)
    s_barrier
    s_add_u32 m0, s30, 49152
    s_add_u32 s3, s32, 1179648
    buffer_load_dwordx4 v8, s[12:15], s3 offen offset:0 lds
    buffer_load_dwordx4 v9, s[12:15], s3 offen offset:1024 lds
    buffer_load_dwordx4 v10, s[12:15], s3 offen offset:2048 lds
    buffer_load_dwordx4 v11, s[12:15], s3 offen offset:3072 lds
    s_add_u32 m0, s30, 32768
    s_add_u32 s3, s31, 24576
    buffer_load_dwordx4 v3, s[8:11], s3 offen offset:0 lds
    buffer_load_dwordx4 v3, s[8:11], s3 offen offset:1024 lds
    buffer_load_dwordx4 v3, s[8:11], s3 offen offset:2048 lds
    buffer_load_dwordx4 v3, s[8:11], s3 offen offset:3072 lds
    s_waitcnt vmcnt(8)
    s_barrier
    s_add_u32 m0, s30, 81920
    s_add_u32 s3, s32, 1376256
    buffer_load_dwordx4 v8, s[12:15], s3 offen offset:0 lds
    buffer_load_dwordx4 v9, s[12:15], s3 offen offset:1024 lds
    buffer_load_dwordx4 v10, s[12:15], s3 offen offset:2048 lds
    buffer_load_dwordx4 v11, s[12:15], s3 offen offset:3072 lds
    s_add_u32 m0, s30, 65536
    s_add_u32 s3, s31, 28672
    buffer_load_dwordx4 v3, s[8:11], s3 offen offset:0 lds
    buffer_load_dwordx4 v3, s[8:11], s3 offen offset:1024 lds
    buffer_load_dwordx4 v3, s[8:11], s3 offen offset:2048 lds
    buffer_load_dwordx4 v3, s[8:11], s3 offen offset:3072 lds
    s_waitcnt vmcnt(8)
    s_barrier
    s_waitcnt vmcnt(0)
    s_barrier
    s_endpgm
qkv_b_kernel_cw:
    s_lshr_b32 s27, s26, 1
    s_and_b32 s28, s26, 1
    s_mov_b32 s29, 0x3f803f80
    s_load_dwordx2 s[16:17], s[0:1], 64
    s_load_dwordx2 s[40:41], s[0:1], 64
    s_lshl_b32 s3, s27, 13
    v_add_u32 v16, s3, v3
    v_bfe_u32 v12, v2, 2, 2
    v_lshrrev_b32 v13, 5, v2
    v_lshlrev_b32 v13, 2, v13
    v_add_u32 v13, v13, v12
    v_mul_u32_u24 v13, 256, v13
    v_bfe_u32 v14, v2, 4, 1
    v_lshlrev_b32 v14, 5, v14
    v_and_b32 v15, 3, v2
    v_lshlrev_b32 v15, 3, v15
    v_add3_u32 v13, v13, v14, v15
    v_add_u32 v13, 16384, v13
    s_lshl_b32 s3, s28, 1
    s_add_u32 s3, s3, 0
    v_xor_b32 v14, s3, v12
    v_lshlrev_b32 v14, 6, v14
    v_add_u32 v20, v13, v14
    s_lshl_b32 s3, s28, 1
    s_add_u32 s3, s3, 1
    v_xor_b32 v14, s3, v12
    v_lshlrev_b32 v14, 6, v14
    v_add_u32 v21, v13, v14
    v_add_u32 v4, 0x10000, v16
    v_add_u32 v10, 0x20000, v16
    v_add_u32 v8, 0x10000, v20
    v_add_u32 v14, 0x20000, v20
    v_add_u32 v9, 0x10000, v21
    v_add_u32 v15, 0x20000, v21
    s_waitcnt lgkmcnt(0)
    s_add_u32 s16, s16, 0x200000
    s_addc_u32 s17, s17, 0
    s_mov_b32 s18, 0x600000
    s_mov_b32 s19, 0x00020000
    s_add_u32 s40, s40, 0x1200000
    s_addc_u32 s41, s41, 0
    s_mov_b32 s42, 0x200000
    s_mov_b32 s43, 0x00020000
    s_lshl_b32 s37, s24, 2
    s_lshl_b32 s38, s27, 1
    s_add_u32 s37, s37, s38
    s_lshl_b32 s37, s37, 12
    v_and_b32 v22, 31, v2
    v_lshrrev_b32 v1, 5, v2
    v_lshlrev_b32 v23, 2, v22
    v_lshlrev_b32 v22, 3, v22
    v_lshl_add_u32 v22, v1, 11, v22
    s_lshl_b32 s38, s25, 9
    s_lshl_b32 s39, s28, 8
    s_add_u32 s38, s38, s39
    s_add_u32 s38, s38, 1056768
    buffer_load_dwordx2 v[160:161], v22, s[40:43], s37 offen offset:0
    buffer_load_dwordx2 v[162:163], v22, s[40:43], s37 offen offset:256
    buffer_load_dwordx2 v[164:165], v22, s[40:43], s37 offen offset:512
    buffer_load_dwordx2 v[166:167], v22, s[40:43], s37 offen offset:768
    buffer_load_dwordx2 v[168:169], v22, s[40:43], s37 offen offset:1024
    buffer_load_dwordx2 v[170:171], v22, s[40:43], s37 offen offset:1280
    buffer_load_dwordx2 v[172:173], v22, s[40:43], s37 offen offset:1536
    buffer_load_dwordx2 v[174:175], v22, s[40:43], s37 offen offset:1792
    s_add_u32 s37, s37, 4096
    buffer_load_dwordx2 v[176:177], v22, s[40:43], s37 offen offset:0
    buffer_load_dwordx2 v[178:179], v22, s[40:43], s37 offen offset:256
    buffer_load_dwordx2 v[180:181], v22, s[40:43], s37 offen offset:512
    buffer_load_dwordx2 v[182:183], v22, s[40:43], s37 offen offset:768
    buffer_load_dwordx2 v[184:185], v22, s[40:43], s37 offen offset:1024
    buffer_load_dwordx2 v[186:187], v22, s[40:43], s37 offen offset:1280
    buffer_load_dwordx2 v[188:189], v22, s[40:43], s37 offen offset:1536
    buffer_load_dwordx2 v[190:191], v22, s[40:43], s37 offen offset:1792
    buffer_load_dword v132, v23, s[40:43], s38 offen offset:0
    buffer_load_dword v133, v23, s[40:43], s38 offen offset:128
    s_cmp_ge_u32 s25, 8
    s_cbranch_scc1 qkv_b_kernel_v
    v_mov_b32 v64, 0
    v_mov_b32 v65, 0
    v_mov_b32 v66, 0
    v_mov_b32 v67, 0
    v_mov_b32 v68, 0
    v_mov_b32 v69, 0
    v_mov_b32 v70, 0
    v_mov_b32 v71, 0
    v_mov_b32 v72, 0
    v_mov_b32 v73, 0
    v_mov_b32 v74, 0
    v_mov_b32 v75, 0
    v_mov_b32 v76, 0
    v_mov_b32 v77, 0
    v_mov_b32 v78, 0
    v_mov_b32 v79, 0
    v_mov_b32 v80, 0
    v_mov_b32 v81, 0
    v_mov_b32 v82, 0
    v_mov_b32 v83, 0
    v_mov_b32 v84, 0
    v_mov_b32 v85, 0
    v_mov_b32 v86, 0
    v_mov_b32 v87, 0
    v_mov_b32 v88, 0
    v_mov_b32 v89, 0
    v_mov_b32 v90, 0
    v_mov_b32 v91, 0
    v_mov_b32 v92, 0
    v_mov_b32 v93, 0
    v_mov_b32 v94, 0
    v_mov_b32 v95, 0
    v_mov_b32 v96, 0
    v_mov_b32 v97, 0
    v_mov_b32 v98, 0
    v_mov_b32 v99, 0
    v_mov_b32 v100, 0
    v_mov_b32 v101, 0
    v_mov_b32 v102, 0
    v_mov_b32 v103, 0
    v_mov_b32 v104, 0
    v_mov_b32 v105, 0
    v_mov_b32 v106, 0
    v_mov_b32 v107, 0
    v_mov_b32 v108, 0
    v_mov_b32 v109, 0
    v_mov_b32 v110, 0
    v_mov_b32 v111, 0
    v_mov_b32 v112, 0
    v_mov_b32 v113, 0
    v_mov_b32 v114, 0
    v_mov_b32 v115, 0
    v_mov_b32 v116, 0
    v_mov_b32 v117, 0
    v_mov_b32 v118, 0
    v_mov_b32 v119, 0
    v_mov_b32 v120, 0
    v_mov_b32 v121, 0
    v_mov_b32 v122, 0
    v_mov_b32 v123, 0
    v_mov_b32 v124, 0
    v_mov_b32 v125, 0
    v_mov_b32 v126, 0
    v_mov_b32 v127, 0
    s_waitcnt vmcnt(0)
    v_add_f32 v160, v160, v162
    v_add_f32 v161, v161, v163
    v_add_f32 v160, v160, v164
    v_add_f32 v161, v161, v165
    v_add_f32 v160, v160, v166
    v_add_f32 v161, v161, v167
    v_add_f32 v160, v160, v168
    v_add_f32 v161, v161, v169
    v_add_f32 v160, v160, v170
    v_add_f32 v161, v161, v171
    v_add_f32 v160, v160, v172
    v_add_f32 v161, v161, v173
    v_add_f32 v160, v160, v174
    v_add_f32 v161, v161, v175
    v_mov_b32 v128, v160
    v_mov_b32 v130, v161
    v_add_f32 v176, v176, v178
    v_add_f32 v177, v177, v179
    v_add_f32 v176, v176, v180
    v_add_f32 v177, v177, v181
    v_add_f32 v176, v176, v182
    v_add_f32 v177, v177, v183
    v_add_f32 v176, v176, v184
    v_add_f32 v177, v177, v185
    v_add_f32 v176, v176, v186
    v_add_f32 v177, v177, v187
    v_add_f32 v176, v176, v188
    v_add_f32 v177, v177, v189
    v_add_f32 v176, v176, v190
    v_add_f32 v177, v177, v191
    v_mov_b32 v129, v176
    v_mov_b32 v131, v177
    v_mul_f32 v132, 0.5, v132
    v_mul_f32 v133, 0.5, v133
    v_mov_b32 v144, v128
    s_nop 1
    v_permlane32_swap_b32 v128, v144
    s_nop 1
    v_add_f32 v128, v128, v144
    v_mov_b32 v144, v130
    s_nop 1
    v_permlane32_swap_b32 v130, v144
    s_nop 1
    v_add_f32 v130, v130, v144
    v_mul_f32 v128, 0xbb000000, v128
    v_mul_f32 v130, 0x3b000000, v130
    v_fma_f32 v130, -v128, v128, v130
    v_add_f32 v130, 0x3727c5ac, v130
    v_rsq_f32 v130, v130
    v_cvt_pk_bf16_f32 v32, v128, v128
    v_and_b32 v144, 0xffff0000, v32
    v_sub_f32 v144, v128, v144
    v_cvt_pk_bf16_f32 v33, v144, v144
    v_mov_b32 v34, 0
    v_mov_b32 v35, 0
    v_mov_b32 v144, v129
    s_nop 1
    v_permlane32_swap_b32 v129, v144
    s_nop 1
    v_add_f32 v129, v129, v144
    v_mov_b32 v144, v131
    s_nop 1
    v_permlane32_swap_b32 v131, v144
    s_nop 1
    v_add_f32 v131, v131, v144
    v_mul_f32 v129, 0xbb000000, v129
    v_mul_f32 v131, 0x3b000000, v131
    v_fma_f32 v131, -v129, v129, v131
    v_add_f32 v131, 0x3727c5ac, v131
    v_rsq_f32 v131, v131
    v_cvt_pk_bf16_f32 v36, v129, v129
    v_and_b32 v144, 0xffff0000, v36
    v_sub_f32 v144, v129, v144
    v_cvt_pk_bf16_f32 v37, v144, v144
    v_mov_b32 v38, 0
    v_mov_b32 v39, 0
    v_cvt_pk_bf16_f32 v48, v132, v132
    v_and_b32 v144, 0xffff0000, v48
    v_sub_f32 v144, v132, v144
    v_cvt_pk_bf16_f32 v48, v132, v144
    v_mov_b32 v49, v48
    v_mov_b32 v50, 0
    v_mov_b32 v51, 0
    v_cvt_pk_bf16_f32 v52, v133, v133
    v_and_b32 v144, 0xffff0000, v52
    v_sub_f32 v144, v133, v144
    v_cvt_pk_bf16_f32 v52, v133, v144
    v_mov_b32 v53, v52
    v_mov_b32 v54, 0
    v_mov_b32 v55, 0
    s_nop 1
    v_mfma_f32_32x32x16_bf16 v[64:79], v[48:51], v[32:35], v[64:79]
    v_mfma_f32_32x32x16_bf16 v[80:95], v[52:55], v[32:35], v[80:95]
    v_mfma_f32_32x32x16_bf16 v[96:111], v[48:51], v[36:39], v[96:111]
    v_mfma_f32_32x32x16_bf16 v[112:127], v[52:55], v[36:39], v[112:127]
    s_barrier
    ds_read_b128 v[32:35], v16 offset:0
    ds_read_b128 v[36:39], v16 offset:4096
    ds_read_b64_tr_b16 v[48:49], v20 offset:0
    ds_read_b64_tr_b16 v[50:51], v20 offset:2048
    ds_read_b64_tr_b16 v[52:53], v21 offset:0
    ds_read_b64_tr_b16 v[54:55], v21 offset:2048
    ds_read_b128 v[40:43], v16 offset:1024
    ds_read_b128 v[44:47], v16 offset:5120
    ds_read_b64_tr_b16 v[56:57], v20 offset:4096
    ds_read_b64_tr_b16 v[58:59], v20 offset:6144
    ds_read_b64_tr_b16 v[60:61], v21 offset:4096
    ds_read_b64_tr_b16 v[62:63], v21 offset:6144
    s_waitcnt lgkmcnt(6)
    v_mfma_f32_32x32x16_bf16 v[64:79], v[48:51], v[32:35], v[64:79]
    ds_read_b128 v[196:199], v16 offset:2048
    ds_read_b128 v[200:203], v16 offset:6144
    v_mfma_f32_32x32x16_bf16 v[80:95], v[52:55], v[32:35], v[80:95]
    ds_read_b64_tr_b16 v[204:205], v20 offset:8192
    ds_read_b64_tr_b16 v[206:207], v20 offset:10240
    v_mfma_f32_32x32x16_bf16 v[96:111], v[48:51], v[36:39], v[96:111]
    ds_read_b64_tr_b16 v[208:209], v21 offset:8192
    ds_read_b64_tr_b16 v[210:211], v21 offset:10240
    v_mfma_f32_32x32x16_bf16 v[112:127], v[52:55], v[36:39], v[112:127]
    s_waitcnt lgkmcnt(6)
    v_mfma_f32_32x32x16_bf16 v[64:79], v[56:59], v[40:43], v[64:79]
    ds_read_b128 v[32:35], v16 offset:3072
    ds_read_b128 v[36:39], v16 offset:7168
    v_mfma_f32_32x32x16_bf16 v[80:95], v[60:63], v[40:43], v[80:95]
    ds_read_b64_tr_b16 v[48:49], v20 offset:12288
    ds_read_b64_tr_b16 v[50:51], v20 offset:14336
    v_mfma_f32_32x32x16_bf16 v[96:111], v[56:59], v[44:47], v[96:111]
    ds_read_b64_tr_b16 v[52:53], v21 offset:12288
    ds_read_b64_tr_b16 v[54:55], v21 offset:14336
    v_mfma_f32_32x32x16_bf16 v[112:127], v[60:63], v[44:47], v[112:127]
    s_waitcnt lgkmcnt(6)
    v_mfma_f32_32x32x16_bf16 v[64:79], v[204:207], v[196:199], v[64:79]
    s_barrier
    ds_read_b128 v[40:43], v16 offset:32768
    ds_read_b128 v[44:47], v16 offset:36864
    v_mfma_f32_32x32x16_bf16 v[80:95], v[208:211], v[196:199], v[80:95]
    ds_read_b64_tr_b16 v[56:57], v20 offset:32768
    ds_read_b64_tr_b16 v[58:59], v20 offset:34816
    v_mfma_f32_32x32x16_bf16 v[96:111], v[204:207], v[200:203], v[96:111]
    ds_read_b64_tr_b16 v[60:61], v21 offset:32768
    ds_read_b64_tr_b16 v[62:63], v21 offset:34816
    v_mfma_f32_32x32x16_bf16 v[112:127], v[208:211], v[200:203], v[112:127]
    s_waitcnt lgkmcnt(6)
    v_mfma_f32_32x32x16_bf16 v[64:79], v[48:51], v[32:35], v[64:79]
    ds_read_b128 v[196:199], v16 offset:33792
    ds_read_b128 v[200:203], v16 offset:37888
    v_mfma_f32_32x32x16_bf16 v[80:95], v[52:55], v[32:35], v[80:95]
    ds_read_b64_tr_b16 v[204:205], v20 offset:36864
    ds_read_b64_tr_b16 v[206:207], v20 offset:38912
    v_mfma_f32_32x32x16_bf16 v[96:111], v[48:51], v[36:39], v[96:111]
    ds_read_b64_tr_b16 v[208:209], v21 offset:36864
    ds_read_b64_tr_b16 v[210:211], v21 offset:38912
    v_mfma_f32_32x32x16_bf16 v[112:127], v[52:55], v[36:39], v[112:127]
    s_waitcnt lgkmcnt(6)
    v_mfma_f32_32x32x16_bf16 v[64:79], v[56:59], v[40:43], v[64:79]
    ds_read_b128 v[32:35], v16 offset:34816
    ds_read_b128 v[36:39], v16 offset:38912
    v_mfma_f32_32x32x16_bf16 v[80:95], v[60:63], v[40:43], v[80:95]
    ds_read_b64_tr_b16 v[48:49], v20 offset:40960
    ds_read_b64_tr_b16 v[50:51], v20 offset:43008
    v_mfma_f32_32x32x16_bf16 v[96:111], v[56:59], v[44:47], v[96:111]
    ds_read_b64_tr_b16 v[52:53], v21 offset:40960
    ds_read_b64_tr_b16 v[54:55], v21 offset:43008
    v_mfma_f32_32x32x16_bf16 v[112:127], v[60:63], v[44:47], v[112:127]
    s_waitcnt lgkmcnt(6)
    v_mfma_f32_32x32x16_bf16 v[64:79], v[204:207], v[196:199], v[64:79]
    ds_read_b128 v[40:43], v16 offset:35840
    ds_read_b128 v[44:47], v16 offset:39936
    v_mfma_f32_32x32x16_bf16 v[80:95], v[208:211], v[196:199], v[80:95]
    ds_read_b64_tr_b16 v[56:57], v20 offset:45056
    ds_read_b64_tr_b16 v[58:59], v20 offset:47104
    v_mfma_f32_32x32x16_bf16 v[96:111], v[204:207], v[200:203], v[96:111]
    ds_read_b64_tr_b16 v[60:61], v21 offset:45056
    ds_read_b64_tr_b16 v[62:63], v21 offset:47104
    v_mfma_f32_32x32x16_bf16 v[112:127], v[208:211], v[200:203], v[112:127]
    s_waitcnt lgkmcnt(6)
    v_mfma_f32_32x32x16_bf16 v[64:79], v[48:51], v[32:35], v[64:79]
    s_barrier
    ds_read_b128 v[196:199], v4 offset:0
    ds_read_b128 v[200:203], v4 offset:4096
    v_mfma_f32_32x32x16_bf16 v[80:95], v[52:55], v[32:35], v[80:95]
    ds_read_b64_tr_b16 v[204:205], v8 offset:0
    ds_read_b64_tr_b16 v[206:207], v8 offset:2048
    v_mfma_f32_32x32x16_bf16 v[96:111], v[48:51], v[36:39], v[96:111]
    ds_read_b64_tr_b16 v[208:209], v9 offset:0
    ds_read_b64_tr_b16 v[210:211], v9 offset:2048
    v_mfma_f32_32x32x16_bf16 v[112:127], v[52:55], v[36:39], v[112:127]
    s_waitcnt lgkmcnt(6)
    v_mfma_f32_32x32x16_bf16 v[64:79], v[56:59], v[40:43], v[64:79]
    ds_read_b128 v[32:35], v4 offset:1024
    ds_read_b128 v[36:39], v4 offset:5120
    v_mfma_f32_32x32x16_bf16 v[80:95], v[60:63], v[40:43], v[80:95]
    ds_read_b64_tr_b16 v[48:49], v8 offset:4096
    ds_read_b64_tr_b16 v[50:51], v8 offset:6144
    v_mfma_f32_32x32x16_bf16 v[96:111], v[56:59], v[44:47], v[96:111]
    ds_read_b64_tr_b16 v[52:53], v9 offset:4096
    ds_read_b64_tr_b16 v[54:55], v9 offset:6144
    v_mfma_f32_32x32x16_bf16 v[112:127], v[60:63], v[44:47], v[112:127]
    s_waitcnt lgkmcnt(6)
    v_mfma_f32_32x32x16_bf16 v[64:79], v[204:207], v[196:199], v[64:79]
    ds_read_b128 v[40:43], v4 offset:2048
    ds_read_b128 v[44:47], v4 offset:6144
    v_mfma_f32_32x32x16_bf16 v[80:95], v[208:211], v[196:199], v[80:95]
    ds_read_b64_tr_b16 v[56:57], v8 offset:8192
    ds_read_b64_tr_b16 v[58:59], v8 offset:10240
    v_mfma_f32_32x32x16_bf16 v[96:111], v[204:207], v[200:203], v[96:111]
    ds_read_b64_tr_b16 v[60:61], v9 offset:8192
    ds_read_b64_tr_b16 v[62:63], v9 offset:10240
    v_mfma_f32_32x32x16_bf16 v[112:127], v[208:211], v[200:203], v[112:127]
    s_waitcnt lgkmcnt(6)
    v_mfma_f32_32x32x16_bf16 v[64:79], v[48:51], v[32:35], v[64:79]
    ds_read_b128 v[196:199], v4 offset:3072
    ds_read_b128 v[200:203], v4 offset:7168
    v_mfma_f32_32x32x16_bf16 v[80:95], v[52:55], v[32:35], v[80:95]
    ds_read_b64_tr_b16 v[204:205], v8 offset:12288
    ds_read_b64_tr_b16 v[206:207], v8 offset:14336
    v_mfma_f32_32x32x16_bf16 v[96:111], v[48:51], v[36:39], v[96:111]
    ds_read_b64_tr_b16 v[208:209], v9 offset:12288
    ds_read_b64_tr_b16 v[210:211], v9 offset:14336
    v_mfma_f32_32x32x16_bf16 v[112:127], v[52:55], v[36:39], v[112:127]
    s_waitcnt lgkmcnt(6)
    v_mfma_f32_32x32x16_bf16 v[64:79], v[56:59], v[40:43], v[64:79]
    s_barrier
    ds_read_b128 v[32:35], v4 offset:32768
    ds_read_b128 v[36:39], v4 offset:36864
    v_mfma_f32_32x32x16_bf16 v[80:95], v[60:63], v[40:43], v[80:95]
    ds_read_b64_tr_b16 v[48:49], v8 offset:32768
    ds_read_b64_tr_b16 v[50:51], v8 offset:34816
    v_mfma_f32_32x32x16_bf16 v[96:111], v[56:59], v[44:47], v[96:111]
    ds_read_b64_tr_b16 v[52:53], v9 offset:32768
    ds_read_b64_tr_b16 v[54:55], v9 offset:34816
    v_mfma_f32_32x32x16_bf16 v[112:127], v[60:63], v[44:47], v[112:127]
    s_waitcnt lgkmcnt(6)
    v_mfma_f32_32x32x16_bf16 v[64:79], v[204:207], v[196:199], v[64:79]
    ds_read_b128 v[40:43], v4 offset:33792
    ds_read_b128 v[44:47], v4 offset:37888
    v_mfma_f32_32x32x16_bf16 v[80:95], v[208:211], v[196:199], v[80:95]
    ds_read_b64_tr_b16 v[56:57], v8 offset:36864
    ds_read_b64_tr_b16 v[58:59], v8 offset:38912
    v_mfma_f32_32x32x16_bf16 v[96:111], v[204:207], v[200:203], v[96:111]
    ds_read_b64_tr_b16 v[60:61], v9 offset:36864
    ds_read_b64_tr_b16 v[62:63], v9 offset:38912
    v_mfma_f32_32x32x16_bf16 v[112:127], v[208:211], v[200:203], v[112:127]
    s_waitcnt lgkmcnt(6)
    v_mfma_f32_32x32x16_bf16 v[64:79], v[48:51], v[32:35], v[64:79]
    ds_read_b128 v[196:199], v4 offset:34816
    ds_read_b128 v[200:203], v4 offset:38912
    v_mfma_f32_32x32x16_bf16 v[80:95], v[52:55], v[32:35], v[80:95]
    ds_read_b64_tr_b16 v[204:205], v8 offset:40960
    ds_read_b64_tr_b16 v[206:207], v8 offset:43008
    v_mfma_f32_32x32x16_bf16 v[96:111], v[48:51], v[36:39], v[96:111]
    ds_read_b64_tr_b16 v[208:209], v9 offset:40960
    ds_read_b64_tr_b16 v[210:211], v9 offset:43008
    v_mfma_f32_32x32x16_bf16 v[112:127], v[52:55], v[36:39], v[112:127]
    s_waitcnt lgkmcnt(6)
    v_mfma_f32_32x32x16_bf16 v[64:79], v[56:59], v[40:43], v[64:79]
    ds_read_b128 v[32:35], v4 offset:35840
    ds_read_b128 v[36:39], v4 offset:39936
    v_mfma_f32_32x32x16_bf16 v[80:95], v[60:63], v[40:43], v[80:95]
    ds_read_b64_tr_b16 v[48:49], v8 offset:45056
    ds_read_b64_tr_b16 v[50:51], v8 offset:47104
    v_mfma_f32_32x32x16_bf16 v[96:111], v[56:59], v[44:47], v[96:111]
    ds_read_b64_tr_b16 v[52:53], v9 offset:45056
    ds_read_b64_tr_b16 v[54:55], v9 offset:47104
    v_mfma_f32_32x32x16_bf16 v[112:127], v[60:63], v[44:47], v[112:127]
    s_waitcnt lgkmcnt(6)
    v_mfma_f32_32x32x16_bf16 v[64:79], v[204:207], v[196:199], v[64:79]
    s_barrier
    ds_read_b128 v[40:43], v10 offset:0
    ds_read_b128 v[44:47], v10 offset:4096
    v_mfma_f32_32x32x16_bf16 v[80:95], v[208:211], v[196:199], v[80:95]
    ds_read_b64_tr_b16 v[56:57], v14 offset:0
    ds_read_b64_tr_b16 v[58:59], v14 offset:2048
    v_mfma_f32_32x32x16_bf16 v[96:111], v[204:207], v[200:203], v[96:111]
    ds_read_b64_tr_b16 v[60:61], v15 offset:0
    ds_read_b64_tr_b16 v[62:63], v15 offset:2048
    v_mfma_f32_32x32x16_bf16 v[112:127], v[208:211], v[200:203], v[112:127]
    s_waitcnt lgkmcnt(6)
    v_mfma_f32_32x32x16_bf16 v[64:79], v[48:51], v[32:35], v[64:79]
    ds_read_b128 v[196:199], v10 offset:1024
    ds_read_b128 v[200:203], v10 offset:5120
    v_mfma_f32_32x32x16_bf16 v[80:95], v[52:55], v[32:35], v[80:95]
    ds_read_b64_tr_b16 v[204:205], v14 offset:4096
    ds_read_b64_tr_b16 v[206:207], v14 offset:6144
    v_mfma_f32_32x32x16_bf16 v[96:111], v[48:51], v[36:39], v[96:111]
    ds_read_b64_tr_b16 v[208:209], v15 offset:4096
    ds_read_b64_tr_b16 v[210:211], v15 offset:6144
    v_mfma_f32_32x32x16_bf16 v[112:127], v[52:55], v[36:39], v[112:127]
    s_waitcnt lgkmcnt(6)
    v_mfma_f32_32x32x16_bf16 v[64:79], v[56:59], v[40:43], v[64:79]
    ds_read_b128 v[32:35], v10 offset:2048
    ds_read_b128 v[36:39], v10 offset:6144
    v_mfma_f32_32x32x16_bf16 v[80:95], v[60:63], v[40:43], v[80:95]
    ds_read_b64_tr_b16 v[48:49], v14 offset:8192
    ds_read_b64_tr_b16 v[50:51], v14 offset:10240
    v_mfma_f32_32x32x16_bf16 v[96:111], v[56:59], v[44:47], v[96:111]
    ds_read_b64_tr_b16 v[52:53], v15 offset:8192
    ds_read_b64_tr_b16 v[54:55], v15 offset:10240
    v_mfma_f32_32x32x16_bf16 v[112:127], v[60:63], v[44:47], v[112:127]
    s_waitcnt lgkmcnt(6)
    v_mfma_f32_32x32x16_bf16 v[64:79], v[204:207], v[196:199], v[64:79]
    ds_read_b128 v[40:43], v10 offset:3072
    ds_read_b128 v[44:47], v10 offset:7168
    v_mfma_f32_32x32x16_bf16 v[80:95], v[208:211], v[196:199], v[80:95]
    ds_read_b64_tr_b16 v[56:57], v14 offset:12288
    ds_read_b64_tr_b16 v[58:59], v14 offset:14336
    v_mfma_f32_32x32x16_bf16 v[96:111], v[204:207], v[200:203], v[96:111]
    ds_read_b64_tr_b16 v[60:61], v15 offset:12288
    ds_read_b64_tr_b16 v[62:63], v15 offset:14336
    v_mfma_f32_32x32x16_bf16 v[112:127], v[208:211], v[200:203], v[112:127]
    s_waitcnt lgkmcnt(6)
    v_mfma_f32_32x32x16_bf16 v[64:79], v[48:51], v[32:35], v[64:79]
    s_barrier
    ds_read_b128 v[196:199], v16 offset:0
    ds_read_b128 v[200:203], v16 offset:4096
    v_mfma_f32_32x32x16_bf16 v[80:95], v[52:55], v[32:35], v[80:95]
    ds_read_b64_tr_b16 v[204:205], v20 offset:0
    ds_read_b64_tr_b16 v[206:207], v20 offset:2048
    v_mfma_f32_32x32x16_bf16 v[96:111], v[48:51], v[36:39], v[96:111]
    ds_read_b64_tr_b16 v[208:209], v21 offset:0
    ds_read_b64_tr_b16 v[210:211], v21 offset:2048
    v_mfma_f32_32x32x16_bf16 v[112:127], v[52:55], v[36:39], v[112:127]
    s_waitcnt lgkmcnt(6)
    v_mfma_f32_32x32x16_bf16 v[64:79], v[56:59], v[40:43], v[64:79]
    ds_read_b128 v[32:35], v16 offset:1024
    ds_read_b128 v[36:39], v16 offset:5120
    v_mfma_f32_32x32x16_bf16 v[80:95], v[60:63], v[40:43], v[80:95]
    ds_read_b64_tr_b16 v[48:49], v20 offset:4096
    ds_read_b64_tr_b16 v[50:51], v20 offset:6144
    v_mfma_f32_32x32x16_bf16 v[96:111], v[56:59], v[44:47], v[96:111]
    ds_read_b64_tr_b16 v[52:53], v21 offset:4096
    ds_read_b64_tr_b16 v[54:55], v21 offset:6144
    v_mfma_f32_32x32x16_bf16 v[112:127], v[60:63], v[44:47], v[112:127]
    s_waitcnt lgkmcnt(6)
    v_mfma_f32_32x32x16_bf16 v[64:79], v[204:207], v[196:199], v[64:79]
    ds_read_b128 v[40:43], v16 offset:2048
    ds_read_b128 v[44:47], v16 offset:6144
    v_mfma_f32_32x32x16_bf16 v[80:95], v[208:211], v[196:199], v[80:95]
    ds_read_b64_tr_b16 v[56:57], v20 offset:8192
    ds_read_b64_tr_b16 v[58:59], v20 offset:10240
    v_mfma_f32_32x32x16_bf16 v[96:111], v[204:207], v[200:203], v[96:111]
    ds_read_b64_tr_b16 v[60:61], v21 offset:8192
    ds_read_b64_tr_b16 v[62:63], v21 offset:10240
    v_mfma_f32_32x32x16_bf16 v[112:127], v[208:211], v[200:203], v[112:127]
    s_waitcnt lgkmcnt(6)
    v_mfma_f32_32x32x16_bf16 v[64:79], v[48:51], v[32:35], v[64:79]
    ds_read_b128 v[196:199], v16 offset:3072
    ds_read_b128 v[200:203], v16 offset:7168
    v_mfma_f32_32x32x16_bf16 v[80:95], v[52:55], v[32:35], v[80:95]
    ds_read_b64_tr_b16 v[204:205], v20 offset:12288
    ds_read_b64_tr_b16 v[206:207], v20 offset:14336
    v_mfma_f32_32x32x16_bf16 v[96:111], v[48:51], v[36:39], v[96:111]
    ds_read_b64_tr_b16 v[208:209], v21 offset:12288
    ds_read_b64_tr_b16 v[210:211], v21 offset:14336
    v_mfma_f32_32x32x16_bf16 v[112:127], v[52:55], v[36:39], v[112:127]
    s_waitcnt lgkmcnt(6)
    v_mfma_f32_32x32x16_bf16 v[64:79], v[56:59], v[40:43], v[64:79]
    s_barrier
    ds_read_b128 v[32:35], v16 offset:32768
    ds_read_b128 v[36:39], v16 offset:36864
    v_mfma_f32_32x32x16_bf16 v[80:95], v[60:63], v[40:43], v[80:95]
    ds_read_b64_tr_b16 v[48:49], v20 offset:32768
    ds_read_b64_tr_b16 v[50:51], v20 offset:34816
    v_mfma_f32_32x32x16_bf16 v[96:111], v[56:59], v[44:47], v[96:111]
    ds_read_b64_tr_b16 v[52:53], v21 offset:32768
    ds_read_b64_tr_b16 v[54:55], v21 offset:34816
    v_mfma_f32_32x32x16_bf16 v[112:127], v[60:63], v[44:47], v[112:127]
    s_waitcnt lgkmcnt(6)
    v_mfma_f32_32x32x16_bf16 v[64:79], v[204:207], v[196:199], v[64:79]
    ds_read_b128 v[40:43], v16 offset:33792
    ds_read_b128 v[44:47], v16 offset:37888
    v_mfma_f32_32x32x16_bf16 v[80:95], v[208:211], v[196:199], v[80:95]
    ds_read_b64_tr_b16 v[56:57], v20 offset:36864
    ds_read_b64_tr_b16 v[58:59], v20 offset:38912
    v_mfma_f32_32x32x16_bf16 v[96:111], v[204:207], v[200:203], v[96:111]
    ds_read_b64_tr_b16 v[60:61], v21 offset:36864
    ds_read_b64_tr_b16 v[62:63], v21 offset:38912
    v_mfma_f32_32x32x16_bf16 v[112:127], v[208:211], v[200:203], v[112:127]
    s_waitcnt lgkmcnt(6)
    v_mfma_f32_32x32x16_bf16 v[64:79], v[48:51], v[32:35], v[64:79]
    ds_read_b128 v[196:199], v16 offset:34816
    ds_read_b128 v[200:203], v16 offset:38912
    v_mfma_f32_32x32x16_bf16 v[80:95], v[52:55], v[32:35], v[80:95]
    ds_read_b64_tr_b16 v[204:205], v20 offset:40960
    ds_read_b64_tr_b16 v[206:207], v20 offset:43008
    v_mfma_f32_32x32x16_bf16 v[96:111], v[48:51], v[36:39], v[96:111]
    ds_read_b64_tr_b16 v[208:209], v21 offset:40960
    ds_read_b64_tr_b16 v[210:211], v21 offset:43008
    v_mfma_f32_32x32x16_bf16 v[112:127], v[52:55], v[36:39], v[112:127]
    s_waitcnt lgkmcnt(6)
    v_mfma_f32_32x32x16_bf16 v[64:79], v[56:59], v[40:43], v[64:79]
    ds_read_b128 v[32:35], v16 offset:35840
    ds_read_b128 v[36:39], v16 offset:39936
    v_mfma_f32_32x32x16_bf16 v[80:95], v[60:63], v[40:43], v[80:95]
    ds_read_b64_tr_b16 v[48:49], v20 offset:45056
    ds_read_b64_tr_b16 v[50:51], v20 offset:47104
    v_mfma_f32_32x32x16_bf16 v[96:111], v[56:59], v[44:47], v[96:111]
    ds_read_b64_tr_b16 v[52:53], v21 offset:45056
    ds_read_b64_tr_b16 v[54:55], v21 offset:47104
    v_mfma_f32_32x32x16_bf16 v[112:127], v[60:63], v[44:47], v[112:127]
    s_waitcnt lgkmcnt(6)
    v_mfma_f32_32x32x16_bf16 v[64:79], v[204:207], v[196:199], v[64:79]
    s_barrier
    ds_read_b128 v[40:43], v4 offset:0
    ds_read_b128 v[44:47], v4 offset:4096
    v_mfma_f32_32x32x16_bf16 v[80:95], v[208:211], v[196:199], v[80:95]
    ds_read_b64_tr_b16 v[56:57], v8 offset:0
    ds_read_b64_tr_b16 v[58:59], v8 offset:2048
    v_mfma_f32_32x32x16_bf16 v[96:111], v[204:207], v[200:203], v[96:111]
    ds_read_b64_tr_b16 v[60:61], v9 offset:0
    ds_read_b64_tr_b16 v[62:63], v9 offset:2048
    v_mfma_f32_32x32x16_bf16 v[112:127], v[208:211], v[200:203], v[112:127]
    s_waitcnt lgkmcnt(6)
    v_mfma_f32_32x32x16_bf16 v[64:79], v[48:51], v[32:35], v[64:79]
    ds_read_b128 v[196:199], v4 offset:1024
    ds_read_b128 v[200:203], v4 offset:5120
    v_mfma_f32_32x32x16_bf16 v[80:95], v[52:55], v[32:35], v[80:95]
    ds_read_b64_tr_b16 v[204:205], v8 offset:4096
    ds_read_b64_tr_b16 v[206:207], v8 offset:6144
    v_mfma_f32_32x32x16_bf16 v[96:111], v[48:51], v[36:39], v[96:111]
    ds_read_b64_tr_b16 v[208:209], v9 offset:4096
    ds_read_b64_tr_b16 v[210:211], v9 offset:6144
    v_mfma_f32_32x32x16_bf16 v[112:127], v[52:55], v[36:39], v[112:127]
    s_waitcnt lgkmcnt(6)
    v_mfma_f32_32x32x16_bf16 v[64:79], v[56:59], v[40:43], v[64:79]
    ds_read_b128 v[32:35], v4 offset:2048
    ds_read_b128 v[36:39], v4 offset:6144
    v_mfma_f32_32x32x16_bf16 v[80:95], v[60:63], v[40:43], v[80:95]
    ds_read_b64_tr_b16 v[48:49], v8 offset:8192
    ds_read_b64_tr_b16 v[50:51], v8 offset:10240
    v_mfma_f32_32x32x16_bf16 v[96:111], v[56:59], v[44:47], v[96:111]
    ds_read_b64_tr_b16 v[52:53], v9 offset:8192
    ds_read_b64_tr_b16 v[54:55], v9 offset:10240
    v_mfma_f32_32x32x16_bf16 v[112:127], v[60:63], v[44:47], v[112:127]
    s_waitcnt lgkmcnt(6)
    v_mfma_f32_32x32x16_bf16 v[64:79], v[204:207], v[196:199], v[64:79]
    ds_read_b128 v[40:43], v4 offset:3072
    ds_read_b128 v[44:47], v4 offset:7168
    v_mfma_f32_32x32x16_bf16 v[80:95], v[208:211], v[196:199], v[80:95]
    ds_read_b64_tr_b16 v[56:57], v8 offset:12288
    ds_read_b64_tr_b16 v[58:59], v8 offset:14336
    v_mfma_f32_32x32x16_bf16 v[96:111], v[204:207], v[200:203], v[96:111]
    ds_read_b64_tr_b16 v[60:61], v9 offset:12288
    ds_read_b64_tr_b16 v[62:63], v9 offset:14336
    v_mfma_f32_32x32x16_bf16 v[112:127], v[208:211], v[200:203], v[112:127]
    s_waitcnt lgkmcnt(6)
    v_mfma_f32_32x32x16_bf16 v[64:79], v[48:51], v[32:35], v[64:79]
    v_mfma_f32_32x32x16_bf16 v[80:95], v[52:55], v[32:35], v[80:95]
    v_mfma_f32_32x32x16_bf16 v[96:111], v[48:51], v[36:39], v[96:111]
    v_mfma_f32_32x32x16_bf16 v[112:127], v[52:55], v[36:39], v[112:127]
    s_waitcnt lgkmcnt(0)
    v_mfma_f32_32x32x16_bf16 v[64:79], v[56:59], v[40:43], v[64:79]
    v_mfma_f32_32x32x16_bf16 v[80:95], v[60:63], v[40:43], v[80:95]
    v_mfma_f32_32x32x16_bf16 v[96:111], v[56:59], v[44:47], v[96:111]
    v_mfma_f32_32x32x16_bf16 v[112:127], v[60:63], v[44:47], v[112:127]
    s_mov_b32 s3, 0x3eb8aa3b
    s_cmp_lt_u32 s25, 4
    s_cselect_b32 s3, s3, 1.0
    v_mul_f32 v130, s3, v130
    v_mul_f32 v131, s3, v131
    s_lshl_b32 s33, s25, 3
    s_lshl_b32 s34, s28, 2
    s_add_u32 s33, s33, s34
    s_lshl_b32 s33, s33, 16
    s_lshl_b32 s34, s24, 2
    s_lshl_b32 s35, s27, 1
    s_add_u32 s34, s34, s35
    s_lshl_b32 s34, s34, 10
    s_add_u32 s33, s33, s34
    s_nop 7
    v_pk_mul_f32 v[64:65], v[64:65], v[130:131] op_sel:[0,0] op_sel_hi:[1,0]
    v_pk_mul_f32 v[66:67], v[66:67], v[130:131] op_sel:[0,0] op_sel_hi:[1,0]
    v_pk_mul_f32 v[68:69], v[68:69], v[130:131] op_sel:[0,0] op_sel_hi:[1,0]
    v_pk_mul_f32 v[70:71], v[70:71], v[130:131] op_sel:[0,0] op_sel_hi:[1,0]
    v_pk_mul_f32 v[72:73], v[72:73], v[130:131] op_sel:[0,0] op_sel_hi:[1,0]
    v_pk_mul_f32 v[74:75], v[74:75], v[130:131] op_sel:[0,0] op_sel_hi:[1,0]
    v_pk_mul_f32 v[76:77], v[76:77], v[130:131] op_sel:[0,0] op_sel_hi:[1,0]
    v_pk_mul_f32 v[78:79], v[78:79], v[130:131] op_sel:[0,0] op_sel_hi:[1,0]
    v_cvt_pk_bf16_f32 v148, v64, v65
    v_cvt_pk_bf16_f32 v149, v66, v67
    v_cvt_pk_bf16_f32 v150, v68, v69
    v_cvt_pk_bf16_f32 v151, v70, v71
    s_add_u32 s3, s33, 0
    buffer_store_dwordx4 v[148:151], v3, s[16:19], s3 offen sc0 sc1
    v_cvt_pk_bf16_f32 v152, v72, v73
    v_cvt_pk_bf16_f32 v153, v74, v75
    v_cvt_pk_bf16_f32 v154, v76, v77
    v_cvt_pk_bf16_f32 v155, v78, v79
    s_add_u32 s3, s33, 65536
    buffer_store_dwordx4 v[152:155], v3, s[16:19], s3 offen sc0 sc1
    v_pk_mul_f32 v[80:81], v[80:81], v[130:131] op_sel:[0,0] op_sel_hi:[1,0]
    v_pk_mul_f32 v[82:83], v[82:83], v[130:131] op_sel:[0,0] op_sel_hi:[1,0]
    v_pk_mul_f32 v[84:85], v[84:85], v[130:131] op_sel:[0,0] op_sel_hi:[1,0]
    v_pk_mul_f32 v[86:87], v[86:87], v[130:131] op_sel:[0,0] op_sel_hi:[1,0]
    v_pk_mul_f32 v[88:89], v[88:89], v[130:131] op_sel:[0,0] op_sel_hi:[1,0]
    v_pk_mul_f32 v[90:91], v[90:91], v[130:131] op_sel:[0,0] op_sel_hi:[1,0]
    v_pk_mul_f32 v[92:93], v[92:93], v[130:131] op_sel:[0,0] op_sel_hi:[1,0]
    v_pk_mul_f32 v[94:95], v[94:95], v[130:131] op_sel:[0,0] op_sel_hi:[1,0]
    v_cvt_pk_bf16_f32 v156, v80, v81
    v_cvt_pk_bf16_f32 v157, v82, v83
    v_cvt_pk_bf16_f32 v158, v84, v85
    v_cvt_pk_bf16_f32 v159, v86, v87
    s_add_u32 s3, s33, 131072
    buffer_store_dwordx4 v[156:159], v3, s[16:19], s3 offen sc0 sc1
    v_cvt_pk_bf16_f32 v148, v88, v89
    v_cvt_pk_bf16_f32 v149, v90, v91
    v_cvt_pk_bf16_f32 v150, v92, v93
    v_cvt_pk_bf16_f32 v151, v94, v95
    s_add_u32 s3, s33, 196608
    buffer_store_dwordx4 v[148:151], v3, s[16:19], s3 offen sc0 sc1
    v_pk_mul_f32 v[96:97], v[96:97], v[130:131] op_sel:[0,1] op_sel_hi:[1,1]
    v_pk_mul_f32 v[98:99], v[98:99], v[130:131] op_sel:[0,1] op_sel_hi:[1,1]
    v_pk_mul_f32 v[100:101], v[100:101], v[130:131] op_sel:[0,1] op_sel_hi:[1,1]
    v_pk_mul_f32 v[102:103], v[102:103], v[130:131] op_sel:[0,1] op_sel_hi:[1,1]
    v_pk_mul_f32 v[104:105], v[104:105], v[130:131] op_sel:[0,1] op_sel_hi:[1,1]
    v_pk_mul_f32 v[106:107], v[106:107], v[130:131] op_sel:[0,1] op_sel_hi:[1,1]
    v_pk_mul_f32 v[108:109], v[108:109], v[130:131] op_sel:[0,1] op_sel_hi:[1,1]
    v_pk_mul_f32 v[110:111], v[110:111], v[130:131] op_sel:[0,1] op_sel_hi:[1,1]
    v_cvt_pk_bf16_f32 v152, v96, v97
    v_cvt_pk_bf16_f32 v153, v98, v99
    v_cvt_pk_bf16_f32 v154, v100, v101
    v_cvt_pk_bf16_f32 v155, v102, v103
    s_add_u32 s3, s33, 1024
    buffer_store_dwordx4 v[152:155], v3, s[16:19], s3 offen sc0 sc1
    v_cvt_pk_bf16_f32 v156, v104, v105
    v_cvt_pk_bf16_f32 v157, v106, v107
    v_cvt_pk_bf16_f32 v158, v108, v109
    v_cvt_pk_bf16_f32 v159, v110, v111
    s_add_u32 s3, s33, 66560
    buffer_store_dwordx4 v[156:159], v3, s[16:19], s3 offen sc0 sc1
    v_pk_mul_f32 v[112:113], v[112:113], v[130:131] op_sel:[0,1] op_sel_hi:[1,1]
    v_pk_mul_f32 v[114:115], v[114:115], v[130:131] op_sel:[0,1] op_sel_hi:[1,1]
    v_pk_mul_f32 v[116:117], v[116:117], v[130:131] op_sel:[0,1] op_sel_hi:[1,1]
    v_pk_mul_f32 v[118:119], v[118:119], v[130:131] op_sel:[0,1] op_sel_hi:[1,1]
    v_pk_mul_f32 v[120:121], v[120:121], v[130:131] op_sel:[0,1] op_sel_hi:[1,1]
    v_pk_mul_f32 v[122:123], v[122:123], v[130:131] op_sel:[0,1] op_sel_hi:[1,1]
    v_pk_mul_f32 v[124:125], v[124:125], v[130:131] op_sel:[0,1] op_sel_hi:[1,1]
    v_pk_mul_f32 v[126:127], v[126:127], v[130:131] op_sel:[0,1] op_sel_hi:[1,1]
    v_cvt_pk_bf16_f32 v148, v112, v113
    v_cvt_pk_bf16_f32 v149, v114, v115
    v_cvt_pk_bf16_f32 v150, v116, v117
    v_cvt_pk_bf16_f32 v151, v118, v119
    s_add_u32 s3, s33, 132096
    buffer_store_dwordx4 v[148:151], v3, s[16:19], s3 offen sc0 sc1
    v_cvt_pk_bf16_f32 v152, v120, v121
    v_cvt_pk_bf16_f32 v153, v122, v123
    v_cvt_pk_bf16_f32 v154, v124, v125
    v_cvt_pk_bf16_f32 v155, v126, v127
    s_add_u32 s3, s33, 197632
    buffer_store_dwordx4 v[152:155], v3, s[16:19], s3 offen sc0 sc1
    s_branch qkv_b_kernel_fin
qkv_b_kernel_v:
    v_mov_b32 v64, 0
    v_mov_b32 v65, 0
    v_mov_b32 v66, 0
    v_mov_b32 v67, 0
    v_mov_b32 v68, 0
    v_mov_b32 v69, 0
    v_mov_b32 v70, 0
    v_mov_b32 v71, 0
    v_mov_b32 v72, 0
    v_mov_b32 v73, 0
    v_mov_b32 v74, 0
    v_mov_b32 v75, 0
    v_mov_b32 v76, 0
    v_mov_b32 v77, 0
    v_mov_b32 v78, 0
    v_mov_b32 v79, 0
    v_mov_b32 v80, 0
    v_mov_b32 v81, 0
    v_mov_b32 v82, 0
    v_mov_b32 v83, 0
    v_mov_b32 v84, 0
    v_mov_b32 v85, 0
    v_mov_b32 v86, 0
    v_mov_b32 v87, 0
    v_mov_b32 v88, 0
    v_mov_b32 v89, 0
    v_mov_b32 v90, 0
    v_mov_b32 v91, 0
    v_mov_b32 v92, 0
    v_mov_b32 v93, 0
    v_mov_b32 v94, 0
    v_mov_b32 v95, 0
    v_mov_b32 v96, 0
    v_mov_b32 v97, 0
    v_mov_b32 v98, 0
    v_mov_b32 v99, 0
    v_mov_b32 v100, 0
    v_mov_b32 v101, 0
    v_mov_b32 v102, 0
    v_mov_b32 v103, 0
    v_mov_b32 v104, 0
    v_mov_b32 v105, 0
    v_mov_b32 v106, 0
    v_mov_b32 v107, 0
    v_mov_b32 v108, 0
    v_mov_b32 v109, 0
    v_mov_b32 v110, 0
    v_mov_b32 v111, 0
    v_mov_b32 v112, 0
    v_mov_b32 v113, 0
    v_mov_b32 v114, 0
    v_mov_b32 v115, 0
    v_mov_b32 v116, 0
    v_mov_b32 v117, 0
    v_mov_b32 v118, 0
    v_mov_b32 v119, 0
    v_mov_b32 v120, 0
    v_mov_b32 v121, 0
    v_mov_b32 v122, 0
    v_mov_b32 v123, 0
    v_mov_b32 v124, 0
    v_mov_b32 v125, 0
    v_mov_b32 v126, 0
    v_mov_b32 v127, 0
    s_waitcnt vmcnt(0)
    v_add_f32 v160, v160, v162
    v_add_f32 v161, v161, v163
    v_add_f32 v160, v160, v164
    v_add_f32 v161, v161, v165
    v_add_f32 v160, v160, v166
    v_add_f32 v161, v161, v167
    v_add_f32 v160, v160, v168
    v_add_f32 v161, v161, v169
    v_add_f32 v160, v160, v170
    v_add_f32 v161, v161, v171
    v_add_f32 v160, v160, v172
    v_add_f32 v161, v161, v173
    v_add_f32 v160, v160, v174
    v_add_f32 v161, v161, v175
    v_mov_b32 v128, v160
    v_mov_b32 v130, v161
    v_add_f32 v176, v176, v178
    v_add_f32 v177, v177, v179
    v_add_f32 v176, v176, v180
    v_add_f32 v177, v177, v181
    v_add_f32 v176, v176, v182
    v_add_f32 v177, v177, v183
    v_add_f32 v176, v176, v184
    v_add_f32 v177, v177, v185
    v_add_f32 v176, v176, v186
    v_add_f32 v177, v177, v187
    v_add_f32 v176, v176, v188
    v_add_f32 v177, v177, v189
    v_add_f32 v176, v176, v190
    v_add_f32 v177, v177, v191
    v_mov_b32 v129, v176
    v_mov_b32 v131, v177
    v_mul_f32 v132, 0.5, v132
    v_mul_f32 v133, 0.5, v133
    v_mov_b32 v144, v128
    s_nop 1
    v_permlane32_swap_b32 v128, v144
    s_nop 1
    v_add_f32 v128, v128, v144
    v_mov_b32 v144, v130
    s_nop 1
    v_permlane32_swap_b32 v130, v144
    s_nop 1
    v_add_f32 v130, v130, v144
    v_mul_f32 v128, 0xbb000000, v128
    v_mul_f32 v130, 0x3b000000, v130
    v_fma_f32 v130, -v128, v128, v130
    v_add_f32 v130, 0x3727c5ac, v130
    v_rsq_f32 v130, v130
    v_cvt_pk_bf16_f32 v32, v128, v128
    v_and_b32 v144, 0xffff0000, v32
    v_sub_f32 v144, v128, v144
    v_cvt_pk_bf16_f32 v33, v144, v144
    v_mov_b32 v34, 0
    v_mov_b32 v35, 0
    v_mov_b32 v144, v129
    s_nop 1
    v_permlane32_swap_b32 v129, v144
    s_nop 1
    v_add_f32 v129, v129, v144
    v_mov_b32 v144, v131
    s_nop 1
    v_permlane32_swap_b32 v131, v144
    s_nop 1
    v_add_f32 v131, v131, v144
    v_mul_f32 v129, 0xbb000000, v129
    v_mul_f32 v131, 0x3b000000, v131
    v_fma_f32 v131, -v129, v129, v131
    v_add_f32 v131, 0x3727c5ac, v131
    v_rsq_f32 v131, v131
    v_cvt_pk_bf16_f32 v36, v129, v129
    v_and_b32 v144, 0xffff0000, v36
    v_sub_f32 v144, v129, v144
    v_cvt_pk_bf16_f32 v37, v144, v144
    v_mov_b32 v38, 0
    v_mov_b32 v39, 0
    v_cvt_pk_bf16_f32 v48, v132, v132
    v_and_b32 v144, 0xffff0000, v48
    v_sub_f32 v144, v132, v144
    v_cvt_pk_bf16_f32 v48, v132, v144
    v_mov_b32 v49, v48
    v_mov_b32 v50, 0
    v_mov_b32 v51, 0
    v_cvt_pk_bf16_f32 v52, v133, v133
    v_and_b32 v144, 0xffff0000, v52
    v_sub_f32 v144, v133, v144
    v_cvt_pk_bf16_f32 v52, v133, v144
    v_mov_b32 v53, v52
    v_mov_b32 v54, 0
    v_mov_b32 v55, 0
    s_nop 1
    v_mfma_f32_32x32x16_bf16 v[64:79], v[32:35], v[48:51], v[64:79]
    v_mfma_f32_32x32x16_bf16 v[80:95], v[32:35], v[52:55], v[80:95]
    v_mfma_f32_32x32x16_bf16 v[96:111], v[36:39], v[48:51], v[96:111]
    v_mfma_f32_32x32x16_bf16 v[112:127], v[36:39], v[52:55], v[112:127]
    s_barrier
    ds_read_b128 v[32:35], v16 offset:0
    ds_read_b128 v[36:39], v16 offset:4096
    ds_read_b64_tr_b16 v[48:49], v20 offset:0
    ds_read_b64_tr_b16 v[50:51], v20 offset:2048
    ds_read_b64_tr_b16 v[52:53], v21 offset:0
    ds_read_b64_tr_b16 v[54:55], v21 offset:2048
    ds_read_b128 v[40:43], v16 offset:1024
    ds_read_b128 v[44:47], v16 offset:5120
    ds_read_b64_tr_b16 v[56:57], v20 offset:4096
    ds_read_b64_tr_b16 v[58:59], v20 offset:6144
    ds_read_b64_tr_b16 v[60:61], v21 offset:4096
    ds_read_b64_tr_b16 v[62:63], v21 offset:6144
    s_waitcnt lgkmcnt(6)
    v_mfma_f32_32x32x16_bf16 v[64:79], v[32:35], v[48:51], v[64:79]
    ds_read_b128 v[196:199], v16 offset:2048
    ds_read_b128 v[200:203], v16 offset:6144
    v_mfma_f32_32x32x16_bf16 v[80:95], v[32:35], v[52:55], v[80:95]
    ds_read_b64_tr_b16 v[204:205], v20 offset:8192
    ds_read_b64_tr_b16 v[206:207], v20 offset:10240
    v_mfma_f32_32x32x16_bf16 v[96:111], v[36:39], v[48:51], v[96:111]
    ds_read_b64_tr_b16 v[208:209], v21 offset:8192
    ds_read_b64_tr_b16 v[210:211], v21 offset:10240
    v_mfma_f32_32x32x16_bf16 v[112:127], v[36:39], v[52:55], v[112:127]
    s_waitcnt lgkmcnt(6)
    v_mfma_f32_32x32x16_bf16 v[64:79], v[40:43], v[56:59], v[64:79]
    ds_read_b128 v[32:35], v16 offset:3072
    ds_read_b128 v[36:39], v16 offset:7168
    v_mfma_f32_32x32x16_bf16 v[80:95], v[40:43], v[60:63], v[80:95]
    ds_read_b64_tr_b16 v[48:49], v20 offset:12288
    ds_read_b64_tr_b16 v[50:51], v20 offset:14336
    v_mfma_f32_32x32x16_bf16 v[96:111], v[44:47], v[56:59], v[96:111]
    ds_read_b64_tr_b16 v[52:53], v21 offset:12288
    ds_read_b64_tr_b16 v[54:55], v21 offset:14336
    v_mfma_f32_32x32x16_bf16 v[112:127], v[44:47], v[60:63], v[112:127]
    s_waitcnt lgkmcnt(6)
    v_mfma_f32_32x32x16_bf16 v[64:79], v[196:199], v[204:207], v[64:79]
    s_barrier
    ds_read_b128 v[40:43], v16 offset:32768
    ds_read_b128 v[44:47], v16 offset:36864
    v_mfma_f32_32x32x16_bf16 v[80:95], v[196:199], v[208:211], v[80:95]
    ds_read_b64_tr_b16 v[56:57], v20 offset:32768
    ds_read_b64_tr_b16 v[58:59], v20 offset:34816
    v_mfma_f32_32x32x16_bf16 v[96:111], v[200:203], v[204:207], v[96:111]
    ds_read_b64_tr_b16 v[60:61], v21 offset:32768
    ds_read_b64_tr_b16 v[62:63], v21 offset:34816
    v_mfma_f32_32x32x16_bf16 v[112:127], v[200:203], v[208:211], v[112:127]
    s_waitcnt lgkmcnt(6)
    v_mfma_f32_32x32x16_bf16 v[64:79], v[32:35], v[48:51], v[64:79]
    ds_read_b128 v[196:199], v16 offset:33792
    ds_read_b128 v[200:203], v16 offset:37888
    v_mfma_f32_32x32x16_bf16 v[80:95], v[32:35], v[52:55], v[80:95]
    ds_read_b64_tr_b16 v[204:205], v20 offset:36864
    ds_read_b64_tr_b16 v[206:207], v20 offset:38912
    v_mfma_f32_32x32x16_bf16 v[96:111], v[36:39], v[48:51], v[96:111]
    ds_read_b64_tr_b16 v[208:209], v21 offset:36864
    ds_read_b64_tr_b16 v[210:211], v21 offset:38912
    v_mfma_f32_32x32x16_bf16 v[112:127], v[36:39], v[52:55], v[112:127]
    s_waitcnt lgkmcnt(6)
    v_mfma_f32_32x32x16_bf16 v[64:79], v[40:43], v[56:59], v[64:79]
    ds_read_b128 v[32:35], v16 offset:34816
    ds_read_b128 v[36:39], v16 offset:38912
    v_mfma_f32_32x32x16_bf16 v[80:95], v[40:43], v[60:63], v[80:95]
    ds_read_b64_tr_b16 v[48:49], v20 offset:40960
    ds_read_b64_tr_b16 v[50:51], v20 offset:43008
    v_mfma_f32_32x32x16_bf16 v[96:111], v[44:47], v[56:59], v[96:111]
    ds_read_b64_tr_b16 v[52:53], v21 offset:40960
    ds_read_b64_tr_b16 v[54:55], v21 offset:43008
    v_mfma_f32_32x32x16_bf16 v[112:127], v[44:47], v[60:63], v[112:127]
    s_waitcnt lgkmcnt(6)
    v_mfma_f32_32x32x16_bf16 v[64:79], v[196:199], v[204:207], v[64:79]
    ds_read_b128 v[40:43], v16 offset:35840
    ds_read_b128 v[44:47], v16 offset:39936
    v_mfma_f32_32x32x16_bf16 v[80:95], v[196:199], v[208:211], v[80:95]
    ds_read_b64_tr_b16 v[56:57], v20 offset:45056
    ds_read_b64_tr_b16 v[58:59], v20 offset:47104
    v_mfma_f32_32x32x16_bf16 v[96:111], v[200:203], v[204:207], v[96:111]
    ds_read_b64_tr_b16 v[60:61], v21 offset:45056
    ds_read_b64_tr_b16 v[62:63], v21 offset:47104
    v_mfma_f32_32x32x16_bf16 v[112:127], v[200:203], v[208:211], v[112:127]
    s_waitcnt lgkmcnt(6)
    v_mfma_f32_32x32x16_bf16 v[64:79], v[32:35], v[48:51], v[64:79]
    s_barrier
    ds_read_b128 v[196:199], v4 offset:0
    ds_read_b128 v[200:203], v4 offset:4096
    v_mfma_f32_32x32x16_bf16 v[80:95], v[32:35], v[52:55], v[80:95]
    ds_read_b64_tr_b16 v[204:205], v8 offset:0
    ds_read_b64_tr_b16 v[206:207], v8 offset:2048
    v_mfma_f32_32x32x16_bf16 v[96:111], v[36:39], v[48:51], v[96:111]
    ds_read_b64_tr_b16 v[208:209], v9 offset:0
    ds_read_b64_tr_b16 v[210:211], v9 offset:2048
    v_mfma_f32_32x32x16_bf16 v[112:127], v[36:39], v[52:55], v[112:127]
    s_waitcnt lgkmcnt(6)
    v_mfma_f32_32x32x16_bf16 v[64:79], v[40:43], v[56:59], v[64:79]
    ds_read_b128 v[32:35], v4 offset:1024
    ds_read_b128 v[36:39], v4 offset:5120
    v_mfma_f32_32x32x16_bf16 v[80:95], v[40:43], v[60:63], v[80:95]
    ds_read_b64_tr_b16 v[48:49], v8 offset:4096
    ds_read_b64_tr_b16 v[50:51], v8 offset:6144
    v_mfma_f32_32x32x16_bf16 v[96:111], v[44:47], v[56:59], v[96:111]
    ds_read_b64_tr_b16 v[52:53], v9 offset:4096
    ds_read_b64_tr_b16 v[54:55], v9 offset:6144
    v_mfma_f32_32x32x16_bf16 v[112:127], v[44:47], v[60:63], v[112:127]
    s_waitcnt lgkmcnt(6)
    v_mfma_f32_32x32x16_bf16 v[64:79], v[196:199], v[204:207], v[64:79]
    ds_read_b128 v[40:43], v4 offset:2048
    ds_read_b128 v[44:47], v4 offset:6144
    v_mfma_f32_32x32x16_bf16 v[80:95], v[196:199], v[208:211], v[80:95]
    ds_read_b64_tr_b16 v[56:57], v8 offset:8192
    ds_read_b64_tr_b16 v[58:59], v8 offset:10240
    v_mfma_f32_32x32x16_bf16 v[96:111], v[200:203], v[204:207], v[96:111]
    ds_read_b64_tr_b16 v[60:61], v9 offset:8192
    ds_read_b64_tr_b16 v[62:63], v9 offset:10240
    v_mfma_f32_32x32x16_bf16 v[112:127], v[200:203], v[208:211], v[112:127]
    s_waitcnt lgkmcnt(6)
    v_mfma_f32_32x32x16_bf16 v[64:79], v[32:35], v[48:51], v[64:79]
    ds_read_b128 v[196:199], v4 offset:3072
    ds_read_b128 v[200:203], v4 offset:7168
    v_mfma_f32_32x32x16_bf16 v[80:95], v[32:35], v[52:55], v[80:95]
    ds_read_b64_tr_b16 v[204:205], v8 offset:12288
    ds_read_b64_tr_b16 v[206:207], v8 offset:14336
    v_mfma_f32_32x32x16_bf16 v[96:111], v[36:39], v[48:51], v[96:111]
    ds_read_b64_tr_b16 v[208:209], v9 offset:12288
    ds_read_b64_tr_b16 v[210:211], v9 offset:14336
    v_mfma_f32_32x32x16_bf16 v[112:127], v[36:39], v[52:55], v[112:127]
    s_waitcnt lgkmcnt(6)
    v_mfma_f32_32x32x16_bf16 v[64:79], v[40:43], v[56:59], v[64:79]
    s_barrier
    ds_read_b128 v[32:35], v4 offset:32768
    ds_read_b128 v[36:39], v4 offset:36864
    v_mfma_f32_32x32x16_bf16 v[80:95], v[40:43], v[60:63], v[80:95]
    ds_read_b64_tr_b16 v[48:49], v8 offset:32768
    ds_read_b64_tr_b16 v[50:51], v8 offset:34816
    v_mfma_f32_32x32x16_bf16 v[96:111], v[44:47], v[56:59], v[96:111]
    ds_read_b64_tr_b16 v[52:53], v9 offset:32768
    ds_read_b64_tr_b16 v[54:55], v9 offset:34816
    v_mfma_f32_32x32x16_bf16 v[112:127], v[44:47], v[60:63], v[112:127]
    s_waitcnt lgkmcnt(6)
    v_mfma_f32_32x32x16_bf16 v[64:79], v[196:199], v[204:207], v[64:79]
    ds_read_b128 v[40:43], v4 offset:33792
    ds_read_b128 v[44:47], v4 offset:37888
    v_mfma_f32_32x32x16_bf16 v[80:95], v[196:199], v[208:211], v[80:95]
    ds_read_b64_tr_b16 v[56:57], v8 offset:36864
    ds_read_b64_tr_b16 v[58:59], v8 offset:38912
    v_mfma_f32_32x32x16_bf16 v[96:111], v[200:203], v[204:207], v[96:111]
    ds_read_b64_tr_b16 v[60:61], v9 offset:36864
    ds_read_b64_tr_b16 v[62:63], v9 offset:38912
    v_mfma_f32_32x32x16_bf16 v[112:127], v[200:203], v[208:211], v[112:127]
    s_waitcnt lgkmcnt(6)
    v_mfma_f32_32x32x16_bf16 v[64:79], v[32:35], v[48:51], v[64:79]
    ds_read_b128 v[196:199], v4 offset:34816
    ds_read_b128 v[200:203], v4 offset:38912
    v_mfma_f32_32x32x16_bf16 v[80:95], v[32:35], v[52:55], v[80:95]
    ds_read_b64_tr_b16 v[204:205], v8 offset:40960
    ds_read_b64_tr_b16 v[206:207], v8 offset:43008
    v_mfma_f32_32x32x16_bf16 v[96:111], v[36:39], v[48:51], v[96:111]
    ds_read_b64_tr_b16 v[208:209], v9 offset:40960
    ds_read_b64_tr_b16 v[210:211], v9 offset:43008
    v_mfma_f32_32x32x16_bf16 v[112:127], v[36:39], v[52:55], v[112:127]
    s_waitcnt lgkmcnt(6)
    v_mfma_f32_32x32x16_bf16 v[64:79], v[40:43], v[56:59], v[64:79]
    ds_read_b128 v[32:35], v4 offset:35840
    ds_read_b128 v[36:39], v4 offset:39936
    v_mfma_f32_32x32x16_bf16 v[80:95], v[40:43], v[60:63], v[80:95]
    ds_read_b64_tr_b16 v[48:49], v8 offset:45056
    ds_read_b64_tr_b16 v[50:51], v8 offset:47104
    v_mfma_f32_32x32x16_bf16 v[96:111], v[44:47], v[56:59], v[96:111]
    ds_read_b64_tr_b16 v[52:53], v9 offset:45056
    ds_read_b64_tr_b16 v[54:55], v9 offset:47104
    v_mfma_f32_32x32x16_bf16 v[112:127], v[44:47], v[60:63], v[112:127]
    s_waitcnt lgkmcnt(6)
    v_mfma_f32_32x32x16_bf16 v[64:79], v[196:199], v[204:207], v[64:79]
    s_barrier
    ds_read_b128 v[40:43], v10 offset:0
    ds_read_b128 v[44:47], v10 offset:4096
    v_mfma_f32_32x32x16_bf16 v[80:95], v[196:199], v[208:211], v[80:95]
    ds_read_b64_tr_b16 v[56:57], v14 offset:0
    ds_read_b64_tr_b16 v[58:59], v14 offset:2048
    v_mfma_f32_32x32x16_bf16 v[96:111], v[200:203], v[204:207], v[96:111]
    ds_read_b64_tr_b16 v[60:61], v15 offset:0
    ds_read_b64_tr_b16 v[62:63], v15 offset:2048
    v_mfma_f32_32x32x16_bf16 v[112:127], v[200:203], v[208:211], v[112:127]
    s_waitcnt lgkmcnt(6)
    v_mfma_f32_32x32x16_bf16 v[64:79], v[32:35], v[48:51], v[64:79]
    ds_read_b128 v[196:199], v10 offset:1024
    ds_read_b128 v[200:203], v10 offset:5120
    v_mfma_f32_32x32x16_bf16 v[80:95], v[32:35], v[52:55], v[80:95]
    ds_read_b64_tr_b16 v[204:205], v14 offset:4096
    ds_read_b64_tr_b16 v[206:207], v14 offset:6144
    v_mfma_f32_32x32x16_bf16 v[96:111], v[36:39], v[48:51], v[96:111]
    ds_read_b64_tr_b16 v[208:209], v15 offset:4096
    ds_read_b64_tr_b16 v[210:211], v15 offset:6144
    v_mfma_f32_32x32x16_bf16 v[112:127], v[36:39], v[52:55], v[112:127]
    s_waitcnt lgkmcnt(6)
    v_mfma_f32_32x32x16_bf16 v[64:79], v[40:43], v[56:59], v[64:79]
    ds_read_b128 v[32:35], v10 offset:2048
    ds_read_b128 v[36:39], v10 offset:6144
    v_mfma_f32_32x32x16_bf16 v[80:95], v[40:43], v[60:63], v[80:95]
    ds_read_b64_tr_b16 v[48:49], v14 offset:8192
    ds_read_b64_tr_b16 v[50:51], v14 offset:10240
    v_mfma_f32_32x32x16_bf16 v[96:111], v[44:47], v[56:59], v[96:111]
    ds_read_b64_tr_b16 v[52:53], v15 offset:8192
    ds_read_b64_tr_b16 v[54:55], v15 offset:10240
    v_mfma_f32_32x32x16_bf16 v[112:127], v[44:47], v[60:63], v[112:127]
    s_waitcnt lgkmcnt(6)
    v_mfma_f32_32x32x16_bf16 v[64:79], v[196:199], v[204:207], v[64:79]
    ds_read_b128 v[40:43], v10 offset:3072
    ds_read_b128 v[44:47], v10 offset:7168
    v_mfma_f32_32x32x16_bf16 v[80:95], v[196:199], v[208:211], v[80:95]
    ds_read_b64_tr_b16 v[56:57], v14 offset:12288
    ds_read_b64_tr_b16 v[58:59], v14 offset:14336
    v_mfma_f32_32x32x16_bf16 v[96:111], v[200:203], v[204:207], v[96:111]
    ds_read_b64_tr_b16 v[60:61], v15 offset:12288
    ds_read_b64_tr_b16 v[62:63], v15 offset:14336
    v_mfma_f32_32x32x16_bf16 v[112:127], v[200:203], v[208:211], v[112:127]
    s_waitcnt lgkmcnt(6)
    v_mfma_f32_32x32x16_bf16 v[64:79], v[32:35], v[48:51], v[64:79]
    s_barrier
    ds_read_b128 v[196:199], v16 offset:0
    ds_read_b128 v[200:203], v16 offset:4096
    v_mfma_f32_32x32x16_bf16 v[80:95], v[32:35], v[52:55], v[80:95]
    ds_read_b64_tr_b16 v[204:205], v20 offset:0
    ds_read_b64_tr_b16 v[206:207], v20 offset:2048
    v_mfma_f32_32x32x16_bf16 v[96:111], v[36:39], v[48:51], v[96:111]
    ds_read_b64_tr_b16 v[208:209], v21 offset:0
    ds_read_b64_tr_b16 v[210:211], v21 offset:2048
    v_mfma_f32_32x32x16_bf16 v[112:127], v[36:39], v[52:55], v[112:127]
    s_waitcnt lgkmcnt(6)
    v_mfma_f32_32x32x16_bf16 v[64:79], v[40:43], v[56:59], v[64:79]
    ds_read_b128 v[32:35], v16 offset:1024
    ds_read_b128 v[36:39], v16 offset:5120
    v_mfma_f32_32x32x16_bf16 v[80:95], v[40:43], v[60:63], v[80:95]
    ds_read_b64_tr_b16 v[48:49], v20 offset:4096
    ds_read_b64_tr_b16 v[50:51], v20 offset:6144
    v_mfma_f32_32x32x16_bf16 v[96:111], v[44:47], v[56:59], v[96:111]
    ds_read_b64_tr_b16 v[52:53], v21 offset:4096
    ds_read_b64_tr_b16 v[54:55], v21 offset:6144
    v_mfma_f32_32x32x16_bf16 v[112:127], v[44:47], v[60:63], v[112:127]
    s_waitcnt lgkmcnt(6)
    v_mfma_f32_32x32x16_bf16 v[64:79], v[196:199], v[204:207], v[64:79]
    ds_read_b128 v[40:43], v16 offset:2048
    ds_read_b128 v[44:47], v16 offset:6144
    v_mfma_f32_32x32x16_bf16 v[80:95], v[196:199], v[208:211], v[80:95]
    ds_read_b64_tr_b16 v[56:57], v20 offset:8192
    ds_read_b64_tr_b16 v[58:59], v20 offset:10240
    v_mfma_f32_32x32x16_bf16 v[96:111], v[200:203], v[204:207], v[96:111]
    ds_read_b64_tr_b16 v[60:61], v21 offset:8192
    ds_read_b64_tr_b16 v[62:63], v21 offset:10240
    v_mfma_f32_32x32x16_bf16 v[112:127], v[200:203], v[208:211], v[112:127]
    s_waitcnt lgkmcnt(6)
    v_mfma_f32_32x32x16_bf16 v[64:79], v[32:35], v[48:51], v[64:79]
    ds_read_b128 v[196:199], v16 offset:3072
    ds_read_b128 v[200:203], v16 offset:7168
    v_mfma_f32_32x32x16_bf16 v[80:95], v[32:35], v[52:55], v[80:95]
    ds_read_b64_tr_b16 v[204:205], v20 offset:12288
    ds_read_b64_tr_b16 v[206:207], v20 offset:14336
    v_mfma_f32_32x32x16_bf16 v[96:111], v[36:39], v[48:51], v[96:111]
    ds_read_b64_tr_b16 v[208:209], v21 offset:12288
    ds_read_b64_tr_b16 v[210:211], v21 offset:14336
    v_mfma_f32_32x32x16_bf16 v[112:127], v[36:39], v[52:55], v[112:127]
    s_waitcnt lgkmcnt(6)
    v_mfma_f32_32x32x16_bf16 v[64:79], v[40:43], v[56:59], v[64:79]
    s_barrier
    ds_read_b128 v[32:35], v16 offset:32768
    ds_read_b128 v[36:39], v16 offset:36864
    v_mfma_f32_32x32x16_bf16 v[80:95], v[40:43], v[60:63], v[80:95]
    ds_read_b64_tr_b16 v[48:49], v20 offset:32768
    ds_read_b64_tr_b16 v[50:51], v20 offset:34816
    v_mfma_f32_32x32x16_bf16 v[96:111], v[44:47], v[56:59], v[96:111]
    ds_read_b64_tr_b16 v[52:53], v21 offset:32768
    ds_read_b64_tr_b16 v[54:55], v21 offset:34816
    v_mfma_f32_32x32x16_bf16 v[112:127], v[44:47], v[60:63], v[112:127]
    s_waitcnt lgkmcnt(6)
    v_mfma_f32_32x32x16_bf16 v[64:79], v[196:199], v[204:207], v[64:79]
    ds_read_b128 v[40:43], v16 offset:33792
    ds_read_b128 v[44:47], v16 offset:37888
    v_mfma_f32_32x32x16_bf16 v[80:95], v[196:199], v[208:211], v[80:95]
    ds_read_b64_tr_b16 v[56:57], v20 offset:36864
    ds_read_b64_tr_b16 v[58:59], v20 offset:38912
    v_mfma_f32_32x32x16_bf16 v[96:111], v[200:203], v[204:207], v[96:111]
    ds_read_b64_tr_b16 v[60:61], v21 offset:36864
    ds_read_b64_tr_b16 v[62:63], v21 offset:38912
    v_mfma_f32_32x32x16_bf16 v[112:127], v[200:203], v[208:211], v[112:127]
    s_waitcnt lgkmcnt(6)
    v_mfma_f32_32x32x16_bf16 v[64:79], v[32:35], v[48:51], v[64:79]
    ds_read_b128 v[196:199], v16 offset:34816
    ds_read_b128 v[200:203], v16 offset:38912
    v_mfma_f32_32x32x16_bf16 v[80:95], v[32:35], v[52:55], v[80:95]
    ds_read_b64_tr_b16 v[204:205], v20 offset:40960
    ds_read_b64_tr_b16 v[206:207], v20 offset:43008
    v_mfma_f32_32x32x16_bf16 v[96:111], v[36:39], v[48:51], v[96:111]
    ds_read_b64_tr_b16 v[208:209], v21 offset:40960
    ds_read_b64_tr_b16 v[210:211], v21 offset:43008
    v_mfma_f32_32x32x16_bf16 v[112:127], v[36:39], v[52:55], v[112:127]
    s_waitcnt lgkmcnt(6)
    v_mfma_f32_32x32x16_bf16 v[64:79], v[40:43], v[56:59], v[64:79]
    ds_read_b128 v[32:35], v16 offset:35840
    ds_read_b128 v[36:39], v16 offset:39936
    v_mfma_f32_32x32x16_bf16 v[80:95], v[40:43], v[60:63], v[80:95]
    ds_read_b64_tr_b16 v[48:49], v20 offset:45056
    ds_read_b64_tr_b16 v[50:51], v20 offset:47104
    v_mfma_f32_32x32x16_bf16 v[96:111], v[44:47], v[56:59], v[96:111]
    ds_read_b64_tr_b16 v[52:53], v21 offset:45056
    ds_read_b64_tr_b16 v[54:55], v21 offset:47104
    v_mfma_f32_32x32x16_bf16 v[112:127], v[44:47], v[60:63], v[112:127]
    s_waitcnt lgkmcnt(6)
    v_mfma_f32_32x32x16_bf16 v[64:79], v[196:199], v[204:207], v[64:79]
    s_barrier
    ds_read_b128 v[40:43], v4 offset:0
    ds_read_b128 v[44:47], v4 offset:4096
    v_mfma_f32_32x32x16_bf16 v[80:95], v[196:199], v[208:211], v[80:95]
    ds_read_b64_tr_b16 v[56:57], v8 offset:0
    ds_read_b64_tr_b16 v[58:59], v8 offset:2048
    v_mfma_f32_32x32x16_bf16 v[96:111], v[200:203], v[204:207], v[96:111]
    ds_read_b64_tr_b16 v[60:61], v9 offset:0
    ds_read_b64_tr_b16 v[62:63], v9 offset:2048
    v_mfma_f32_32x32x16_bf16 v[112:127], v[200:203], v[208:211], v[112:127]
    s_waitcnt lgkmcnt(6)
    v_mfma_f32_32x32x16_bf16 v[64:79], v[32:35], v[48:51], v[64:79]
    ds_read_b128 v[196:199], v4 offset:1024
    ds_read_b128 v[200:203], v4 offset:5120
    v_mfma_f32_32x32x16_bf16 v[80:95], v[32:35], v[52:55], v[80:95]
    ds_read_b64_tr_b16 v[204:205], v8 offset:4096
    ds_read_b64_tr_b16 v[206:207], v8 offset:6144
    v_mfma_f32_32x32x16_bf16 v[96:111], v[36:39], v[48:51], v[96:111]
    ds_read_b64_tr_b16 v[208:209], v9 offset:4096
    ds_read_b64_tr_b16 v[210:211], v9 offset:6144
    v_mfma_f32_32x32x16_bf16 v[112:127], v[36:39], v[52:55], v[112:127]
    s_waitcnt lgkmcnt(6)
    v_mfma_f32_32x32x16_bf16 v[64:79], v[40:43], v[56:59], v[64:79]
    ds_read_b128 v[32:35], v4 offset:2048
    ds_read_b128 v[36:39], v4 offset:6144
    v_mfma_f32_32x32x16_bf16 v[80:95], v[40:43], v[60:63], v[80:95]
    ds_read_b64_tr_b16 v[48:49], v8 offset:8192
    ds_read_b64_tr_b16 v[50:51], v8 offset:10240
    v_mfma_f32_32x32x16_bf16 v[96:111], v[44:47], v[56:59], v[96:111]
    ds_read_b64_tr_b16 v[52:53], v9 offset:8192
    ds_read_b64_tr_b16 v[54:55], v9 offset:10240
    v_mfma_f32_32x32x16_bf16 v[112:127], v[44:47], v[60:63], v[112:127]
    s_waitcnt lgkmcnt(6)
    v_mfma_f32_32x32x16_bf16 v[64:79], v[196:199], v[204:207], v[64:79]
    ds_read_b128 v[40:43], v4 offset:3072
    ds_read_b128 v[44:47], v4 offset:7168
    v_mfma_f32_32x32x16_bf16 v[80:95], v[196:199], v[208:211], v[80:95]
    ds_read_b64_tr_b16 v[56:57], v8 offset:12288
    ds_read_b64_tr_b16 v[58:59], v8 offset:14336
    v_mfma_f32_32x32x16_bf16 v[96:111], v[200:203], v[204:207], v[96:111]
    ds_read_b64_tr_b16 v[60:61], v9 offset:12288
    ds_read_b64_tr_b16 v[62:63], v9 offset:14336
    v_mfma_f32_32x32x16_bf16 v[112:127], v[200:203], v[208:211], v[112:127]
    s_waitcnt lgkmcnt(6)
    v_mfma_f32_32x32x16_bf16 v[64:79], v[32:35], v[48:51], v[64:79]
    v_mfma_f32_32x32x16_bf16 v[80:95], v[32:35], v[52:55], v[80:95]
    v_mfma_f32_32x32x16_bf16 v[96:111], v[36:39], v[48:51], v[96:111]
    v_mfma_f32_32x32x16_bf16 v[112:127], v[36:39], v[52:55], v[112:127]
    s_waitcnt lgkmcnt(0)
    v_mfma_f32_32x32x16_bf16 v[64:79], v[40:43], v[56:59], v[64:79]
    v_mfma_f32_32x32x16_bf16 v[80:95], v[40:43], v[60:63], v[80:95]
    v_mfma_f32_32x32x16_bf16 v[96:111], v[44:47], v[56:59], v[96:111]
    v_mfma_f32_32x32x16_bf16 v[112:127], v[44:47], v[60:63], v[112:127]
    s_barrier
    v_and_b32 v12, 31, v2
    v_lshlrev_b32 v12, 2, v12
    s_lshl_b32 s3, s26, 8
    s_add_u32 s3, s3, 8192
    v_add_u32 v12, s3, v12
    ds_write_b32 v12, v130
    ds_write_b32 v12, v131 offset:128
    v_lshrrev_b32 v13, 5, v2
    v_lshlrev_b32 v13, 4, v13
    v_add_u32 v13, s3, v13
    s_waitcnt lgkmcnt(0)
    s_nop 15
    ds_read_b128 v[32:35], v13 offset:0
    ds_read_b128 v[36:39], v13 offset:32
    ds_read_b128 v[40:43], v13 offset:64
    ds_read_b128 v[44:47], v13 offset:96
    ds_read_b128 v[48:51], v13 offset:128
    ds_read_b128 v[52:55], v13 offset:160
    ds_read_b128 v[56:59], v13 offset:192
    ds_read_b128 v[60:63], v13 offset:224
    s_lshl_b32 s33, s25, 3
    s_lshl_b32 s34, s28, 2
    s_add_u32 s33, s33, s34
    s_lshl_b32 s33, s33, 16
    s_lshl_b32 s34, s24, 2
    s_lshl_b32 s35, s27, 1
    s_add_u32 s34, s34, s35
    s_lshl_b32 s34, s34, 10
    s_add_u32 s33, s33, s34
    v_bfe_u32 v12, v2, 4, 1
    v_lshlrev_b32 v12, 16, v12
    v_lshrrev_b32 v13, 5, v2
    v_lshlrev_b32 v13, 8, v13
    v_and_b32 v14, 15, v2
    v_lshlrev_b32 v14, 4, v14
    v_add3_u32 v12, v12, v13, v14
    s_waitcnt lgkmcnt(0)
    v_pk_mul_f32 v[64:65], v[64:65], v[32:33]
    v_pk_mul_f32 v[66:67], v[66:67], v[34:35]
    v_pk_mul_f32 v[68:69], v[68:69], v[36:37]
    v_pk_mul_f32 v[70:71], v[70:71], v[38:39]
    v_pk_mul_f32 v[72:73], v[72:73], v[40:41]
    v_pk_mul_f32 v[74:75], v[74:75], v[42:43]
    v_pk_mul_f32 v[76:77], v[76:77], v[44:45]
    v_pk_mul_f32 v[78:79], v[78:79], v[46:47]
    v_cvt_pk_bf16_f32 v148, v64, v65
    v_cvt_pk_bf16_f32 v149, v66, v67
    v_cvt_pk_bf16_f32 v150, v68, v69
    v_cvt_pk_bf16_f32 v151, v70, v71
    s_add_u32 s3, s33, 0
    buffer_store_dwordx4 v[148:151], v12, s[16:19], s3 offen sc0 sc1
    v_cvt_pk_bf16_f32 v152, v72, v73
    v_cvt_pk_bf16_f32 v153, v74, v75
    v_cvt_pk_bf16_f32 v154, v76, v77
    v_cvt_pk_bf16_f32 v155, v78, v79
    s_add_u32 s3, s33, 512
    buffer_store_dwordx4 v[152:155], v12, s[16:19], s3 offen sc0 sc1
    v_pk_mul_f32 v[80:81], v[80:81], v[32:33]
    v_pk_mul_f32 v[82:83], v[82:83], v[34:35]
    v_pk_mul_f32 v[84:85], v[84:85], v[36:37]
    v_pk_mul_f32 v[86:87], v[86:87], v[38:39]
    v_pk_mul_f32 v[88:89], v[88:89], v[40:41]
    v_pk_mul_f32 v[90:91], v[90:91], v[42:43]
    v_pk_mul_f32 v[92:93], v[92:93], v[44:45]
    v_pk_mul_f32 v[94:95], v[94:95], v[46:47]
    v_cvt_pk_bf16_f32 v156, v80, v81
    v_cvt_pk_bf16_f32 v157, v82, v83
    v_cvt_pk_bf16_f32 v158, v84, v85
    v_cvt_pk_bf16_f32 v159, v86, v87
    s_add_u32 s3, s33, 131072
    buffer_store_dwordx4 v[156:159], v12, s[16:19], s3 offen sc0 sc1
    v_cvt_pk_bf16_f32 v148, v88, v89
    v_cvt_pk_bf16_f32 v149, v90, v91
    v_cvt_pk_bf16_f32 v150, v92, v93
    v_cvt_pk_bf16_f32 v151, v94, v95
    s_add_u32 s3, s33, 131584
    buffer_store_dwordx4 v[148:151], v12, s[16:19], s3 offen sc0 sc1
    v_pk_mul_f32 v[96:97], v[96:97], v[48:49]
    v_pk_mul_f32 v[98:99], v[98:99], v[50:51]
    v_pk_mul_f32 v[100:101], v[100:101], v[52:53]
    v_pk_mul_f32 v[102:103], v[102:103], v[54:55]
    v_pk_mul_f32 v[104:105], v[104:105], v[56:57]
    v_pk_mul_f32 v[106:107], v[106:107], v[58:59]
    v_pk_mul_f32 v[108:109], v[108:109], v[60:61]
    v_pk_mul_f32 v[110:111], v[110:111], v[62:63]
    v_cvt_pk_bf16_f32 v152, v96, v97
    v_cvt_pk_bf16_f32 v153, v98, v99
    v_cvt_pk_bf16_f32 v154, v100, v101
    v_cvt_pk_bf16_f32 v155, v102, v103
    s_add_u32 s3, s33, 1024
    buffer_store_dwordx4 v[152:155], v12, s[16:19], s3 offen sc0 sc1
    v_cvt_pk_bf16_f32 v156, v104, v105
    v_cvt_pk_bf16_f32 v157, v106, v107
    v_cvt_pk_bf16_f32 v158, v108, v109
    v_cvt_pk_bf16_f32 v159, v110, v111
    s_add_u32 s3, s33, 1536
    buffer_store_dwordx4 v[156:159], v12, s[16:19], s3 offen sc0 sc1
    v_pk_mul_f32 v[112:113], v[112:113], v[48:49]
    v_pk_mul_f32 v[114:115], v[114:115], v[50:51]
    v_pk_mul_f32 v[116:117], v[116:117], v[52:53]
    v_pk_mul_f32 v[118:119], v[118:119], v[54:55]
    v_pk_mul_f32 v[120:121], v[120:121], v[56:57]
    v_pk_mul_f32 v[122:123], v[122:123], v[58:59]
    v_pk_mul_f32 v[124:125], v[124:125], v[60:61]
    v_pk_mul_f32 v[126:127], v[126:127], v[62:63]
    v_cvt_pk_bf16_f32 v148, v112, v113
    v_cvt_pk_bf16_f32 v149, v114, v115
    v_cvt_pk_bf16_f32 v150, v116, v117
    v_cvt_pk_bf16_f32 v151, v118, v119
    s_add_u32 s3, s33, 132096
    buffer_store_dwordx4 v[148:151], v12, s[16:19], s3 offen sc0 sc1
    v_cvt_pk_bf16_f32 v152, v120, v121
    v_cvt_pk_bf16_f32 v153, v122, v123
    v_cvt_pk_bf16_f32 v154, v124, v125
    v_cvt_pk_bf16_f32 v155, v126, v127
    s_add_u32 s3, s33, 132608
    buffer_store_dwordx4 v[152:155], v12, s[16:19], s3 offen sc0 sc1
qkv_b_kernel_fin:
qkv_b_kernel_done:
    s_endpgm
.section .rodata,"a"
.p2align 6
.amdhsa_kernel qkv_b_kernel
  .amdhsa_next_free_vgpr 212
  .amdhsa_next_free_sgpr 96
  .amdhsa_accum_offset 212
  .amdhsa_group_segment_fixed_size 0
  .amdhsa_kernarg_size 72
  .amdhsa_user_sgpr_count 2
  .amdhsa_user_sgpr_kernarg_segment_ptr 1
  .amdhsa_system_sgpr_workgroup_id_x 1
  .amdhsa_float_denorm_mode_32 3
.end_amdhsa_kernel
.text
.globl ffn1_kernel
.p2align 8
.type ffn1_kernel,@function
ffn1_kernel:
    s_cmp_ge_u32 s2, 224
    s_cbranch_scc1 ffn1_kernel_done
    s_load_dwordx2 s[8:9], s[0:1], 64
    s_load_dwordx2 s[12:13], s[0:1], 32
    v_lshrrev_b32 v1, 6, v0
    v_and_b32 v2, 63, v0
    s_and_b32 s3, s2, 7
    s_lshr_b32 s4, s2, 3
    v_readfirstlane_b32 s26, v1
    s_and_b32 s5, s3, 3
    s_lshr_b32 s3, s3, 2
    s_lshl_b32 s5, s5, 2
    s_and_b32 s24, s4, 3
    s_add_u32 s24, s24, s5
    s_lshr_b32 s4, s4, 2
    s_mul_i32 s3, s3, 7
    s_add_u32 s25, s3, s4
    v_lshlrev_b32 v3, 4, v2
    s_cmp_lt_u32 s26, 4
    s_cbranch_scc1 ffn1_kernel_cw
    s_sub_u32 s26, s26, 4
    s_lshr_b32 s27, s26, 1
    s_and_b32 s28, s26, 1
    s_lshl_b32 s30, s26, 12
    v_lshrrev_b32 v12, 4, v2
    v_bfe_u32 v13, v2, 2, 2
    v_xor_b32 v13, v13, v12
    v_lshlrev_b32 v13, 6, v13
    v_and_b32 v14, 3, v2
    v_lshlrev_b32 v14, 4, v14
    v_mul_u32_u24 v12, 3584, v12
    v_add3_u32 v8, v12, v13, v14
    v_add_u32 v9, 13312, v8
    v_add_u32 v10, 26624, v8
    v_add_u32 v11, 39936, v8
    s_lshl_b32 s31, s24, 2
    s_add_u32 s31, s31, s26
    s_lshl_b32 s31, s31, 15
    s_mul_i32 s32, s26, 57344
    s_lshl_b32 s3, s25, 8
    s_add_u32 s32, s32, s3
    s_waitcnt lgkmcnt(0)
    s_mov_b32 s10, 0x200000
    s_mov_b32 s11, 0x00020000
    s_mov_b32 s14, 0x1c0000
    s_mov_b32 s15, 0x00020000
    s_add_u32 m0, s30, 16384
    s_add_u32 s3, s32, 0
    buffer_load_dwordx4 v8, s[12:15], s3 offen offset:0 lds
    buffer_load_dwordx4 v9, s[12:15], s3 offen offset:1024 lds
    buffer_load_dwordx4 v10, s[12:15], s3 offen offset:2048 lds
    buffer_load_dwordx4 v11, s[12:15], s3 offen offset:3072 lds
    s_add_u32 m0, s30, 0
    s_add_u32 s3, s31, 0
    buffer_load_dwordx4 v3, s[8:11], s3 offen offset:0 lds
    buffer_load_dwordx4 v3, s[8:11], s3 offen offset:1024 lds
    buffer_load_dwordx4 v3, s[8:11], s3 offen offset:2048 lds
    buffer_load_dwordx4 v3, s[8:11], s3 offen offset:3072 lds
    s_add_u32 m0, s30, 49152
    s_add_u32 s3, s32, 229376
    buffer_load_dwordx4 v8, s[12:15], s3 offen offset:0 lds
    buffer_load_dwordx4 v9, s[12:15], s3 offen offset:1024 lds
    buffer_load_dwordx4 v10, s[12:15], s3 offen offset:2048 lds
    buffer_load_dwordx4 v11, s[12:15], s3 offen offset:3072 lds
    s_add_u32 m0, s30, 32768
    s_add_u32 s3, s31, 4096
    buffer_load_dwordx4 v3, s[8:11], s3 offen offset:0 lds
    buffer_load_dwordx4 v3, s[8:11], s3 offen offset:1024 lds
    buffer_load_dwordx4 v3, s[8:11], s3 offen offset:2048 lds
    buffer_load_dwordx4 v3, s[8:11], s3 offen offset:3072 lds
    s_waitcnt vmcnt(8)
    s_barrier
    s_add_u32 m0, s30, 81920
    s_add_u32 s3, s32, 458752
    buffer_load_dwordx4 v8, s[12:15], s3 offen offset:0 lds
    buffer_load_dwordx4 v9, s[12:15], s3 offen offset:1024 lds
    buffer_load_dwordx4 v10, s[12:15], s3 offen offset:2048 lds
    buffer_load_dwordx4 v11, s[12:15], s3 offen offset:3072 lds
    s_add_u32 m0, s30, 65536
    s_add_u32 s3, s31, 8192
    buffer_load_dwordx4 v3, s[8:11], s3 offen offset:0 lds
    buffer_load_dwordx4 v3, s[8:11], s3 offen offset:1024 lds
    buffer_load_dwordx4 v3, s[8:11], s3 offen offset:2048 lds
    buffer_load_dwordx4 v3, s[8:11], s3 offen offset:3072 lds
    s_waitcnt vmcnt(8)
    s_barrier
    s_add_u32 m0, s30, 114688
    s_add_u32 s3, s32, 688128
    buffer_load_dwordx4 v8, s[12:15], s3 offen offset:0 lds
    buffer_load_dwordx4 v9, s[12:15], s3 offen offset:1024 lds
    buffer_load_dwordx4 v10, s[12:15], s3 offen offset:2048 lds
    buffer_load_dwordx4 v11, s[12:15], s3 offen offset:3072 lds
    s_add_u32 m0, s30, 98304
    s_add_u32 s3, s31, 12288
    buffer_load_dwordx4 v3, s[8:11], s3 offen offset:0 lds
    buffer_load_dwordx4 v3, s[8:11], s3 offen offset:1024 lds
    buffer_load_dwordx4 v3, s[8:11], s3 offen offset:2048 lds
    buffer_load_dwordx4 v3, s[8:11], s3 offen offset:3072 lds
    s_waitcnt vmcnt(8)
    s_barrier
    s_add_u32 m0, s30, 147456
    s_add_u32 s3, s32, 917504
    buffer_load_dwordx4 v8, s[12:15], s3 offen offset:0 lds
    buffer_load_dwordx4 v9, s[12:15], s3 offen offset:1024 lds
    buffer_load_dwordx4 v10, s[12:15], s3 offen offset:2048 lds
    buffer_load_dwordx4 v11, s[12:15], s3 offen offset:3072 lds
    s_add_u32 m0, s30, 131072
    s_add_u32 s3, s31, 16384
    buffer_load_dwordx4 v3, s[8:11], s3 offen offset:0 lds
    buffer_load_dwordx4 v3, s[8:11], s3 offen offset:1024 lds
    buffer_load_dwordx4 v3, s[8:11], s3 offen offset:2048 lds
    buffer_load_dwordx4 v3, s[8:11], s3 offen offset:3072 lds
    s_waitcnt vmcnt(8)
    s_barrier
    s_add_u32 m0, s30, 16384
    s_add_u32 s3, s32, 1146880
    buffer_load_dwordx4 v8, s[12:15], s3 offen offset:0 lds
    buffer_load_dwordx4 v9, s[12:15], s3 offen offset:1024 lds
    buffer_load_dwordx4 v10, s[12:15], s3 offen offset:2048 lds
    buffer_load_dwordx4 v11, s[12:15], s3 offen offset:3072 lds
    s_add_u32 m0, s30, 0
    s_add_u32 s3, s31, 20480
    buffer_load_dwordx4 v3, s[8:11], s3 offen offset:0 lds
    buffer_load_dwordx4 v3, s[8:11], s3 offen offset:1024 lds
    buffer_load_dwordx4 v3, s[8:11], s3 offen offset:2048 lds
    buffer_load_dwordx4 v3, s[8:11], s3 offen offset:3072 lds
    s_waitcnt vmcnt(8)
    s_barrier
    s_add_u32 m0, s30, 49152
    s_add_u32 s3, s32, 1376256
    buffer_load_dwordx4 v8, s[12:15], s3 offen offset:0 lds
    buffer_load_dwordx4 v9, s[12:15], s3 offen offset:1024 lds
    buffer_load_dwordx4 v10, s[12:15], s3 offen offset:2048 lds
    buffer_load_dwordx4 v11, s[12:15], s3 offen offset:3072 lds
    s_add_u32 m0, s30, 32768
    s_add_u32 s3, s31, 24576
    buffer_load_dwordx4 v3, s[8:11], s3 offen offset:0 lds
    buffer_load_dwordx4 v3, s[8:11], s3 offen offset:1024 lds
    buffer_load_dwordx4 v3, s[8:11], s3 offen offset:2048 lds
    buffer_load_dwordx4 v3, s[8:11], s3 offen offset:3072 lds
    s_waitcnt vmcnt(8)
    s_barrier
    s_add_u32 m0, s30, 81920
    s_add_u32 s3, s32, 1605632
    buffer_load_dwordx4 v8, s[12:15], s3 offen offset:0 lds
    buffer_load_dwordx4 v9, s[12:15], s3 offen offset:1024 lds
    buffer_load_dwordx4 v10, s[12:15], s3 offen offset:2048 lds
    buffer_load_dwordx4 v11, s[12:15], s3 offen offset:3072 lds
    s_add_u32 m0, s30, 65536
    s_add_u32 s3, s31, 28672
    buffer_load_dwordx4 v3, s[8:11], s3 offen offset:0 lds
    buffer_load_dwordx4 v3, s[8:11], s3 offen offset:1024 lds
    buffer_load_dwordx4 v3, s[8:11], s3 offen offset:2048 lds
    buffer_load_dwordx4 v3, s[8:11], s3 offen offset:3072 lds
    s_waitcnt vmcnt(8)
    s_barrier
    s_waitcnt vmcnt(0)
    s_barrier
    s_endpgm
ffn1_kernel_cw:
    s_lshr_b32 s27, s26, 1
    s_and_b32 s28, s26, 1
    s_mov_b32 s29, 0x3f803f80
    s_load_dwordx2 s[16:17], s[0:1], 64
    s_load_dwordx2 s[40:41], s[0:1], 64
    s_lshl_b32 s3, s27, 13
    v_add_u32 v16, s3, v3
    v_bfe_u32 v12, v2, 2, 2
    v_lshrrev_b32 v13, 5, v2
    v_lshlrev_b32 v13, 2, v13
    v_add_u32 v13, v13, v12
    v_mul_u32_u24 v13, 256, v13
    v_bfe_u32 v14, v2, 4, 1
    v_lshlrev_b32 v14, 5, v14
    v_and_b32 v15, 3, v2
    v_lshlrev_b32 v15, 3, v15
    v_add3_u32 v13, v13, v14, v15
    v_add_u32 v13, 16384, v13
    s_lshl_b32 s3, s28, 1
    s_add_u32 s3, s3, 0
    v_xor_b32 v14, s3, v12
    v_lshlrev_b32 v14, 6, v14
    v_add_u32 v20, v13, v14
    s_lshl_b32 s3, s28, 1
    s_add_u32 s3, s3, 1
    v_xor_b32 v14, s3, v12
    v_lshlrev_b32 v14, 6, v14
    v_add_u32 v21, v13, v14
    v_add_u32 v4, 0x10000, v16
    v_add_u32 v10, 0x20000, v16
    v_add_u32 v8, 0x10000, v20
    v_add_u32 v14, 0x20000, v20
    v_add_u32 v9, 0x10000, v21
    v_add_u32 v15, 0x20000, v21
    s_waitcnt lgkmcnt(0)
    s_add_u32 s16, s16, 0xa00000
    s_addc_u32 s17, s17, 0
    s_mov_b32 s18, 0x700000
    s_mov_b32 s19, 0x00020000
    s_add_u32 s40, s40, 0x1200000
    s_addc_u32 s41, s41, 0
    s_mov_b32 s42, 0x200000
    s_mov_b32 s43, 0x00020000
    s_lshl_b32 s37, s24, 2
    s_lshl_b32 s38, s27, 1
    s_add_u32 s37, s37, s38
    s_lshl_b32 s37, s37, 12
    v_and_b32 v22, 31, v2
    v_lshrrev_b32 v1, 5, v2
    v_lshlrev_b32 v23, 2, v22
    v_lshlrev_b32 v22, 3, v22
    v_lshl_add_u32 v22, v1, 11, v22
    s_lshl_b32 s38, s25, 9
    s_lshl_b32 s39, s28, 8
    s_add_u32 s38, s38, s39
    s_add_u32 s38, s38, 1048576
    buffer_load_dwordx2 v[160:161], v22, s[40:43], s37 offen offset:0
    buffer_load_dwordx2 v[162:163], v22, s[40:43], s37 offen offset:256
    buffer_load_dwordx2 v[164:165], v22, s[40:43], s37 offen offset:512
    buffer_load_dwordx2 v[166:167], v22, s[40:43], s37 offen offset:768
    buffer_load_dwordx2 v[168:169], v22, s[40:43], s37 offen offset:1024
    buffer_load_dwordx2 v[170:171], v22, s[40:43], s37 offen offset:1280
    buffer_load_dwordx2 v[172:173], v22, s[40:43], s37 offen offset:1536
    buffer_load_dwordx2 v[174:175], v22, s[40:43], s37 offen offset:1792
    s_add_u32 s37, s37, 4096
    buffer_load_dwordx2 v[176:177], v22, s[40:43], s37 offen offset:0
    buffer_load_dwordx2 v[178:179], v22, s[40:43], s37 offen offset:256
    buffer_load_dwordx2 v[180:181], v22, s[40:43], s37 offen offset:512
    buffer_load_dwordx2 v[182:183], v22, s[40:43], s37 offen offset:768
    buffer_load_dwordx2 v[184:185], v22, s[40:43], s37 offen offset:1024
    buffer_load_dwordx2 v[186:187], v22, s[40:43], s37 offen offset:1280
    buffer_load_dwordx2 v[188:189], v22, s[40:43], s37 offen offset:1536
    buffer_load_dwordx2 v[190:191], v22, s[40:43], s37 offen offset:1792
    buffer_load_dword v132, v23, s[40:43], s38 offen offset:0
    buffer_load_dword v133, v23, s[40:43], s38 offen offset:128
    v_mov_b32 v64, 0
    v_mov_b32 v65, 0
    v_mov_b32 v66, 0
    v_mov_b32 v67, 0
    v_mov_b32 v68, 0
    v_mov_b32 v69, 0
    v_mov_b32 v70, 0
    v_mov_b32 v71, 0
    v_mov_b32 v72, 0
    v_mov_b32 v73, 0
    v_mov_b32 v74, 0
    v_mov_b32 v75, 0
    v_mov_b32 v76, 0
    v_mov_b32 v77, 0
    v_mov_b32 v78, 0
    v_mov_b32 v79, 0
    v_mov_b32 v80, 0
    v_mov_b32 v81, 0
    v_mov_b32 v82, 0
    v_mov_b32 v83, 0
    v_mov_b32 v84, 0
    v_mov_b32 v85, 0
    v_mov_b32 v86, 0
    v_mov_b32 v87, 0
    v_mov_b32 v88, 0
    v_mov_b32 v89, 0
    v_mov_b32 v90, 0
    v_mov_b32 v91, 0
    v_mov_b32 v92, 0
    v_mov_b32 v93, 0
    v_mov_b32 v94, 0
    v_mov_b32 v95, 0
    v_mov_b32 v96, 0
    v_mov_b32 v97, 0
    v_mov_b32 v98, 0
    v_mov_b32 v99, 0
    v_mov_b32 v100, 0
    v_mov_b32 v101, 0
    v_mov_b32 v102, 0
    v_mov_b32 v103, 0
    v_mov_b32 v104, 0
    v_mov_b32 v105, 0
    v_mov_b32 v106, 0
    v_mov_b32 v107, 0
    v_mov_b32 v108, 0
    v_mov_b32 v109, 0
    v_mov_b32 v110, 0
    v_mov_b32 v111, 0
    v_mov_b32 v112, 0
    v_mov_b32 v113, 0
    v_mov_b32 v114, 0
    v_mov_b32 v115, 0
    v_mov_b32 v116, 0
    v_mov_b32 v117, 0
    v_mov_b32 v118, 0
    v_mov_b32 v119, 0
    v_mov_b32 v120, 0
    v_mov_b32 v121, 0
    v_mov_b32 v122, 0
    v_mov_b32 v123, 0
    v_mov_b32 v124, 0
    v_mov_b32 v125, 0
    v_mov_b32 v126, 0
    v_mov_b32 v127, 0
    s_waitcnt vmcnt(0)
    v_add_f32 v160, v160, v162
    v_add_f32 v161, v161, v163
    v_add_f32 v160, v160, v164
    v_add_f32 v161, v161, v165
    v_add_f32 v160, v160, v166
    v_add_f32 v161, v161, v167
    v_add_f32 v160, v160, v168
    v_add_f32 v161, v161, v169
    v_add_f32 v160, v160, v170
    v_add_f32 v161, v161, v171
    v_add_f32 v160, v160, v172
    v_add_f32 v161, v161, v173
    v_add_f32 v160, v160, v174
    v_add_f32 v161, v161, v175
    v_mov_b32 v128, v160
    v_mov_b32 v130, v161
    v_add_f32 v176, v176, v178
    v_add_f32 v177, v177, v179
    v_add_f32 v176, v176, v180
    v_add_f32 v177, v177, v181
    v_add_f32 v176, v176, v182
    v_add_f32 v177, v177, v183
    v_add_f32 v176, v176, v184
    v_add_f32 v177, v177, v185
    v_add_f32 v176, v176, v186
    v_add_f32 v177, v177, v187
    v_add_f32 v176, v176, v188
    v_add_f32 v177, v177, v189
    v_add_f32 v176, v176, v190
    v_add_f32 v177, v177, v191
    v_mov_b32 v129, v176
    v_mov_b32 v131, v177
    v_mul_f32 v132, 0.5, v132
    v_mul_f32 v133, 0.5, v133
    v_mov_b32 v144, v128
    s_nop 1
    v_permlane32_swap_b32 v128, v144
    s_nop 1
    v_add_f32 v128, v128, v144
    v_mov_b32 v144, v130
    s_nop 1
    v_permlane32_swap_b32 v130, v144
    s_nop 1
    v_add_f32 v130, v130, v144
    v_mul_f32 v128, 0xbb000000, v128
    v_mul_f32 v130, 0x3b000000, v130
    v_fma_f32 v130, -v128, v128, v130
    v_add_f32 v130, 0x3727c5ac, v130
    v_rsq_f32 v130, v130
    v_cvt_pk_bf16_f32 v32, v128, v128
    v_and_b32 v144, 0xffff0000, v32
    v_sub_f32 v144, v128, v144
    v_cvt_pk_bf16_f32 v33, v144, v144
    v_mov_b32 v34, 0
    v_mov_b32 v35, 0
    v_mov_b32 v144, v129
    s_nop 1
    v_permlane32_swap_b32 v129, v144
    s_nop 1
    v_add_f32 v129, v129, v144
    v_mov_b32 v144, v131
    s_nop 1
    v_permlane32_swap_b32 v131, v144
    s_nop 1
    v_add_f32 v131, v131, v144
    v_mul_f32 v129, 0xbb000000, v129
    v_mul_f32 v131, 0x3b000000, v131
    v_fma_f32 v131, -v129, v129, v131
    v_add_f32 v131, 0x3727c5ac, v131
    v_rsq_f32 v131, v131
    v_cvt_pk_bf16_f32 v36, v129, v129
    v_and_b32 v144, 0xffff0000, v36
    v_sub_f32 v144, v129, v144
    v_cvt_pk_bf16_f32 v37, v144, v144
    v_mov_b32 v38, 0
    v_mov_b32 v39, 0
    v_cvt_pk_bf16_f32 v48, v132, v132
    v_and_b32 v144, 0xffff0000, v48
    v_sub_f32 v144, v132, v144
    v_cvt_pk_bf16_f32 v48, v132, v144
    v_mov_b32 v49, v48
    v_mov_b32 v50, 0
    v_mov_b32 v51, 0
    v_cvt_pk_bf16_f32 v52, v133, v133
    v_and_b32 v144, 0xffff0000, v52
    v_sub_f32 v144, v133, v144
    v_cvt_pk_bf16_f32 v52, v133, v144
    v_mov_b32 v53, v52
    v_mov_b32 v54, 0
    v_mov_b32 v55, 0
    s_nop 1
    v_mfma_f32_32x32x16_bf16 v[64:79], v[48:51], v[32:35], v[64:79]
    v_mfma_f32_32x32x16_bf16 v[80:95], v[52:55], v[32:35], v[80:95]
    v_mfma_f32_32x32x16_bf16 v[96:111], v[48:51], v[36:39], v[96:111]
    v_mfma_f32_32x32x16_bf16 v[112:127], v[52:55], v[36:39], v[112:127]
    s_barrier
    ds_read_b128 v[32:35], v16 offset:0
    ds_read_b128 v[36:39], v16 offset:4096
    ds_read_b64_tr_b16 v[48:49], v20 offset:0
    ds_read_b64_tr_b16 v[50:51], v20 offset:2048
    ds_read_b64_tr_b16 v[52:53], v21 offset:0
    ds_read_b64_tr_b16 v[54:55], v21 offset:2048
    ds_read_b128 v[40:43], v16 offset:1024
    ds_read_b128 v[44:47], v16 offset:5120
    ds_read_b64_tr_b16 v[56:57], v20 offset:4096
    ds_read_b64_tr_b16 v[58:59], v20 offset:6144
    ds_read_b64_tr_b16 v[60:61], v21 offset:4096
    ds_read_b64_tr_b16 v[62:63], v21 offset:6144
    s_waitcnt lgkmcnt(6)
    v_mfma_f32_32x32x16_bf16 v[64:79], v[48:51], v[32:35], v[64:79]
    ds_read_b128 v[196:199], v16 offset:2048
    ds_read_b128 v[200:203], v16 offset:6144
    v_mfma_f32_32x32x16_bf16 v[80:95], v[52:55], v[32:35], v[80:95]
    ds_read_b64_tr_b16 v[204:205], v20 offset:8192
    ds_read_b64_tr_b16 v[206:207], v20 offset:10240
    v_mfma_f32_32x32x16_bf16 v[96:111], v[48:51], v[36:39], v[96:111]
    ds_read_b64_tr_b16 v[208:209], v21 offset:8192
    ds_read_b64_tr_b16 v[210:211], v21 offset:10240
    v_mfma_f32_32x32x16_bf16 v[112:127], v[52:55], v[36:39], v[112:127]
    s_waitcnt lgkmcnt(6)
    v_mfma_f32_32x32x16_bf16 v[64:79], v[56:59], v[40:43], v[64:79]
    ds_read_b128 v[32:35], v16 offset:3072
    ds_read_b128 v[36:39], v16 offset:7168
    v_mfma_f32_32x32x16_bf16 v[80:95], v[60:63], v[40:43], v[80:95]
    ds_read_b64_tr_b16 v[48:49], v20 offset:12288
    ds_read_b64_tr_b16 v[50:51], v20 offset:14336
    v_mfma_f32_32x32x16_bf16 v[96:111], v[56:59], v[44:47], v[96:111]
    ds_read_b64_tr_b16 v[52:53], v21 offset:12288
    ds_read_b64_tr_b16 v[54:55], v21 offset:14336
    v_mfma_f32_32x32x16_bf16 v[112:127], v[60:63], v[44:47], v[112:127]
    s_waitcnt lgkmcnt(6)
    v_mfma_f32_32x32x16_bf16 v[64:79], v[204:207], v[196:199], v[64:79]
    s_barrier
    ds_read_b128 v[40:43], v16 offset:32768
    ds_read_b128 v[44:47], v16 offset:36864
    v_mfma_f32_32x32x16_bf16 v[80:95], v[208:211], v[196:199], v[80:95]
    ds_read_b64_tr_b16 v[56:57], v20 offset:32768
    ds_read_b64_tr_b16 v[58:59], v20 offset:34816
    v_mfma_f32_32x32x16_bf16 v[96:111], v[204:207], v[200:203], v[96:111]
    ds_read_b64_tr_b16 v[60:61], v21 offset:32768
    ds_read_b64_tr_b16 v[62:63], v21 offset:34816
    v_mfma_f32_32x32x16_bf16 v[112:127], v[208:211], v[200:203], v[112:127]
    s_waitcnt lgkmcnt(6)
    v_mfma_f32_32x32x16_bf16 v[64:79], v[48:51], v[32:35], v[64:79]
    ds_read_b128 v[196:199], v16 offset:33792
    ds_read_b128 v[200:203], v16 offset:37888
    v_mfma_f32_32x32x16_bf16 v[80:95], v[52:55], v[32:35], v[80:95]
    ds_read_b64_tr_b16 v[204:205], v20 offset:36864
    ds_read_b64_tr_b16 v[206:207], v20 offset:38912
    v_mfma_f32_32x32x16_bf16 v[96:111], v[48:51], v[36:39], v[96:111]
    ds_read_b64_tr_b16 v[208:209], v21 offset:36864
    ds_read_b64_tr_b16 v[210:211], v21 offset:38912
    v_mfma_f32_32x32x16_bf16 v[112:127], v[52:55], v[36:39], v[112:127]
    s_waitcnt lgkmcnt(6)
    v_mfma_f32_32x32x16_bf16 v[64:79], v[56:59], v[40:43], v[64:79]
    ds_read_b128 v[32:35], v16 offset:34816
    ds_read_b128 v[36:39], v16 offset:38912
    v_mfma_f32_32x32x16_bf16 v[80:95], v[60:63], v[40:43], v[80:95]
    ds_read_b64_tr_b16 v[48:49], v20 offset:40960
    ds_read_b64_tr_b16 v[50:51], v20 offset:43008
    v_mfma_f32_32x32x16_bf16 v[96:111], v[56:59], v[44:47], v[96:111]
    ds_read_b64_tr_b16 v[52:53], v21 offset:40960
    ds_read_b64_tr_b16 v[54:55], v21 offset:43008
    v_mfma_f32_32x32x16_bf16 v[112:127], v[60:63], v[44:47], v[112:127]
    s_waitcnt lgkmcnt(6)
    v_mfma_f32_32x32x16_bf16 v[64:79], v[204:207], v[196:199], v[64:79]
    ds_read_b128 v[40:43], v16 offset:35840
    ds_read_b128 v[44:47], v16 offset:39936
    v_mfma_f32_32x32x16_bf16 v[80:95], v[208:211], v[196:199], v[80:95]
    ds_read_b64_tr_b16 v[56:57], v20 offset:45056
    ds_read_b64_tr_b16 v[58:59], v20 offset:47104
    v_mfma_f32_32x32x16_bf16 v[96:111], v[204:207], v[200:203], v[96:111]
    ds_read_b64_tr_b16 v[60:61], v21 offset:45056
    ds_read_b64_tr_b16 v[62:63], v21 offset:47104
    v_mfma_f32_32x32x16_bf16 v[112:127], v[208:211], v[200:203], v[112:127]
    s_waitcnt lgkmcnt(6)
    v_mfma_f32_32x32x16_bf16 v[64:79], v[48:51], v[32:35], v[64:79]
    s_barrier
    ds_read_b128 v[196:199], v4 offset:0
    ds_read_b128 v[200:203], v4 offset:4096
    v_mfma_f32_32x32x16_bf16 v[80:95], v[52:55], v[32:35], v[80:95]
    ds_read_b64_tr_b16 v[204:205], v8 offset:0
    ds_read_b64_tr_b16 v[206:207], v8 offset:2048
    v_mfma_f32_32x32x16_bf16 v[96:111], v[48:51], v[36:39], v[96:111]
    ds_read_b64_tr_b16 v[208:209], v9 offset:0
    ds_read_b64_tr_b16 v[210:211], v9 offset:2048
    v_mfma_f32_32x32x16_bf16 v[112:127], v[52:55], v[36:39], v[112:127]
    s_waitcnt lgkmcnt(6)
    v_mfma_f32_32x32x16_bf16 v[64:79], v[56:59], v[40:43], v[64:79]
    ds_read_b128 v[32:35], v4 offset:1024
    ds_read_b128 v[36:39], v4 offset:5120
    v_mfma_f32_32x32x16_bf16 v[80:95], v[60:63], v[40:43], v[80:95]
    ds_read_b64_tr_b16 v[48:49], v8 offset:4096
    ds_read_b64_tr_b16 v[50:51], v8 offset:6144
    v_mfma_f32_32x32x16_bf16 v[96:111], v[56:59], v[44:47], v[96:111]
    ds_read_b64_tr_b16 v[52:53], v9 offset:4096
    ds_read_b64_tr_b16 v[54:55], v9 offset:6144
    v_mfma_f32_32x32x16_bf16 v[112:127], v[60:63], v[44:47], v[112:127]
    s_waitcnt lgkmcnt(6)
    v_mfma_f32_32x32x16_bf16 v[64:79], v[204:207], v[196:199], v[64:79]
    ds_read_b128 v[40:43], v4 offset:2048
    ds_read_b128 v[44:47], v4 offset:6144
    v_mfma_f32_32x32x16_bf16 v[80:95], v[208:211], v[196:199], v[80:95]
    ds_read_b64_tr_b16 v[56:57], v8 offset:8192
    ds_read_b64_tr_b16 v[58:59], v8 offset:10240
    v_mfma_f32_32x32x16_bf16 v[96:111], v[204:207], v[200:203], v[96:111]
    ds_read_b64_tr_b16 v[60:61], v9 offset:8192
    ds_read_b64_tr_b16 v[62:63], v9 offset:10240
    v_mfma_f32_32x32x16_bf16 v[112:127], v[208:211], v[200:203], v[112:127]
    s_waitcnt lgkmcnt(6)
    v_mfma_f32_32x32x16_bf16 v[64:79], v[48:51], v[32:35], v[64:79]
    ds_read_b128 v[196:199], v4 offset:3072
    ds_read_b128 v[200:203], v4 offset:7168
    v_mfma_f32_32x32x16_bf16 v[80:95], v[52:55], v[32:35], v[80:95]
    ds_read_b64_tr_b16 v[204:205], v8 offset:12288
    ds_read_b64_tr_b16 v[206:207], v8 offset:14336
    v_mfma_f32_32x32x16_bf16 v[96:111], v[48:51], v[36:39], v[96:111]
    ds_read_b64_tr_b16 v[208:209], v9 offset:12288
    ds_read_b64_tr_b16 v[210:211], v9 offset:14336
    v_mfma_f32_32x32x16_bf16 v[112:127], v[52:55], v[36:39], v[112:127]
    s_waitcnt lgkmcnt(6)
    v_mfma_f32_32x32x16_bf16 v[64:79], v[56:59], v[40:43], v[64:79]
    s_barrier
    ds_read_b128 v[32:35], v4 offset:32768
    ds_read_b128 v[36:39], v4 offset:36864
    v_mfma_f32_32x32x16_bf16 v[80:95], v[60:63], v[40:43], v[80:95]
    ds_read_b64_tr_b16 v[48:49], v8 offset:32768
    ds_read_b64_tr_b16 v[50:51], v8 offset:34816
    v_mfma_f32_32x32x16_bf16 v[96:111], v[56:59], v[44:47], v[96:111]
    ds_read_b64_tr_b16 v[52:53], v9 offset:32768
    ds_read_b64_tr_b16 v[54:55], v9 offset:34816
    v_mfma_f32_32x32x16_bf16 v[112:127], v[60:63], v[44:47], v[112:127]
    s_waitcnt lgkmcnt(6)
    v_mfma_f32_32x32x16_bf16 v[64:79], v[204:207], v[196:199], v[64:79]
    ds_read_b128 v[40:43], v4 offset:33792
    ds_read_b128 v[44:47], v4 offset:37888
    v_mfma_f32_32x32x16_bf16 v[80:95], v[208:211], v[196:199], v[80:95]
    ds_read_b64_tr_b16 v[56:57], v8 offset:36864
    ds_read_b64_tr_b16 v[58:59], v8 offset:38912
    v_mfma_f32_32x32x16_bf16 v[96:111], v[204:207], v[200:203], v[96:111]
    ds_read_b64_tr_b16 v[60:61], v9 offset:36864
    ds_read_b64_tr_b16 v[62:63], v9 offset:38912
    v_mfma_f32_32x32x16_bf16 v[112:127], v[208:211], v[200:203], v[112:127]
    s_waitcnt lgkmcnt(6)
    v_mfma_f32_32x32x16_bf16 v[64:79], v[48:51], v[32:35], v[64:79]
    ds_read_b128 v[196:199], v4 offset:34816
    ds_read_b128 v[200:203], v4 offset:38912
    v_mfma_f32_32x32x16_bf16 v[80:95], v[52:55], v[32:35], v[80:95]
    ds_read_b64_tr_b16 v[204:205], v8 offset:40960
    ds_read_b64_tr_b16 v[206:207], v8 offset:43008
    v_mfma_f32_32x32x16_bf16 v[96:111], v[48:51], v[36:39], v[96:111]
    ds_read_b64_tr_b16 v[208:209], v9 offset:40960
    ds_read_b64_tr_b16 v[210:211], v9 offset:43008
    v_mfma_f32_32x32x16_bf16 v[112:127], v[52:55], v[36:39], v[112:127]
    s_waitcnt lgkmcnt(6)
    v_mfma_f32_32x32x16_bf16 v[64:79], v[56:59], v[40:43], v[64:79]
    ds_read_b128 v[32:35], v4 offset:35840
    ds_read_b128 v[36:39], v4 offset:39936
    v_mfma_f32_32x32x16_bf16 v[80:95], v[60:63], v[40:43], v[80:95]
    ds_read_b64_tr_b16 v[48:49], v8 offset:45056
    ds_read_b64_tr_b16 v[50:51], v8 offset:47104
    v_mfma_f32_32x32x16_bf16 v[96:111], v[56:59], v[44:47], v[96:111]
    ds_read_b64_tr_b16 v[52:53], v9 offset:45056
    ds_read_b64_tr_b16 v[54:55], v9 offset:47104
    v_mfma_f32_32x32x16_bf16 v[112:127], v[60:63], v[44:47], v[112:127]
    s_waitcnt lgkmcnt(6)
    v_mfma_f32_32x32x16_bf16 v[64:79], v[204:207], v[196:199], v[64:79]
    s_barrier
    ds_read_b128 v[40:43], v10 offset:0
    ds_read_b128 v[44:47], v10 offset:4096
    v_mfma_f32_32x32x16_bf16 v[80:95], v[208:211], v[196:199], v[80:95]
    ds_read_b64_tr_b16 v[56:57], v14 offset:0
    ds_read_b64_tr_b16 v[58:59], v14 offset:2048
    v_mfma_f32_32x32x16_bf16 v[96:111], v[204:207], v[200:203], v[96:111]
    ds_read_b64_tr_b16 v[60:61], v15 offset:0
    ds_read_b64_tr_b16 v[62:63], v15 offset:2048
    v_mfma_f32_32x32x16_bf16 v[112:127], v[208:211], v[200:203], v[112:127]
    s_waitcnt lgkmcnt(6)
    v_mfma_f32_32x32x16_bf16 v[64:79], v[48:51], v[32:35], v[64:79]
    ds_read_b128 v[196:199], v10 offset:1024
    ds_read_b128 v[200:203], v10 offset:5120
    v_mfma_f32_32x32x16_bf16 v[80:95], v[52:55], v[32:35], v[80:95]
    ds_read_b64_tr_b16 v[204:205], v14 offset:4096
    ds_read_b64_tr_b16 v[206:207], v14 offset:6144
    v_mfma_f32_32x32x16_bf16 v[96:111], v[48:51], v[36:39], v[96:111]
    ds_read_b64_tr_b16 v[208:209], v15 offset:4096
    ds_read_b64_tr_b16 v[210:211], v15 offset:6144
    v_mfma_f32_32x32x16_bf16 v[112:127], v[52:55], v[36:39], v[112:127]
    s_waitcnt lgkmcnt(6)
    v_mfma_f32_32x32x16_bf16 v[64:79], v[56:59], v[40:43], v[64:79]
    ds_read_b128 v[32:35], v10 offset:2048
    ds_read_b128 v[36:39], v10 offset:6144
    v_mfma_f32_32x32x16_bf16 v[80:95], v[60:63], v[40:43], v[80:95]
    ds_read_b64_tr_b16 v[48:49], v14 offset:8192
    ds_read_b64_tr_b16 v[50:51], v14 offset:10240
    v_mfma_f32_32x32x16_bf16 v[96:111], v[56:59], v[44:47], v[96:111]
    ds_read_b64_tr_b16 v[52:53], v15 offset:8192
    ds_read_b64_tr_b16 v[54:55], v15 offset:10240
    v_mfma_f32_32x32x16_bf16 v[112:127], v[60:63], v[44:47], v[112:127]
    s_waitcnt lgkmcnt(6)
    v_mfma_f32_32x32x16_bf16 v[64:79], v[204:207], v[196:199], v[64:79]
    ds_read_b128 v[40:43], v10 offset:3072
    ds_read_b128 v[44:47], v10 offset:7168
    v_mfma_f32_32x32x16_bf16 v[80:95], v[208:211], v[196:199], v[80:95]
    ds_read_b64_tr_b16 v[56:57], v14 offset:12288
    ds_read_b64_tr_b16 v[58:59], v14 offset:14336
    v_mfma_f32_32x32x16_bf16 v[96:111], v[204:207], v[200:203], v[96:111]
    ds_read_b64_tr_b16 v[60:61], v15 offset:12288
    ds_read_b64_tr_b16 v[62:63], v15 offset:14336
    v_mfma_f32_32x32x16_bf16 v[112:127], v[208:211], v[200:203], v[112:127]
    s_waitcnt lgkmcnt(6)
    v_mfma_f32_32x32x16_bf16 v[64:79], v[48:51], v[32:35], v[64:79]
    s_barrier
    ds_read_b128 v[196:199], v16 offset:0
    ds_read_b128 v[200:203], v16 offset:4096
    v_mfma_f32_32x32x16_bf16 v[80:95], v[52:55], v[32:35], v[80:95]
    ds_read_b64_tr_b16 v[204:205], v20 offset:0
    ds_read_b64_tr_b16 v[206:207], v20 offset:2048
    v_mfma_f32_32x32x16_bf16 v[96:111], v[48:51], v[36:39], v[96:111]
    ds_read_b64_tr_b16 v[208:209], v21 offset:0
    ds_read_b64_tr_b16 v[210:211], v21 offset:2048
    v_mfma_f32_32x32x16_bf16 v[112:127], v[52:55], v[36:39], v[112:127]
    s_waitcnt lgkmcnt(6)
    v_mfma_f32_32x32x16_bf16 v[64:79], v[56:59], v[40:43], v[64:79]
    ds_read_b128 v[32:35], v16 offset:1024
    ds_read_b128 v[36:39], v16 offset:5120
    v_mfma_f32_32x32x16_bf16 v[80:95], v[60:63], v[40:43], v[80:95]
    ds_read_b64_tr_b16 v[48:49], v20 offset:4096
    ds_read_b64_tr_b16 v[50:51], v20 offset:6144
    v_mfma_f32_32x32x16_bf16 v[96:111], v[56:59], v[44:47], v[96:111]
    ds_read_b64_tr_b16 v[52:53], v21 offset:4096
    ds_read_b64_tr_b16 v[54:55], v21 offset:6144
    v_mfma_f32_32x32x16_bf16 v[112:127], v[60:63], v[44:47], v[112:127]
    s_waitcnt lgkmcnt(6)
    v_mfma_f32_32x32x16_bf16 v[64:79], v[204:207], v[196:199], v[64:79]
    ds_read_b128 v[40:43], v16 offset:2048
    ds_read_b128 v[44:47], v16 offset:6144
    v_mfma_f32_32x32x16_bf16 v[80:95], v[208:211], v[196:199], v[80:95]
    ds_read_b64_tr_b16 v[56:57], v20 offset:8192
    ds_read_b64_tr_b16 v[58:59], v20 offset:10240
    v_mfma_f32_32x32x16_bf16 v[96:111], v[204:207], v[200:203], v[96:111]
    ds_read_b64_tr_b16 v[60:61], v21 offset:8192
    ds_read_b64_tr_b16 v[62:63], v21 offset:10240
    v_mfma_f32_32x32x16_bf16 v[112:127], v[208:211], v[200:203], v[112:127]
    s_waitcnt lgkmcnt(6)
    v_mfma_f32_32x32x16_bf16 v[64:79], v[48:51], v[32:35], v[64:79]
    ds_read_b128 v[196:199], v16 offset:3072
    ds_read_b128 v[200:203], v16 offset:7168
    v_mfma_f32_32x32x16_bf16 v[80:95], v[52:55], v[32:35], v[80:95]
    ds_read_b64_tr_b16 v[204:205], v20 offset:12288
    ds_read_b64_tr_b16 v[206:207], v20 offset:14336
    v_mfma_f32_32x32x16_bf16 v[96:111], v[48:51], v[36:39], v[96:111]
    ds_read_b64_tr_b16 v[208:209], v21 offset:12288
    ds_read_b64_tr_b16 v[210:211], v21 offset:14336
    v_mfma_f32_32x32x16_bf16 v[112:127], v[52:55], v[36:39], v[112:127]
    s_waitcnt lgkmcnt(6)
    v_mfma_f32_32x32x16_bf16 v[64:79], v[56:59], v[40:43], v[64:79]
    s_barrier
    ds_read_b128 v[32:35], v16 offset:32768
    ds_read_b128 v[36:39], v16 offset:36864
    v_mfma_f32_32x32x16_bf16 v[80:95], v[60:63], v[40:43], v[80:95]
    ds_read_b64_tr_b16 v[48:49], v20 offset:32768
    ds_read_b64_tr_b16 v[50:51], v20 offset:34816
    v_mfma_f32_32x32x16_bf16 v[96:111], v[56:59], v[44:47], v[96:111]
    ds_read_b64_tr_b16 v[52:53], v21 offset:32768
    ds_read_b64_tr_b16 v[54:55], v21 offset:34816
    v_mfma_f32_32x32x16_bf16 v[112:127], v[60:63], v[44:47], v[112:127]
    s_waitcnt lgkmcnt(6)
    v_mfma_f32_32x32x16_bf16 v[64:79], v[204:207], v[196:199], v[64:79]
    ds_read_b128 v[40:43], v16 offset:33792
    ds_read_b128 v[44:47], v16 offset:37888
    v_mfma_f32_32x32x16_bf16 v[80:95], v[208:211], v[196:199], v[80:95]
    ds_read_b64_tr_b16 v[56:57], v20 offset:36864
    ds_read_b64_tr_b16 v[58:59], v20 offset:38912
    v_mfma_f32_32x32x16_bf16 v[96:111], v[204:207], v[200:203], v[96:111]
    ds_read_b64_tr_b16 v[60:61], v21 offset:36864
    ds_read_b64_tr_b16 v[62:63], v21 offset:38912
    v_mfma_f32_32x32x16_bf16 v[112:127], v[208:211], v[200:203], v[112:127]
    s_waitcnt lgkmcnt(6)
    v_mfma_f32_32x32x16_bf16 v[64:79], v[48:51], v[32:35], v[64:79]
    ds_read_b128 v[196:199], v16 offset:34816
    ds_read_b128 v[200:203], v16 offset:38912
    v_mfma_f32_32x32x16_bf16 v[80:95], v[52:55], v[32:35], v[80:95]
    ds_read_b64_tr_b16 v[204:205], v20 offset:40960
    ds_read_b64_tr_b16 v[206:207], v20 offset:43008
    v_mfma_f32_32x32x16_bf16 v[96:111], v[48:51], v[36:39], v[96:111]
    ds_read_b64_tr_b16 v[208:209], v21 offset:40960
    ds_read_b64_tr_b16 v[210:211], v21 offset:43008
    v_mfma_f32_32x32x16_bf16 v[112:127], v[52:55], v[36:39], v[112:127]
    s_waitcnt lgkmcnt(6)
    v_mfma_f32_32x32x16_bf16 v[64:79], v[56:59], v[40:43], v[64:79]
    ds_read_b128 v[32:35], v16 offset:35840
    ds_read_b128 v[36:39], v16 offset:39936
    v_mfma_f32_32x32x16_bf16 v[80:95], v[60:63], v[40:43], v[80:95]
    ds_read_b64_tr_b16 v[48:49], v20 offset:45056
    ds_read_b64_tr_b16 v[50:51], v20 offset:47104
    v_mfma_f32_32x32x16_bf16 v[96:111], v[56:59], v[44:47], v[96:111]
    ds_read_b64_tr_b16 v[52:53], v21 offset:45056
    ds_read_b64_tr_b16 v[54:55], v21 offset:47104
    v_mfma_f32_32x32x16_bf16 v[112:127], v[60:63], v[44:47], v[112:127]
    s_waitcnt lgkmcnt(6)
    v_mfma_f32_32x32x16_bf16 v[64:79], v[204:207], v[196:199], v[64:79]
    s_barrier
    ds_read_b128 v[40:43], v4 offset:0
    ds_read_b128 v[44:47], v4 offset:4096
    v_mfma_f32_32x32x16_bf16 v[80:95], v[208:211], v[196:199], v[80:95]
    ds_read_b64_tr_b16 v[56:57], v8 offset:0
    ds_read_b64_tr_b16 v[58:59], v8 offset:2048
    v_mfma_f32_32x32x16_bf16 v[96:111], v[204:207], v[200:203], v[96:111]
    ds_read_b64_tr_b16 v[60:61], v9 offset:0
    ds_read_b64_tr_b16 v[62:63], v9 offset:2048
    v_mfma_f32_32x32x16_bf16 v[112:127], v[208:211], v[200:203], v[112:127]
    s_waitcnt lgkmcnt(6)
    v_mfma_f32_32x32x16_bf16 v[64:79], v[48:51], v[32:35], v[64:79]
    ds_read_b128 v[196:199], v4 offset:1024
    ds_read_b128 v[200:203], v4 offset:5120
    v_mfma_f32_32x32x16_bf16 v[80:95], v[52:55], v[32:35], v[80:95]
    ds_read_b64_tr_b16 v[204:205], v8 offset:4096
    ds_read_b64_tr_b16 v[206:207], v8 offset:6144
    v_mfma_f32_32x32x16_bf16 v[96:111], v[48:51], v[36:39], v[96:111]
    ds_read_b64_tr_b16 v[208:209], v9 offset:4096
    ds_read_b64_tr_b16 v[210:211], v9 offset:6144
    v_mfma_f32_32x32x16_bf16 v[112:127], v[52:55], v[36:39], v[112:127]
    s_waitcnt lgkmcnt(6)
    v_mfma_f32_32x32x16_bf16 v[64:79], v[56:59], v[40:43], v[64:79]
    ds_read_b128 v[32:35], v4 offset:2048
    ds_read_b128 v[36:39], v4 offset:6144
    v_mfma_f32_32x32x16_bf16 v[80:95], v[60:63], v[40:43], v[80:95]
    ds_read_b64_tr_b16 v[48:49], v8 offset:8192
    ds_read_b64_tr_b16 v[50:51], v8 offset:10240
    v_mfma_f32_32x32x16_bf16 v[96:111], v[56:59], v[44:47], v[96:111]
    ds_read_b64_tr_b16 v[52:53], v9 offset:8192
    ds_read_b64_tr_b16 v[54:55], v9 offset:10240
    v_mfma_f32_32x32x16_bf16 v[112:127], v[60:63], v[44:47], v[112:127]
    s_waitcnt lgkmcnt(6)
    v_mfma_f32_32x32x16_bf16 v[64:79], v[204:207], v[196:199], v[64:79]
    ds_read_b128 v[40:43], v4 offset:3072
    ds_read_b128 v[44:47], v4 offset:7168
    v_mfma_f32_32x32x16_bf16 v[80:95], v[208:211], v[196:199], v[80:95]
    ds_read_b64_tr_b16 v[56:57], v8 offset:12288
    ds_read_b64_tr_b16 v[58:59], v8 offset:14336
    v_mfma_f32_32x32x16_bf16 v[96:111], v[204:207], v[200:203], v[96:111]
    ds_read_b64_tr_b16 v[60:61], v9 offset:12288
    ds_read_b64_tr_b16 v[62:63], v9 offset:14336
    v_mfma_f32_32x32x16_bf16 v[112:127], v[208:211], v[200:203], v[112:127]
    s_waitcnt lgkmcnt(6)
    v_mfma_f32_32x32x16_bf16 v[64:79], v[48:51], v[32:35], v[64:79]
    v_mfma_f32_32x32x16_bf16 v[80:95], v[52:55], v[32:35], v[80:95]
    v_mfma_f32_32x32x16_bf16 v[96:111], v[48:51], v[36:39], v[96:111]
    v_mfma_f32_32x32x16_bf16 v[112:127], v[52:55], v[36:39], v[112:127]
    s_waitcnt lgkmcnt(0)
    v_mfma_f32_32x32x16_bf16 v[64:79], v[56:59], v[40:43], v[64:79]
    v_mfma_f32_32x32x16_bf16 v[80:95], v[60:63], v[40:43], v[80:95]
    v_mfma_f32_32x32x16_bf16 v[96:111], v[56:59], v[44:47], v[96:111]
    v_mfma_f32_32x32x16_bf16 v[112:127], v[60:63], v[44:47], v[112:127]
    s_lshl_b32 s34, s24, 2
    s_lshl_b32 s35, s27, 1
    s_add_u32 s34, s34, s35
    s_mul_i32 s33, s34, 114688
    s_lshl_b32 s34, s25, 3
    s_lshl_b32 s35, s28, 2
    s_add_u32 s34, s34, s35
    s_lshl_b32 s34, s34, 10
    s_add_u32 s33, s33, s34
    v_mul_f32 v144, 0xbfb8aa3b, v130
    v_rcp_f32 v128, v130
    s_nop 7
    v_pk_mul_f32 v[32:33], v[64:65], v[144:145] op_sel_hi:[1,0]
    v_pk_mul_f32 v[34:35], v[66:67], v[144:145] op_sel_hi:[1,0]
    v_pk_mul_f32 v[36:37], v[68:69], v[144:145] op_sel_hi:[1,0]
    v_pk_mul_f32 v[38:39], v[70:71], v[144:145] op_sel_hi:[1,0]
    v_exp_f32 v32, v32
    v_exp_f32 v33, v33
    v_exp_f32 v34, v34
    v_exp_f32 v35, v35
    v_exp_f32 v36, v36
    v_exp_f32 v37, v37
    v_exp_f32 v38, v38
    v_exp_f32 v39, v39
    v_pk_fma_f32 v[32:33], v[32:33], v[128:129], v[128:129] op_sel:[0,0,0] op_sel_hi:[1,0,0]
    v_pk_fma_f32 v[34:35], v[34:35], v[128:129], v[128:129] op_sel:[0,0,0] op_sel_hi:[1,0,0]
    v_pk_fma_f32 v[36:37], v[36:37], v[128:129], v[128:129] op_sel:[0,0,0] op_sel_hi:[1,0,0]
    v_pk_fma_f32 v[38:39], v[38:39], v[128:129], v[128:129] op_sel:[0,0,0] op_sel_hi:[1,0,0]
    v_rcp_f32 v32, v32
    v_rcp_f32 v33, v33
    v_rcp_f32 v34, v34
    v_rcp_f32 v35, v35
    v_rcp_f32 v36, v36
    v_rcp_f32 v37, v37
    v_rcp_f32 v38, v38
    v_rcp_f32 v39, v39
    v_pk_mul_f32 v[64:65], v[64:65], v[32:33]
    v_pk_mul_f32 v[66:67], v[66:67], v[34:35]
    v_pk_mul_f32 v[68:69], v[68:69], v[36:37]
    v_pk_mul_f32 v[70:71], v[70:71], v[38:39]
    v_cvt_pk_bf16_f32 v148, v64, v65
    v_cvt_pk_bf16_f32 v149, v66, v67
    v_cvt_pk_bf16_f32 v150, v68, v69
    v_cvt_pk_bf16_f32 v151, v70, v71
    s_add_u32 s3, s33, 0
    buffer_store_dwordx4 v[148:151], v3, s[16:19], s3 offen sc0 sc1
    v_pk_mul_f32 v[32:33], v[72:73], v[144:145] op_sel_hi:[1,0]
    v_pk_mul_f32 v[34:35], v[74:75], v[144:145] op_sel_hi:[1,0]
    v_pk_mul_f32 v[36:37], v[76:77], v[144:145] op_sel_hi:[1,0]
    v_pk_mul_f32 v[38:39], v[78:79], v[144:145] op_sel_hi:[1,0]
    v_exp_f32 v32, v32
    v_exp_f32 v33, v33
    v_exp_f32 v34, v34
    v_exp_f32 v35, v35
    v_exp_f32 v36, v36
    v_exp_f32 v37, v37
    v_exp_f32 v38, v38
    v_exp_f32 v39, v39
    v_pk_fma_f32 v[32:33], v[32:33], v[128:129], v[128:129] op_sel:[0,0,0] op_sel_hi:[1,0,0]
    v_pk_fma_f32 v[34:35], v[34:35], v[128:129], v[128:129] op_sel:[0,0,0] op_sel_hi:[1,0,0]
    v_pk_fma_f32 v[36:37], v[36:37], v[128:129], v[128:129] op_sel:[0,0,0] op_sel_hi:[1,0,0]
    v_pk_fma_f32 v[38:39], v[38:39], v[128:129], v[128:129] op_sel:[0,0,0] op_sel_hi:[1,0,0]
    v_rcp_f32 v32, v32
    v_rcp_f32 v33, v33
    v_rcp_f32 v34, v34
    v_rcp_f32 v35, v35
    v_rcp_f32 v36, v36
    v_rcp_f32 v37, v37
    v_rcp_f32 v38, v38
    v_rcp_f32 v39, v39
    v_pk_mul_f32 v[72:73], v[72:73], v[32:33]
    v_pk_mul_f32 v[74:75], v[74:75], v[34:35]
    v_pk_mul_f32 v[76:77], v[76:77], v[36:37]
    v_pk_mul_f32 v[78:79], v[78:79], v[38:39]
    v_cvt_pk_bf16_f32 v152, v72, v73
    v_cvt_pk_bf16_f32 v153, v74, v75
    v_cvt_pk_bf16_f32 v154, v76, v77
    v_cvt_pk_bf16_f32 v155, v78, v79
    s_add_u32 s3, s33, 1024
    buffer_store_dwordx4 v[152:155], v3, s[16:19], s3 offen sc0 sc1
    v_pk_mul_f32 v[32:33], v[80:81], v[144:145] op_sel_hi:[1,0]
    v_pk_mul_f32 v[34:35], v[82:83], v[144:145] op_sel_hi:[1,0]
    v_pk_mul_f32 v[36:37], v[84:85], v[144:145] op_sel_hi:[1,0]
    v_pk_mul_f32 v[38:39], v[86:87], v[144:145] op_sel_hi:[1,0]
    v_exp_f32 v32, v32
    v_exp_f32 v33, v33
    v_exp_f32 v34, v34
    v_exp_f32 v35, v35
    v_exp_f32 v36, v36
    v_exp_f32 v37, v37
    v_exp_f32 v38, v38
    v_exp_f32 v39, v39
    v_pk_fma_f32 v[32:33], v[32:33], v[128:129], v[128:129] op_sel:[0,0,0] op_sel_hi:[1,0,0]
    v_pk_fma_f32 v[34:35], v[34:35], v[128:129], v[128:129] op_sel:[0,0,0] op_sel_hi:[1,0,0]
    v_pk_fma_f32 v[36:37], v[36:37], v[128:129], v[128:129] op_sel:[0,0,0] op_sel_hi:[1,0,0]
    v_pk_fma_f32 v[38:39], v[38:39], v[128:129], v[128:129] op_sel:[0,0,0] op_sel_hi:[1,0,0]
    v_rcp_f32 v32, v32
    v_rcp_f32 v33, v33
    v_rcp_f32 v34, v34
    v_rcp_f32 v35, v35
    v_rcp_f32 v36, v36
    v_rcp_f32 v37, v37
    v_rcp_f32 v38, v38
    v_rcp_f32 v39, v39
    v_pk_mul_f32 v[80:81], v[80:81], v[32:33]
    v_pk_mul_f32 v[82:83], v[82:83], v[34:35]
    v_pk_mul_f32 v[84:85], v[84:85], v[36:37]
    v_pk_mul_f32 v[86:87], v[86:87], v[38:39]
    v_cvt_pk_bf16_f32 v156, v80, v81
    v_cvt_pk_bf16_f32 v157, v82, v83
    v_cvt_pk_bf16_f32 v158, v84, v85
    v_cvt_pk_bf16_f32 v159, v86, v87
    s_add_u32 s3, s33, 2048
    buffer_store_dwordx4 v[156:159], v3, s[16:19], s3 offen sc0 sc1
    v_pk_mul_f32 v[32:33], v[88:89], v[144:145] op_sel_hi:[1,0]
    v_pk_mul_f32 v[34:35], v[90:91], v[144:145] op_sel_hi:[1,0]
    v_pk_mul_f32 v[36:37], v[92:93], v[144:145] op_sel_hi:[1,0]
    v_pk_mul_f32 v[38:39], v[94:95], v[144:145] op_sel_hi:[1,0]
    v_exp_f32 v32, v32
    v_exp_f32 v33, v33
    v_exp_f32 v34, v34
    v_exp_f32 v35, v35
    v_exp_f32 v36, v36
    v_exp_f32 v37, v37
    v_exp_f32 v38, v38
    v_exp_f32 v39, v39
    v_pk_fma_f32 v[32:33], v[32:33], v[128:129], v[128:129] op_sel:[0,0,0] op_sel_hi:[1,0,0]
    v_pk_fma_f32 v[34:35], v[34:35], v[128:129], v[128:129] op_sel:[0,0,0] op_sel_hi:[1,0,0]
    v_pk_fma_f32 v[36:37], v[36:37], v[128:129], v[128:129] op_sel:[0,0,0] op_sel_hi:[1,0,0]
    v_pk_fma_f32 v[38:39], v[38:39], v[128:129], v[128:129] op_sel:[0,0,0] op_sel_hi:[1,0,0]
    v_rcp_f32 v32, v32
    v_rcp_f32 v33, v33
    v_rcp_f32 v34, v34
    v_rcp_f32 v35, v35
    v_rcp_f32 v36, v36
    v_rcp_f32 v37, v37
    v_rcp_f32 v38, v38
    v_rcp_f32 v39, v39
    v_pk_mul_f32 v[88:89], v[88:89], v[32:33]
    v_pk_mul_f32 v[90:91], v[90:91], v[34:35]
    v_pk_mul_f32 v[92:93], v[92:93], v[36:37]
    v_pk_mul_f32 v[94:95], v[94:95], v[38:39]
    v_cvt_pk_bf16_f32 v148, v88, v89
    v_cvt_pk_bf16_f32 v149, v90, v91
    v_cvt_pk_bf16_f32 v150, v92, v93
    v_cvt_pk_bf16_f32 v151, v94, v95
    s_add_u32 s3, s33, 3072
    buffer_store_dwordx4 v[148:151], v3, s[16:19], s3 offen sc0 sc1
    v_mul_f32 v144, 0xbfb8aa3b, v131
    v_rcp_f32 v129, v131
    v_pk_mul_f32 v[32:33], v[96:97], v[144:145] op_sel_hi:[1,0]
    v_pk_mul_f32 v[34:35], v[98:99], v[144:145] op_sel_hi:[1,0]
    v_pk_mul_f32 v[36:37], v[100:101], v[144:145] op_sel_hi:[1,0]
    v_pk_mul_f32 v[38:39], v[102:103], v[144:145] op_sel_hi:[1,0]
    v_exp_f32 v32, v32
    v_exp_f32 v33, v33
    v_exp_f32 v34, v34
    v_exp_f32 v35, v35
    v_exp_f32 v36, v36
    v_exp_f32 v37, v37
    v_exp_f32 v38, v38
    v_exp_f32 v39, v39
    v_pk_fma_f32 v[32:33], v[32:33], v[128:129], v[128:129] op_sel:[0,1,1] op_sel_hi:[1,1,1]
    v_pk_fma_f32 v[34:35], v[34:35], v[128:129], v[128:129] op_sel:[0,1,1] op_sel_hi:[1,1,1]
    v_pk_fma_f32 v[36:37], v[36:37], v[128:129], v[128:129] op_sel:[0,1,1] op_sel_hi:[1,1,1]
    v_pk_fma_f32 v[38:39], v[38:39], v[128:129], v[128:129] op_sel:[0,1,1] op_sel_hi:[1,1,1]
    v_rcp_f32 v32, v32
    v_rcp_f32 v33, v33
    v_rcp_f32 v34, v34
    v_rcp_f32 v35, v35
    v_rcp_f32 v36, v36
    v_rcp_f32 v37, v37
    v_rcp_f32 v38, v38
    v_rcp_f32 v39, v39
    v_pk_mul_f32 v[96:97], v[96:97], v[32:33]
    v_pk_mul_f32 v[98:99], v[98:99], v[34:35]
    v_pk_mul_f32 v[100:101], v[100:101], v[36:37]
    v_pk_mul_f32 v[102:103], v[102:103], v[38:39]
    v_cvt_pk_bf16_f32 v152, v96, v97
    v_cvt_pk_bf16_f32 v153, v98, v99
    v_cvt_pk_bf16_f32 v154, v100, v101
    v_cvt_pk_bf16_f32 v155, v102, v103
    s_add_u32 s3, s33, 114688
    buffer_store_dwordx4 v[152:155], v3, s[16:19], s3 offen sc0 sc1
    v_pk_mul_f32 v[32:33], v[104:105], v[144:145] op_sel_hi:[1,0]
    v_pk_mul_f32 v[34:35], v[106:107], v[144:145] op_sel_hi:[1,0]
    v_pk_mul_f32 v[36:37], v[108:109], v[144:145] op_sel_hi:[1,0]
    v_pk_mul_f32 v[38:39], v[110:111], v[144:145] op_sel_hi:[1,0]
    v_exp_f32 v32, v32
    v_exp_f32 v33, v33
    v_exp_f32 v34, v34
    v_exp_f32 v35, v35
    v_exp_f32 v36, v36
    v_exp_f32 v37, v37
    v_exp_f32 v38, v38
    v_exp_f32 v39, v39
    v_pk_fma_f32 v[32:33], v[32:33], v[128:129], v[128:129] op_sel:[0,1,1] op_sel_hi:[1,1,1]
    v_pk_fma_f32 v[34:35], v[34:35], v[128:129], v[128:129] op_sel:[0,1,1] op_sel_hi:[1,1,1]
    v_pk_fma_f32 v[36:37], v[36:37], v[128:129], v[128:129] op_sel:[0,1,1] op_sel_hi:[1,1,1]
    v_pk_fma_f32 v[38:39], v[38:39], v[128:129], v[128:129] op_sel:[0,1,1] op_sel_hi:[1,1,1]
    v_rcp_f32 v32, v32
    v_rcp_f32 v33, v33
    v_rcp_f32 v34, v34
    v_rcp_f32 v35, v35
    v_rcp_f32 v36, v36
    v_rcp_f32 v37, v37
    v_rcp_f32 v38, v38
    v_rcp_f32 v39, v39
    v_pk_mul_f32 v[104:105], v[104:105], v[32:33]
    v_pk_mul_f32 v[106:107], v[106:107], v[34:35]
    v_pk_mul_f32 v[108:109], v[108:109], v[36:37]
    v_pk_mul_f32 v[110:111], v[110:111], v[38:39]
    v_cvt_pk_bf16_f32 v156, v104, v105
    v_cvt_pk_bf16_f32 v157, v106, v107
    v_cvt_pk_bf16_f32 v158, v108, v109
    v_cvt_pk_bf16_f32 v159, v110, v111
    s_add_u32 s3, s33, 115712
    buffer_store_dwordx4 v[156:159], v3, s[16:19], s3 offen sc0 sc1
    v_pk_mul_f32 v[32:33], v[112:113], v[144:145] op_sel_hi:[1,0]
    v_pk_mul_f32 v[34:35], v[114:115], v[144:145] op_sel_hi:[1,0]
    v_pk_mul_f32 v[36:37], v[116:117], v[144:145] op_sel_hi:[1,0]
    v_pk_mul_f32 v[38:39], v[118:119], v[144:145] op_sel_hi:[1,0]
    v_exp_f32 v32, v32
    v_exp_f32 v33, v33
    v_exp_f32 v34, v34
    v_exp_f32 v35, v35
    v_exp_f32 v36, v36
    v_exp_f32 v37, v37
    v_exp_f32 v38, v38
    v_exp_f32 v39, v39
    v_pk_fma_f32 v[32:33], v[32:33], v[128:129], v[128:129] op_sel:[0,1,1] op_sel_hi:[1,1,1]
    v_pk_fma_f32 v[34:35], v[34:35], v[128:129], v[128:129] op_sel:[0,1,1] op_sel_hi:[1,1,1]
    v_pk_fma_f32 v[36:37], v[36:37], v[128:129], v[128:129] op_sel:[0,1,1] op_sel_hi:[1,1,1]
    v_pk_fma_f32 v[38:39], v[38:39], v[128:129], v[128:129] op_sel:[0,1,1] op_sel_hi:[1,1,1]
    v_rcp_f32 v32, v32
    v_rcp_f32 v33, v33
    v_rcp_f32 v34, v34
    v_rcp_f32 v35, v35
    v_rcp_f32 v36, v36
    v_rcp_f32 v37, v37
    v_rcp_f32 v38, v38
    v_rcp_f32 v39, v39
    v_pk_mul_f32 v[112:113], v[112:113], v[32:33]
    v_pk_mul_f32 v[114:115], v[114:115], v[34:35]
    v_pk_mul_f32 v[116:117], v[116:117], v[36:37]
    v_pk_mul_f32 v[118:119], v[118:119], v[38:39]
    v_cvt_pk_bf16_f32 v148, v112, v113
    v_cvt_pk_bf16_f32 v149, v114, v115
    v_cvt_pk_bf16_f32 v150, v116, v117
    v_cvt_pk_bf16_f32 v151, v118, v119
    s_add_u32 s3, s33, 116736
    buffer_store_dwordx4 v[148:151], v3, s[16:19], s3 offen sc0 sc1
    v_pk_mul_f32 v[32:33], v[120:121], v[144:145] op_sel_hi:[1,0]
    v_pk_mul_f32 v[34:35], v[122:123], v[144:145] op_sel_hi:[1,0]
    v_pk_mul_f32 v[36:37], v[124:125], v[144:145] op_sel_hi:[1,0]
    v_pk_mul_f32 v[38:39], v[126:127], v[144:145] op_sel_hi:[1,0]
    v_exp_f32 v32, v32
    v_exp_f32 v33, v33
    v_exp_f32 v34, v34
    v_exp_f32 v35, v35
    v_exp_f32 v36, v36
    v_exp_f32 v37, v37
    v_exp_f32 v38, v38
    v_exp_f32 v39, v39
    v_pk_fma_f32 v[32:33], v[32:33], v[128:129], v[128:129] op_sel:[0,1,1] op_sel_hi:[1,1,1]
    v_pk_fma_f32 v[34:35], v[34:35], v[128:129], v[128:129] op_sel:[0,1,1] op_sel_hi:[1,1,1]
    v_pk_fma_f32 v[36:37], v[36:37], v[128:129], v[128:129] op_sel:[0,1,1] op_sel_hi:[1,1,1]
    v_pk_fma_f32 v[38:39], v[38:39], v[128:129], v[128:129] op_sel:[0,1,1] op_sel_hi:[1,1,1]
    v_rcp_f32 v32, v32
    v_rcp_f32 v33, v33
    v_rcp_f32 v34, v34
    v_rcp_f32 v35, v35
    v_rcp_f32 v36, v36
    v_rcp_f32 v37, v37
    v_rcp_f32 v38, v38
    v_rcp_f32 v39, v39
    v_pk_mul_f32 v[120:121], v[120:121], v[32:33]
    v_pk_mul_f32 v[122:123], v[122:123], v[34:35]
    v_pk_mul_f32 v[124:125], v[124:125], v[36:37]
    v_pk_mul_f32 v[126:127], v[126:127], v[38:39]
    v_cvt_pk_bf16_f32 v152, v120, v121
    v_cvt_pk_bf16_f32 v153, v122, v123
    v_cvt_pk_bf16_f32 v154, v124, v125
    v_cvt_pk_bf16_f32 v155, v126, v127
    s_add_u32 s3, s33, 117760
    buffer_store_dwordx4 v[152:155], v3, s[16:19], s3 offen sc0 sc1
ffn1_kernel_fin:
ffn1_kernel_done:
    s_endpgm
.section .rodata,"a"
.p2align 6
.amdhsa_kernel ffn1_kernel
  .amdhsa_next_free_vgpr 212
  .amdhsa_next_free_sgpr 96
  .amdhsa_accum_offset 212
  .amdhsa_group_segment_fixed_size 0
  .amdhsa_kernarg_size 72
  .amdhsa_user_sgpr_count 2
  .amdhsa_user_sgpr_kernarg_segment_ptr 1
  .amdhsa_system_sgpr_workgroup_id_x 1
  .amdhsa_float_denorm_mode_32 3
.end_amdhsa_kernel
.text
.globl wo_a_kernel
.p2align 8
.type wo_a_kernel,@function
wo_a_kernel:
    s_cmp_ge_u32 s2, 256
    s_cbranch_scc1 wo_a_kernel_done
    s_load_dwordx2 s[8:9], s[0:1], 64
    s_load_dwordx2 s[12:13], s[0:1], 16
    v_lshrrev_b32 v1, 6, v0
    v_and_b32 v2, 63, v0
    s_and_b32 s3, s2, 7
    s_lshr_b32 s4, s2, 3
    v_readfirstlane_b32 s26, v1
    s_and_b32 s5, s3, 3
    s_lshr_b32 s3, s3, 2
    s_lshl_b32 s5, s5, 3
    s_and_b32 s24, s4, 7
    s_add_u32 s24, s24, s5
    s_lshr_b32 s4, s4, 3
    s_lshl_b32 s3, s3, 2
    s_add_u32 s25, s3, s4
    v_lshlrev_b32 v3, 4, v2
    s_cmp_lt_u32 s26, 4
    s_cbranch_scc1 wo_a_kernel_cw
    s_sub_u32 s26, s26, 4
    s_lshr_b32 s27, s26, 1
    s_and_b32 s28, s26, 1
    s_lshl_b32 s30, s26, 12
    v_lshrrev_b32 v12, 3, v2
    v_bfe_u32 v13, v2, 2, 1
    v_bfe_u32 v14, v2, 4, 1
    v_xor_b32 v13, v13, v14
    v_lshlrev_b32 v13, 6, v13
    v_and_b32 v14, 3, v2
    v_lshlrev_b32 v14, 4, v14
    v_mul_u32_u24 v12, 1024, v12
    v_add3_u32 v8, v12, v13, v14
    v_add_u32 v9, 7168, v8
    v_add_u32 v10, 14336, v8
    v_add_u32 v11, 21504, v8
    s_lshl_b32 s31, s24, 1
    s_add_u32 s31, s31, s27
    s_mul_i32 s31, s31, 32768
    s_lshl_b32 s3, s28, 12
    s_add_u32 s31, s31, s3
    s_mul_i32 s32, s26, 32768
    s_lshl_b32 s3, s25, 7
    s_add_u32 s32, s32, s3
    s_waitcnt lgkmcnt(0)
    s_add_u32 s8, s8, 0x800000
    s_addc_u32 s9, s9, 0
    s_mov_b32 s10, 0x200000
    s_mov_b32 s11, 0x00020000
    s_mov_b32 s14, 0x80000
    s_mov_b32 s15, 0x00020000
    s_add_u32 m0, s30, 16384
    s_add_u32 s3, s32, 0
    buffer_load_dwordx4 v8, s[12:15], s3 offen offset:0 lds
    buffer_load_dwordx4 v9, s[12:15], s3 offen offset:1024 lds
    buffer_load_dwordx4 v10, s[12:15], s3 offen offset:2048 lds
    buffer_load_dwordx4 v11, s[12:15], s3 offen offset:3072 lds
    s_add_u32 m0, s30, 0
    s_add_u32 s3, s31, 0
    buffer_load_dwordx4 v3, s[8:11], s3 offen offset:0 lds
    buffer_load_dwordx4 v3, s[8:11], s3 offen offset:1024 lds
    buffer_load_dwordx4 v3, s[8:11], s3 offen offset:2048 lds
    buffer_load_dwordx4 v3, s[8:11], s3 offen offset:3072 lds
    s_add_u32 m0, s30, 49152
    s_add_u32 s3, s32, 131072
    buffer_load_dwordx4 v8, s[12:15], s3 offen offset:0 lds
    buffer_load_dwordx4 v9, s[12:15], s3 offen offset:1024 lds
    buffer_load_dwordx4 v10, s[12:15], s3 offen offset:2048 lds
    buffer_load_dwordx4 v11, s[12:15], s3 offen offset:3072 lds
    s_add_u32 m0, s30, 32768
    s_add_u32 s3, s31, 8192
    buffer_load_dwordx4 v3, s[8:11], s3 offen offset:0 lds
    buffer_load_dwordx4 v3, s[8:11], s3 offen offset:1024 lds
    buffer_load_dwordx4 v3, s[8:11], s3 offen offset:2048 lds
    buffer_load_dwordx4 v3, s[8:11], s3 offen offset:3072 lds
    s_waitcnt vmcnt(8)
    s_barrier
    s_add_u32 m0, s30, 81920
    s_add_u32 s3, s32, 262144
    buffer_load_dwordx4 v8, s[12:15], s3 offen offset:0 lds
    buffer_load_dwordx4 v9, s[12:15], s3 offen offset:1024 lds
    buffer_load_dwordx4 v10, s[12:15], s3 offen offset:2048 lds
    buffer_load_dwordx4 v11, s[12:15], s3 offen offset:3072 lds
    s_add_u32 m0, s30, 65536
    s_add_u32 s3, s31, 16384
    buffer_load_dwordx4 v3, s[8:11], s3 offen offset:0 lds
    buffer_load_dwordx4 v3, s[8:11], s3 offen offset:1024 lds
    buffer_load_dwordx4 v3, s[8:11], s3 offen offset:2048 lds
    buffer_load_dwordx4 v3, s[8:11], s3 offen offset:3072 lds
    s_waitcnt vmcnt(8)
    s_barrier
    s_add_u32 m0, s30, 114688
    s_add_u32 s3, s32, 393216
    buffer_load_dwordx4 v8, s[12:15], s3 offen offset:0 lds
    buffer_load_dwordx4 v9, s[12:15], s3 offen offset:1024 lds
    buffer_load_dwordx4 v10, s[12:15], s3 offen offset:2048 lds
    buffer_load_dwordx4 v11, s[12:15], s3 offen offset:3072 lds
    s_add_u32 m0, s30, 98304
    s_add_u32 s3, s31, 24576
    buffer_load_dwordx4 v3, s[8:11], s3 offen offset:0 lds
    buffer_load_dwordx4 v3, s[8:11], s3 offen offset:1024 lds
    buffer_load_dwordx4 v3, s[8:11], s3 offen offset:2048 lds
    buffer_load_dwordx4 v3, s[8:11], s3 offen offset:3072 lds
    s_waitcnt vmcnt(8)
    s_barrier
    s_waitcnt vmcnt(0)
    s_barrier
    s_endpgm
wo_a_kernel_cw:
    s_lshr_b32 s27, s26, 1
    s_and_b32 s28, s26, 1
    s_mov_b32 s29, 0x3f803f80
    s_load_dwordx2 s[16:17], s[0:1], 64
    s_load_dwordx2 s[20:21], s[0:1], 0
    s_load_dwordx2 s[40:41], s[0:1], 64
    s_lshl_b32 s3, s27, 13
    v_add_u32 v16, s3, v3
    v_bfe_u32 v12, v2, 2, 2
    v_lshrrev_b32 v13, 5, v2
    v_lshlrev_b32 v13, 2, v13
    v_add_u32 v13, v13, v12
    v_mul_u32_u24 v13, 128, v13
    v_bfe_u32 v14, v2, 4, 1
    v_lshlrev_b32 v14, 5, v14
    v_and_b32 v15, 3, v2
    v_lshlrev_b32 v15, 3, v15
    v_add3_u32 v13, v13, v14, v15
    v_add_u32 v13, 16384, v13
    v_lshrrev_b32 v12, 1, v12
    v_xor_b32 v14, s28, v12
    v_lshlrev_b32 v14, 6, v14
    v_add_u32 v20, v13, v14
    v_add_u32 v4, 0x10000, v16
    v_add_u32 v10, 0x20000, v16
    v_add_u32 v8, 0x10000, v20
    v_add_u32 v14, 0x20000, v20
    s_waitcnt lgkmcnt(0)
    s_mov_b32 s18, 0x200000
    s_mov_b32 s19, 0x00020000
    s_mov_b32 s22, 0x200000
    s_mov_b32 s23, 0x00020000
    s_add_u32 s40, s40, 0x1200000
    s_addc_u32 s41, s41, 0
    s_mov_b32 s42, 0x200000
    s_mov_b32 s43, 0x00020000
    s_lshl_b32 s33, s24, 1
    s_add_u32 s33, s33, s27
    s_lshl_b32 s34, s25, 1
    s_add_u32 s34, s34, s28
    s_lshl_b32 s35, s33, 15
    s_lshl_b32 s36, s34, 6
    s_add_u32 s36, s36, s35
    s_lshl_b32 s37, s33, 12
    s_lshl_b32 s38, s34, 8
    s_add_u32 s37, s37, s38
    s_lshl_b32 s34, s34, 11
    s_add_u32 s33, s35, s34
    v_and_b32 v22, 31, v2
    v_lshlrev_b32 v23, 3, v22
    v_lshlrev_b32 v22, 10, v22
    v_lshrrev_b32 v1, 5, v2
    v_lshl_add_u32 v22, v1, 3, v22
    v_lshl_add_u32 v23, v1, 2, v23
    buffer_load_dwordx2 v[24:25], v22, s[20:23], s36 offen offset:0
    buffer_load_dwordx2 v[26:27], v22, s[20:23], s36 offen offset:16
    buffer_load_dwordx2 v[28:29], v22, s[20:23], s36 offen offset:32
    buffer_load_dwordx2 v[30:31], v22, s[20:23], s36 offen offset:48
    v_mov_b32 v64, 0
    v_mov_b32 v65, 0
    v_mov_b32 v66, 0
    v_mov_b32 v67, 0
    v_mov_b32 v68, 0
    v_mov_b32 v69, 0
    v_mov_b32 v70, 0
    v_mov_b32 v71, 0
    v_mov_b32 v72, 0
    v_mov_b32 v73, 0
    v_mov_b32 v74, 0
    v_mov_b32 v75, 0
    v_mov_b32 v76, 0
    v_mov_b32 v77, 0
    v_mov_b32 v78, 0
    v_mov_b32 v79, 0
    s_barrier
    ds_read_b128 v[32:35], v16 offset:0
    ds_read_b64_tr_b16 v[48:49], v20 offset:0
    ds_read_b64_tr_b16 v[50:51], v20 offset:1024
    ds_read_b128 v[36:39], v16 offset:1024
    ds_read_b64_tr_b16 v[52:53], v20 offset:2048
    ds_read_b64_tr_b16 v[54:55], v20 offset:3072
    ds_read_b128 v[40:43], v16 offset:2048
    ds_read_b64_tr_b16 v[56:57], v20 offset:4096
    ds_read_b64_tr_b16 v[58:59], v20 offset:5120
    s_waitcnt lgkmcnt(6)
    v_mfma_f32_32x32x16_bf16 v[64:79], v[48:51], v[32:35], v[64:79]
    ds_read_b128 v[44:47], v16 offset:3072
    ds_read_b64_tr_b16 v[60:61], v20 offset:6144
    ds_read_b64_tr_b16 v[62:63], v20 offset:7168
    s_waitcnt lgkmcnt(6)
    v_mfma_f32_32x32x16_bf16 v[64:79], v[52:55], v[36:39], v[64:79]
    ds_read_b128 v[32:35], v16 offset:4096
    ds_read_b64_tr_b16 v[48:49], v20 offset:8192
    ds_read_b64_tr_b16 v[50:51], v20 offset:9216
    s_waitcnt lgkmcnt(6)
    v_mfma_f32_32x32x16_bf16 v[64:79], v[56:59], v[40:43], v[64:79]
    ds_read_b128 v[36:39], v16 offset:5120
    ds_read_b64_tr_b16 v[52:53], v20 offset:10240
    ds_read_b64_tr_b16 v[54:55], v20 offset:11264
    s_waitcnt lgkmcnt(6)
    v_mfma_f32_32x32x16_bf16 v[64:79], v[60:63], v[44:47], v[64:79]
    ds_read_b128 v[40:43], v16 offset:6144
    ds_read_b64_tr_b16 v[56:57], v20 offset:12288
    ds_read_b64_tr_b16 v[58:59], v20 offset:13312
    s_waitcnt lgkmcnt(6)
    v_mfma_f32_32x32x16_bf16 v[64:79], v[48:51], v[32:35], v[64:79]
    ds_read_b128 v[44:47], v16 offset:7168
    ds_read_b64_tr_b16 v[60:61], v20 offset:14336
    ds_read_b64_tr_b16 v[62:63], v20 offset:15360
    s_waitcnt lgkmcnt(6)
    v_mfma_f32_32x32x16_bf16 v[64:79], v[52:55], v[36:39], v[64:79]
    s_barrier
    ds_read_b128 v[32:35], v16 offset:32768
    ds_read_b64_tr_b16 v[48:49], v20 offset:32768
    ds_read_b64_tr_b16 v[50:51], v20 offset:33792
    s_waitcnt lgkmcnt(6)
    v_mfma_f32_32x32x16_bf16 v[64:79], v[56:59], v[40:43], v[64:79]
    ds_read_b128 v[36:39], v16 offset:33792
    ds_read_b64_tr_b16 v[52:53], v20 offset:34816
    ds_read_b64_tr_b16 v[54:55], v20 offset:35840
    s_waitcnt lgkmcnt(6)
    v_mfma_f32_32x32x16_bf16 v[64:79], v[60:63], v[44:47], v[64:79]
    ds_read_b128 v[40:43], v16 offset:34816
    ds_read_b64_tr_b16 v[56:57], v20 offset:36864
    ds_read_b64_tr_b16 v[58:59], v20 offset:37888
    s_waitcnt lgkmcnt(6)
    v_mfma_f32_32x32x16_bf16 v[64:79], v[48:51], v[32:35], v[64:79]
    ds_read_b128 v[44:47], v16 offset:35840
    ds_read_b64_tr_b16 v[60:61], v20 offset:38912
    ds_read_b64_tr_b16 v[62:63], v20 offset:39936
    s_waitcnt lgkmcnt(6)
    v_mfma_f32_32x32x16_bf16 v[64:79], v[52:55], v[36:39], v[64:79]
    ds_read_b128 v[32:35], v16 offset:36864
    ds_read_b64_tr_b16 v[48:49], v20 offset:40960
    ds_read_b64_tr_b16 v[50:51], v20 offset:41984
    s_waitcnt lgkmcnt(6)
    v_mfma_f32_32x32x16_bf16 v[64:79], v[56:59], v[40:43], v[64:79]
    ds_read_b128 v[36:39], v16 offset:37888
    ds_read_b64_tr_b16 v[52:53], v20 offset:43008
    ds_read_b64_tr_b16 v[54:55], v20 offset:44032
    s_waitcnt lgkmcnt(6)
    v_mfma_f32_32x32x16_bf16 v[64:79], v[60:63], v[44:47], v[64:79]
    ds_read_b128 v[40:43], v16 offset:38912
    ds_read_b64_tr_b16 v[56:57], v20 offset:45056
    ds_read_b64_tr_b16 v[58:59], v20 offset:46080
    s_waitcnt lgkmcnt(6)
    v_mfma_f32_32x32x16_bf16 v[64:79], v[48:51], v[32:35], v[64:79]
    ds_read_b128 v[44:47], v16 offset:39936
    ds_read_b64_tr_b16 v[60:61], v20 offset:47104
    ds_read_b64_tr_b16 v[62:63], v20 offset:48128
    s_waitcnt lgkmcnt(6)
    v_mfma_f32_32x32x16_bf16 v[64:79], v[52:55], v[36:39], v[64:79]
    s_barrier
    ds_read_b128 v[32:35], v4 offset:0
    ds_read_b64_tr_b16 v[48:49], v8 offset:0
    ds_read_b64_tr_b16 v[50:51], v8 offset:1024
    s_waitcnt lgkmcnt(6)
    v_mfma_f32_32x32x16_bf16 v[64:79], v[56:59], v[40:43], v[64:79]
    ds_read_b128 v[36:39], v4 offset:1024
    ds_read_b64_tr_b16 v[52:53], v8 offset:2048
    ds_read_b64_tr_b16 v[54:55], v8 offset:3072
    s_waitcnt lgkmcnt(6)
    v_mfma_f32_32x32x16_bf16 v[64:79], v[60:63], v[44:47], v[64:79]
    ds_read_b128 v[40:43], v4 offset:2048
    ds_read_b64_tr_b16 v[56:57], v8 offset:4096
    ds_read_b64_tr_b16 v[58:59], v8 offset:5120
    s_waitcnt lgkmcnt(6)
    v_mfma_f32_32x32x16_bf16 v[64:79], v[48:51], v[32:35], v[64:79]
    ds_read_b128 v[44:47], v4 offset:3072
    ds_read_b64_tr_b16 v[60:61], v8 offset:6144
    ds_read_b64_tr_b16 v[62:63], v8 offset:7168
    s_waitcnt lgkmcnt(6)
    v_mfma_f32_32x32x16_bf16 v[64:79], v[52:55], v[36:39], v[64:79]
    ds_read_b128 v[32:35], v4 offset:4096
    ds_read_b64_tr_b16 v[48:49], v8 offset:8192
    ds_read_b64_tr_b16 v[50:51], v8 offset:9216
    s_waitcnt lgkmcnt(6)
    v_mfma_f32_32x32x16_bf16 v[64:79], v[56:59], v[40:43], v[64:79]
    ds_read_b128 v[36:39], v4 offset:5120
    ds_read_b64_tr_b16 v[52:53], v8 offset:10240
    ds_read_b64_tr_b16 v[54:55], v8 offset:11264
    s_waitcnt lgkmcnt(6)
    v_mfma_f32_32x32x16_bf16 v[64:79], v[60:63], v[44:47], v[64:79]
    ds_read_b128 v[40:43], v4 offset:6144
    ds_read_b64_tr_b16 v[56:57], v8 offset:12288
    ds_read_b64_tr_b16 v[58:59], v8 offset:13312
    s_waitcnt lgkmcnt(6)
    v_mfma_f32_32x32x16_bf16 v[64:79], v[48:51], v[32:35], v[64:79]
    ds_read_b128 v[44:47], v4 offset:7168
    ds_read_b64_tr_b16 v[60:61], v8 offset:14336
    ds_read_b64_tr_b16 v[62:63], v8 offset:15360
    s_waitcnt lgkmcnt(6)
    v_mfma_f32_32x32x16_bf16 v[64:79], v[52:55], v[36:39], v[64:79]
    s_barrier
    ds_read_b128 v[32:35], v4 offset:32768
    ds_read_b64_tr_b16 v[48:49], v8 offset:32768
    ds_read_b64_tr_b16 v[50:51], v8 offset:33792
    s_waitcnt lgkmcnt(6)
    v_mfma_f32_32x32x16_bf16 v[64:79], v[56:59], v[40:43], v[64:79]
    ds_read_b128 v[36:39], v4 offset:33792
    ds_read_b64_tr_b16 v[52:53], v8 offset:34816
    ds_read_b64_tr_b16 v[54:55], v8 offset:35840
    s_waitcnt lgkmcnt(6)
    v_mfma_f32_32x32x16_bf16 v[64:79], v[60:63], v[44:47], v[64:79]
    ds_read_b128 v[40:43], v4 offset:34816
    ds_read_b64_tr_b16 v[56:57], v8 offset:36864
    ds_read_b64_tr_b16 v[58:59], v8 offset:37888
    s_waitcnt lgkmcnt(6)
    v_mfma_f32_32x32x16_bf16 v[64:79], v[48:51], v[32:35], v[64:79]
    ds_read_b128 v[44:47], v4 offset:35840
    ds_read_b64_tr_b16 v[60:61], v8 offset:38912
    ds_read_b64_tr_b16 v[62:63], v8 offset:39936
    s_waitcnt lgkmcnt(6)
    v_mfma_f32_32x32x16_bf16 v[64:79], v[52:55], v[36:39], v[64:79]
    ds_read_b128 v[32:35], v4 offset:36864
    ds_read_b64_tr_b16 v[48:49], v8 offset:40960
    ds_read_b64_tr_b16 v[50:51], v8 offset:41984
    s_waitcnt lgkmcnt(6)
    v_mfma_f32_32x32x16_bf16 v[64:79], v[56:59], v[40:43], v[64:79]
    ds_read_b128 v[36:39], v4 offset:37888
    ds_read_b64_tr_b16 v[52:53], v8 offset:43008
    ds_read_b64_tr_b16 v[54:55], v8 offset:44032
    s_waitcnt lgkmcnt(6)
    v_mfma_f32_32x32x16_bf16 v[64:79], v[60:63], v[44:47], v[64:79]
    ds_read_b128 v[40:43], v4 offset:38912
    ds_read_b64_tr_b16 v[56:57], v8 offset:45056
    ds_read_b64_tr_b16 v[58:59], v8 offset:46080
    s_waitcnt lgkmcnt(6)
    v_mfma_f32_32x32x16_bf16 v[64:79], v[48:51], v[32:35], v[64:79]
    ds_read_b128 v[44:47], v4 offset:39936
    ds_read_b64_tr_b16 v[60:61], v8 offset:47104
    ds_read_b64_tr_b16 v[62:63], v8 offset:48128
    s_waitcnt lgkmcnt(6)
    v_mfma_f32_32x32x16_bf16 v[64:79], v[52:55], v[36:39], v[64:79]
    s_waitcnt lgkmcnt(3)
    v_mfma_f32_32x32x16_bf16 v[64:79], v[56:59], v[40:43], v[64:79]
    s_waitcnt lgkmcnt(0)
    v_mfma_f32_32x32x16_bf16 v[64:79], v[60:63], v[44:47], v[64:79]
    s_waitcnt vmcnt(0)
    s_nop 15
    v_lshlrev_b32 v144, 16, v24
    v_and_b32 v145, 0xffff0000, v24
    v_add_f32 v64, v64, v144
    v_add_f32 v65, v65, v145
    v_lshlrev_b32 v144, 16, v25
    v_and_b32 v145, 0xffff0000, v25
    v_add_f32 v66, v66, v144
    v_add_f32 v67, v67, v145
    v_lshlrev_b32 v144, 16, v26
    v_and_b32 v145, 0xffff0000, v26
    v_add_f32 v68, v68, v144
    v_add_f32 v69, v69, v145
    v_lshlrev_b32 v144, 16, v27
    v_and_b32 v145, 0xffff0000, v27
    v_add_f32 v70, v70, v144
    v_add_f32 v71, v71, v145
    v_lshlrev_b32 v144, 16, v28
    v_and_b32 v145, 0xffff0000, v28
    v_add_f32 v72, v72, v144
    v_add_f32 v73, v73, v145
    v_lshlrev_b32 v144, 16, v29
    v_and_b32 v145, 0xffff0000, v29
    v_add_f32 v74, v74, v144
    v_add_f32 v75, v75, v145
    v_lshlrev_b32 v144, 16, v30
    v_and_b32 v145, 0xffff0000, v30
    v_add_f32 v76, v76, v144
    v_add_f32 v77, v77, v145
    v_lshlrev_b32 v144, 16, v31
    v_and_b32 v145, 0xffff0000, v31
    v_add_f32 v78, v78, v144
    v_add_f32 v79, v79, v145
    v_cvt_pk_bf16_f32 v148, v64, v65
    v_cvt_pk_bf16_f32 v149, v66, v67
    v_cvt_pk_bf16_f32 v150, v68, v69
    v_cvt_pk_bf16_f32 v151, v70, v71
    v_cvt_pk_bf16_f32 v152, v72, v73
    v_cvt_pk_bf16_f32 v153, v74, v75
    v_cvt_pk_bf16_f32 v154, v76, v77
    v_cvt_pk_bf16_f32 v155, v78, v79
    buffer_store_dwordx4 v[148:151], v3, s[16:19], s33 offen offset:0 sc0 sc1
    buffer_store_dwordx4 v[152:155], v3, s[16:19], s33 offen offset:1024 sc0 sc1
    v_mov_b32 v128, 0
    v_mov_b32 v130, 0
    v_dot2_f32_bf16 v128, v148, s29, v128
    v_dot2_f32_bf16 v130, v148, v148, v130
    v_dot2_f32_bf16 v128, v149, s29, v128
    v_dot2_f32_bf16 v130, v149, v149, v130
    v_dot2_f32_bf16 v128, v150, s29, v128
    v_dot2_f32_bf16 v130, v150, v150, v130
    v_dot2_f32_bf16 v128, v151, s29, v128
    v_dot2_f32_bf16 v130, v151, v151, v130
    v_dot2_f32_bf16 v128, v152, s29, v128
    v_dot2_f32_bf16 v130, v152, v152, v130
    v_dot2_f32_bf16 v128, v153, s29, v128
    v_dot2_f32_bf16 v130, v153, v153, v130
    v_dot2_f32_bf16 v128, v154, s29, v128
    v_dot2_f32_bf16 v130, v154, v154, v130
    v_dot2_f32_bf16 v128, v155, s29, v128
    v_dot2_f32_bf16 v130, v155, v155, v130
    v_mov_b32 v144, v128
    s_nop 1
    v_permlane32_swap_b32 v128, v144
    s_nop 1
    v_add_f32 v128, v128, v144
    v_mov_b32 v144, v130
    s_nop 1
    v_permlane32_swap_b32 v130, v144
    s_nop 1
    v_add_f32 v130, v130, v144
    v_cmp_gt_u32 vcc, 32, v2
    s_nop 1
    v_cndmask_b32 v128, v130, v128, vcc
    buffer_store_dword v128, v23, s[40:43], s37 offen
wo_a_kernel_fin:
wo_a_kernel_done:
    s_endpgm
.section .rodata,"a"
.p2align 6
.amdhsa_kernel wo_a_kernel
  .amdhsa_next_free_vgpr 196
  .amdhsa_next_free_sgpr 96
  .amdhsa_accum_offset 196
  .amdhsa_group_segment_fixed_size 0
  .amdhsa_kernarg_size 72
  .amdhsa_user_sgpr_count 2
  .amdhsa_user_sgpr_kernarg_segment_ptr 1
  .amdhsa_system_sgpr_workgroup_id_x 1
  .amdhsa_float_denorm_mode_32 3
.end_amdhsa_kernel
.text
.globl wo_b_kernel
.p2align 8
.type wo_b_kernel,@function
wo_b_kernel:
    s_cmp_ge_u32 s2, 256
    s_cbranch_scc1 wo_b_kernel_done
    s_load_dwordx2 s[8:9], s[0:1], 64
    s_load_dwordx2 s[12:13], s[0:1], 16
    v_lshrrev_b32 v1, 6, v0
    v_and_b32 v2, 63, v0
    s_and_b32 s3, s2, 7
    s_lshr_b32 s4, s2, 3
    v_readfirstlane_b32 s26, v1
    s_and_b32 s5, s3, 3
    s_lshr_b32 s3, s3, 2
    s_lshl_b32 s5, s5, 3
    s_and_b32 s24, s4, 7
    s_add_u32 s24, s24, s5
    s_lshr_b32 s4, s4, 3
    s_lshl_b32 s3, s3, 2
    s_add_u32 s25, s3, s4
    v_lshlrev_b32 v3, 4, v2
    s_cmp_lt_u32 s26, 4
    s_cbranch_scc1 wo_b_kernel_cw
    s_sub_u32 s26, s26, 4
    s_lshr_b32 s27, s26, 1
    s_and_b32 s28, s26, 1
    s_lshl_b32 s30, s26, 12
    v_lshrrev_b32 v12, 3, v2
    v_bfe_u32 v13, v2, 2, 1
    v_bfe_u32 v14, v2, 4, 1
    v_xor_b32 v13, v13, v14
    v_lshlrev_b32 v13, 6, v13
    v_and_b32 v14, 3, v2
    v_lshlrev_b32 v14, 4, v14
    v_mul_u32_u24 v12, 1024, v12
    v_add3_u32 v8, v12, v13, v14
    v_add_u32 v9, 7168, v8
    v_add_u32 v10, 14336, v8
    v_add_u32 v11, 21504, v8
    s_lshl_b32 s31, s24, 1
    s_add_u32 s31, s31, s27
    s_mul_i32 s31, s31, 32768
    s_lshl_b32 s3, s28, 12
    s_add_u32 s31, s31, s3
    s_mul_i32 s32, s26, 32768
    s_lshl_b32 s3, s25, 7
    s_add_u32 s32, s32, s3
    s_waitcnt lgkmcnt(0)
    s_add_u32 s8, s8, 0x800000
    s_addc_u32 s9, s9, 0
    s_mov_b32 s10, 0x200000
    s_mov_b32 s11, 0x00020000
    s_mov_b32 s14, 0x80000
    s_mov_b32 s15, 0x00020000
    s_add_u32 m0, s30, 16384
    s_add_u32 s3, s32, 0
    buffer_load_dwordx4 v8, s[12:15], s3 offen offset:0 lds
    buffer_load_dwordx4 v9, s[12:15], s3 offen offset:1024 lds
    buffer_load_dwordx4 v10, s[12:15], s3 offen offset:2048 lds
    buffer_load_dwordx4 v11, s[12:15], s3 offen offset:3072 lds
    s_add_u32 m0, s30, 0
    s_add_u32 s3, s31, 0
    buffer_load_dwordx4 v3, s[8:11], s3 offen offset:0 lds
    buffer_load_dwordx4 v3, s[8:11], s3 offen offset:1024 lds
    buffer_load_dwordx4 v3, s[8:11], s3 offen offset:2048 lds
    buffer_load_dwordx4 v3, s[8:11], s3 offen offset:3072 lds
    s_add_u32 m0, s30, 49152
    s_add_u32 s3, s32, 131072
    buffer_load_dwordx4 v8, s[12:15], s3 offen offset:0 lds
    buffer_load_dwordx4 v9, s[12:15], s3 offen offset:1024 lds
    buffer_load_dwordx4 v10, s[12:15], s3 offen offset:2048 lds
    buffer_load_dwordx4 v11, s[12:15], s3 offen offset:3072 lds
    s_add_u32 m0, s30, 32768
    s_add_u32 s3, s31, 8192
    buffer_load_dwordx4 v3, s[8:11], s3 offen offset:0 lds
    buffer_load_dwordx4 v3, s[8:11], s3 offen offset:1024 lds
    buffer_load_dwordx4 v3, s[8:11], s3 offen offset:2048 lds
    buffer_load_dwordx4 v3, s[8:11], s3 offen offset:3072 lds
    s_waitcnt vmcnt(8)
    s_barrier
    s_add_u32 m0, s30, 81920
    s_add_u32 s3, s32, 262144
    buffer_load_dwordx4 v8, s[12:15], s3 offen offset:0 lds
    buffer_load_dwordx4 v9, s[12:15], s3 offen offset:1024 lds
    buffer_load_dwordx4 v10, s[12:15], s3 offen offset:2048 lds
    buffer_load_dwordx4 v11, s[12:15], s3 offen offset:3072 lds
    s_add_u32 m0, s30, 65536
    s_add_u32 s3, s31, 16384
    buffer_load_dwordx4 v3, s[8:11], s3 offen offset:0 lds
    buffer_load_dwordx4 v3, s[8:11], s3 offen offset:1024 lds
    buffer_load_dwordx4 v3, s[8:11], s3 offen offset:2048 lds
    buffer_load_dwordx4 v3, s[8:11], s3 offen offset:3072 lds
    s_waitcnt vmcnt(8)
    s_barrier
    s_add_u32 m0, s30, 114688
    s_add_u32 s3, s32, 393216
    buffer_load_dwordx4 v8, s[12:15], s3 offen offset:0 lds
    buffer_load_dwordx4 v9, s[12:15], s3 offen offset:1024 lds
    buffer_load_dwordx4 v10, s[12:15], s3 offen offset:2048 lds
    buffer_load_dwordx4 v11, s[12:15], s3 offen offset:3072 lds
    s_add_u32 m0, s30, 98304
    s_add_u32 s3, s31, 24576
    buffer_load_dwordx4 v3, s[8:11], s3 offen offset:0 lds
    buffer_load_dwordx4 v3, s[8:11], s3 offen offset:1024 lds
    buffer_load_dwordx4 v3, s[8:11], s3 offen offset:2048 lds
    buffer_load_dwordx4 v3, s[8:11], s3 offen offset:3072 lds
    s_waitcnt vmcnt(8)
    s_barrier
    s_waitcnt vmcnt(0)
    s_barrier
    s_endpgm
wo_b_kernel_cw:
    s_lshr_b32 s27, s26, 1
    s_and_b32 s28, s26, 1
    s_mov_b32 s29, 0x3f803f80
    s_load_dwordx2 s[16:17], s[0:1], 64
    s_load_dwordx2 s[20:21], s[0:1], 64
    s_load_dwordx2 s[40:41], s[0:1], 64
    s_lshl_b32 s3, s27, 13
    v_add_u32 v16, s3, v3
    v_bfe_u32 v12, v2, 2, 2
    v_lshrrev_b32 v13, 5, v2
    v_lshlrev_b32 v13, 2, v13
    v_add_u32 v13, v13, v12
    v_mul_u32_u24 v13, 128, v13
    v_bfe_u32 v14, v2, 4, 1
    v_lshlrev_b32 v14, 5, v14
    v_and_b32 v15, 3, v2
    v_lshlrev_b32 v15, 3, v15
    v_add3_u32 v13, v13, v14, v15
    v_add_u32 v13, 16384, v13
    v_lshrrev_b32 v12, 1, v12
    v_xor_b32 v14, s28, v12
    v_lshlrev_b32 v14, 6, v14
    v_add_u32 v20, v13, v14
    v_add_u32 v4, 0x10000, v16
    v_add_u32 v10, 0x20000, v16
    v_add_u32 v8, 0x10000, v20
    v_add_u32 v14, 0x20000, v20
    s_waitcnt lgkmcnt(0)
    s_mov_b32 s18, 0x200000
    s_mov_b32 s19, 0x00020000
    s_mov_b32 s22, 0x200000
    s_mov_b32 s23, 0x00020000
    s_add_u32 s40, s40, 0x1200000
    s_addc_u32 s41, s41, 0
    s_mov_b32 s42, 0x200000
    s_mov_b32 s43, 0x00020000
    s_lshl_b32 s33, s24, 1
    s_add_u32 s33, s33, s27
    s_lshl_b32 s34, s25, 1
    s_add_u32 s34, s34, s28
    s_lshl_b32 s35, s33, 15
    s_lshl_b32 s36, s34, 6
    s_add_u32 s36, s36, s35
    s_lshl_b32 s37, s33, 12
    s_lshl_b32 s38, s34, 8
    s_add_u32 s37, s37, s38
    s_lshl_b32 s34, s34, 11
    s_add_u32 s33, s35, s34
    v_and_b32 v22, 31, v2
    v_lshlrev_b32 v23, 3, v22
    v_lshlrev_b32 v22, 10, v22
    v_lshrrev_b32 v1, 5, v2
    v_lshl_add_u32 v22, v1, 3, v22
    v_lshl_add_u32 v23, v1, 2, v23
    buffer_load_dwordx4 v[24:27], v3, s[20:23], s33 offen offset:0
    buffer_load_dwordx4 v[28:31], v3, s[20:23], s33 offen offset:1024
    v_mov_b32 v64, 0
    v_mov_b32 v65, 0
    v_mov_b32 v66, 0
    v_mov_b32 v67, 0
    v_mov_b32 v68, 0
    v_mov_b32 v69, 0
    v_mov_b32 v70, 0
    v_mov_b32 v71, 0
    v_mov_b32 v72, 0
    v_mov_b32 v73, 0
    v_mov_b32 v74, 0
    v_mov_b32 v75, 0
    v_mov_b32 v76, 0
    v_mov_b32 v77, 0
    v_mov_b32 v78, 0
    v_mov_b32 v79, 0
    s_barrier
    ds_read_b128 v[32:35], v16 offset:0
    ds_read_b64_tr_b16 v[48:49], v20 offset:0
    ds_read_b64_tr_b16 v[50:51], v20 offset:1024
    ds_read_b128 v[36:39], v16 offset:1024
    ds_read_b64_tr_b16 v[52:53], v20 offset:2048
    ds_read_b64_tr_b16 v[54:55], v20 offset:3072
    ds_read_b128 v[40:43], v16 offset:2048
    ds_read_b64_tr_b16 v[56:57], v20 offset:4096
    ds_read_b64_tr_b16 v[58:59], v20 offset:5120
    s_waitcnt lgkmcnt(6)
    v_mfma_f32_32x32x16_bf16 v[64:79], v[48:51], v[32:35], v[64:79]
    ds_read_b128 v[44:47], v16 offset:3072
    ds_read_b64_tr_b16 v[60:61], v20 offset:6144
    ds_read_b64_tr_b16 v[62:63], v20 offset:7168
    s_waitcnt lgkmcnt(6)
    v_mfma_f32_32x32x16_bf16 v[64:79], v[52:55], v[36:39], v[64:79]
    ds_read_b128 v[32:35], v16 offset:4096
    ds_read_b64_tr_b16 v[48:49], v20 offset:8192
    ds_read_b64_tr_b16 v[50:51], v20 offset:9216
    s_waitcnt lgkmcnt(6)
    v_mfma_f32_32x32x16_bf16 v[64:79], v[56:59], v[40:43], v[64:79]
    ds_read_b128 v[36:39], v16 offset:5120
    ds_read_b64_tr_b16 v[52:53], v20 offset:10240
    ds_read_b64_tr_b16 v[54:55], v20 offset:11264
    s_waitcnt lgkmcnt(6)
    v_mfma_f32_32x32x16_bf16 v[64:79], v[60:63], v[44:47], v[64:79]
    ds_read_b128 v[40:43], v16 offset:6144
    ds_read_b64_tr_b16 v[56:57], v20 offset:12288
    ds_read_b64_tr_b16 v[58:59], v20 offset:13312
    s_waitcnt lgkmcnt(6)
    v_mfma_f32_32x32x16_bf16 v[64:79], v[48:51], v[32:35], v[64:79]
    ds_read_b128 v[44:47], v16 offset:7168
    ds_read_b64_tr_b16 v[60:61], v20 offset:14336
    ds_read_b64_tr_b16 v[62:63], v20 offset:15360
    s_waitcnt lgkmcnt(6)
    v_mfma_f32_32x32x16_bf16 v[64:79], v[52:55], v[36:39], v[64:79]
    s_barrier
    ds_read_b128 v[32:35], v16 offset:32768
    ds_read_b64_tr_b16 v[48:49], v20 offset:32768
    ds_read_b64_tr_b16 v[50:51], v20 offset:33792
    s_waitcnt lgkmcnt(6)
    v_mfma_f32_32x32x16_bf16 v[64:79], v[56:59], v[40:43], v[64:79]
    ds_read_b128 v[36:39], v16 offset:33792
    ds_read_b64_tr_b16 v[52:53], v20 offset:34816
    ds_read_b64_tr_b16 v[54:55], v20 offset:35840
    s_waitcnt lgkmcnt(6)
    v_mfma_f32_32x32x16_bf16 v[64:79], v[60:63], v[44:47], v[64:79]
    ds_read_b128 v[40:43], v16 offset:34816
    ds_read_b64_tr_b16 v[56:57], v20 offset:36864
    ds_read_b64_tr_b16 v[58:59], v20 offset:37888
    s_waitcnt lgkmcnt(6)
    v_mfma_f32_32x32x16_bf16 v[64:79], v[48:51], v[32:35], v[64:79]
    ds_read_b128 v[44:47], v16 offset:35840
    ds_read_b64_tr_b16 v[60:61], v20 offset:38912
    ds_read_b64_tr_b16 v[62:63], v20 offset:39936
    s_waitcnt lgkmcnt(6)
    v_mfma_f32_32x32x16_bf16 v[64:79], v[52:55], v[36:39], v[64:79]
    ds_read_b128 v[32:35], v16 offset:36864
    ds_read_b64_tr_b16 v[48:49], v20 offset:40960
    ds_read_b64_tr_b16 v[50:51], v20 offset:41984
    s_waitcnt lgkmcnt(6)
    v_mfma_f32_32x32x16_bf16 v[64:79], v[56:59], v[40:43], v[64:79]
    ds_read_b128 v[36:39], v16 offset:37888
    ds_read_b64_tr_b16 v[52:53], v20 offset:43008
    ds_read_b64_tr_b16 v[54:55], v20 offset:44032
    s_waitcnt lgkmcnt(6)
    v_mfma_f32_32x32x16_bf16 v[64:79], v[60:63], v[44:47], v[64:79]
    ds_read_b128 v[40:43], v16 offset:38912
    ds_read_b64_tr_b16 v[56:57], v20 offset:45056
    ds_read_b64_tr_b16 v[58:59], v20 offset:46080
    s_waitcnt lgkmcnt(6)
    v_mfma_f32_32x32x16_bf16 v[64:79], v[48:51], v[32:35], v[64:79]
    ds_read_b128 v[44:47], v16 offset:39936
    ds_read_b64_tr_b16 v[60:61], v20 offset:47104
    ds_read_b64_tr_b16 v[62:63], v20 offset:48128
    s_waitcnt lgkmcnt(6)
    v_mfma_f32_32x32x16_bf16 v[64:79], v[52:55], v[36:39], v[64:79]
    s_barrier
    ds_read_b128 v[32:35], v4 offset:0
    ds_read_b64_tr_b16 v[48:49], v8 offset:0
    ds_read_b64_tr_b16 v[50:51], v8 offset:1024
    s_waitcnt lgkmcnt(6)
    v_mfma_f32_32x32x16_bf16 v[64:79], v[56:59], v[40:43], v[64:79]
    ds_read_b128 v[36:39], v4 offset:1024
    ds_read_b64_tr_b16 v[52:53], v8 offset:2048
    ds_read_b64_tr_b16 v[54:55], v8 offset:3072
    s_waitcnt lgkmcnt(6)
    v_mfma_f32_32x32x16_bf16 v[64:79], v[60:63], v[44:47], v[64:79]
    ds_read_b128 v[40:43], v4 offset:2048
    ds_read_b64_tr_b16 v[56:57], v8 offset:4096
    ds_read_b64_tr_b16 v[58:59], v8 offset:5120
    s_waitcnt lgkmcnt(6)
    v_mfma_f32_32x32x16_bf16 v[64:79], v[48:51], v[32:35], v[64:79]
    ds_read_b128 v[44:47], v4 offset:3072
    ds_read_b64_tr_b16 v[60:61], v8 offset:6144
    ds_read_b64_tr_b16 v[62:63], v8 offset:7168
    s_waitcnt lgkmcnt(6)
    v_mfma_f32_32x32x16_bf16 v[64:79], v[52:55], v[36:39], v[64:79]
    ds_read_b128 v[32:35], v4 offset:4096
    ds_read_b64_tr_b16 v[48:49], v8 offset:8192
    ds_read_b64_tr_b16 v[50:51], v8 offset:9216
    s_waitcnt lgkmcnt(6)
    v_mfma_f32_32x32x16_bf16 v[64:79], v[56:59], v[40:43], v[64:79]
    ds_read_b128 v[36:39], v4 offset:5120
    ds_read_b64_tr_b16 v[52:53], v8 offset:10240
    ds_read_b64_tr_b16 v[54:55], v8 offset:11264
    s_waitcnt lgkmcnt(6)
    v_mfma_f32_32x32x16_bf16 v[64:79], v[60:63], v[44:47], v[64:79]
    ds_read_b128 v[40:43], v4 offset:6144
    ds_read_b64_tr_b16 v[56:57], v8 offset:12288
    ds_read_b64_tr_b16 v[58:59], v8 offset:13312
    s_waitcnt lgkmcnt(6)
    v_mfma_f32_32x32x16_bf16 v[64:79], v[48:51], v[32:35], v[64:79]
    ds_read_b128 v[44:47], v4 offset:7168
    ds_read_b64_tr_b16 v[60:61], v8 offset:14336
    ds_read_b64_tr_b16 v[62:63], v8 offset:15360
    s_waitcnt lgkmcnt(6)
    v_mfma_f32_32x32x16_bf16 v[64:79], v[52:55], v[36:39], v[64:79]
    s_barrier
    ds_read_b128 v[32:35], v4 offset:32768
    ds_read_b64_tr_b16 v[48:49], v8 offset:32768
    ds_read_b64_tr_b16 v[50:51], v8 offset:33792
    s_waitcnt lgkmcnt(6)
    v_mfma_f32_32x32x16_bf16 v[64:79], v[56:59], v[40:43], v[64:79]
    ds_read_b128 v[36:39], v4 offset:33792
    ds_read_b64_tr_b16 v[52:53], v8 offset:34816
    ds_read_b64_tr_b16 v[54:55], v8 offset:35840
    s_waitcnt lgkmcnt(6)
    v_mfma_f32_32x32x16_bf16 v[64:79], v[60:63], v[44:47], v[64:79]
    ds_read_b128 v[40:43], v4 offset:34816
    ds_read_b64_tr_b16 v[56:57], v8 offset:36864
    ds_read_b64_tr_b16 v[58:59], v8 offset:37888
    s_waitcnt lgkmcnt(6)
    v_mfma_f32_32x32x16_bf16 v[64:79], v[48:51], v[32:35], v[64:79]
    ds_read_b128 v[44:47], v4 offset:35840
    ds_read_b64_tr_b16 v[60:61], v8 offset:38912
    ds_read_b64_tr_b16 v[62:63], v8 offset:39936
    s_waitcnt lgkmcnt(6)
    v_mfma_f32_32x32x16_bf16 v[64:79], v[52:55], v[36:39], v[64:79]
    ds_read_b128 v[32:35], v4 offset:36864
    ds_read_b64_tr_b16 v[48:49], v8 offset:40960
    ds_read_b64_tr_b16 v[50:51], v8 offset:41984
    s_waitcnt lgkmcnt(6)
    v_mfma_f32_32x32x16_bf16 v[64:79], v[56:59], v[40:43], v[64:79]
    ds_read_b128 v[36:39], v4 offset:37888
    ds_read_b64_tr_b16 v[52:53], v8 offset:43008
    ds_read_b64_tr_b16 v[54:55], v8 offset:44032
    s_waitcnt lgkmcnt(6)
    v_mfma_f32_32x32x16_bf16 v[64:79], v[60:63], v[44:47], v[64:79]
    ds_read_b128 v[40:43], v4 offset:38912
    ds_read_b64_tr_b16 v[56:57], v8 offset:45056
    ds_read_b64_tr_b16 v[58:59], v8 offset:46080
    s_waitcnt lgkmcnt(6)
    v_mfma_f32_32x32x16_bf16 v[64:79], v[48:51], v[32:35], v[64:79]
    ds_read_b128 v[44:47], v4 offset:39936
    ds_read_b64_tr_b16 v[60:61], v8 offset:47104
    ds_read_b64_tr_b16 v[62:63], v8 offset:48128
    s_waitcnt lgkmcnt(6)
    v_mfma_f32_32x32x16_bf16 v[64:79], v[52:55], v[36:39], v[64:79]
    s_waitcnt lgkmcnt(3)
    v_mfma_f32_32x32x16_bf16 v[64:79], v[56:59], v[40:43], v[64:79]
    s_waitcnt lgkmcnt(0)
    v_mfma_f32_32x32x16_bf16 v[64:79], v[60:63], v[44:47], v[64:79]
    s_waitcnt vmcnt(0)
    s_nop 15
    v_lshlrev_b32 v144, 16, v24
    v_and_b32 v145, 0xffff0000, v24
    v_add_f32 v64, v64, v144
    v_add_f32 v65, v65, v145
    v_lshlrev_b32 v144, 16, v25
    v_and_b32 v145, 0xffff0000, v25
    v_add_f32 v66, v66, v144
    v_add_f32 v67, v67, v145
    v_lshlrev_b32 v144, 16, v26
    v_and_b32 v145, 0xffff0000, v26
    v_add_f32 v68, v68, v144
    v_add_f32 v69, v69, v145
    v_lshlrev_b32 v144, 16, v27
    v_and_b32 v145, 0xffff0000, v27
    v_add_f32 v70, v70, v144
    v_add_f32 v71, v71, v145
    v_lshlrev_b32 v144, 16, v28
    v_and_b32 v145, 0xffff0000, v28
    v_add_f32 v72, v72, v144
    v_add_f32 v73, v73, v145
    v_lshlrev_b32 v144, 16, v29
    v_and_b32 v145, 0xffff0000, v29
    v_add_f32 v74, v74, v144
    v_add_f32 v75, v75, v145
    v_lshlrev_b32 v144, 16, v30
    v_and_b32 v145, 0xffff0000, v30
    v_add_f32 v76, v76, v144
    v_add_f32 v77, v77, v145
    v_lshlrev_b32 v144, 16, v31
    v_and_b32 v145, 0xffff0000, v31
    v_add_f32 v78, v78, v144
    v_add_f32 v79, v79, v145
    v_cvt_pk_bf16_f32 v148, v64, v65
    v_cvt_pk_bf16_f32 v149, v66, v67
    v_cvt_pk_bf16_f32 v150, v68, v69
    v_cvt_pk_bf16_f32 v151, v70, v71
    v_cvt_pk_bf16_f32 v152, v72, v73
    v_cvt_pk_bf16_f32 v153, v74, v75
    v_cvt_pk_bf16_f32 v154, v76, v77
    v_cvt_pk_bf16_f32 v155, v78, v79
    buffer_store_dwordx4 v[148:151], v3, s[16:19], s33 offen offset:0 sc0 sc1
    buffer_store_dwordx4 v[152:155], v3, s[16:19], s33 offen offset:1024 sc0 sc1
    v_mov_b32 v128, 0
    v_mov_b32 v130, 0
    v_dot2_f32_bf16 v128, v148, s29, v128
    v_dot2_f32_bf16 v130, v148, v148, v130
    v_dot2_f32_bf16 v128, v149, s29, v128
    v_dot2_f32_bf16 v130, v149, v149, v130
    v_dot2_f32_bf16 v128, v150, s29, v128
    v_dot2_f32_bf16 v130, v150, v150, v130
    v_dot2_f32_bf16 v128, v151, s29, v128
    v_dot2_f32_bf16 v130, v151, v151, v130
    v_dot2_f32_bf16 v128, v152, s29, v128
    v_dot2_f32_bf16 v130, v152, v152, v130
    v_dot2_f32_bf16 v128, v153, s29, v128
    v_dot2_f32_bf16 v130, v153, v153, v130
    v_dot2_f32_bf16 v128, v154, s29, v128
    v_dot2_f32_bf16 v130, v154, v154, v130
    v_dot2_f32_bf16 v128, v155, s29, v128
    v_dot2_f32_bf16 v130, v155, v155, v130
    v_mov_b32 v144, v128
    s_nop 1
    v_permlane32_swap_b32 v128, v144
    s_nop 1
    v_add_f32 v128, v128, v144
    v_mov_b32 v144, v130
    s_nop 1
    v_permlane32_swap_b32 v130, v144
    s_nop 1
    v_add_f32 v130, v130, v144
    v_cmp_gt_u32 vcc, 32, v2
    s_nop 1
    v_cndmask_b32 v128, v130, v128, vcc
    buffer_store_dword v128, v23, s[40:43], s37 offen
wo_b_kernel_fin:
wo_b_kernel_done:
    s_endpgm
.section .rodata,"a"
.p2align 6
.amdhsa_kernel wo_b_kernel
  .amdhsa_next_free_vgpr 196
  .amdhsa_next_free_sgpr 96
  .amdhsa_accum_offset 196
  .amdhsa_group_segment_fixed_size 0
  .amdhsa_kernarg_size 72
  .amdhsa_user_sgpr_count 2
  .amdhsa_user_sgpr_kernarg_segment_ptr 1
  .amdhsa_system_sgpr_workgroup_id_x 1
  .amdhsa_float_denorm_mode_32 3
.end_amdhsa_kernel
.text
.globl w2_a_kernel
.p2align 8
.type w2_a_kernel,@function
w2_a_kernel:
    s_cmp_ge_u32 s2, 256
    s_cbranch_scc1 w2_a_kernel_done
    s_load_dwordx2 s[8:9], s[0:1], 64
    s_load_dwordx2 s[12:13], s[0:1], 40
    v_lshrrev_b32 v1, 6, v0
    v_and_b32 v2, 63, v0
    s_and_b32 s3, s2, 7
    s_lshr_b32 s4, s2, 3
    v_readfirstlane_b32 s26, v1
    s_and_b32 s5, s3, 3
    s_lshr_b32 s3, s3, 2
    s_lshl_b32 s5, s5, 3
    s_and_b32 s24, s4, 7
    s_add_u32 s24, s24, s5
    s_lshr_b32 s4, s4, 3
    s_lshl_b32 s3, s3, 2
    s_add_u32 s25, s3, s4
    v_lshlrev_b32 v3, 4, v2
    s_cmp_lt_u32 s26, 4
    s_cbranch_scc1 w2_a_kernel_cw
    s_sub_u32 s26, s26, 4
    s_lshr_b32 s27, s26, 1
    s_and_b32 s28, s26, 1
    s_lshl_b32 s30, s26, 12
    v_lshrrev_b32 v12, 3, v2
    v_bfe_u32 v13, v2, 2, 1
    v_bfe_u32 v14, v2, 4, 1
    v_xor_b32 v13, v13, v14
    v_lshlrev_b32 v13, 6, v13
    v_and_b32 v14, 3, v2
    v_lshlrev_b32 v14, 4, v14
    v_mul_u32_u24 v12, 1024, v12
    v_add3_u32 v8, v12, v13, v14
    v_add_u32 v9, 7168, v8
    v_add_u32 v10, 14336, v8
    v_add_u32 v11, 21504, v8
    s_lshl_b32 s31, s24, 1
    s_add_u32 s31, s31, s27
    s_mul_i32 s31, s31, 114688
    s_lshl_b32 s3, s28, 12
    s_add_u32 s31, s31, s3
    s_mul_i32 s32, s26, 32768
    s_lshl_b32 s3, s25, 7
    s_add_u32 s32, s32, s3
    s_waitcnt lgkmcnt(0)
    s_add_u32 s8, s8, 0xa00000
    s_addc_u32 s9, s9, 0
    s_mov_b32 s10, 0x700000
    s_mov_b32 s11, 0x00020000
    s_mov_b32 s14, 0x1c0000
    s_mov_b32 s15, 0x00020000
    s_add_u32 m0, s30, 16384
    s_add_u32 s3, s32, 0
    buffer_load_dwordx4 v8, s[12:15], s3 offen offset:0 lds
    buffer_load_dwordx4 v9, s[12:15], s3 offen offset:1024 lds
    buffer_load_dwordx4 v10, s[12:15], s3 offen offset:2048 lds
    buffer_load_dwordx4 v11, s[12:15], s3 offen offset:3072 lds
    s_add_u32 m0, s30, 0
    s_add_u32 s3, s31, 0
    buffer_load_dwordx4 v3, s[8:11], s3 offen offset:0 lds
    buffer_load_dwordx4 v3, s[8:11], s3 offen offset:1024 lds
    buffer_load_dwordx4 v3, s[8:11], s3 offen offset:2048 lds
    buffer_load_dwordx4 v3, s[8:11], s3 offen offset:3072 lds
    s_add_u32 m0, s30, 49152
    s_add_u32 s3, s32, 131072
    buffer_load_dwordx4 v8, s[12:15], s3 offen offset:0 lds
    buffer_load_dwordx4 v9, s[12:15], s3 offen offset:1024 lds
    buffer_load_dwordx4 v10, s[12:15], s3 offen offset:2048 lds
    buffer_load_dwordx4 v11, s[12:15], s3 offen offset:3072 lds
    s_add_u32 m0, s30, 32768
    s_add_u32 s3, s31, 8192
    buffer_load_dwordx4 v3, s[8:11], s3 offen offset:0 lds
    buffer_load_dwordx4 v3, s[8:11], s3 offen offset:1024 lds
    buffer_load_dwordx4 v3, s[8:11], s3 offen offset:2048 lds
    buffer_load_dwordx4 v3, s[8:11], s3 offen offset:3072 lds
    s_waitcnt vmcnt(8)
    s_barrier
    s_add_u32 m0, s30, 81920
    s_add_u32 s3, s32, 262144
    buffer_load_dwordx4 v8, s[12:15], s3 offen offset:0 lds
    buffer_load_dwordx4 v9, s[12:15], s3 offen offset:1024 lds
    buffer_load_dwordx4 v10, s[12:15], s3 offen offset:2048 lds
    buffer_load_dwordx4 v11, s[12:15], s3 offen offset:3072 lds
    s_add_u32 m0, s30, 65536
    s_add_u32 s3, s31, 16384
    buffer_load_dwordx4 v3, s[8:11], s3 offen offset:0 lds
    buffer_load_dwordx4 v3, s[8:11], s3 offen offset:1024 lds
    buffer_load_dwordx4 v3, s[8:11], s3 offen offset:2048 lds
    buffer_load_dwordx4 v3, s[8:11], s3 offen offset:3072 lds
    s_waitcnt vmcnt(8)
    s_barrier
    s_add_u32 m0, s30, 114688
    s_add_u32 s3, s32, 393216
    buffer_load_dwordx4 v8, s[12:15], s3 offen offset:0 lds
    buffer_load_dwordx4 v9, s[12:15], s3 offen offset:1024 lds
    buffer_load_dwordx4 v10, s[12:15], s3 offen offset:2048 lds
    buffer_load_dwordx4 v11, s[12:15], s3 offen offset:3072 lds
    s_add_u32 m0, s30, 98304
    s_add_u32 s3, s31, 24576
    buffer_load_dwordx4 v3, s[8:11], s3 offen offset:0 lds
    buffer_load_dwordx4 v3, s[8:11], s3 offen offset:1024 lds
    buffer_load_dwordx4 v3, s[8:11], s3 offen offset:2048 lds
    buffer_load_dwordx4 v3, s[8:11], s3 offen offset:3072 lds
    s_waitcnt vmcnt(8)
    s_barrier
    s_add_u32 m0, s30, 147456
    s_add_u32 s3, s32, 524288
    buffer_load_dwordx4 v8, s[12:15], s3 offen offset:0 lds
    buffer_load_dwordx4 v9, s[12:15], s3 offen offset:1024 lds
    buffer_load_dwordx4 v10, s[12:15], s3 offen offset:2048 lds
    buffer_load_dwordx4 v11, s[12:15], s3 offen offset:3072 lds
    s_add_u32 m0, s30, 131072
    s_add_u32 s3, s31, 32768
    buffer_load_dwordx4 v3, s[8:11], s3 offen offset:0 lds
    buffer_load_dwordx4 v3, s[8:11], s3 offen offset:1024 lds
    buffer_load_dwordx4 v3, s[8:11], s3 offen offset:2048 lds
    buffer_load_dwordx4 v3, s[8:11], s3 offen offset:3072 lds
    s_waitcnt vmcnt(8)
    s_barrier
    s_add_u32 m0, s30, 16384
    s_add_u32 s3, s32, 655360
    buffer_load_dwordx4 v8, s[12:15], s3 offen offset:0 lds
    buffer_load_dwordx4 v9, s[12:15], s3 offen offset:1024 lds
    buffer_load_dwordx4 v10, s[12:15], s3 offen offset:2048 lds
    buffer_load_dwordx4 v11, s[12:15], s3 offen offset:3072 lds
    s_add_u32 m0, s30, 0
    s_add_u32 s3, s31, 40960
    buffer_load_dwordx4 v3, s[8:11], s3 offen offset:0 lds
    buffer_load_dwordx4 v3, s[8:11], s3 offen offset:1024 lds
    buffer_load_dwordx4 v3, s[8:11], s3 offen offset:2048 lds
    buffer_load_dwordx4 v3, s[8:11], s3 offen offset:3072 lds
    s_waitcnt vmcnt(8)
    s_barrier
    s_add_u32 m0, s30, 49152
    s_add_u32 s3, s32, 786432
    buffer_load_dwordx4 v8, s[12:15], s3 offen offset:0 lds
    buffer_load_dwordx4 v9, s[12:15], s3 offen offset:1024 lds
    buffer_load_dwordx4 v10, s[12:15], s3 offen offset:2048 lds
    buffer_load_dwordx4 v11, s[12:15], s3 offen offset:3072 lds
    s_add_u32 m0, s30, 32768
    s_add_u32 s3, s31, 49152
    buffer_load_dwordx4 v3, s[8:11], s3 offen offset:0 lds
    buffer_load_dwordx4 v3, s[8:11], s3 offen offset:1024 lds
    buffer_load_dwordx4 v3, s[8:11], s3 offen offset:2048 lds
    buffer_load_dwordx4 v3, s[8:11], s3 offen offset:3072 lds
    s_waitcnt vmcnt(8)
    s_barrier
    s_add_u32 m0, s30, 81920
    s_add_u32 s3, s32, 917504
    buffer_load_dwordx4 v8, s[12:15], s3 offen offset:0 lds
    buffer_load_dwordx4 v9, s[12:15], s3 offen offset:1024 lds
    buffer_load_dwordx4 v10, s[12:15], s3 offen offset:2048 lds
    buffer_load_dwordx4 v11, s[12:15], s3 offen offset:3072 lds
    s_add_u32 m0, s30, 65536
    s_add_u32 s3, s31, 57344
    buffer_load_dwordx4 v3, s[8:11], s3 offen offset:0 lds
    buffer_load_dwordx4 v3, s[8:11], s3 offen offset:1024 lds
    buffer_load_dwordx4 v3, s[8:11], s3 offen offset:2048 lds
    buffer_load_dwordx4 v3, s[8:11], s3 offen offset:3072 lds
    s_waitcnt vmcnt(8)
    s_barrier
    s_add_u32 m0, s30, 114688
    s_add_u32 s3, s32, 1048576
    buffer_load_dwordx4 v8, s[12:15], s3 offen offset:0 lds
    buffer_load_dwordx4 v9, s[12:15], s3 offen offset:1024 lds
    buffer_load_dwordx4 v10, s[12:15], s3 offen offset:2048 lds
    buffer_load_dwordx4 v11, s[12:15], s3 offen offset:3072 lds
    s_add_u32 m0, s30, 98304
    s_add_u32 s3, s31, 65536
    buffer_load_dwordx4 v3, s[8:11], s3 offen offset:0 lds
    buffer_load_dwordx4 v3, s[8:11], s3 offen offset:1024 lds
    buffer_load_dwordx4 v3, s[8:11], s3 offen offset:2048 lds
    buffer_load_dwordx4 v3, s[8:11], s3 offen offset:3072 lds
    s_waitcnt vmcnt(8)
    s_barrier
    s_add_u32 m0, s30, 147456
    s_add_u32 s3, s32, 1179648
    buffer_load_dwordx4 v8, s[12:15], s3 offen offset:0 lds
    buffer_load_dwordx4 v9, s[12:15], s3 offen offset:1024 lds
    buffer_load_dwordx4 v10, s[12:15], s3 offen offset:2048 lds
    buffer_load_dwordx4 v11, s[12:15], s3 offen offset:3072 lds
    s_add_u32 m0, s30, 131072
    s_add_u32 s3, s31, 73728
    buffer_load_dwordx4 v3, s[8:11], s3 offen offset:0 lds
    buffer_load_dwordx4 v3, s[8:11], s3 offen offset:1024 lds
    buffer_load_dwordx4 v3, s[8:11], s3 offen offset:2048 lds
    buffer_load_dwordx4 v3, s[8:11], s3 offen offset:3072 lds
    s_waitcnt vmcnt(8)
    s_barrier
    s_add_u32 m0, s30, 16384
    s_add_u32 s3, s32, 1310720
    buffer_load_dwordx4 v8, s[12:15], s3 offen offset:0 lds
    buffer_load_dwordx4 v9, s[12:15], s3 offen offset:1024 lds
    buffer_load_dwordx4 v10, s[12:15], s3 offen offset:2048 lds
    buffer_load_dwordx4 v11, s[12:15], s3 offen offset:3072 lds
    s_add_u32 m0, s30, 0
    s_add_u32 s3, s31, 81920
    buffer_load_dwordx4 v3, s[8:11], s3 offen offset:0 lds
    buffer_load_dwordx4 v3, s[8:11], s3 offen offset:1024 lds
    buffer_load_dwordx4 v3, s[8:11], s3 offen offset:2048 lds
    buffer_load_dwordx4 v3, s[8:11], s3 offen offset:3072 lds
    s_waitcnt vmcnt(8)
    s_barrier
    s_add_u32 m0, s30, 49152
    s_add_u32 s3, s32, 1441792
    buffer_load_dwordx4 v8, s[12:15], s3 offen offset:0 lds
    buffer_load_dwordx4 v9, s[12:15], s3 offen offset:1024 lds
    buffer_load_dwordx4 v10, s[12:15], s3 offen offset:2048 lds
    buffer_load_dwordx4 v11, s[12:15], s3 offen offset:3072 lds
    s_add_u32 m0, s30, 32768
    s_add_u32 s3, s31, 90112
    buffer_load_dwordx4 v3, s[8:11], s3 offen offset:0 lds
    buffer_load_dwordx4 v3, s[8:11], s3 offen offset:1024 lds
    buffer_load_dwordx4 v3, s[8:11], s3 offen offset:2048 lds
    buffer_load_dwordx4 v3, s[8:11], s3 offen offset:3072 lds
    s_waitcnt vmcnt(8)
    s_barrier
    s_add_u32 m0, s30, 81920
    s_add_u32 s3, s32, 1572864
    buffer_load_dwordx4 v8, s[12:15], s3 offen offset:0 lds
    buffer_load_dwordx4 v9, s[12:15], s3 offen offset:1024 lds
    buffer_load_dwordx4 v10, s[12:15], s3 offen offset:2048 lds
    buffer_load_dwordx4 v11, s[12:15], s3 offen offset:3072 lds
    s_add_u32 m0, s30, 65536
    s_add_u32 s3, s31, 98304
    buffer_load_dwordx4 v3, s[8:11], s3 offen offset:0 lds
    buffer_load_dwordx4 v3, s[8:11], s3 offen offset:1024 lds
    buffer_load_dwordx4 v3, s[8:11], s3 offen offset:2048 lds
    buffer_load_dwordx4 v3, s[8:11], s3 offen offset:3072 lds
    s_waitcnt vmcnt(8)
    s_barrier
    s_add_u32 m0, s30, 114688
    s_add_u32 s3, s32, 1703936
    buffer_load_dwordx4 v8, s[12:15], s3 offen offset:0 lds
    buffer_load_dwordx4 v9, s[12:15], s3 offen offset:1024 lds
    buffer_load_dwordx4 v10, s[12:15], s3 offen offset:2048 lds
    buffer_load_dwordx4 v11, s[12:15], s3 offen offset:3072 lds
    s_add_u32 m0, s30, 98304
    s_add_u32 s3, s31, 106496
    buffer_load_dwordx4 v3, s[8:11], s3 offen offset:0 lds
    buffer_load_dwordx4 v3, s[8:11], s3 offen offset:1024 lds
    buffer_load_dwordx4 v3, s[8:11], s3 offen offset:2048 lds
    buffer_load_dwordx4 v3, s[8:11], s3 offen offset:3072 lds
    s_waitcnt vmcnt(8)
    s_barrier
    s_waitcnt vmcnt(0)
    s_barrier
    s_endpgm
w2_a_kernel_cw:
    s_lshr_b32 s27, s26, 1
    s_and_b32 s28, s26, 1
    s_mov_b32 s29, 0x3f803f80
    s_load_dwordx2 s[16:17], s[0:1], 64
    s_load_dwordx2 s[20:21], s[0:1], 64
    s_load_dwordx2 s[40:41], s[0:1], 64
    s_lshl_b32 s3, s27, 13
    v_add_u32 v16, s3, v3
    v_bfe_u32 v12, v2, 2, 2
    v_lshrrev_b32 v13, 5, v2
    v_lshlrev_b32 v13, 2, v13
    v_add_u32 v13, v13, v12
    v_mul_u32_u24 v13, 128, v13
    v_bfe_u32 v14, v2, 4, 1
    v_lshlrev_b32 v14, 5, v14
    v_and_b32 v15, 3, v2
    v_lshlrev_b32 v15, 3, v15
    v_add3_u32 v13, v13, v14, v15
    v_add_u32 v13, 16384, v13
    v_lshrrev_b32 v12, 1, v12
    v_xor_b32 v14, s28, v12
    v_lshlrev_b32 v14, 6, v14
    v_add_u32 v20, v13, v14
    v_add_u32 v4, 0x10000, v16
    v_add_u32 v10, 0x20000, v16
    v_add_u32 v8, 0x10000, v20
    v_add_u32 v14, 0x20000, v20
    s_waitcnt lgkmcnt(0)
    s_mov_b32 s18, 0x200000
    s_mov_b32 s19, 0x00020000
    s_mov_b32 s22, 0x200000
    s_mov_b32 s23, 0x00020000
    s_add_u32 s40, s40, 0x1200000
    s_addc_u32 s41, s41, 0
    s_mov_b32 s42, 0x200000
    s_mov_b32 s43, 0x00020000
    s_lshl_b32 s33, s24, 1
    s_add_u32 s33, s33, s27
    s_lshl_b32 s34, s25, 1
    s_add_u32 s34, s34, s28
    s_lshl_b32 s35, s33, 15
    s_lshl_b32 s36, s34, 6
    s_add_u32 s36, s36, s35
    s_lshl_b32 s37, s33, 12
    s_lshl_b32 s38, s34, 8
    s_add_u32 s37, s37, s38
    s_lshl_b32 s34, s34, 11
    s_add_u32 s33, s35, s34
    v_and_b32 v22, 31, v2
    v_lshlrev_b32 v23, 3, v22
    v_lshlrev_b32 v22, 10, v22
    v_lshrrev_b32 v1, 5, v2
    v_lshl_add_u32 v22, v1, 3, v22
    v_lshl_add_u32 v23, v1, 2, v23
    buffer_load_dwordx4 v[24:27], v3, s[20:23], s33 offen offset:0
    buffer_load_dwordx4 v[28:31], v3, s[20:23], s33 offen offset:1024
    v_mov_b32 v64, 0
    v_mov_b32 v65, 0
    v_mov_b32 v66, 0
    v_mov_b32 v67, 0
    v_mov_b32 v68, 0
    v_mov_b32 v69, 0
    v_mov_b32 v70, 0
    v_mov_b32 v71, 0
    v_mov_b32 v72, 0
    v_mov_b32 v73, 0
    v_mov_b32 v74, 0
    v_mov_b32 v75, 0
    v_mov_b32 v76, 0
    v_mov_b32 v77, 0
    v_mov_b32 v78, 0
    v_mov_b32 v79, 0
    s_barrier
    ds_read_b128 v[32:35], v16 offset:0
    ds_read_b64_tr_b16 v[48:49], v20 offset:0
    ds_read_b64_tr_b16 v[50:51], v20 offset:1024
    ds_read_b128 v[36:39], v16 offset:1024
    ds_read_b64_tr_b16 v[52:53], v20 offset:2048
    ds_read_b64_tr_b16 v[54:55], v20 offset:3072
    ds_read_b128 v[40:43], v16 offset:2048
    ds_read_b64_tr_b16 v[56:57], v20 offset:4096
    ds_read_b64_tr_b16 v[58:59], v20 offset:5120
    s_waitcnt lgkmcnt(6)
    v_mfma_f32_32x32x16_bf16 v[64:79], v[48:51], v[32:35], v[64:79]
    ds_read_b128 v[44:47], v16 offset:3072
    ds_read_b64_tr_b16 v[60:61], v20 offset:6144
    ds_read_b64_tr_b16 v[62:63], v20 offset:7168
    s_waitcnt lgkmcnt(6)
    v_mfma_f32_32x32x16_bf16 v[64:79], v[52:55], v[36:39], v[64:79]
    ds_read_b128 v[32:35], v16 offset:4096
    ds_read_b64_tr_b16 v[48:49], v20 offset:8192
    ds_read_b64_tr_b16 v[50:51], v20 offset:9216
    s_waitcnt lgkmcnt(6)
    v_mfma_f32_32x32x16_bf16 v[64:79], v[56:59], v[40:43], v[64:79]
    ds_read_b128 v[36:39], v16 offset:5120
    ds_read_b64_tr_b16 v[52:53], v20 offset:10240
    ds_read_b64_tr_b16 v[54:55], v20 offset:11264
    s_waitcnt lgkmcnt(6)
    v_mfma_f32_32x32x16_bf16 v[64:79], v[60:63], v[44:47], v[64:79]
    ds_read_b128 v[40:43], v16 offset:6144
    ds_read_b64_tr_b16 v[56:57], v20 offset:12288
    ds_read_b64_tr_b16 v[58:59], v20 offset:13312
    s_waitcnt lgkmcnt(6)
    v_mfma_f32_32x32x16_bf16 v[64:79], v[48:51], v[32:35], v[64:79]
    ds_read_b128 v[44:47], v16 offset:7168
    ds_read_b64_tr_b16 v[60:61], v20 offset:14336
    ds_read_b64_tr_b16 v[62:63], v20 offset:15360
    s_waitcnt lgkmcnt(6)
    v_mfma_f32_32x32x16_bf16 v[64:79], v[52:55], v[36:39], v[64:79]
    s_barrier
    ds_read_b128 v[32:35], v16 offset:32768
    ds_read_b64_tr_b16 v[48:49], v20 offset:32768
    ds_read_b64_tr_b16 v[50:51], v20 offset:33792
    s_waitcnt lgkmcnt(6)
    v_mfma_f32_32x32x16_bf16 v[64:79], v[56:59], v[40:43], v[64:79]
    ds_read_b128 v[36:39], v16 offset:33792
    ds_read_b64_tr_b16 v[52:53], v20 offset:34816
    ds_read_b64_tr_b16 v[54:55], v20 offset:35840
    s_waitcnt lgkmcnt(6)
    v_mfma_f32_32x32x16_bf16 v[64:79], v[60:63], v[44:47], v[64:79]
    ds_read_b128 v[40:43], v16 offset:34816
    ds_read_b64_tr_b16 v[56:57], v20 offset:36864
    ds_read_b64_tr_b16 v[58:59], v20 offset:37888
    s_waitcnt lgkmcnt(6)
    v_mfma_f32_32x32x16_bf16 v[64:79], v[48:51], v[32:35], v[64:79]
    ds_read_b128 v[44:47], v16 offset:35840
    ds_read_b64_tr_b16 v[60:61], v20 offset:38912
    ds_read_b64_tr_b16 v[62:63], v20 offset:39936
    s_waitcnt lgkmcnt(6)
    v_mfma_f32_32x32x16_bf16 v[64:79], v[52:55], v[36:39], v[64:79]
    ds_read_b128 v[32:35], v16 offset:36864
    ds_read_b64_tr_b16 v[48:49], v20 offset:40960
    ds_read_b64_tr_b16 v[50:51], v20 offset:41984
    s_waitcnt lgkmcnt(6)
    v_mfma_f32_32x32x16_bf16 v[64:79], v[56:59], v[40:43], v[64:79]
    ds_read_b128 v[36:39], v16 offset:37888
    ds_read_b64_tr_b16 v[52:53], v20 offset:43008
    ds_read_b64_tr_b16 v[54:55], v20 offset:44032
    s_waitcnt lgkmcnt(6)
    v_mfma_f32_32x32x16_bf16 v[64:79], v[60:63], v[44:47], v[64:79]
    ds_read_b128 v[40:43], v16 offset:38912
    ds_read_b64_tr_b16 v[56:57], v20 offset:45056
    ds_read_b64_tr_b16 v[58:59], v20 offset:46080
    s_waitcnt lgkmcnt(6)
    v_mfma_f32_32x32x16_bf16 v[64:79], v[48:51], v[32:35], v[64:79]
    ds_read_b128 v[44:47], v16 offset:39936
    ds_read_b64_tr_b16 v[60:61], v20 offset:47104
    ds_read_b64_tr_b16 v[62:63], v20 offset:48128
    s_waitcnt lgkmcnt(6)
    v_mfma_f32_32x32x16_bf16 v[64:79], v[52:55], v[36:39], v[64:79]
    s_barrier
    ds_read_b128 v[32:35], v4 offset:0
    ds_read_b64_tr_b16 v[48:49], v8 offset:0
    ds_read_b64_tr_b16 v[50:51], v8 offset:1024
    s_waitcnt lgkmcnt(6)
    v_mfma_f32_32x32x16_bf16 v[64:79], v[56:59], v[40:43], v[64:79]
    ds_read_b128 v[36:39], v4 offset:1024
    ds_read_b64_tr_b16 v[52:53], v8 offset:2048
    ds_read_b64_tr_b16 v[54:55], v8 offset:3072
    s_waitcnt lgkmcnt(6)
    v_mfma_f32_32x32x16_bf16 v[64:79], v[60:63], v[44:47], v[64:79]
    ds_read_b128 v[40:43], v4 offset:2048
    ds_read_b64_tr_b16 v[56:57], v8 offset:4096
    ds_read_b64_tr_b16 v[58:59], v8 offset:5120
    s_waitcnt lgkmcnt(6)
    v_mfma_f32_32x32x16_bf16 v[64:79], v[48:51], v[32:35], v[64:79]
    ds_read_b128 v[44:47], v4 offset:3072
    ds_read_b64_tr_b16 v[60:61], v8 offset:6144
    ds_read_b64_tr_b16 v[62:63], v8 offset:7168
    s_waitcnt lgkmcnt(6)
    v_mfma_f32_32x32x16_bf16 v[64:79], v[52:55], v[36:39], v[64:79]
    ds_read_b128 v[32:35], v4 offset:4096
    ds_read_b64_tr_b16 v[48:49], v8 offset:8192
    ds_read_b64_tr_b16 v[50:51], v8 offset:9216
    s_waitcnt lgkmcnt(6)
    v_mfma_f32_32x32x16_bf16 v[64:79], v[56:59], v[40:43], v[64:79]
    ds_read_b128 v[36:39], v4 offset:5120
    ds_read_b64_tr_b16 v[52:53], v8 offset:10240
    ds_read_b64_tr_b16 v[54:55], v8 offset:11264
    s_waitcnt lgkmcnt(6)
    v_mfma_f32_32x32x16_bf16 v[64:79], v[60:63], v[44:47], v[64:79]
    ds_read_b128 v[40:43], v4 offset:6144
    ds_read_b64_tr_b16 v[56:57], v8 offset:12288
    ds_read_b64_tr_b16 v[58:59], v8 offset:13312
    s_waitcnt lgkmcnt(6)
    v_mfma_f32_32x32x16_bf16 v[64:79], v[48:51], v[32:35], v[64:79]
    ds_read_b128 v[44:47], v4 offset:7168
    ds_read_b64_tr_b16 v[60:61], v8 offset:14336
    ds_read_b64_tr_b16 v[62:63], v8 offset:15360
    s_waitcnt lgkmcnt(6)
    v_mfma_f32_32x32x16_bf16 v[64:79], v[52:55], v[36:39], v[64:79]
    s_barrier
    ds_read_b128 v[32:35], v4 offset:32768
    ds_read_b64_tr_b16 v[48:49], v8 offset:32768
    ds_read_b64_tr_b16 v[50:51], v8 offset:33792
    s_waitcnt lgkmcnt(6)
    v_mfma_f32_32x32x16_bf16 v[64:79], v[56:59], v[40:43], v[64:79]
    ds_read_b128 v[36:39], v4 offset:33792
    ds_read_b64_tr_b16 v[52:53], v8 offset:34816
    ds_read_b64_tr_b16 v[54:55], v8 offset:35840
    s_waitcnt lgkmcnt(6)
    v_mfma_f32_32x32x16_bf16 v[64:79], v[60:63], v[44:47], v[64:79]
    ds_read_b128 v[40:43], v4 offset:34816
    ds_read_b64_tr_b16 v[56:57], v8 offset:36864
    ds_read_b64_tr_b16 v[58:59], v8 offset:37888
    s_waitcnt lgkmcnt(6)
    v_mfma_f32_32x32x16_bf16 v[64:79], v[48:51], v[32:35], v[64:79]
    ds_read_b128 v[44:47], v4 offset:35840
    ds_read_b64_tr_b16 v[60:61], v8 offset:38912
    ds_read_b64_tr_b16 v[62:63], v8 offset:39936
    s_waitcnt lgkmcnt(6)
    v_mfma_f32_32x32x16_bf16 v[64:79], v[52:55], v[36:39], v[64:79]
    ds_read_b128 v[32:35], v4 offset:36864
    ds_read_b64_tr_b16 v[48:49], v8 offset:40960
    ds_read_b64_tr_b16 v[50:51], v8 offset:41984
    s_waitcnt lgkmcnt(6)
    v_mfma_f32_32x32x16_bf16 v[64:79], v[56:59], v[40:43], v[64:79]
    ds_read_b128 v[36:39], v4 offset:37888
    ds_read_b64_tr_b16 v[52:53], v8 offset:43008
    ds_read_b64_tr_b16 v[54:55], v8 offset:44032
    s_waitcnt lgkmcnt(6)
    v_mfma_f32_32x32x16_bf16 v[64:79], v[60:63], v[44:47], v[64:79]
    ds_read_b128 v[40:43], v4 offset:38912
    ds_read_b64_tr_b16 v[56:57], v8 offset:45056
    ds_read_b64_tr_b16 v[58:59], v8 offset:46080
    s_waitcnt lgkmcnt(6)
    v_mfma_f32_32x32x16_bf16 v[64:79], v[48:51], v[32:35], v[64:79]
    ds_read_b128 v[44:47], v4 offset:39936
    ds_read_b64_tr_b16 v[60:61], v8 offset:47104
    ds_read_b64_tr_b16 v[62:63], v8 offset:48128
    s_waitcnt lgkmcnt(6)
    v_mfma_f32_32x32x16_bf16 v[64:79], v[52:55], v[36:39], v[64:79]
    s_barrier
    ds_read_b128 v[32:35], v10 offset:0
    ds_read_b64_tr_b16 v[48:49], v14 offset:0
    ds_read_b64_tr_b16 v[50:51], v14 offset:1024
    s_waitcnt lgkmcnt(6)
    v_mfma_f32_32x32x16_bf16 v[64:79], v[56:59], v[40:43], v[64:79]
    ds_read_b128 v[36:39], v10 offset:1024
    ds_read_b64_tr_b16 v[52:53], v14 offset:2048
    ds_read_b64_tr_b16 v[54:55], v14 offset:3072
    s_waitcnt lgkmcnt(6)
    v_mfma_f32_32x32x16_bf16 v[64:79], v[60:63], v[44:47], v[64:79]
    ds_read_b128 v[40:43], v10 offset:2048
    ds_read_b64_tr_b16 v[56:57], v14 offset:4096
    ds_read_b64_tr_b16 v[58:59], v14 offset:5120
    s_waitcnt lgkmcnt(6)
    v_mfma_f32_32x32x16_bf16 v[64:79], v[48:51], v[32:35], v[64:79]
    ds_read_b128 v[44:47], v10 offset:3072
    ds_read_b64_tr_b16 v[60:61], v14 offset:6144
    ds_read_b64_tr_b16 v[62:63], v14 offset:7168
    s_waitcnt lgkmcnt(6)
    v_mfma_f32_32x32x16_bf16 v[64:79], v[52:55], v[36:39], v[64:79]
    ds_read_b128 v[32:35], v10 offset:4096
    ds_read_b64_tr_b16 v[48:49], v14 offset:8192
    ds_read_b64_tr_b16 v[50:51], v14 offset:9216
    s_waitcnt lgkmcnt(6)
    v_mfma_f32_32x32x16_bf16 v[64:79], v[56:59], v[40:43], v[64:79]
    ds_read_b128 v[36:39], v10 offset:5120
    ds_read_b64_tr_b16 v[52:53], v14 offset:10240
    ds_read_b64_tr_b16 v[54:55], v14 offset:11264
    s_waitcnt lgkmcnt(6)
    v_mfma_f32_32x32x16_bf16 v[64:79], v[60:63], v[44:47], v[64:79]
    ds_read_b128 v[40:43], v10 offset:6144
    ds_read_b64_tr_b16 v[56:57], v14 offset:12288
    ds_read_b64_tr_b16 v[58:59], v14 offset:13312
    s_waitcnt lgkmcnt(6)
    v_mfma_f32_32x32x16_bf16 v[64:79], v[48:51], v[32:35], v[64:79]
    ds_read_b128 v[44:47], v10 offset:7168
    ds_read_b64_tr_b16 v[60:61], v14 offset:14336
    ds_read_b64_tr_b16 v[62:63], v14 offset:15360
    s_waitcnt lgkmcnt(6)
    v_mfma_f32_32x32x16_bf16 v[64:79], v[52:55], v[36:39], v[64:79]
    s_barrier
    ds_read_b128 v[32:35], v16 offset:0
    ds_read_b64_tr_b16 v[48:49], v20 offset:0
    ds_read_b64_tr_b16 v[50:51], v20 offset:1024
    s_waitcnt lgkmcnt(6)
    v_mfma_f32_32x32x16_bf16 v[64:79], v[56:59], v[40:43], v[64:79]
    ds_read_b128 v[36:39], v16 offset:1024
    ds_read_b64_tr_b16 v[52:53], v20 offset:2048
    ds_read_b64_tr_b16 v[54:55], v20 offset:3072
    s_waitcnt lgkmcnt(6)
    v_mfma_f32_32x32x16_bf16 v[64:79], v[60:63], v[44:47], v[64:79]
    ds_read_b128 v[40:43], v16 offset:2048
    ds_read_b64_tr_b16 v[56:57], v20 offset:4096
    ds_read_b64_tr_b16 v[58:59], v20 offset:5120
    s_waitcnt lgkmcnt(6)
    v_mfma_f32_32x32x16_bf16 v[64:79], v[48:51], v[32:35], v[64:79]
    ds_read_b128 v[44:47], v16 offset:3072
    ds_read_b64_tr_b16 v[60:61], v20 offset:6144
    ds_read_b64_tr_b16 v[62:63], v20 offset:7168
    s_waitcnt lgkmcnt(6)
    v_mfma_f32_32x32x16_bf16 v[64:79], v[52:55], v[36:39], v[64:79]
    ds_read_b128 v[32:35], v16 offset:4096
    ds_read_b64_tr_b16 v[48:49], v20 offset:8192
    ds_read_b64_tr_b16 v[50:51], v20 offset:9216
    s_waitcnt lgkmcnt(6)
    v_mfma_f32_32x32x16_bf16 v[64:79], v[56:59], v[40:43], v[64:79]
    ds_read_b128 v[36:39], v16 offset:5120
    ds_read_b64_tr_b16 v[52:53], v20 offset:10240
    ds_read_b64_tr_b16 v[54:55], v20 offset:11264
    s_waitcnt lgkmcnt(6)
    v_mfma_f32_32x32x16_bf16 v[64:79], v[60:63], v[44:47], v[64:79]
    ds_read_b128 v[40:43], v16 offset:6144
    ds_read_b64_tr_b16 v[56:57], v20 offset:12288
    ds_read_b64_tr_b16 v[58:59], v20 offset:13312
    s_waitcnt lgkmcnt(6)
    v_mfma_f32_32x32x16_bf16 v[64:79], v[48:51], v[32:35], v[64:79]
    ds_read_b128 v[44:47], v16 offset:7168
    ds_read_b64_tr_b16 v[60:61], v20 offset:14336
    ds_read_b64_tr_b16 v[62:63], v20 offset:15360
    s_waitcnt lgkmcnt(6)
    v_mfma_f32_32x32x16_bf16 v[64:79], v[52:55], v[36:39], v[64:79]
    s_barrier
    ds_read_b128 v[32:35], v16 offset:32768
    ds_read_b64_tr_b16 v[48:49], v20 offset:32768
    ds_read_b64_tr_b16 v[50:51], v20 offset:33792
    s_waitcnt lgkmcnt(6)
    v_mfma_f32_32x32x16_bf16 v[64:79], v[56:59], v[40:43], v[64:79]
    ds_read_b128 v[36:39], v16 offset:33792
    ds_read_b64_tr_b16 v[52:53], v20 offset:34816
    ds_read_b64_tr_b16 v[54:55], v20 offset:35840
    s_waitcnt lgkmcnt(6)
    v_mfma_f32_32x32x16_bf16 v[64:79], v[60:63], v[44:47], v[64:79]
    ds_read_b128 v[40:43], v16 offset:34816
    ds_read_b64_tr_b16 v[56:57], v20 offset:36864
    ds_read_b64_tr_b16 v[58:59], v20 offset:37888
    s_waitcnt lgkmcnt(6)
    v_mfma_f32_32x32x16_bf16 v[64:79], v[48:51], v[32:35], v[64:79]
    ds_read_b128 v[44:47], v16 offset:35840
    ds_read_b64_tr_b16 v[60:61], v20 offset:38912
    ds_read_b64_tr_b16 v[62:63], v20 offset:39936
    s_waitcnt lgkmcnt(6)
    v_mfma_f32_32x32x16_bf16 v[64:79], v[52:55], v[36:39], v[64:79]
    ds_read_b128 v[32:35], v16 offset:36864
    ds_read_b64_tr_b16 v[48:49], v20 offset:40960
    ds_read_b64_tr_b16 v[50:51], v20 offset:41984
    s_waitcnt lgkmcnt(6)
    v_mfma_f32_32x32x16_bf16 v[64:79], v[56:59], v[40:43], v[64:79]
    ds_read_b128 v[36:39], v16 offset:37888
    ds_read_b64_tr_b16 v[52:53], v20 offset:43008
    ds_read_b64_tr_b16 v[54:55], v20 offset:44032
    s_waitcnt lgkmcnt(6)
    v_mfma_f32_32x32x16_bf16 v[64:79], v[60:63], v[44:47], v[64:79]
    ds_read_b128 v[40:43], v16 offset:38912
    ds_read_b64_tr_b16 v[56:57], v20 offset:45056
    ds_read_b64_tr_b16 v[58:59], v20 offset:46080
    s_waitcnt lgkmcnt(6)
    v_mfma_f32_32x32x16_bf16 v[64:79], v[48:51], v[32:35], v[64:79]
    ds_read_b128 v[44:47], v16 offset:39936
    ds_read_b64_tr_b16 v[60:61], v20 offset:47104
    ds_read_b64_tr_b16 v[62:63], v20 offset:48128
    s_waitcnt lgkmcnt(6)
    v_mfma_f32_32x32x16_bf16 v[64:79], v[52:55], v[36:39], v[64:79]
    s_barrier
    ds_read_b128 v[32:35], v4 offset:0
    ds_read_b64_tr_b16 v[48:49], v8 offset:0
    ds_read_b64_tr_b16 v[50:51], v8 offset:1024
    s_waitcnt lgkmcnt(6)
    v_mfma_f32_32x32x16_bf16 v[64:79], v[56:59], v[40:43], v[64:79]
    ds_read_b128 v[36:39], v4 offset:1024
    ds_read_b64_tr_b16 v[52:53], v8 offset:2048
    ds_read_b64_tr_b16 v[54:55], v8 offset:3072
    s_waitcnt lgkmcnt(6)
    v_mfma_f32_32x32x16_bf16 v[64:79], v[60:63], v[44:47], v[64:79]
    ds_read_b128 v[40:43], v4 offset:2048
    ds_read_b64_tr_b16 v[56:57], v8 offset:4096
    ds_read_b64_tr_b16 v[58:59], v8 offset:5120
    s_waitcnt lgkmcnt(6)
    v_mfma_f32_32x32x16_bf16 v[64:79], v[48:51], v[32:35], v[64:79]
    ds_read_b128 v[44:47], v4 offset:3072
    ds_read_b64_tr_b16 v[60:61], v8 offset:6144
    ds_read_b64_tr_b16 v[62:63], v8 offset:7168
    s_waitcnt lgkmcnt(6)
    v_mfma_f32_32x32x16_bf16 v[64:79], v[52:55], v[36:39], v[64:79]
    ds_read_b128 v[32:35], v4 offset:4096
    ds_read_b64_tr_b16 v[48:49], v8 offset:8192
    ds_read_b64_tr_b16 v[50:51], v8 offset:9216
    s_waitcnt lgkmcnt(6)
    v_mfma_f32_32x32x16_bf16 v[64:79], v[56:59], v[40:43], v[64:79]
    ds_read_b128 v[36:39], v4 offset:5120
    ds_read_b64_tr_b16 v[52:53], v8 offset:10240
    ds_read_b64_tr_b16 v[54:55], v8 offset:11264
    s_waitcnt lgkmcnt(6)
    v_mfma_f32_32x32x16_bf16 v[64:79], v[60:63], v[44:47], v[64:79]
    ds_read_b128 v[40:43], v4 offset:6144
    ds_read_b64_tr_b16 v[56:57], v8 offset:12288
    ds_read_b64_tr_b16 v[58:59], v8 offset:13312
    s_waitcnt lgkmcnt(6)
    v_mfma_f32_32x32x16_bf16 v[64:79], v[48:51], v[32:35], v[64:79]
    ds_read_b128 v[44:47], v4 offset:7168
    ds_read_b64_tr_b16 v[60:61], v8 offset:14336
    ds_read_b64_tr_b16 v[62:63], v8 offset:15360
    s_waitcnt lgkmcnt(6)
    v_mfma_f32_32x32x16_bf16 v[64:79], v[52:55], v[36:39], v[64:79]
    s_barrier
    ds_read_b128 v[32:35], v4 offset:32768
    ds_read_b64_tr_b16 v[48:49], v8 offset:32768
    ds_read_b64_tr_b16 v[50:51], v8 offset:33792
    s_waitcnt lgkmcnt(6)
    v_mfma_f32_32x32x16_bf16 v[64:79], v[56:59], v[40:43], v[64:79]
    ds_read_b128 v[36:39], v4 offset:33792
    ds_read_b64_tr_b16 v[52:53], v8 offset:34816
    ds_read_b64_tr_b16 v[54:55], v8 offset:35840
    s_waitcnt lgkmcnt(6)
    v_mfma_f32_32x32x16_bf16 v[64:79], v[60:63], v[44:47], v[64:79]
    ds_read_b128 v[40:43], v4 offset:34816
    ds_read_b64_tr_b16 v[56:57], v8 offset:36864
    ds_read_b64_tr_b16 v[58:59], v8 offset:37888
    s_waitcnt lgkmcnt(6)
    v_mfma_f32_32x32x16_bf16 v[64:79], v[48:51], v[32:35], v[64:79]
    ds_read_b128 v[44:47], v4 offset:35840
    ds_read_b64_tr_b16 v[60:61], v8 offset:38912
    ds_read_b64_tr_b16 v[62:63], v8 offset:39936
    s_waitcnt lgkmcnt(6)
    v_mfma_f32_32x32x16_bf16 v[64:79], v[52:55], v[36:39], v[64:79]
    ds_read_b128 v[32:35], v4 offset:36864
    ds_read_b64_tr_b16 v[48:49], v8 offset:40960
    ds_read_b64_tr_b16 v[50:51], v8 offset:41984
    s_waitcnt lgkmcnt(6)
    v_mfma_f32_32x32x16_bf16 v[64:79], v[56:59], v[40:43], v[64:79]
    ds_read_b128 v[36:39], v4 offset:37888
    ds_read_b64_tr_b16 v[52:53], v8 offset:43008
    ds_read_b64_tr_b16 v[54:55], v8 offset:44032
    s_waitcnt lgkmcnt(6)
    v_mfma_f32_32x32x16_bf16 v[64:79], v[60:63], v[44:47], v[64:79]
    ds_read_b128 v[40:43], v4 offset:38912
    ds_read_b64_tr_b16 v[56:57], v8 offset:45056
    ds_read_b64_tr_b16 v[58:59], v8 offset:46080
    s_waitcnt lgkmcnt(6)
    v_mfma_f32_32x32x16_bf16 v[64:79], v[48:51], v[32:35], v[64:79]
    ds_read_b128 v[44:47], v4 offset:39936
    ds_read_b64_tr_b16 v[60:61], v8 offset:47104
    ds_read_b64_tr_b16 v[62:63], v8 offset:48128
    s_waitcnt lgkmcnt(6)
    v_mfma_f32_32x32x16_bf16 v[64:79], v[52:55], v[36:39], v[64:79]
    s_barrier
    ds_read_b128 v[32:35], v10 offset:0
    ds_read_b64_tr_b16 v[48:49], v14 offset:0
    ds_read_b64_tr_b16 v[50:51], v14 offset:1024
    s_waitcnt lgkmcnt(6)
    v_mfma_f32_32x32x16_bf16 v[64:79], v[56:59], v[40:43], v[64:79]
    ds_read_b128 v[36:39], v10 offset:1024
    ds_read_b64_tr_b16 v[52:53], v14 offset:2048
    ds_read_b64_tr_b16 v[54:55], v14 offset:3072
    s_waitcnt lgkmcnt(6)
    v_mfma_f32_32x32x16_bf16 v[64:79], v[60:63], v[44:47], v[64:79]
    ds_read_b128 v[40:43], v10 offset:2048
    ds_read_b64_tr_b16 v[56:57], v14 offset:4096
    ds_read_b64_tr_b16 v[58:59], v14 offset:5120
    s_waitcnt lgkmcnt(6)
    v_mfma_f32_32x32x16_bf16 v[64:79], v[48:51], v[32:35], v[64:79]
    ds_read_b128 v[44:47], v10 offset:3072
    ds_read_b64_tr_b16 v[60:61], v14 offset:6144
    ds_read_b64_tr_b16 v[62:63], v14 offset:7168
    s_waitcnt lgkmcnt(6)
    v_mfma_f32_32x32x16_bf16 v[64:79], v[52:55], v[36:39], v[64:79]
    ds_read_b128 v[32:35], v10 offset:4096
    ds_read_b64_tr_b16 v[48:49], v14 offset:8192
    ds_read_b64_tr_b16 v[50:51], v14 offset:9216
    s_waitcnt lgkmcnt(6)
    v_mfma_f32_32x32x16_bf16 v[64:79], v[56:59], v[40:43], v[64:79]
    ds_read_b128 v[36:39], v10 offset:5120
    ds_read_b64_tr_b16 v[52:53], v14 offset:10240
    ds_read_b64_tr_b16 v[54:55], v14 offset:11264
    s_waitcnt lgkmcnt(6)
    v_mfma_f32_32x32x16_bf16 v[64:79], v[60:63], v[44:47], v[64:79]
    ds_read_b128 v[40:43], v10 offset:6144
    ds_read_b64_tr_b16 v[56:57], v14 offset:12288
    ds_read_b64_tr_b16 v[58:59], v14 offset:13312
    s_waitcnt lgkmcnt(6)
    v_mfma_f32_32x32x16_bf16 v[64:79], v[48:51], v[32:35], v[64:79]
    ds_read_b128 v[44:47], v10 offset:7168
    ds_read_b64_tr_b16 v[60:61], v14 offset:14336
    ds_read_b64_tr_b16 v[62:63], v14 offset:15360
    s_waitcnt lgkmcnt(6)
    v_mfma_f32_32x32x16_bf16 v[64:79], v[52:55], v[36:39], v[64:79]
    s_barrier
    ds_read_b128 v[32:35], v16 offset:0
    ds_read_b64_tr_b16 v[48:49], v20 offset:0
    ds_read_b64_tr_b16 v[50:51], v20 offset:1024
    s_waitcnt lgkmcnt(6)
    v_mfma_f32_32x32x16_bf16 v[64:79], v[56:59], v[40:43], v[64:79]
    ds_read_b128 v[36:39], v16 offset:1024
    ds_read_b64_tr_b16 v[52:53], v20 offset:2048
    ds_read_b64_tr_b16 v[54:55], v20 offset:3072
    s_waitcnt lgkmcnt(6)
    v_mfma_f32_32x32x16_bf16 v[64:79], v[60:63], v[44:47], v[64:79]
    ds_read_b128 v[40:43], v16 offset:2048
    ds_read_b64_tr_b16 v[56:57], v20 offset:4096
    ds_read_b64_tr_b16 v[58:59], v20 offset:5120
    s_waitcnt lgkmcnt(6)
    v_mfma_f32_32x32x16_bf16 v[64:79], v[48:51], v[32:35], v[64:79]
    ds_read_b128 v[44:47], v16 offset:3072
    ds_read_b64_tr_b16 v[60:61], v20 offset:6144
    ds_read_b64_tr_b16 v[62:63], v20 offset:7168
    s_waitcnt lgkmcnt(6)
    v_mfma_f32_32x32x16_bf16 v[64:79], v[52:55], v[36:39], v[64:79]
    ds_read_b128 v[32:35], v16 offset:4096
    ds_read_b64_tr_b16 v[48:49], v20 offset:8192
    ds_read_b64_tr_b16 v[50:51], v20 offset:9216
    s_waitcnt lgkmcnt(6)
    v_mfma_f32_32x32x16_bf16 v[64:79], v[56:59], v[40:43], v[64:79]
    ds_read_b128 v[36:39], v16 offset:5120
    ds_read_b64_tr_b16 v[52:53], v20 offset:10240
    ds_read_b64_tr_b16 v[54:55], v20 offset:11264
    s_waitcnt lgkmcnt(6)
    v_mfma_f32_32x32x16_bf16 v[64:79], v[60:63], v[44:47], v[64:79]
    ds_read_b128 v[40:43], v16 offset:6144
    ds_read_b64_tr_b16 v[56:57], v20 offset:12288
    ds_read_b64_tr_b16 v[58:59], v20 offset:13312
    s_waitcnt lgkmcnt(6)
    v_mfma_f32_32x32x16_bf16 v[64:79], v[48:51], v[32:35], v[64:79]
    ds_read_b128 v[44:47], v16 offset:7168
    ds_read_b64_tr_b16 v[60:61], v20 offset:14336
    ds_read_b64_tr_b16 v[62:63], v20 offset:15360
    s_waitcnt lgkmcnt(6)
    v_mfma_f32_32x32x16_bf16 v[64:79], v[52:55], v[36:39], v[64:79]
    s_barrier
    ds_read_b128 v[32:35], v16 offset:32768
    ds_read_b64_tr_b16 v[48:49], v20 offset:32768
    ds_read_b64_tr_b16 v[50:51], v20 offset:33792
    s_waitcnt lgkmcnt(6)
    v_mfma_f32_32x32x16_bf16 v[64:79], v[56:59], v[40:43], v[64:79]
    ds_read_b128 v[36:39], v16 offset:33792
    ds_read_b64_tr_b16 v[52:53], v20 offset:34816
    ds_read_b64_tr_b16 v[54:55], v20 offset:35840
    s_waitcnt lgkmcnt(6)
    v_mfma_f32_32x32x16_bf16 v[64:79], v[60:63], v[44:47], v[64:79]
    ds_read_b128 v[40:43], v16 offset:34816
    ds_read_b64_tr_b16 v[56:57], v20 offset:36864
    ds_read_b64_tr_b16 v[58:59], v20 offset:37888
    s_waitcnt lgkmcnt(6)
    v_mfma_f32_32x32x16_bf16 v[64:79], v[48:51], v[32:35], v[64:79]
    ds_read_b128 v[44:47], v16 offset:35840
    ds_read_b64_tr_b16 v[60:61], v20 offset:38912
    ds_read_b64_tr_b16 v[62:63], v20 offset:39936
    s_waitcnt lgkmcnt(6)
    v_mfma_f32_32x32x16_bf16 v[64:79], v[52:55], v[36:39], v[64:79]
    ds_read_b128 v[32:35], v16 offset:36864
    ds_read_b64_tr_b16 v[48:49], v20 offset:40960
    ds_read_b64_tr_b16 v[50:51], v20 offset:41984
    s_waitcnt lgkmcnt(6)
    v_mfma_f32_32x32x16_bf16 v[64:79], v[56:59], v[40:43], v[64:79]
    ds_read_b128 v[36:39], v16 offset:37888
    ds_read_b64_tr_b16 v[52:53], v20 offset:43008
    ds_read_b64_tr_b16 v[54:55], v20 offset:44032
    s_waitcnt lgkmcnt(6)
    v_mfma_f32_32x32x16_bf16 v[64:79], v[60:63], v[44:47], v[64:79]
    ds_read_b128 v[40:43], v16 offset:38912
    ds_read_b64_tr_b16 v[56:57], v20 offset:45056
    ds_read_b64_tr_b16 v[58:59], v20 offset:46080
    s_waitcnt lgkmcnt(6)
    v_mfma_f32_32x32x16_bf16 v[64:79], v[48:51], v[32:35], v[64:79]
    ds_read_b128 v[44:47], v16 offset:39936
    ds_read_b64_tr_b16 v[60:61], v20 offset:47104
    ds_read_b64_tr_b16 v[62:63], v20 offset:48128
    s_waitcnt lgkmcnt(6)
    v_mfma_f32_32x32x16_bf16 v[64:79], v[52:55], v[36:39], v[64:79]
    s_barrier
    ds_read_b128 v[32:35], v4 offset:0
    ds_read_b64_tr_b16 v[48:49], v8 offset:0
    ds_read_b64_tr_b16 v[50:51], v8 offset:1024
    s_waitcnt lgkmcnt(6)
    v_mfma_f32_32x32x16_bf16 v[64:79], v[56:59], v[40:43], v[64:79]
    ds_read_b128 v[36:39], v4 offset:1024
    ds_read_b64_tr_b16 v[52:53], v8 offset:2048
    ds_read_b64_tr_b16 v[54:55], v8 offset:3072
    s_waitcnt lgkmcnt(6)
    v_mfma_f32_32x32x16_bf16 v[64:79], v[60:63], v[44:47], v[64:79]
    ds_read_b128 v[40:43], v4 offset:2048
    ds_read_b64_tr_b16 v[56:57], v8 offset:4096
    ds_read_b64_tr_b16 v[58:59], v8 offset:5120
    s_waitcnt lgkmcnt(6)
    v_mfma_f32_32x32x16_bf16 v[64:79], v[48:51], v[32:35], v[64:79]
    ds_read_b128 v[44:47], v4 offset:3072
    ds_read_b64_tr_b16 v[60:61], v8 offset:6144
    ds_read_b64_tr_b16 v[62:63], v8 offset:7168
    s_waitcnt lgkmcnt(6)
    v_mfma_f32_32x32x16_bf16 v[64:79], v[52:55], v[36:39], v[64:79]
    ds_read_b128 v[32:35], v4 offset:4096
    ds_read_b64_tr_b16 v[48:49], v8 offset:8192
    ds_read_b64_tr_b16 v[50:51], v8 offset:9216
    s_waitcnt lgkmcnt(6)
    v_mfma_f32_32x32x16_bf16 v[64:79], v[56:59], v[40:43], v[64:79]
    ds_read_b128 v[36:39], v4 offset:5120
    ds_read_b64_tr_b16 v[52:53], v8 offset:10240
    ds_read_b64_tr_b16 v[54:55], v8 offset:11264
    s_waitcnt lgkmcnt(6)
    v_mfma_f32_32x32x16_bf16 v[64:79], v[60:63], v[44:47], v[64:79]
    ds_read_b128 v[40:43], v4 offset:6144
    ds_read_b64_tr_b16 v[56:57], v8 offset:12288
    ds_read_b64_tr_b16 v[58:59], v8 offset:13312
    s_waitcnt lgkmcnt(6)
    v_mfma_f32_32x32x16_bf16 v[64:79], v[48:51], v[32:35], v[64:79]
    ds_read_b128 v[44:47], v4 offset:7168
    ds_read_b64_tr_b16 v[60:61], v8 offset:14336
    ds_read_b64_tr_b16 v[62:63], v8 offset:15360
    s_waitcnt lgkmcnt(6)
    v_mfma_f32_32x32x16_bf16 v[64:79], v[52:55], v[36:39], v[64:79]
    s_barrier
    ds_read_b128 v[32:35], v4 offset:32768
    ds_read_b64_tr_b16 v[48:49], v8 offset:32768
    ds_read_b64_tr_b16 v[50:51], v8 offset:33792
    s_waitcnt lgkmcnt(6)
    v_mfma_f32_32x32x16_bf16 v[64:79], v[56:59], v[40:43], v[64:79]
    ds_read_b128 v[36:39], v4 offset:33792
    ds_read_b64_tr_b16 v[52:53], v8 offset:34816
    ds_read_b64_tr_b16 v[54:55], v8 offset:35840
    s_waitcnt lgkmcnt(6)
    v_mfma_f32_32x32x16_bf16 v[64:79], v[60:63], v[44:47], v[64:79]
    ds_read_b128 v[40:43], v4 offset:34816
    ds_read_b64_tr_b16 v[56:57], v8 offset:36864
    ds_read_b64_tr_b16 v[58:59], v8 offset:37888
    s_waitcnt lgkmcnt(6)
    v_mfma_f32_32x32x16_bf16 v[64:79], v[48:51], v[32:35], v[64:79]
    ds_read_b128 v[44:47], v4 offset:35840
    ds_read_b64_tr_b16 v[60:61], v8 offset:38912
    ds_read_b64_tr_b16 v[62:63], v8 offset:39936
    s_waitcnt lgkmcnt(6)
    v_mfma_f32_32x32x16_bf16 v[64:79], v[52:55], v[36:39], v[64:79]
    ds_read_b128 v[32:35], v4 offset:36864
    ds_read_b64_tr_b16 v[48:49], v8 offset:40960
    ds_read_b64_tr_b16 v[50:51], v8 offset:41984
    s_waitcnt lgkmcnt(6)
    v_mfma_f32_32x32x16_bf16 v[64:79], v[56:59], v[40:43], v[64:79]
    ds_read_b128 v[36:39], v4 offset:37888
    ds_read_b64_tr_b16 v[52:53], v8 offset:43008
    ds_read_b64_tr_b16 v[54:55], v8 offset:44032
    s_waitcnt lgkmcnt(6)
    v_mfma_f32_32x32x16_bf16 v[64:79], v[60:63], v[44:47], v[64:79]
    ds_read_b128 v[40:43], v4 offset:38912
    ds_read_b64_tr_b16 v[56:57], v8 offset:45056
    ds_read_b64_tr_b16 v[58:59], v8 offset:46080
    s_waitcnt lgkmcnt(6)
    v_mfma_f32_32x32x16_bf16 v[64:79], v[48:51], v[32:35], v[64:79]
    ds_read_b128 v[44:47], v4 offset:39936
    ds_read_b64_tr_b16 v[60:61], v8 offset:47104
    ds_read_b64_tr_b16 v[62:63], v8 offset:48128
    s_waitcnt lgkmcnt(6)
    v_mfma_f32_32x32x16_bf16 v[64:79], v[52:55], v[36:39], v[64:79]
    s_waitcnt lgkmcnt(3)
    v_mfma_f32_32x32x16_bf16 v[64:79], v[56:59], v[40:43], v[64:79]
    s_waitcnt lgkmcnt(0)
    v_mfma_f32_32x32x16_bf16 v[64:79], v[60:63], v[44:47], v[64:79]
    s_waitcnt vmcnt(0)
    s_nop 15
    v_lshlrev_b32 v144, 16, v24
    v_and_b32 v145, 0xffff0000, v24
    v_add_f32 v64, v64, v144
    v_add_f32 v65, v65, v145
    v_lshlrev_b32 v144, 16, v25
    v_and_b32 v145, 0xffff0000, v25
    v_add_f32 v66, v66, v144
    v_add_f32 v67, v67, v145
    v_lshlrev_b32 v144, 16, v26
    v_and_b32 v145, 0xffff0000, v26
    v_add_f32 v68, v68, v144
    v_add_f32 v69, v69, v145
    v_lshlrev_b32 v144, 16, v27
    v_and_b32 v145, 0xffff0000, v27
    v_add_f32 v70, v70, v144
    v_add_f32 v71, v71, v145
    v_lshlrev_b32 v144, 16, v28
    v_and_b32 v145, 0xffff0000, v28
    v_add_f32 v72, v72, v144
    v_add_f32 v73, v73, v145
    v_lshlrev_b32 v144, 16, v29
    v_and_b32 v145, 0xffff0000, v29
    v_add_f32 v74, v74, v144
    v_add_f32 v75, v75, v145
    v_lshlrev_b32 v144, 16, v30
    v_and_b32 v145, 0xffff0000, v30
    v_add_f32 v76, v76, v144
    v_add_f32 v77, v77, v145
    v_lshlrev_b32 v144, 16, v31
    v_and_b32 v145, 0xffff0000, v31
    v_add_f32 v78, v78, v144
    v_add_f32 v79, v79, v145
    v_cvt_pk_bf16_f32 v148, v64, v65
    v_cvt_pk_bf16_f32 v149, v66, v67
    v_cvt_pk_bf16_f32 v150, v68, v69
    v_cvt_pk_bf16_f32 v151, v70, v71
    v_cvt_pk_bf16_f32 v152, v72, v73
    v_cvt_pk_bf16_f32 v153, v74, v75
    v_cvt_pk_bf16_f32 v154, v76, v77
    v_cvt_pk_bf16_f32 v155, v78, v79
    buffer_store_dwordx4 v[148:151], v3, s[16:19], s33 offen offset:0 sc0 sc1
    buffer_store_dwordx4 v[152:155], v3, s[16:19], s33 offen offset:1024 sc0 sc1
    v_mov_b32 v128, 0
    v_mov_b32 v130, 0
    v_dot2_f32_bf16 v128, v148, s29, v128
    v_dot2_f32_bf16 v130, v148, v148, v130
    v_dot2_f32_bf16 v128, v149, s29, v128
    v_dot2_f32_bf16 v130, v149, v149, v130
    v_dot2_f32_bf16 v128, v150, s29, v128
    v_dot2_f32_bf16 v130, v150, v150, v130
    v_dot2_f32_bf16 v128, v151, s29, v128
    v_dot2_f32_bf16 v130, v151, v151, v130
    v_dot2_f32_bf16 v128, v152, s29, v128
    v_dot2_f32_bf16 v130, v152, v152, v130
    v_dot2_f32_bf16 v128, v153, s29, v128
    v_dot2_f32_bf16 v130, v153, v153, v130
    v_dot2_f32_bf16 v128, v154, s29, v128
    v_dot2_f32_bf16 v130, v154, v154, v130
    v_dot2_f32_bf16 v128, v155, s29, v128
    v_dot2_f32_bf16 v130, v155, v155, v130
    v_mov_b32 v144, v128
    s_nop 1
    v_permlane32_swap_b32 v128, v144
    s_nop 1
    v_add_f32 v128, v128, v144
    v_mov_b32 v144, v130
    s_nop 1
    v_permlane32_swap_b32 v130, v144
    s_nop 1
    v_add_f32 v130, v130, v144
    v_cmp_gt_u32 vcc, 32, v2
    s_nop 1
    v_cndmask_b32 v128, v130, v128, vcc
    buffer_store_dword v128, v23, s[40:43], s37 offen
w2_a_kernel_fin:
w2_a_kernel_done:
    s_endpgm
.section .rodata,"a"
.p2align 6
.amdhsa_kernel w2_a_kernel
  .amdhsa_next_free_vgpr 196
  .amdhsa_next_free_sgpr 96
  .amdhsa_accum_offset 196
  .amdhsa_group_segment_fixed_size 0
  .amdhsa_kernarg_size 72
  .amdhsa_user_sgpr_count 2
  .amdhsa_user_sgpr_kernarg_segment_ptr 1
  .amdhsa_system_sgpr_workgroup_id_x 1
  .amdhsa_float_denorm_mode_32 3
.end_amdhsa_kernel
.text
.globl w2_b_kernel
.p2align 8
.type w2_b_kernel,@function
w2_b_kernel:
    s_cmp_ge_u32 s2, 256
    s_cbranch_scc1 w2_b_kernel_done
    s_load_dwordx2 s[8:9], s[0:1], 64
    s_load_dwordx2 s[12:13], s[0:1], 40
    v_lshrrev_b32 v1, 6, v0
    v_and_b32 v2, 63, v0
    s_and_b32 s3, s2, 7
    s_lshr_b32 s4, s2, 3
    v_readfirstlane_b32 s26, v1
    s_and_b32 s5, s3, 3
    s_lshr_b32 s3, s3, 2
    s_lshl_b32 s5, s5, 3
    s_and_b32 s24, s4, 7
    s_add_u32 s24, s24, s5
    s_lshr_b32 s4, s4, 3
    s_lshl_b32 s3, s3, 2
    s_add_u32 s25, s3, s4
    v_lshlrev_b32 v3, 4, v2
    s_cmp_lt_u32 s26, 4
    s_cbranch_scc1 w2_b_kernel_cw
    s_sub_u32 s26, s26, 4
    s_lshr_b32 s27, s26, 1
    s_and_b32 s28, s26, 1
    s_lshl_b32 s30, s26, 12
    v_lshrrev_b32 v12, 3, v2
    v_bfe_u32 v13, v2, 2, 1
    v_bfe_u32 v14, v2, 4, 1
    v_xor_b32 v13, v13, v14
    v_lshlrev_b32 v13, 6, v13
    v_and_b32 v14, 3, v2
    v_lshlrev_b32 v14, 4, v14
    v_mul_u32_u24 v12, 1024, v12
    v_add3_u32 v8, v12, v13, v14
    v_add_u32 v9, 7168, v8
    v_add_u32 v10, 14336, v8
    v_add_u32 v11, 21504, v8
    s_lshl_b32 s31, s24, 1
    s_add_u32 s31, s31, s27
    s_mul_i32 s31, s31, 114688
    s_lshl_b32 s3, s28, 12
    s_add_u32 s31, s31, s3
    s_mul_i32 s32, s26, 32768
    s_lshl_b32 s3, s25, 7
    s_add_u32 s32, s32, s3
    s_waitcnt lgkmcnt(0)
    s_add_u32 s8, s8, 0xa00000
    s_addc_u32 s9, s9, 0
    s_mov_b32 s10, 0x700000
    s_mov_b32 s11, 0x00020000
    s_mov_b32 s14, 0x1c0000
    s_mov_b32 s15, 0x00020000
    s_add_u32 m0, s30, 16384
    s_add_u32 s3, s32, 0
    buffer_load_dwordx4 v8, s[12:15], s3 offen offset:0 lds
    buffer_load_dwordx4 v9, s[12:15], s3 offen offset:1024 lds
    buffer_load_dwordx4 v10, s[12:15], s3 offen offset:2048 lds
    buffer_load_dwordx4 v11, s[12:15], s3 offen offset:3072 lds
    s_add_u32 m0, s30, 0
    s_add_u32 s3, s31, 0
    buffer_load_dwordx4 v3, s[8:11], s3 offen offset:0 lds
    buffer_load_dwordx4 v3, s[8:11], s3 offen offset:1024 lds
    buffer_load_dwordx4 v3, s[8:11], s3 offen offset:2048 lds
    buffer_load_dwordx4 v3, s[8:11], s3 offen offset:3072 lds
    s_add_u32 m0, s30, 49152
    s_add_u32 s3, s32, 131072
    buffer_load_dwordx4 v8, s[12:15], s3 offen offset:0 lds
    buffer_load_dwordx4 v9, s[12:15], s3 offen offset:1024 lds
    buffer_load_dwordx4 v10, s[12:15], s3 offen offset:2048 lds
    buffer_load_dwordx4 v11, s[12:15], s3 offen offset:3072 lds
    s_add_u32 m0, s30, 32768
    s_add_u32 s3, s31, 8192
    buffer_load_dwordx4 v3, s[8:11], s3 offen offset:0 lds
    buffer_load_dwordx4 v3, s[8:11], s3 offen offset:1024 lds
    buffer_load_dwordx4 v3, s[8:11], s3 offen offset:2048 lds
    buffer_load_dwordx4 v3, s[8:11], s3 offen offset:3072 lds
    s_waitcnt vmcnt(8)
    s_barrier
    s_add_u32 m0, s30, 81920
    s_add_u32 s3, s32, 262144
    buffer_load_dwordx4 v8, s[12:15], s3 offen offset:0 lds
    buffer_load_dwordx4 v9, s[12:15], s3 offen offset:1024 lds
    buffer_load_dwordx4 v10, s[12:15], s3 offen offset:2048 lds
    buffer_load_dwordx4 v11, s[12:15], s3 offen offset:3072 lds
    s_add_u32 m0, s30, 65536
    s_add_u32 s3, s31, 16384
    buffer_load_dwordx4 v3, s[8:11], s3 offen offset:0 lds
    buffer_load_dwordx4 v3, s[8:11], s3 offen offset:1024 lds
    buffer_load_dwordx4 v3, s[8:11], s3 offen offset:2048 lds
    buffer_load_dwordx4 v3, s[8:11], s3 offen offset:3072 lds
    s_waitcnt vmcnt(8)
    s_barrier
    s_add_u32 m0, s30, 114688
    s_add_u32 s3, s32, 393216
    buffer_load_dwordx4 v8, s[12:15], s3 offen offset:0 lds
    buffer_load_dwordx4 v9, s[12:15], s3 offen offset:1024 lds
    buffer_load_dwordx4 v10, s[12:15], s3 offen offset:2048 lds
    buffer_load_dwordx4 v11, s[12:15], s3 offen offset:3072 lds
    s_add_u32 m0, s30, 98304
    s_add_u32 s3, s31, 24576
    buffer_load_dwordx4 v3, s[8:11], s3 offen offset:0 lds
    buffer_load_dwordx4 v3, s[8:11], s3 offen offset:1024 lds
    buffer_load_dwordx4 v3, s[8:11], s3 offen offset:2048 lds
    buffer_load_dwordx4 v3, s[8:11], s3 offen offset:3072 lds
    s_waitcnt vmcnt(8)
    s_barrier
    s_add_u32 m0, s30, 147456
    s_add_u32 s3, s32, 524288
    buffer_load_dwordx4 v8, s[12:15], s3 offen offset:0 lds
    buffer_load_dwordx4 v9, s[12:15], s3 offen offset:1024 lds
    buffer_load_dwordx4 v10, s[12:15], s3 offen offset:2048 lds
    buffer_load_dwordx4 v11, s[12:15], s3 offen offset:3072 lds
    s_add_u32 m0, s30, 131072
    s_add_u32 s3, s31, 32768
    buffer_load_dwordx4 v3, s[8:11], s3 offen offset:0 lds
    buffer_load_dwordx4 v3, s[8:11], s3 offen offset:1024 lds
    buffer_load_dwordx4 v3, s[8:11], s3 offen offset:2048 lds
    buffer_load_dwordx4 v3, s[8:11], s3 offen offset:3072 lds
    s_waitcnt vmcnt(8)
    s_barrier
    s_add_u32 m0, s30, 16384
    s_add_u32 s3, s32, 655360
    buffer_load_dwordx4 v8, s[12:15], s3 offen offset:0 lds
    buffer_load_dwordx4 v9, s[12:15], s3 offen offset:1024 lds
    buffer_load_dwordx4 v10, s[12:15], s3 offen offset:2048 lds
    buffer_load_dwordx4 v11, s[12:15], s3 offen offset:3072 lds
    s_add_u32 m0, s30, 0
    s_add_u32 s3, s31, 40960
    buffer_load_dwordx4 v3, s[8:11], s3 offen offset:0 lds
    buffer_load_dwordx4 v3, s[8:11], s3 offen offset:1024 lds
    buffer_load_dwordx4 v3, s[8:11], s3 offen offset:2048 lds
    buffer_load_dwordx4 v3, s[8:11], s3 offen offset:3072 lds
    s_waitcnt vmcnt(8)
    s_barrier
    s_add_u32 m0, s30, 49152
    s_add_u32 s3, s32, 786432
    buffer_load_dwordx4 v8, s[12:15], s3 offen offset:0 lds
    buffer_load_dwordx4 v9, s[12:15], s3 offen offset:1024 lds
    buffer_load_dwordx4 v10, s[12:15], s3 offen offset:2048 lds
    buffer_load_dwordx4 v11, s[12:15], s3 offen offset:3072 lds
    s_add_u32 m0, s30, 32768
    s_add_u32 s3, s31, 49152
    buffer_load_dwordx4 v3, s[8:11], s3 offen offset:0 lds
    buffer_load_dwordx4 v3, s[8:11], s3 offen offset:1024 lds
    buffer_load_dwordx4 v3, s[8:11], s3 offen offset:2048 lds
    buffer_load_dwordx4 v3, s[8:11], s3 offen offset:3072 lds
    s_waitcnt vmcnt(8)
    s_barrier
    s_add_u32 m0, s30, 81920
    s_add_u32 s3, s32, 917504
    buffer_load_dwordx4 v8, s[12:15], s3 offen offset:0 lds
    buffer_load_dwordx4 v9, s[12:15], s3 offen offset:1024 lds
    buffer_load_dwordx4 v10, s[12:15], s3 offen offset:2048 lds
    buffer_load_dwordx4 v11, s[12:15], s3 offen offset:3072 lds
    s_add_u32 m0, s30, 65536
    s_add_u32 s3, s31, 57344
    buffer_load_dwordx4 v3, s[8:11], s3 offen offset:0 lds
    buffer_load_dwordx4 v3, s[8:11], s3 offen offset:1024 lds
    buffer_load_dwordx4 v3, s[8:11], s3 offen offset:2048 lds
    buffer_load_dwordx4 v3, s[8:11], s3 offen offset:3072 lds
    s_waitcnt vmcnt(8)
    s_barrier
    s_add_u32 m0, s30, 114688
    s_add_u32 s3, s32, 1048576
    buffer_load_dwordx4 v8, s[12:15], s3 offen offset:0 lds
    buffer_load_dwordx4 v9, s[12:15], s3 offen offset:1024 lds
    buffer_load_dwordx4 v10, s[12:15], s3 offen offset:2048 lds
    buffer_load_dwordx4 v11, s[12:15], s3 offen offset:3072 lds
    s_add_u32 m0, s30, 98304
    s_add_u32 s3, s31, 65536
    buffer_load_dwordx4 v3, s[8:11], s3 offen offset:0 lds
    buffer_load_dwordx4 v3, s[8:11], s3 offen offset:1024 lds
    buffer_load_dwordx4 v3, s[8:11], s3 offen offset:2048 lds
    buffer_load_dwordx4 v3, s[8:11], s3 offen offset:3072 lds
    s_waitcnt vmcnt(8)
    s_barrier
    s_add_u32 m0, s30, 147456
    s_add_u32 s3, s32, 1179648
    buffer_load_dwordx4 v8, s[12:15], s3 offen offset:0 lds
    buffer_load_dwordx4 v9, s[12:15], s3 offen offset:1024 lds
    buffer_load_dwordx4 v10, s[12:15], s3 offen offset:2048 lds
    buffer_load_dwordx4 v11, s[12:15], s3 offen offset:3072 lds
    s_add_u32 m0, s30, 131072
    s_add_u32 s3, s31, 73728
    buffer_load_dwordx4 v3, s[8:11], s3 offen offset:0 lds
    buffer_load_dwordx4 v3, s[8:11], s3 offen offset:1024 lds
    buffer_load_dwordx4 v3, s[8:11], s3 offen offset:2048 lds
    buffer_load_dwordx4 v3, s[8:11], s3 offen offset:3072 lds
    s_waitcnt vmcnt(8)
    s_barrier
    s_add_u32 m0, s30, 16384
    s_add_u32 s3, s32, 1310720
    buffer_load_dwordx4 v8, s[12:15], s3 offen offset:0 lds
    buffer_load_dwordx4 v9, s[12:15], s3 offen offset:1024 lds
    buffer_load_dwordx4 v10, s[12:15], s3 offen offset:2048 lds
    buffer_load_dwordx4 v11, s[12:15], s3 offen offset:3072 lds
    s_add_u32 m0, s30, 0
    s_add_u32 s3, s31, 81920
    buffer_load_dwordx4 v3, s[8:11], s3 offen offset:0 lds
    buffer_load_dwordx4 v3, s[8:11], s3 offen offset:1024 lds
    buffer_load_dwordx4 v3, s[8:11], s3 offen offset:2048 lds
    buffer_load_dwordx4 v3, s[8:11], s3 offen offset:3072 lds
    s_waitcnt vmcnt(8)
    s_barrier
    s_add_u32 m0, s30, 49152
    s_add_u32 s3, s32, 1441792
    buffer_load_dwordx4 v8, s[12:15], s3 offen offset:0 lds
    buffer_load_dwordx4 v9, s[12:15], s3 offen offset:1024 lds
    buffer_load_dwordx4 v10, s[12:15], s3 offen offset:2048 lds
    buffer_load_dwordx4 v11, s[12:15], s3 offen offset:3072 lds
    s_add_u32 m0, s30, 32768
    s_add_u32 s3, s31, 90112
    buffer_load_dwordx4 v3, s[8:11], s3 offen offset:0 lds
    buffer_load_dwordx4 v3, s[8:11], s3 offen offset:1024 lds
    buffer_load_dwordx4 v3, s[8:11], s3 offen offset:2048 lds
    buffer_load_dwordx4 v3, s[8:11], s3 offen offset:3072 lds
    s_waitcnt vmcnt(8)
    s_barrier
    s_add_u32 m0, s30, 81920
    s_add_u32 s3, s32, 1572864
    buffer_load_dwordx4 v8, s[12:15], s3 offen offset:0 lds
    buffer_load_dwordx4 v9, s[12:15], s3 offen offset:1024 lds
    buffer_load_dwordx4 v10, s[12:15], s3 offen offset:2048 lds
    buffer_load_dwordx4 v11, s[12:15], s3 offen offset:3072 lds
    s_add_u32 m0, s30, 65536
    s_add_u32 s3, s31, 98304
    buffer_load_dwordx4 v3, s[8:11], s3 offen offset:0 lds
    buffer_load_dwordx4 v3, s[8:11], s3 offen offset:1024 lds
    buffer_load_dwordx4 v3, s[8:11], s3 offen offset:2048 lds
    buffer_load_dwordx4 v3, s[8:11], s3 offen offset:3072 lds
    s_waitcnt vmcnt(8)
    s_barrier
    s_add_u32 m0, s30, 114688
    s_add_u32 s3, s32, 1703936
    buffer_load_dwordx4 v8, s[12:15], s3 offen offset:0 lds
    buffer_load_dwordx4 v9, s[12:15], s3 offen offset:1024 lds
    buffer_load_dwordx4 v10, s[12:15], s3 offen offset:2048 lds
    buffer_load_dwordx4 v11, s[12:15], s3 offen offset:3072 lds
    s_add_u32 m0, s30, 98304
    s_add_u32 s3, s31, 106496
    buffer_load_dwordx4 v3, s[8:11], s3 offen offset:0 lds
    buffer_load_dwordx4 v3, s[8:11], s3 offen offset:1024 lds
    buffer_load_dwordx4 v3, s[8:11], s3 offen offset:2048 lds
    buffer_load_dwordx4 v3, s[8:11], s3 offen offset:3072 lds
    s_waitcnt vmcnt(8)
    s_barrier
    s_waitcnt vmcnt(0)
    s_barrier
    s_endpgm
w2_b_kernel_cw:
    s_lshr_b32 s27, s26, 1
    s_and_b32 s28, s26, 1
    s_mov_b32 s29, 0x3f803f80
    s_load_dwordx2 s[16:17], s[0:1], 48
    s_load_dwordx2 s[20:21], s[0:1], 64
    s_lshl_b32 s3, s27, 13
    v_add_u32 v16, s3, v3
    v_bfe_u32 v12, v2, 2, 2
    v_lshrrev_b32 v13, 5, v2
    v_lshlrev_b32 v13, 2, v13
    v_add_u32 v13, v13, v12
    v_mul_u32_u24 v13, 128, v13
    v_bfe_u32 v14, v2, 4, 1
    v_lshlrev_b32 v14, 5, v14
    v_and_b32 v15, 3, v2
    v_lshlrev_b32 v15, 3, v15
    v_add3_u32 v13, v13, v14, v15
    v_add_u32 v13, 16384, v13
    v_lshrrev_b32 v12, 1, v12
    v_xor_b32 v14, s28, v12
    v_lshlrev_b32 v14, 6, v14
    v_add_u32 v20, v13, v14
    v_add_u32 v4, 0x10000, v16
    v_add_u32 v10, 0x20000, v16
    v_add_u32 v8, 0x10000, v20
    v_add_u32 v14, 0x20000, v20
    s_waitcnt lgkmcnt(0)
    s_mov_b32 s18, 0x200000
    s_mov_b32 s19, 0x00020000
    s_mov_b32 s22, 0x200000
    s_mov_b32 s23, 0x00020000
    s_lshl_b32 s33, s24, 1
    s_add_u32 s33, s33, s27
    s_lshl_b32 s34, s25, 1
    s_add_u32 s34, s34, s28
    s_lshl_b32 s35, s33, 15
    s_lshl_b32 s36, s34, 6
    s_add_u32 s36, s36, s35
    s_lshl_b32 s37, s33, 12
    s_lshl_b32 s38, s34, 8
    s_add_u32 s37, s37, s38
    s_lshl_b32 s34, s34, 11
    s_add_u32 s33, s35, s34
    v_and_b32 v22, 31, v2
    v_lshlrev_b32 v23, 3, v22
    v_lshlrev_b32 v22, 10, v22
    v_lshrrev_b32 v1, 5, v2
    v_lshl_add_u32 v22, v1, 3, v22
    v_lshl_add_u32 v23, v1, 2, v23
    buffer_load_dwordx4 v[24:27], v3, s[20:23], s33 offen offset:0
    buffer_load_dwordx4 v[28:31], v3, s[20:23], s33 offen offset:1024
    v_mov_b32 v64, 0
    v_mov_b32 v65, 0
    v_mov_b32 v66, 0
    v_mov_b32 v67, 0
    v_mov_b32 v68, 0
    v_mov_b32 v69, 0
    v_mov_b32 v70, 0
    v_mov_b32 v71, 0
    v_mov_b32 v72, 0
    v_mov_b32 v73, 0
    v_mov_b32 v74, 0
    v_mov_b32 v75, 0
    v_mov_b32 v76, 0
    v_mov_b32 v77, 0
    v_mov_b32 v78, 0
    v_mov_b32 v79, 0
    s_barrier
    ds_read_b128 v[32:35], v16 offset:0
    ds_read_b64_tr_b16 v[48:49], v20 offset:0
    ds_read_b64_tr_b16 v[50:51], v20 offset:1024
    ds_read_b128 v[36:39], v16 offset:1024
    ds_read_b64_tr_b16 v[52:53], v20 offset:2048
    ds_read_b64_tr_b16 v[54:55], v20 offset:3072
    ds_read_b128 v[40:43], v16 offset:2048
    ds_read_b64_tr_b16 v[56:57], v20 offset:4096
    ds_read_b64_tr_b16 v[58:59], v20 offset:5120
    s_waitcnt lgkmcnt(6)
    v_mfma_f32_32x32x16_bf16 v[64:79], v[48:51], v[32:35], v[64:79]
    ds_read_b128 v[44:47], v16 offset:3072
    ds_read_b64_tr_b16 v[60:61], v20 offset:6144
    ds_read_b64_tr_b16 v[62:63], v20 offset:7168
    s_waitcnt lgkmcnt(6)
    v_mfma_f32_32x32x16_bf16 v[64:79], v[52:55], v[36:39], v[64:79]
    ds_read_b128 v[32:35], v16 offset:4096
    ds_read_b64_tr_b16 v[48:49], v20 offset:8192
    ds_read_b64_tr_b16 v[50:51], v20 offset:9216
    s_waitcnt lgkmcnt(6)
    v_mfma_f32_32x32x16_bf16 v[64:79], v[56:59], v[40:43], v[64:79]
    ds_read_b128 v[36:39], v16 offset:5120
    ds_read_b64_tr_b16 v[52:53], v20 offset:10240
    ds_read_b64_tr_b16 v[54:55], v20 offset:11264
    s_waitcnt lgkmcnt(6)
    v_mfma_f32_32x32x16_bf16 v[64:79], v[60:63], v[44:47], v[64:79]
    ds_read_b128 v[40:43], v16 offset:6144
    ds_read_b64_tr_b16 v[56:57], v20 offset:12288
    ds_read_b64_tr_b16 v[58:59], v20 offset:13312
    s_waitcnt lgkmcnt(6)
    v_mfma_f32_32x32x16_bf16 v[64:79], v[48:51], v[32:35], v[64:79]
    ds_read_b128 v[44:47], v16 offset:7168
    ds_read_b64_tr_b16 v[60:61], v20 offset:14336
    ds_read_b64_tr_b16 v[62:63], v20 offset:15360
    s_waitcnt lgkmcnt(6)
    v_mfma_f32_32x32x16_bf16 v[64:79], v[52:55], v[36:39], v[64:79]
    s_barrier
    ds_read_b128 v[32:35], v16 offset:32768
    ds_read_b64_tr_b16 v[48:49], v20 offset:32768
    ds_read_b64_tr_b16 v[50:51], v20 offset:33792
    s_waitcnt lgkmcnt(6)
    v_mfma_f32_32x32x16_bf16 v[64:79], v[56:59], v[40:43], v[64:79]
    ds_read_b128 v[36:39], v16 offset:33792
    ds_read_b64_tr_b16 v[52:53], v20 offset:34816
    ds_read_b64_tr_b16 v[54:55], v20 offset:35840
    s_waitcnt lgkmcnt(6)
    v_mfma_f32_32x32x16_bf16 v[64:79], v[60:63], v[44:47], v[64:79]
    ds_read_b128 v[40:43], v16 offset:34816
    ds_read_b64_tr_b16 v[56:57], v20 offset:36864
    ds_read_b64_tr_b16 v[58:59], v20 offset:37888
    s_waitcnt lgkmcnt(6)
    v_mfma_f32_32x32x16_bf16 v[64:79], v[48:51], v[32:35], v[64:79]
    ds_read_b128 v[44:47], v16 offset:35840
    ds_read_b64_tr_b16 v[60:61], v20 offset:38912
    ds_read_b64_tr_b16 v[62:63], v20 offset:39936
    s_waitcnt lgkmcnt(6)
    v_mfma_f32_32x32x16_bf16 v[64:79], v[52:55], v[36:39], v[64:79]
    ds_read_b128 v[32:35], v16 offset:36864
    ds_read_b64_tr_b16 v[48:49], v20 offset:40960
    ds_read_b64_tr_b16 v[50:51], v20 offset:41984
    s_waitcnt lgkmcnt(6)
    v_mfma_f32_32x32x16_bf16 v[64:79], v[56:59], v[40:43], v[64:79]
    ds_read_b128 v[36:39], v16 offset:37888
    ds_read_b64_tr_b16 v[52:53], v20 offset:43008
    ds_read_b64_tr_b16 v[54:55], v20 offset:44032
    s_waitcnt lgkmcnt(6)
    v_mfma_f32_32x32x16_bf16 v[64:79], v[60:63], v[44:47], v[64:79]
    ds_read_b128 v[40:43], v16 offset:38912
    ds_read_b64_tr_b16 v[56:57], v20 offset:45056
    ds_read_b64_tr_b16 v[58:59], v20 offset:46080
    s_waitcnt lgkmcnt(6)
    v_mfma_f32_32x32x16_bf16 v[64:79], v[48:51], v[32:35], v[64:79]
    ds_read_b128 v[44:47], v16 offset:39936
    ds_read_b64_tr_b16 v[60:61], v20 offset:47104
    ds_read_b64_tr_b16 v[62:63], v20 offset:48128
    s_waitcnt lgkmcnt(6)
    v_mfma_f32_32x32x16_bf16 v[64:79], v[52:55], v[36:39], v[64:79]
    s_barrier
    ds_read_b128 v[32:35], v4 offset:0
    ds_read_b64_tr_b16 v[48:49], v8 offset:0
    ds_read_b64_tr_b16 v[50:51], v8 offset:1024
    s_waitcnt lgkmcnt(6)
    v_mfma_f32_32x32x16_bf16 v[64:79], v[56:59], v[40:43], v[64:79]
    ds_read_b128 v[36:39], v4 offset:1024
    ds_read_b64_tr_b16 v[52:53], v8 offset:2048
    ds_read_b64_tr_b16 v[54:55], v8 offset:3072
    s_waitcnt lgkmcnt(6)
    v_mfma_f32_32x32x16_bf16 v[64:79], v[60:63], v[44:47], v[64:79]
    ds_read_b128 v[40:43], v4 offset:2048
    ds_read_b64_tr_b16 v[56:57], v8 offset:4096
    ds_read_b64_tr_b16 v[58:59], v8 offset:5120
    s_waitcnt lgkmcnt(6)
    v_mfma_f32_32x32x16_bf16 v[64:79], v[48:51], v[32:35], v[64:79]
    ds_read_b128 v[44:47], v4 offset:3072
    ds_read_b64_tr_b16 v[60:61], v8 offset:6144
    ds_read_b64_tr_b16 v[62:63], v8 offset:7168
    s_waitcnt lgkmcnt(6)
    v_mfma_f32_32x32x16_bf16 v[64:79], v[52:55], v[36:39], v[64:79]
    ds_read_b128 v[32:35], v4 offset:4096
    ds_read_b64_tr_b16 v[48:49], v8 offset:8192
    ds_read_b64_tr_b16 v[50:51], v8 offset:9216
    s_waitcnt lgkmcnt(6)
    v_mfma_f32_32x32x16_bf16 v[64:79], v[56:59], v[40:43], v[64:79]
    ds_read_b128 v[36:39], v4 offset:5120
    ds_read_b64_tr_b16 v[52:53], v8 offset:10240
    ds_read_b64_tr_b16 v[54:55], v8 offset:11264
    s_waitcnt lgkmcnt(6)
    v_mfma_f32_32x32x16_bf16 v[64:79], v[60:63], v[44:47], v[64:79]
    ds_read_b128 v[40:43], v4 offset:6144
    ds_read_b64_tr_b16 v[56:57], v8 offset:12288
    ds_read_b64_tr_b16 v[58:59], v8 offset:13312
    s_waitcnt lgkmcnt(6)
    v_mfma_f32_32x32x16_bf16 v[64:79], v[48:51], v[32:35], v[64:79]
    ds_read_b128 v[44:47], v4 offset:7168
    ds_read_b64_tr_b16 v[60:61], v8 offset:14336
    ds_read_b64_tr_b16 v[62:63], v8 offset:15360
    s_waitcnt lgkmcnt(6)
    v_mfma_f32_32x32x16_bf16 v[64:79], v[52:55], v[36:39], v[64:79]
    s_barrier
    ds_read_b128 v[32:35], v4 offset:32768
    ds_read_b64_tr_b16 v[48:49], v8 offset:32768
    ds_read_b64_tr_b16 v[50:51], v8 offset:33792
    s_waitcnt lgkmcnt(6)
    v_mfma_f32_32x32x16_bf16 v[64:79], v[56:59], v[40:43], v[64:79]
    ds_read_b128 v[36:39], v4 offset:33792
    ds_read_b64_tr_b16 v[52:53], v8 offset:34816
    ds_read_b64_tr_b16 v[54:55], v8 offset:35840
    s_waitcnt lgkmcnt(6)
    v_mfma_f32_32x32x16_bf16 v[64:79], v[60:63], v[44:47], v[64:79]
    ds_read_b128 v[40:43], v4 offset:34816
    ds_read_b64_tr_b16 v[56:57], v8 offset:36864
    ds_read_b64_tr_b16 v[58:59], v8 offset:37888
    s_waitcnt lgkmcnt(6)
    v_mfma_f32_32x32x16_bf16 v[64:79], v[48:51], v[32:35], v[64:79]
    ds_read_b128 v[44:47], v4 offset:35840
    ds_read_b64_tr_b16 v[60:61], v8 offset:38912
    ds_read_b64_tr_b16 v[62:63], v8 offset:39936
    s_waitcnt lgkmcnt(6)
    v_mfma_f32_32x32x16_bf16 v[64:79], v[52:55], v[36:39], v[64:79]
    ds_read_b128 v[32:35], v4 offset:36864
    ds_read_b64_tr_b16 v[48:49], v8 offset:40960
    ds_read_b64_tr_b16 v[50:51], v8 offset:41984
    s_waitcnt lgkmcnt(6)
    v_mfma_f32_32x32x16_bf16 v[64:79], v[56:59], v[40:43], v[64:79]
    ds_read_b128 v[36:39], v4 offset:37888
    ds_read_b64_tr_b16 v[52:53], v8 offset:43008
    ds_read_b64_tr_b16 v[54:55], v8 offset:44032
    s_waitcnt lgkmcnt(6)
    v_mfma_f32_32x32x16_bf16 v[64:79], v[60:63], v[44:47], v[64:79]
    ds_read_b128 v[40:43], v4 offset:38912
    ds_read_b64_tr_b16 v[56:57], v8 offset:45056
    ds_read_b64_tr_b16 v[58:59], v8 offset:46080
    s_waitcnt lgkmcnt(6)
    v_mfma_f32_32x32x16_bf16 v[64:79], v[48:51], v[32:35], v[64:79]
    ds_read_b128 v[44:47], v4 offset:39936
    ds_read_b64_tr_b16 v[60:61], v8 offset:47104
    ds_read_b64_tr_b16 v[62:63], v8 offset:48128
    s_waitcnt lgkmcnt(6)
    v_mfma_f32_32x32x16_bf16 v[64:79], v[52:55], v[36:39], v[64:79]
    s_barrier
    ds_read_b128 v[32:35], v10 offset:0
    ds_read_b64_tr_b16 v[48:49], v14 offset:0
    ds_read_b64_tr_b16 v[50:51], v14 offset:1024
    s_waitcnt lgkmcnt(6)
    v_mfma_f32_32x32x16_bf16 v[64:79], v[56:59], v[40:43], v[64:79]
    ds_read_b128 v[36:39], v10 offset:1024
    ds_read_b64_tr_b16 v[52:53], v14 offset:2048
    ds_read_b64_tr_b16 v[54:55], v14 offset:3072
    s_waitcnt lgkmcnt(6)
    v_mfma_f32_32x32x16_bf16 v[64:79], v[60:63], v[44:47], v[64:79]
    ds_read_b128 v[40:43], v10 offset:2048
    ds_read_b64_tr_b16 v[56:57], v14 offset:4096
    ds_read_b64_tr_b16 v[58:59], v14 offset:5120
    s_waitcnt lgkmcnt(6)
    v_mfma_f32_32x32x16_bf16 v[64:79], v[48:51], v[32:35], v[64:79]
    ds_read_b128 v[44:47], v10 offset:3072
    ds_read_b64_tr_b16 v[60:61], v14 offset:6144
    ds_read_b64_tr_b16 v[62:63], v14 offset:7168
    s_waitcnt lgkmcnt(6)
    v_mfma_f32_32x32x16_bf16 v[64:79], v[52:55], v[36:39], v[64:79]
    ds_read_b128 v[32:35], v10 offset:4096
    ds_read_b64_tr_b16 v[48:49], v14 offset:8192
    ds_read_b64_tr_b16 v[50:51], v14 offset:9216
    s_waitcnt lgkmcnt(6)
    v_mfma_f32_32x32x16_bf16 v[64:79], v[56:59], v[40:43], v[64:79]
    ds_read_b128 v[36:39], v10 offset:5120
    ds_read_b64_tr_b16 v[52:53], v14 offset:10240
    ds_read_b64_tr_b16 v[54:55], v14 offset:11264
    s_waitcnt lgkmcnt(6)
    v_mfma_f32_32x32x16_bf16 v[64:79], v[60:63], v[44:47], v[64:79]
    ds_read_b128 v[40:43], v10 offset:6144
    ds_read_b64_tr_b16 v[56:57], v14 offset:12288
    ds_read_b64_tr_b16 v[58:59], v14 offset:13312
    s_waitcnt lgkmcnt(6)
    v_mfma_f32_32x32x16_bf16 v[64:79], v[48:51], v[32:35], v[64:79]
    ds_read_b128 v[44:47], v10 offset:7168
    ds_read_b64_tr_b16 v[60:61], v14 offset:14336
    ds_read_b64_tr_b16 v[62:63], v14 offset:15360
    s_waitcnt lgkmcnt(6)
    v_mfma_f32_32x32x16_bf16 v[64:79], v[52:55], v[36:39], v[64:79]
    s_barrier
    ds_read_b128 v[32:35], v16 offset:0
    ds_read_b64_tr_b16 v[48:49], v20 offset:0
    ds_read_b64_tr_b16 v[50:51], v20 offset:1024
    s_waitcnt lgkmcnt(6)
    v_mfma_f32_32x32x16_bf16 v[64:79], v[56:59], v[40:43], v[64:79]
    ds_read_b128 v[36:39], v16 offset:1024
    ds_read_b64_tr_b16 v[52:53], v20 offset:2048
    ds_read_b64_tr_b16 v[54:55], v20 offset:3072
    s_waitcnt lgkmcnt(6)
    v_mfma_f32_32x32x16_bf16 v[64:79], v[60:63], v[44:47], v[64:79]
    ds_read_b128 v[40:43], v16 offset:2048
    ds_read_b64_tr_b16 v[56:57], v20 offset:4096
    ds_read_b64_tr_b16 v[58:59], v20 offset:5120
    s_waitcnt lgkmcnt(6)
    v_mfma_f32_32x32x16_bf16 v[64:79], v[48:51], v[32:35], v[64:79]
    ds_read_b128 v[44:47], v16 offset:3072
    ds_read_b64_tr_b16 v[60:61], v20 offset:6144
    ds_read_b64_tr_b16 v[62:63], v20 offset:7168
    s_waitcnt lgkmcnt(6)
    v_mfma_f32_32x32x16_bf16 v[64:79], v[52:55], v[36:39], v[64:79]
    ds_read_b128 v[32:35], v16 offset:4096
    ds_read_b64_tr_b16 v[48:49], v20 offset:8192
    ds_read_b64_tr_b16 v[50:51], v20 offset:9216
    s_waitcnt lgkmcnt(6)
    v_mfma_f32_32x32x16_bf16 v[64:79], v[56:59], v[40:43], v[64:79]
    ds_read_b128 v[36:39], v16 offset:5120
    ds_read_b64_tr_b16 v[52:53], v20 offset:10240
    ds_read_b64_tr_b16 v[54:55], v20 offset:11264
    s_waitcnt lgkmcnt(6)
    v_mfma_f32_32x32x16_bf16 v[64:79], v[60:63], v[44:47], v[64:79]
    ds_read_b128 v[40:43], v16 offset:6144
    ds_read_b64_tr_b16 v[56:57], v20 offset:12288
    ds_read_b64_tr_b16 v[58:59], v20 offset:13312
    s_waitcnt lgkmcnt(6)
    v_mfma_f32_32x32x16_bf16 v[64:79], v[48:51], v[32:35], v[64:79]
    ds_read_b128 v[44:47], v16 offset:7168
    ds_read_b64_tr_b16 v[60:61], v20 offset:14336
    ds_read_b64_tr_b16 v[62:63], v20 offset:15360
    s_waitcnt lgkmcnt(6)
    v_mfma_f32_32x32x16_bf16 v[64:79], v[52:55], v[36:39], v[64:79]
    s_barrier
    ds_read_b128 v[32:35], v16 offset:32768
    ds_read_b64_tr_b16 v[48:49], v20 offset:32768
    ds_read_b64_tr_b16 v[50:51], v20 offset:33792
    s_waitcnt lgkmcnt(6)
    v_mfma_f32_32x32x16_bf16 v[64:79], v[56:59], v[40:43], v[64:79]
    ds_read_b128 v[36:39], v16 offset:33792
    ds_read_b64_tr_b16 v[52:53], v20 offset:34816
    ds_read_b64_tr_b16 v[54:55], v20 offset:35840
    s_waitcnt lgkmcnt(6)
    v_mfma_f32_32x32x16_bf16 v[64:79], v[60:63], v[44:47], v[64:79]
    ds_read_b128 v[40:43], v16 offset:34816
    ds_read_b64_tr_b16 v[56:57], v20 offset:36864
    ds_read_b64_tr_b16 v[58:59], v20 offset:37888
    s_waitcnt lgkmcnt(6)
    v_mfma_f32_32x32x16_bf16 v[64:79], v[48:51], v[32:35], v[64:79]
    ds_read_b128 v[44:47], v16 offset:35840
    ds_read_b64_tr_b16 v[60:61], v20 offset:38912
    ds_read_b64_tr_b16 v[62:63], v20 offset:39936
    s_waitcnt lgkmcnt(6)
    v_mfma_f32_32x32x16_bf16 v[64:79], v[52:55], v[36:39], v[64:79]
    ds_read_b128 v[32:35], v16 offset:36864
    ds_read_b64_tr_b16 v[48:49], v20 offset:40960
    ds_read_b64_tr_b16 v[50:51], v20 offset:41984
    s_waitcnt lgkmcnt(6)
    v_mfma_f32_32x32x16_bf16 v[64:79], v[56:59], v[40:43], v[64:79]
    ds_read_b128 v[36:39], v16 offset:37888
    ds_read_b64_tr_b16 v[52:53], v20 offset:43008
    ds_read_b64_tr_b16 v[54:55], v20 offset:44032
    s_waitcnt lgkmcnt(6)
    v_mfma_f32_32x32x16_bf16 v[64:79], v[60:63], v[44:47], v[64:79]
    ds_read_b128 v[40:43], v16 offset:38912
    ds_read_b64_tr_b16 v[56:57], v20 offset:45056
    ds_read_b64_tr_b16 v[58:59], v20 offset:46080
    s_waitcnt lgkmcnt(6)
    v_mfma_f32_32x32x16_bf16 v[64:79], v[48:51], v[32:35], v[64:79]
    ds_read_b128 v[44:47], v16 offset:39936
    ds_read_b64_tr_b16 v[60:61], v20 offset:47104
    ds_read_b64_tr_b16 v[62:63], v20 offset:48128
    s_waitcnt lgkmcnt(6)
    v_mfma_f32_32x32x16_bf16 v[64:79], v[52:55], v[36:39], v[64:79]
    s_barrier
    ds_read_b128 v[32:35], v4 offset:0
    ds_read_b64_tr_b16 v[48:49], v8 offset:0
    ds_read_b64_tr_b16 v[50:51], v8 offset:1024
    s_waitcnt lgkmcnt(6)
    v_mfma_f32_32x32x16_bf16 v[64:79], v[56:59], v[40:43], v[64:79]
    ds_read_b128 v[36:39], v4 offset:1024
    ds_read_b64_tr_b16 v[52:53], v8 offset:2048
    ds_read_b64_tr_b16 v[54:55], v8 offset:3072
    s_waitcnt lgkmcnt(6)
    v_mfma_f32_32x32x16_bf16 v[64:79], v[60:63], v[44:47], v[64:79]
    ds_read_b128 v[40:43], v4 offset:2048
    ds_read_b64_tr_b16 v[56:57], v8 offset:4096
    ds_read_b64_tr_b16 v[58:59], v8 offset:5120
    s_waitcnt lgkmcnt(6)
    v_mfma_f32_32x32x16_bf16 v[64:79], v[48:51], v[32:35], v[64:79]
    ds_read_b128 v[44:47], v4 offset:3072
    ds_read_b64_tr_b16 v[60:61], v8 offset:6144
    ds_read_b64_tr_b16 v[62:63], v8 offset:7168
    s_waitcnt lgkmcnt(6)
    v_mfma_f32_32x32x16_bf16 v[64:79], v[52:55], v[36:39], v[64:79]
    ds_read_b128 v[32:35], v4 offset:4096
    ds_read_b64_tr_b16 v[48:49], v8 offset:8192
    ds_read_b64_tr_b16 v[50:51], v8 offset:9216
    s_waitcnt lgkmcnt(6)
    v_mfma_f32_32x32x16_bf16 v[64:79], v[56:59], v[40:43], v[64:79]
    ds_read_b128 v[36:39], v4 offset:5120
    ds_read_b64_tr_b16 v[52:53], v8 offset:10240
    ds_read_b64_tr_b16 v[54:55], v8 offset:11264
    s_waitcnt lgkmcnt(6)
    v_mfma_f32_32x32x16_bf16 v[64:79], v[60:63], v[44:47], v[64:79]
    ds_read_b128 v[40:43], v4 offset:6144
    ds_read_b64_tr_b16 v[56:57], v8 offset:12288
    ds_read_b64_tr_b16 v[58:59], v8 offset:13312
    s_waitcnt lgkmcnt(6)
    v_mfma_f32_32x32x16_bf16 v[64:79], v[48:51], v[32:35], v[64:79]
    ds_read_b128 v[44:47], v4 offset:7168
    ds_read_b64_tr_b16 v[60:61], v8 offset:14336
    ds_read_b64_tr_b16 v[62:63], v8 offset:15360
    s_waitcnt lgkmcnt(6)
    v_mfma_f32_32x32x16_bf16 v[64:79], v[52:55], v[36:39], v[64:79]
    s_barrier
    ds_read_b128 v[32:35], v4 offset:32768
    ds_read_b64_tr_b16 v[48:49], v8 offset:32768
    ds_read_b64_tr_b16 v[50:51], v8 offset:33792
    s_waitcnt lgkmcnt(6)
    v_mfma_f32_32x32x16_bf16 v[64:79], v[56:59], v[40:43], v[64:79]
    ds_read_b128 v[36:39], v4 offset:33792
    ds_read_b64_tr_b16 v[52:53], v8 offset:34816
    ds_read_b64_tr_b16 v[54:55], v8 offset:35840
    s_waitcnt lgkmcnt(6)
    v_mfma_f32_32x32x16_bf16 v[64:79], v[60:63], v[44:47], v[64:79]
    ds_read_b128 v[40:43], v4 offset:34816
    ds_read_b64_tr_b16 v[56:57], v8 offset:36864
    ds_read_b64_tr_b16 v[58:59], v8 offset:37888
    s_waitcnt lgkmcnt(6)
    v_mfma_f32_32x32x16_bf16 v[64:79], v[48:51], v[32:35], v[64:79]
    ds_read_b128 v[44:47], v4 offset:35840
    ds_read_b64_tr_b16 v[60:61], v8 offset:38912
    ds_read_b64_tr_b16 v[62:63], v8 offset:39936
    s_waitcnt lgkmcnt(6)
    v_mfma_f32_32x32x16_bf16 v[64:79], v[52:55], v[36:39], v[64:79]
    ds_read_b128 v[32:35], v4 offset:36864
    ds_read_b64_tr_b16 v[48:49], v8 offset:40960
    ds_read_b64_tr_b16 v[50:51], v8 offset:41984
    s_waitcnt lgkmcnt(6)
    v_mfma_f32_32x32x16_bf16 v[64:79], v[56:59], v[40:43], v[64:79]
    ds_read_b128 v[36:39], v4 offset:37888
    ds_read_b64_tr_b16 v[52:53], v8 offset:43008
    ds_read_b64_tr_b16 v[54:55], v8 offset:44032
    s_waitcnt lgkmcnt(6)
    v_mfma_f32_32x32x16_bf16 v[64:79], v[60:63], v[44:47], v[64:79]
    ds_read_b128 v[40:43], v4 offset:38912
    ds_read_b64_tr_b16 v[56:57], v8 offset:45056
    ds_read_b64_tr_b16 v[58:59], v8 offset:46080
    s_waitcnt lgkmcnt(6)
    v_mfma_f32_32x32x16_bf16 v[64:79], v[48:51], v[32:35], v[64:79]
    ds_read_b128 v[44:47], v4 offset:39936
    ds_read_b64_tr_b16 v[60:61], v8 offset:47104
    ds_read_b64_tr_b16 v[62:63], v8 offset:48128
    s_waitcnt lgkmcnt(6)
    v_mfma_f32_32x32x16_bf16 v[64:79], v[52:55], v[36:39], v[64:79]
    s_barrier
    ds_read_b128 v[32:35], v10 offset:0
    ds_read_b64_tr_b16 v[48:49], v14 offset:0
    ds_read_b64_tr_b16 v[50:51], v14 offset:1024
    s_waitcnt lgkmcnt(6)
    v_mfma_f32_32x32x16_bf16 v[64:79], v[56:59], v[40:43], v[64:79]
    ds_read_b128 v[36:39], v10 offset:1024
    ds_read_b64_tr_b16 v[52:53], v14 offset:2048
    ds_read_b64_tr_b16 v[54:55], v14 offset:3072
    s_waitcnt lgkmcnt(6)
    v_mfma_f32_32x32x16_bf16 v[64:79], v[60:63], v[44:47], v[64:79]
    ds_read_b128 v[40:43], v10 offset:2048
    ds_read_b64_tr_b16 v[56:57], v14 offset:4096
    ds_read_b64_tr_b16 v[58:59], v14 offset:5120
    s_waitcnt lgkmcnt(6)
    v_mfma_f32_32x32x16_bf16 v[64:79], v[48:51], v[32:35], v[64:79]
    ds_read_b128 v[44:47], v10 offset:3072
    ds_read_b64_tr_b16 v[60:61], v14 offset:6144
    ds_read_b64_tr_b16 v[62:63], v14 offset:7168
    s_waitcnt lgkmcnt(6)
    v_mfma_f32_32x32x16_bf16 v[64:79], v[52:55], v[36:39], v[64:79]
    ds_read_b128 v[32:35], v10 offset:4096
    ds_read_b64_tr_b16 v[48:49], v14 offset:8192
    ds_read_b64_tr_b16 v[50:51], v14 offset:9216
    s_waitcnt lgkmcnt(6)
    v_mfma_f32_32x32x16_bf16 v[64:79], v[56:59], v[40:43], v[64:79]
    ds_read_b128 v[36:39], v10 offset:5120
    ds_read_b64_tr_b16 v[52:53], v14 offset:10240
    ds_read_b64_tr_b16 v[54:55], v14 offset:11264
    s_waitcnt lgkmcnt(6)
    v_mfma_f32_32x32x16_bf16 v[64:79], v[60:63], v[44:47], v[64:79]
    ds_read_b128 v[40:43], v10 offset:6144
    ds_read_b64_tr_b16 v[56:57], v14 offset:12288
    ds_read_b64_tr_b16 v[58:59], v14 offset:13312
    s_waitcnt lgkmcnt(6)
    v_mfma_f32_32x32x16_bf16 v[64:79], v[48:51], v[32:35], v[64:79]
    ds_read_b128 v[44:47], v10 offset:7168
    ds_read_b64_tr_b16 v[60:61], v14 offset:14336
    ds_read_b64_tr_b16 v[62:63], v14 offset:15360
    s_waitcnt lgkmcnt(6)
    v_mfma_f32_32x32x16_bf16 v[64:79], v[52:55], v[36:39], v[64:79]
    s_barrier
    ds_read_b128 v[32:35], v16 offset:0
    ds_read_b64_tr_b16 v[48:49], v20 offset:0
    ds_read_b64_tr_b16 v[50:51], v20 offset:1024
    s_waitcnt lgkmcnt(6)
    v_mfma_f32_32x32x16_bf16 v[64:79], v[56:59], v[40:43], v[64:79]
    ds_read_b128 v[36:39], v16 offset:1024
    ds_read_b64_tr_b16 v[52:53], v20 offset:2048
    ds_read_b64_tr_b16 v[54:55], v20 offset:3072
    s_waitcnt lgkmcnt(6)
    v_mfma_f32_32x32x16_bf16 v[64:79], v[60:63], v[44:47], v[64:79]
    ds_read_b128 v[40:43], v16 offset:2048
    ds_read_b64_tr_b16 v[56:57], v20 offset:4096
    ds_read_b64_tr_b16 v[58:59], v20 offset:5120
    s_waitcnt lgkmcnt(6)
    v_mfma_f32_32x32x16_bf16 v[64:79], v[48:51], v[32:35], v[64:79]
    ds_read_b128 v[44:47], v16 offset:3072
    ds_read_b64_tr_b16 v[60:61], v20 offset:6144
    ds_read_b64_tr_b16 v[62:63], v20 offset:7168
    s_waitcnt lgkmcnt(6)
    v_mfma_f32_32x32x16_bf16 v[64:79], v[52:55], v[36:39], v[64:79]
    ds_read_b128 v[32:35], v16 offset:4096
    ds_read_b64_tr_b16 v[48:49], v20 offset:8192
    ds_read_b64_tr_b16 v[50:51], v20 offset:9216
    s_waitcnt lgkmcnt(6)
    v_mfma_f32_32x32x16_bf16 v[64:79], v[56:59], v[40:43], v[64:79]
    ds_read_b128 v[36:39], v16 offset:5120
    ds_read_b64_tr_b16 v[52:53], v20 offset:10240
    ds_read_b64_tr_b16 v[54:55], v20 offset:11264
    s_waitcnt lgkmcnt(6)
    v_mfma_f32_32x32x16_bf16 v[64:79], v[60:63], v[44:47], v[64:79]
    ds_read_b128 v[40:43], v16 offset:6144
    ds_read_b64_tr_b16 v[56:57], v20 offset:12288
    ds_read_b64_tr_b16 v[58:59], v20 offset:13312
    s_waitcnt lgkmcnt(6)
    v_mfma_f32_32x32x16_bf16 v[64:79], v[48:51], v[32:35], v[64:79]
    ds_read_b128 v[44:47], v16 offset:7168
    ds_read_b64_tr_b16 v[60:61], v20 offset:14336
    ds_read_b64_tr_b16 v[62:63], v20 offset:15360
    s_waitcnt lgkmcnt(6)
    v_mfma_f32_32x32x16_bf16 v[64:79], v[52:55], v[36:39], v[64:79]
    s_barrier
    ds_read_b128 v[32:35], v16 offset:32768
    ds_read_b64_tr_b16 v[48:49], v20 offset:32768
    ds_read_b64_tr_b16 v[50:51], v20 offset:33792
    s_waitcnt lgkmcnt(6)
    v_mfma_f32_32x32x16_bf16 v[64:79], v[56:59], v[40:43], v[64:79]
    ds_read_b128 v[36:39], v16 offset:33792
    ds_read_b64_tr_b16 v[52:53], v20 offset:34816
    ds_read_b64_tr_b16 v[54:55], v20 offset:35840
    s_waitcnt lgkmcnt(6)
    v_mfma_f32_32x32x16_bf16 v[64:79], v[60:63], v[44:47], v[64:79]
    ds_read_b128 v[40:43], v16 offset:34816
    ds_read_b64_tr_b16 v[56:57], v20 offset:36864
    ds_read_b64_tr_b16 v[58:59], v20 offset:37888
    s_waitcnt lgkmcnt(6)
    v_mfma_f32_32x32x16_bf16 v[64:79], v[48:51], v[32:35], v[64:79]
    ds_read_b128 v[44:47], v16 offset:35840
    ds_read_b64_tr_b16 v[60:61], v20 offset:38912
    ds_read_b64_tr_b16 v[62:63], v20 offset:39936
    s_waitcnt lgkmcnt(6)
    v_mfma_f32_32x32x16_bf16 v[64:79], v[52:55], v[36:39], v[64:79]
    ds_read_b128 v[32:35], v16 offset:36864
    ds_read_b64_tr_b16 v[48:49], v20 offset:40960
    ds_read_b64_tr_b16 v[50:51], v20 offset:41984
    s_waitcnt lgkmcnt(6)
    v_mfma_f32_32x32x16_bf16 v[64:79], v[56:59], v[40:43], v[64:79]
    ds_read_b128 v[36:39], v16 offset:37888
    ds_read_b64_tr_b16 v[52:53], v20 offset:43008
    ds_read_b64_tr_b16 v[54:55], v20 offset:44032
    s_waitcnt lgkmcnt(6)
    v_mfma_f32_32x32x16_bf16 v[64:79], v[60:63], v[44:47], v[64:79]
    ds_read_b128 v[40:43], v16 offset:38912
    ds_read_b64_tr_b16 v[56:57], v20 offset:45056
    ds_read_b64_tr_b16 v[58:59], v20 offset:46080
    s_waitcnt lgkmcnt(6)
    v_mfma_f32_32x32x16_bf16 v[64:79], v[48:51], v[32:35], v[64:79]
    ds_read_b128 v[44:47], v16 offset:39936
    ds_read_b64_tr_b16 v[60:61], v20 offset:47104
    ds_read_b64_tr_b16 v[62:63], v20 offset:48128
    s_waitcnt lgkmcnt(6)
    v_mfma_f32_32x32x16_bf16 v[64:79], v[52:55], v[36:39], v[64:79]
    s_barrier
    ds_read_b128 v[32:35], v4 offset:0
    ds_read_b64_tr_b16 v[48:49], v8 offset:0
    ds_read_b64_tr_b16 v[50:51], v8 offset:1024
    s_waitcnt lgkmcnt(6)
    v_mfma_f32_32x32x16_bf16 v[64:79], v[56:59], v[40:43], v[64:79]
    ds_read_b128 v[36:39], v4 offset:1024
    ds_read_b64_tr_b16 v[52:53], v8 offset:2048
    ds_read_b64_tr_b16 v[54:55], v8 offset:3072
    s_waitcnt lgkmcnt(6)
    v_mfma_f32_32x32x16_bf16 v[64:79], v[60:63], v[44:47], v[64:79]
    ds_read_b128 v[40:43], v4 offset:2048
    ds_read_b64_tr_b16 v[56:57], v8 offset:4096
    ds_read_b64_tr_b16 v[58:59], v8 offset:5120
    s_waitcnt lgkmcnt(6)
    v_mfma_f32_32x32x16_bf16 v[64:79], v[48:51], v[32:35], v[64:79]
    ds_read_b128 v[44:47], v4 offset:3072
    ds_read_b64_tr_b16 v[60:61], v8 offset:6144
    ds_read_b64_tr_b16 v[62:63], v8 offset:7168
    s_waitcnt lgkmcnt(6)
    v_mfma_f32_32x32x16_bf16 v[64:79], v[52:55], v[36:39], v[64:79]
    ds_read_b128 v[32:35], v4 offset:4096
    ds_read_b64_tr_b16 v[48:49], v8 offset:8192
    ds_read_b64_tr_b16 v[50:51], v8 offset:9216
    s_waitcnt lgkmcnt(6)
    v_mfma_f32_32x32x16_bf16 v[64:79], v[56:59], v[40:43], v[64:79]
    ds_read_b128 v[36:39], v4 offset:5120
    ds_read_b64_tr_b16 v[52:53], v8 offset:10240
    ds_read_b64_tr_b16 v[54:55], v8 offset:11264
    s_waitcnt lgkmcnt(6)
    v_mfma_f32_32x32x16_bf16 v[64:79], v[60:63], v[44:47], v[64:79]
    ds_read_b128 v[40:43], v4 offset:6144
    ds_read_b64_tr_b16 v[56:57], v8 offset:12288
    ds_read_b64_tr_b16 v[58:59], v8 offset:13312
    s_waitcnt lgkmcnt(6)
    v_mfma_f32_32x32x16_bf16 v[64:79], v[48:51], v[32:35], v[64:79]
    ds_read_b128 v[44:47], v4 offset:7168
    ds_read_b64_tr_b16 v[60:61], v8 offset:14336
    ds_read_b64_tr_b16 v[62:63], v8 offset:15360
    s_waitcnt lgkmcnt(6)
    v_mfma_f32_32x32x16_bf16 v[64:79], v[52:55], v[36:39], v[64:79]
    s_barrier
    ds_read_b128 v[32:35], v4 offset:32768
    ds_read_b64_tr_b16 v[48:49], v8 offset:32768
    ds_read_b64_tr_b16 v[50:51], v8 offset:33792
    s_waitcnt lgkmcnt(6)
    v_mfma_f32_32x32x16_bf16 v[64:79], v[56:59], v[40:43], v[64:79]
    ds_read_b128 v[36:39], v4 offset:33792
    ds_read_b64_tr_b16 v[52:53], v8 offset:34816
    ds_read_b64_tr_b16 v[54:55], v8 offset:35840
    s_waitcnt lgkmcnt(6)
    v_mfma_f32_32x32x16_bf16 v[64:79], v[60:63], v[44:47], v[64:79]
    ds_read_b128 v[40:43], v4 offset:34816
    ds_read_b64_tr_b16 v[56:57], v8 offset:36864
    ds_read_b64_tr_b16 v[58:59], v8 offset:37888
    s_waitcnt lgkmcnt(6)
    v_mfma_f32_32x32x16_bf16 v[64:79], v[48:51], v[32:35], v[64:79]
    ds_read_b128 v[44:47], v4 offset:35840
    ds_read_b64_tr_b16 v[60:61], v8 offset:38912
    ds_read_b64_tr_b16 v[62:63], v8 offset:39936
    s_waitcnt lgkmcnt(6)
    v_mfma_f32_32x32x16_bf16 v[64:79], v[52:55], v[36:39], v[64:79]
    ds_read_b128 v[32:35], v4 offset:36864
    ds_read_b64_tr_b16 v[48:49], v8 offset:40960
    ds_read_b64_tr_b16 v[50:51], v8 offset:41984
    s_waitcnt lgkmcnt(6)
    v_mfma_f32_32x32x16_bf16 v[64:79], v[56:59], v[40:43], v[64:79]
    ds_read_b128 v[36:39], v4 offset:37888
    ds_read_b64_tr_b16 v[52:53], v8 offset:43008
    ds_read_b64_tr_b16 v[54:55], v8 offset:44032
    s_waitcnt lgkmcnt(6)
    v_mfma_f32_32x32x16_bf16 v[64:79], v[60:63], v[44:47], v[64:79]
    ds_read_b128 v[40:43], v4 offset:38912
    ds_read_b64_tr_b16 v[56:57], v8 offset:45056
    ds_read_b64_tr_b16 v[58:59], v8 offset:46080
    s_waitcnt lgkmcnt(6)
    v_mfma_f32_32x32x16_bf16 v[64:79], v[48:51], v[32:35], v[64:79]
    ds_read_b128 v[44:47], v4 offset:39936
    ds_read_b64_tr_b16 v[60:61], v8 offset:47104
    ds_read_b64_tr_b16 v[62:63], v8 offset:48128
    s_waitcnt lgkmcnt(6)
    v_mfma_f32_32x32x16_bf16 v[64:79], v[52:55], v[36:39], v[64:79]
    s_waitcnt lgkmcnt(3)
    v_mfma_f32_32x32x16_bf16 v[64:79], v[56:59], v[40:43], v[64:79]
    s_waitcnt lgkmcnt(0)
    v_mfma_f32_32x32x16_bf16 v[64:79], v[60:63], v[44:47], v[64:79]
    s_waitcnt vmcnt(0)
    s_nop 15
    v_lshlrev_b32 v144, 16, v24
    v_and_b32 v145, 0xffff0000, v24
    v_add_f32 v64, v64, v144
    v_add_f32 v65, v65, v145
    v_lshlrev_b32 v144, 16, v25
    v_and_b32 v145, 0xffff0000, v25
    v_add_f32 v66, v66, v144
    v_add_f32 v67, v67, v145
    v_lshlrev_b32 v144, 16, v26
    v_and_b32 v145, 0xffff0000, v26
    v_add_f32 v68, v68, v144
    v_add_f32 v69, v69, v145
    v_lshlrev_b32 v144, 16, v27
    v_and_b32 v145, 0xffff0000, v27
    v_add_f32 v70, v70, v144
    v_add_f32 v71, v71, v145
    v_lshlrev_b32 v144, 16, v28
    v_and_b32 v145, 0xffff0000, v28
    v_add_f32 v72, v72, v144
    v_add_f32 v73, v73, v145
    v_lshlrev_b32 v144, 16, v29
    v_and_b32 v145, 0xffff0000, v29
    v_add_f32 v74, v74, v144
    v_add_f32 v75, v75, v145
    v_lshlrev_b32 v144, 16, v30
    v_and_b32 v145, 0xffff0000, v30
    v_add_f32 v76, v76, v144
    v_add_f32 v77, v77, v145
    v_lshlrev_b32 v144, 16, v31
    v_and_b32 v145, 0xffff0000, v31
    v_add_f32 v78, v78, v144
    v_add_f32 v79, v79, v145
    v_cvt_pk_bf16_f32 v148, v64, v65
    v_cvt_pk_bf16_f32 v149, v66, v67
    v_cvt_pk_bf16_f32 v150, v68, v69
    v_cvt_pk_bf16_f32 v151, v70, v71
    v_cvt_pk_bf16_f32 v152, v72, v73
    v_cvt_pk_bf16_f32 v153, v74, v75
    v_cvt_pk_bf16_f32 v154, v76, v77
    v_cvt_pk_bf16_f32 v155, v78, v79
    v_lshrrev_b32 v156, 5, v2
    v_lshl_add_u32 v22, v156, 3, v22
    s_nop 1
    v_permlane32_swap_b32 v148, v150
    v_permlane32_swap_b32 v149, v151
    v_permlane32_swap_b32 v152, v154
    v_permlane32_swap_b32 v153, v155
    buffer_store_dwordx4 v[148:151], v22, s[16:19], s36 offen offset:0
    buffer_store_dwordx4 v[152:155], v22, s[16:19], s36 offen offset:32
w2_b_kernel_fin:
w2_b_kernel_done:
    s_endpgm
.section .rodata,"a"
.p2align 6
.amdhsa_kernel w2_b_kernel
  .amdhsa_next_free_vgpr 196
  .amdhsa_next_free_sgpr 96
  .amdhsa_accum_offset 196
  .amdhsa_group_segment_fixed_size 0
  .amdhsa_kernarg_size 72
  .amdhsa_user_sgpr_count 2
  .amdhsa_user_sgpr_kernarg_segment_ptr 1
  .amdhsa_system_sgpr_workgroup_id_x 1
  .amdhsa_float_denorm_mode_32 3
.end_amdhsa_kernel
.text
.globl attn_kernel
.p2align 8
.type attn_kernel,@function
attn_kernel:
    s_cmp_ge_u32 s2, 256
    s_cbranch_scc1 attn_kernel_done
    s_load_dwordx2 s[8:9], s[0:1], 64
    s_load_dwordx2 s[12:13], s[0:1], 64
    s_load_dwordx2 s[16:17], s[0:1], 64
    s_load_dwordx2 s[20:21], s[0:1], 64
    s_and_b32 s24, s2, 7
    s_lshr_b32 s25, s2, 3
    s_and_b32 s26, s25, 3
    s_lshl_b32 s26, s26, 3
    s_add_u32 s24, s24, s26
    s_lshr_b32 s25, s25, 2
    v_lshrrev_b32 v1, 6, v0
    v_and_b32 v2, 63, v0
    v_readfirstlane_b32 s27, v1
    v_lshlrev_b32 v3, 4, v2
    s_lshl_b32 s28, s24, 16
    s_waitcnt lgkmcnt(0)
    s_add_u32 s8, s8, 0x200000
    s_addc_u32 s9, s9, 0
    s_mov_b32 s10, 0x200000
    s_mov_b32 s11, 0x00020000
    s_add_u32 s12, s12, 0x400000
    s_addc_u32 s13, s13, 0
    s_mov_b32 s14, 0x200000
    s_mov_b32 s15, 0x00020000
    s_add_u32 s16, s16, 0x600000
    s_addc_u32 s17, s17, 0
    s_mov_b32 s18, 0x200000
    s_mov_b32 s19, 0x00020000
    s_add_u32 s20, s20, 0x800000
    s_addc_u32 s21, s21, 0
    s_mov_b32 s22, 0x200000
    s_mov_b32 s23, 0x00020000
    s_lshl_b32 s29, s25, 3
    s_add_u32 s29, s29, s27
    s_lshl_b32 s30, s29, 10
    s_add_u32 s30, s30, s28
    buffer_load_dwordx4 v[4:7], v3, s[8:11], s30 offen
    s_lshl_b32 s31, s27, 10
    s_add_u32 s32, s28, s31
    s_add_u32 s33, s31, 65536
    s_add_u32 m0, s31, 0
    s_add_u32 s34, s32, 0
    buffer_load_dwordx4 v3, s[12:15], s34 offen lds
    s_add_u32 m0, s33, 0
    s_nop 0
    buffer_load_dwordx4 v3, s[16:19], s34 offen lds
    v_mov_b32 v8, 0x3f803f80
    v_and_b32 v9, 11, v0
    v_cmp_eq_u32 vcc, 0, v9
    s_nop 1
    v_cndmask_b32 v8, 0, v8, vcc
    v_mov_b32 v9, v8
    v_mov_b32 v10, v8
    v_mov_b32 v11, v8
    v_lshlrev_b32 v12, 4, v0
    v_add_u32 v12, 131072, v12
    ds_write_b128 v12, v[8:11]
    ds_write_b128 v12, v[8:11] offset:2048

    v_mov_b32 v118, 141312
    v_mov_b32 v119, 0
    ds_write_b32 v118, v119
    v_mov_b32 v119, 1
    v_mov_b32 v13, v3
    v_lshrrev_b32 v16, 5, v2
    v_lshlrev_b32 v16, 8, v16
    v_and_b32 v17, 15, v2
    v_lshlrev_b32 v17, 4, v17
    v_add3_u32 v14, v16, v17, 0
    v_add_u32 v14, 65536, v14
    v_and_b32 v18, 16, v2
    v_cmp_ne_u32 vcc, 0, v18
    v_add_u32 v19, 131072, v17
    v_mov_b32 v15, 8192
    s_nop 1
    v_cndmask_b32 v14, v14, v19, vcc
    v_cndmask_b32 v15, v15, 0, vcc

    s_waitcnt vmcnt(0) lgkmcnt(0)
    s_barrier
    ds_read_b128 v[92:95], v13
    s_waitcnt lgkmcnt(0)
    v_mfma_f32_32x32x16_bf16 v[52:67], v[92:95], v[4:7], 0
    s_nop 15
    s_nop 3
    v_max3_f32 v116, v52, v53, v54
    v_max3_f32 v116, v116, v55, v56
    v_max3_f32 v116, v116, v57, v58
    v_max3_f32 v116, v116, v59, v60
    v_max3_f32 v116, v116, v61, v62
    v_max3_f32 v116, v116, v63, v64
    v_max3_f32 v116, v116, v65, v66
    v_max_f32 v116, v116, v67
    v_mov_b32 v117, v116
    s_nop 1
    v_permlane32_swap_b32 v116, v117
    s_nop 1
    v_max_f32 v116, v116, v117
    v_sub_f32 v20, 0, v116
    v_mov_b32 v36, 0
    v_sub_f32 v21, 0, v116
    v_mov_b32 v37, 0
    v_sub_f32 v22, 0, v116
    v_mov_b32 v38, 0
    v_sub_f32 v23, 0, v116
    v_mov_b32 v39, 0
    v_sub_f32 v24, 0, v116
    v_mov_b32 v40, 0
    v_sub_f32 v25, 0, v116
    v_mov_b32 v41, 0
    v_sub_f32 v26, 0, v116
    v_mov_b32 v42, 0
    v_sub_f32 v27, 0, v116
    v_mov_b32 v43, 0
    v_sub_f32 v28, 0, v116
    v_mov_b32 v44, 0
    v_sub_f32 v29, 0, v116
    v_mov_b32 v45, 0
    v_sub_f32 v30, 0, v116
    v_mov_b32 v46, 0
    v_sub_f32 v31, 0, v116
    v_mov_b32 v47, 0
    v_sub_f32 v32, 0, v116
    v_mov_b32 v48, 0
    v_sub_f32 v33, 0, v116
    v_mov_b32 v49, 0
    v_sub_f32 v34, 0, v116
    v_mov_b32 v50, 0
    v_sub_f32 v35, 0, v116
    v_mov_b32 v51, 0
    v_mov_b32 v88, 0
    v_mov_b32 v89, 0
    v_mov_b32 v90, 0
    v_mov_b32 v91, 0
    v_mov_b32 v108, 0
    v_mov_b32 v109, 0
    v_mov_b32 v110, 0
    v_mov_b32 v111, 0
    v_mov_b32 v112, 0
    v_mov_b32 v113, 0
    v_mov_b32 v114, 0
    v_mov_b32 v115, 0
    ds_read_b128 v[96:99], v13 offset:1024
    ds_read_b128 v[100:103], v14
    ds_read_b128 v[104:107], v14 offset:512
    v_mfma_f32_32x32x16_bf16 v[52:67], v[92:95], v[4:7], v[20:35]
    s_mov_b32 s35, 0
    s_nop 7
    s_setprio 3
    s_waitcnt lgkmcnt(2)
    v_mfma_f32_32x32x16_bf16 v[68:83], v[96:99], v[4:7], v[20:35]
    ds_read_b128 v[92:95], v13 offset:2048
    s_add_u32 m0, s31, 8192
    s_add_u32 s34, s32, 8192
    buffer_load_dwordx4 v3, s[12:15], s34 offen lds
    s_add_u32 m0, s33, 8192
    s_nop 0
    buffer_load_dwordx4 v3, s[16:19], s34 offen lds
    v_exp_f32 v52, v52
    v_exp_f32 v53, v53
    v_exp_f32 v54, v54
    v_exp_f32 v55, v55
    v_exp_f32 v56, v56
    v_mfma_f32_32x32x16_bf16 v[36:51], v[112:115], v[88:91], v[36:51]
    ds_read_b128 v[108:111], v14 offset:1024
    v_exp_f32 v57, v57
    v_cvt_pk_bf16_f32 v84, v52, v53
    v_exp_f32 v58, v58
    ds_read_b128 v[112:115], v14 offset:1536
    v_cvt_pk_bf16_f32 v85, v54, v55
    v_exp_f32 v59, v59
    v_exp_f32 v60, v60
    v_cvt_pk_bf16_f32 v86, v56, v57
    v_exp_f32 v61, v61
    v_exp_f32 v62, v62
    v_cvt_pk_bf16_f32 v87, v58, v59
    v_exp_f32 v63, v63
    s_waitcnt lgkmcnt(4)
    v_mfma_f32_32x32x16_bf16 v[36:51], v[100:103], v[84:87], v[36:51]
    v_exp_f32 v64, v64
    v_cvt_pk_bf16_f32 v88, v60, v61
    v_exp_f32 v65, v65
    v_exp_f32 v66, v66
    v_cvt_pk_bf16_f32 v89, v62, v63
    v_exp_f32 v67, v67
    v_cvt_pk_bf16_f32 v90, v64, v65
    v_cvt_pk_bf16_f32 v91, v66, v67
    s_waitcnt lgkmcnt(2)
    v_mfma_f32_32x32x16_bf16 v[52:67], v[92:95], v[4:7], v[20:35]
    ds_read_b128 v[96:99], v13 offset:3072
    s_add_u32 m0, s31, 16384
    s_add_u32 s34, s32, 16384
    buffer_load_dwordx4 v3, s[12:15], s34 offen lds
    s_add_u32 m0, s33, 16384
    s_nop 0
    buffer_load_dwordx4 v3, s[16:19], s34 offen lds
    v_exp_f32 v68, v68
    v_exp_f32 v69, v69
    v_exp_f32 v70, v70
    v_exp_f32 v71, v71
    v_exp_f32 v72, v72
    v_mfma_f32_32x32x16_bf16 v[36:51], v[104:107], v[88:91], v[36:51]
    ds_read_b128 v[100:103], v14 offset:2048
    v_exp_f32 v73, v73
    v_cvt_pk_bf16_f32 v84, v68, v69
    v_exp_f32 v74, v74
    ds_read_b128 v[104:107], v14 offset:2560
    v_cvt_pk_bf16_f32 v85, v70, v71
    v_exp_f32 v75, v75
    v_exp_f32 v76, v76
    v_cvt_pk_bf16_f32 v86, v72, v73
    v_exp_f32 v77, v77
    v_exp_f32 v78, v78
    v_cvt_pk_bf16_f32 v87, v74, v75
    v_exp_f32 v79, v79
    s_waitcnt lgkmcnt(4)
    v_mfma_f32_32x32x16_bf16 v[36:51], v[108:111], v[84:87], v[36:51]
    v_exp_f32 v80, v80
    v_cvt_pk_bf16_f32 v88, v76, v77
    v_exp_f32 v81, v81
    v_exp_f32 v82, v82
    v_cvt_pk_bf16_f32 v89, v78, v79
    v_exp_f32 v83, v83
    v_cvt_pk_bf16_f32 v90, v80, v81
    v_cvt_pk_bf16_f32 v91, v82, v83
    s_waitcnt lgkmcnt(2)
    v_mfma_f32_32x32x16_bf16 v[68:83], v[96:99], v[4:7], v[20:35]
    ds_read_b128 v[92:95], v13 offset:4096
    s_add_u32 m0, s31, 24576
    s_add_u32 s34, s32, 24576
    buffer_load_dwordx4 v3, s[12:15], s34 offen lds
    s_add_u32 m0, s33, 24576
    s_nop 0
    buffer_load_dwordx4 v3, s[16:19], s34 offen lds
    v_exp_f32 v52, v52
    v_exp_f32 v53, v53
    v_exp_f32 v54, v54
    v_exp_f32 v55, v55
    v_exp_f32 v56, v56
    v_mfma_f32_32x32x16_bf16 v[36:51], v[112:115], v[88:91], v[36:51]
    ds_read_b128 v[108:111], v14 offset:3072
    v_exp_f32 v57, v57
    v_cvt_pk_bf16_f32 v84, v52, v53
    v_exp_f32 v58, v58
    ds_read_b128 v[112:115], v14 offset:3584
    v_cvt_pk_bf16_f32 v85, v54, v55
    v_exp_f32 v59, v59
    v_exp_f32 v60, v60
    v_cvt_pk_bf16_f32 v86, v56, v57
    v_exp_f32 v61, v61
    v_exp_f32 v62, v62
    v_cvt_pk_bf16_f32 v87, v58, v59
    v_exp_f32 v63, v63
    s_waitcnt lgkmcnt(4)
    v_mfma_f32_32x32x16_bf16 v[36:51], v[100:103], v[84:87], v[36:51]
    v_exp_f32 v64, v64
    v_cvt_pk_bf16_f32 v88, v60, v61
    v_exp_f32 v65, v65
    v_exp_f32 v66, v66
    v_cvt_pk_bf16_f32 v89, v62, v63
    v_exp_f32 v67, v67
    v_cvt_pk_bf16_f32 v90, v64, v65
    v_cvt_pk_bf16_f32 v91, v66, v67
    s_waitcnt lgkmcnt(2)
    v_mfma_f32_32x32x16_bf16 v[52:67], v[92:95], v[4:7], v[20:35]
    ds_read_b128 v[96:99], v13 offset:5120
    s_add_u32 m0, s31, 32768
    s_add_u32 s34, s32, 32768
    buffer_load_dwordx4 v3, s[12:15], s34 offen lds
    s_add_u32 m0, s33, 32768
    s_nop 0
    buffer_load_dwordx4 v3, s[16:19], s34 offen lds
    v_exp_f32 v68, v68
    v_exp_f32 v69, v69
    v_exp_f32 v70, v70
    v_exp_f32 v71, v71
    v_exp_f32 v72, v72
    v_mfma_f32_32x32x16_bf16 v[36:51], v[104:107], v[88:91], v[36:51]
    ds_read_b128 v[100:103], v14 offset:4096
    v_exp_f32 v73, v73
    v_cvt_pk_bf16_f32 v84, v68, v69
    v_exp_f32 v74, v74
    ds_read_b128 v[104:107], v14 offset:4608
    v_cvt_pk_bf16_f32 v85, v70, v71
    v_exp_f32 v75, v75
    v_exp_f32 v76, v76
    v_cvt_pk_bf16_f32 v86, v72, v73
    v_exp_f32 v77, v77
    v_exp_f32 v78, v78
    v_cvt_pk_bf16_f32 v87, v74, v75
    v_exp_f32 v79, v79
    s_waitcnt lgkmcnt(4)
    v_mfma_f32_32x32x16_bf16 v[36:51], v[108:111], v[84:87], v[36:51]
    v_exp_f32 v80, v80
    v_cvt_pk_bf16_f32 v88, v76, v77
    v_exp_f32 v81, v81
    v_exp_f32 v82, v82
    v_cvt_pk_bf16_f32 v89, v78, v79
    v_exp_f32 v83, v83
    v_cvt_pk_bf16_f32 v90, v80, v81
    v_cvt_pk_bf16_f32 v91, v82, v83
    s_waitcnt lgkmcnt(2)
    v_mfma_f32_32x32x16_bf16 v[68:83], v[96:99], v[4:7], v[20:35]
    ds_read_b128 v[92:95], v13 offset:6144
    s_add_u32 m0, s31, 40960
    s_add_u32 s34, s32, 40960
    buffer_load_dwordx4 v3, s[12:15], s34 offen lds
    s_add_u32 m0, s33, 40960
    s_nop 0
    buffer_load_dwordx4 v3, s[16:19], s34 offen lds
    v_exp_f32 v52, v52
    v_exp_f32 v53, v53
    v_exp_f32 v54, v54
    v_exp_f32 v55, v55
    v_exp_f32 v56, v56
    v_mfma_f32_32x32x16_bf16 v[36:51], v[112:115], v[88:91], v[36:51]
    ds_read_b128 v[108:111], v14 offset:5120
    v_exp_f32 v57, v57
    v_cvt_pk_bf16_f32 v84, v52, v53
    v_exp_f32 v58, v58
    ds_read_b128 v[112:115], v14 offset:5632
    v_cvt_pk_bf16_f32 v85, v54, v55
    v_exp_f32 v59, v59
    v_exp_f32 v60, v60
    v_cvt_pk_bf16_f32 v86, v56, v57
    v_exp_f32 v61, v61
    v_exp_f32 v62, v62
    v_cvt_pk_bf16_f32 v87, v58, v59
    v_exp_f32 v63, v63
    s_waitcnt lgkmcnt(4)
    v_mfma_f32_32x32x16_bf16 v[36:51], v[100:103], v[84:87], v[36:51]
    v_exp_f32 v64, v64
    v_cvt_pk_bf16_f32 v88, v60, v61
    v_exp_f32 v65, v65
    v_exp_f32 v66, v66
    v_cvt_pk_bf16_f32 v89, v62, v63
    v_exp_f32 v67, v67
    v_cvt_pk_bf16_f32 v90, v64, v65
    v_cvt_pk_bf16_f32 v91, v66, v67
    s_waitcnt lgkmcnt(2)
    v_mfma_f32_32x32x16_bf16 v[52:67], v[92:95], v[4:7], v[20:35]
    ds_read_b128 v[96:99], v13 offset:7168
    s_add_u32 m0, s31, 49152
    s_add_u32 s34, s32, 49152
    buffer_load_dwordx4 v3, s[12:15], s34 offen lds
    s_add_u32 m0, s33, 49152
    s_nop 0
    buffer_load_dwordx4 v3, s[16:19], s34 offen lds
    v_exp_f32 v68, v68
    v_exp_f32 v69, v69
    v_exp_f32 v70, v70
    v_exp_f32 v71, v71
    v_exp_f32 v72, v72
    v_mfma_f32_32x32x16_bf16 v[36:51], v[104:107], v[88:91], v[36:51]
    ds_read_b128 v[100:103], v14 offset:6144
    v_exp_f32 v73, v73
    v_cvt_pk_bf16_f32 v84, v68, v69
    v_exp_f32 v74, v74
    ds_read_b128 v[104:107], v14 offset:6656
    v_cvt_pk_bf16_f32 v85, v70, v71
    v_exp_f32 v75, v75
    v_exp_f32 v76, v76
    v_cvt_pk_bf16_f32 v86, v72, v73
    v_exp_f32 v77, v77
    v_exp_f32 v78, v78
    v_cvt_pk_bf16_f32 v87, v74, v75
    v_exp_f32 v79, v79
    s_waitcnt lgkmcnt(4)
    v_mfma_f32_32x32x16_bf16 v[36:51], v[108:111], v[84:87], v[36:51]
    v_exp_f32 v80, v80
    v_cvt_pk_bf16_f32 v88, v76, v77
    v_exp_f32 v81, v81
    v_exp_f32 v82, v82
    v_cvt_pk_bf16_f32 v89, v78, v79
    v_exp_f32 v83, v83
    v_cvt_pk_bf16_f32 v90, v80, v81
    v_cvt_pk_bf16_f32 v91, v82, v83
    s_waitcnt lgkmcnt(2)
    v_mfma_f32_32x32x16_bf16 v[68:83], v[96:99], v[4:7], v[20:35]
    s_waitcnt vmcnt(8)
    s_barrier
    ds_read_b128 v[92:95], v13 offset:8192
    s_add_u32 m0, s31, 57344
    s_add_u32 s34, s32, 57344
    buffer_load_dwordx4 v3, s[12:15], s34 offen lds
    s_add_u32 m0, s33, 57344
    s_nop 0
    buffer_load_dwordx4 v3, s[16:19], s34 offen lds
    v_exp_f32 v52, v52
    v_exp_f32 v53, v53
    v_exp_f32 v54, v54
    v_exp_f32 v55, v55
    v_exp_f32 v56, v56
    v_mfma_f32_32x32x16_bf16 v[36:51], v[112:115], v[88:91], v[36:51]
    ds_read_b128 v[108:111], v14 offset:7168
    v_exp_f32 v57, v57
    v_cvt_pk_bf16_f32 v84, v52, v53
    v_exp_f32 v58, v58
    ds_read_b128 v[112:115], v14 offset:7680
    v_cvt_pk_bf16_f32 v85, v54, v55
    v_exp_f32 v59, v59
    v_exp_f32 v60, v60
    v_cvt_pk_bf16_f32 v86, v56, v57
    v_exp_f32 v61, v61
    v_exp_f32 v62, v62
    v_cvt_pk_bf16_f32 v87, v58, v59
    v_exp_f32 v63, v63
    s_waitcnt lgkmcnt(4)
    v_mfma_f32_32x32x16_bf16 v[36:51], v[100:103], v[84:87], v[36:51]
    v_exp_f32 v64, v64
    v_cvt_pk_bf16_f32 v88, v60, v61
    v_exp_f32 v65, v65
    v_exp_f32 v66, v66
    v_cvt_pk_bf16_f32 v89, v62, v63
    v_exp_f32 v67, v67
    v_cvt_pk_bf16_f32 v90, v64, v65
    v_cvt_pk_bf16_f32 v91, v66, v67
    s_waitcnt lgkmcnt(2)
    v_mfma_f32_32x32x16_bf16 v[52:67], v[92:95], v[4:7], v[20:35]
    ds_read_b128 v[96:99], v13 offset:9216
    v_exp_f32 v68, v68
    v_exp_f32 v69, v69
    v_exp_f32 v70, v70
    v_exp_f32 v71, v71
    v_exp_f32 v72, v72
    v_mfma_f32_32x32x16_bf16 v[36:51], v[104:107], v[88:91], v[36:51]
    ds_read_b128 v[100:103], v14 offset:8192
    v_exp_f32 v73, v73
    v_cvt_pk_bf16_f32 v84, v68, v69
    v_exp_f32 v74, v74
    ds_read_b128 v[104:107], v14 offset:8704
    v_cvt_pk_bf16_f32 v85, v70, v71
    v_exp_f32 v75, v75
    v_exp_f32 v76, v76
    v_cvt_pk_bf16_f32 v86, v72, v73
    v_exp_f32 v77, v77
    v_exp_f32 v78, v78
    v_cvt_pk_bf16_f32 v87, v74, v75
    v_exp_f32 v79, v79
    s_waitcnt lgkmcnt(4)
    v_mfma_f32_32x32x16_bf16 v[36:51], v[108:111], v[84:87], v[36:51]
    v_exp_f32 v80, v80
    v_cvt_pk_bf16_f32 v88, v76, v77
    v_exp_f32 v81, v81
    v_exp_f32 v82, v82
    v_cvt_pk_bf16_f32 v89, v78, v79
    v_exp_f32 v83, v83
    v_cvt_pk_bf16_f32 v90, v80, v81
    v_cvt_pk_bf16_f32 v91, v82, v83
    v_add_u32 v13, 8192, v13
    v_add_u32 v14, v15, v14
    s_waitcnt vmcnt(0)
    ds_add_u32 v118, v119
    s_waitcnt lgkmcnt(0)
    s_waitcnt lgkmcnt(2)
    v_mfma_f32_32x32x16_bf16 v[68:83], v[96:99], v[4:7], v[20:35]
    ds_read_b128 v[92:95], v13 offset:2048
    v_exp_f32 v52, v52
    v_exp_f32 v53, v53
    v_exp_f32 v54, v54
    v_exp_f32 v55, v55
    v_exp_f32 v56, v56
    v_mfma_f32_32x32x16_bf16 v[36:51], v[112:115], v[88:91], v[36:51]
    ds_read_b128 v[108:111], v14 offset:1024
    v_exp_f32 v57, v57
    v_cvt_pk_bf16_f32 v84, v52, v53
    v_exp_f32 v58, v58
    ds_read_b128 v[112:115], v14 offset:1536
    v_cvt_pk_bf16_f32 v85, v54, v55
    v_exp_f32 v59, v59
    v_exp_f32 v60, v60
    v_cvt_pk_bf16_f32 v86, v56, v57
    v_exp_f32 v61, v61
    v_exp_f32 v62, v62
    v_cvt_pk_bf16_f32 v87, v58, v59
    v_exp_f32 v63, v63
    s_waitcnt lgkmcnt(4)
    v_mfma_f32_32x32x16_bf16 v[36:51], v[100:103], v[84:87], v[36:51]
    v_exp_f32 v64, v64
    v_cvt_pk_bf16_f32 v88, v60, v61
    v_exp_f32 v65, v65
    v_exp_f32 v66, v66
    v_cvt_pk_bf16_f32 v89, v62, v63
    v_exp_f32 v67, v67
    v_cvt_pk_bf16_f32 v90, v64, v65
    v_cvt_pk_bf16_f32 v91, v66, v67
    s_waitcnt lgkmcnt(2)
    v_mfma_f32_32x32x16_bf16 v[52:67], v[92:95], v[4:7], v[20:35]
    ds_read_b128 v[96:99], v13 offset:3072
    v_exp_f32 v68, v68
    v_exp_f32 v69, v69
    v_exp_f32 v70, v70
    v_exp_f32 v71, v71
    v_exp_f32 v72, v72
    v_mfma_f32_32x32x16_bf16 v[36:51], v[104:107], v[88:91], v[36:51]
    ds_read_b128 v[100:103], v14 offset:2048
    v_exp_f32 v73, v73
    v_cvt_pk_bf16_f32 v84, v68, v69
    v_exp_f32 v74, v74
    ds_read_b128 v[104:107], v14 offset:2560
    v_cvt_pk_bf16_f32 v85, v70, v71
    v_exp_f32 v75, v75
    v_exp_f32 v76, v76
    v_cvt_pk_bf16_f32 v86, v72, v73
    v_exp_f32 v77, v77
    v_exp_f32 v78, v78
    v_cvt_pk_bf16_f32 v87, v74, v75
    v_exp_f32 v79, v79
    s_waitcnt lgkmcnt(4)
    v_mfma_f32_32x32x16_bf16 v[36:51], v[108:111], v[84:87], v[36:51]
    v_exp_f32 v80, v80
    v_cvt_pk_bf16_f32 v88, v76, v77
    v_exp_f32 v81, v81
    v_exp_f32 v82, v82
    v_cvt_pk_bf16_f32 v89, v78, v79
    v_exp_f32 v83, v83
    v_cvt_pk_bf16_f32 v90, v80, v81
    v_cvt_pk_bf16_f32 v91, v82, v83
    s_waitcnt lgkmcnt(2)
    v_mfma_f32_32x32x16_bf16 v[68:83], v[96:99], v[4:7], v[20:35]
    ds_read_b128 v[92:95], v13 offset:4096
    v_exp_f32 v52, v52
    v_exp_f32 v53, v53
    v_exp_f32 v54, v54
    v_exp_f32 v55, v55
    v_exp_f32 v56, v56
    v_mfma_f32_32x32x16_bf16 v[36:51], v[112:115], v[88:91], v[36:51]
    ds_read_b128 v[108:111], v14 offset:3072
    v_exp_f32 v57, v57
    v_cvt_pk_bf16_f32 v84, v52, v53
    v_exp_f32 v58, v58
    ds_read_b128 v[112:115], v14 offset:3584
    v_cvt_pk_bf16_f32 v85, v54, v55
    v_exp_f32 v59, v59
    v_exp_f32 v60, v60
    v_cvt_pk_bf16_f32 v86, v56, v57
    v_exp_f32 v61, v61
    v_exp_f32 v62, v62
    v_cvt_pk_bf16_f32 v87, v58, v59
    v_exp_f32 v63, v63
    s_waitcnt lgkmcnt(4)
    v_mfma_f32_32x32x16_bf16 v[36:51], v[100:103], v[84:87], v[36:51]
    v_exp_f32 v64, v64
    v_cvt_pk_bf16_f32 v88, v60, v61
    v_exp_f32 v65, v65
    v_exp_f32 v66, v66
    v_cvt_pk_bf16_f32 v89, v62, v63
    v_exp_f32 v67, v67
    v_cvt_pk_bf16_f32 v90, v64, v65
    v_cvt_pk_bf16_f32 v91, v66, v67
    s_waitcnt lgkmcnt(2)
    v_mfma_f32_32x32x16_bf16 v[52:67], v[92:95], v[4:7], v[20:35]
    ds_read_b128 v[96:99], v13 offset:5120
    v_exp_f32 v68, v68
    v_exp_f32 v69, v69
    v_exp_f32 v70, v70
    v_exp_f32 v71, v71
    v_exp_f32 v72, v72
    v_mfma_f32_32x32x16_bf16 v[36:51], v[104:107], v[88:91], v[36:51]
    ds_read_b128 v[100:103], v14 offset:4096
    v_exp_f32 v73, v73
    v_cvt_pk_bf16_f32 v84, v68, v69
    v_exp_f32 v74, v74
    ds_read_b128 v[104:107], v14 offset:4608
    v_cvt_pk_bf16_f32 v85, v70, v71
    v_exp_f32 v75, v75
    v_exp_f32 v76, v76
    v_cvt_pk_bf16_f32 v86, v72, v73
    v_exp_f32 v77, v77
    v_exp_f32 v78, v78
    v_cvt_pk_bf16_f32 v87, v74, v75
    v_exp_f32 v79, v79
    s_waitcnt lgkmcnt(4)
    v_mfma_f32_32x32x16_bf16 v[36:51], v[108:111], v[84:87], v[36:51]
    v_exp_f32 v80, v80
    v_cvt_pk_bf16_f32 v88, v76, v77
    v_exp_f32 v81, v81
    v_exp_f32 v82, v82
    v_cvt_pk_bf16_f32 v89, v78, v79
    v_exp_f32 v83, v83
    v_cvt_pk_bf16_f32 v90, v80, v81
    v_cvt_pk_bf16_f32 v91, v82, v83
    s_waitcnt lgkmcnt(2)
    v_mfma_f32_32x32x16_bf16 v[68:83], v[96:99], v[4:7], v[20:35]
    ds_read_b128 v[92:95], v13 offset:6144
    v_exp_f32 v52, v52
    v_exp_f32 v53, v53
    v_exp_f32 v54, v54
    v_exp_f32 v55, v55
    v_exp_f32 v56, v56
    v_mfma_f32_32x32x16_bf16 v[36:51], v[112:115], v[88:91], v[36:51]
    ds_read_b128 v[108:111], v14 offset:5120
    v_exp_f32 v57, v57
    v_cvt_pk_bf16_f32 v84, v52, v53
    v_exp_f32 v58, v58
    ds_read_b128 v[112:115], v14 offset:5632
    v_cvt_pk_bf16_f32 v85, v54, v55
    v_exp_f32 v59, v59
    v_exp_f32 v60, v60
    v_cvt_pk_bf16_f32 v86, v56, v57
    v_exp_f32 v61, v61
    v_exp_f32 v62, v62
    v_cvt_pk_bf16_f32 v87, v58, v59
    v_exp_f32 v63, v63
    s_waitcnt lgkmcnt(4)
    v_mfma_f32_32x32x16_bf16 v[36:51], v[100:103], v[84:87], v[36:51]
    v_exp_f32 v64, v64
    v_cvt_pk_bf16_f32 v88, v60, v61
    v_exp_f32 v65, v65
    v_exp_f32 v66, v66
    v_cvt_pk_bf16_f32 v89, v62, v63
    v_exp_f32 v67, v67
    v_cvt_pk_bf16_f32 v90, v64, v65
    v_cvt_pk_bf16_f32 v91, v66, v67
    s_waitcnt lgkmcnt(2)
    v_mfma_f32_32x32x16_bf16 v[52:67], v[92:95], v[4:7], v[20:35]
    ds_read_b128 v[96:99], v13 offset:7168
    v_exp_f32 v68, v68
    v_exp_f32 v69, v69
    v_exp_f32 v70, v70
    v_exp_f32 v71, v71
    v_exp_f32 v72, v72
    v_mfma_f32_32x32x16_bf16 v[36:51], v[104:107], v[88:91], v[36:51]
    ds_read_b128 v[100:103], v14 offset:6144
    v_exp_f32 v73, v73
    v_cvt_pk_bf16_f32 v84, v68, v69
    v_exp_f32 v74, v74
    ds_read_b128 v[104:107], v14 offset:6656
    v_cvt_pk_bf16_f32 v85, v70, v71
    v_exp_f32 v75, v75
    v_exp_f32 v76, v76
    v_cvt_pk_bf16_f32 v86, v72, v73
    v_exp_f32 v77, v77
    v_exp_f32 v78, v78
    v_cvt_pk_bf16_f32 v87, v74, v75
    v_exp_f32 v79, v79
    s_waitcnt lgkmcnt(4)
    v_mfma_f32_32x32x16_bf16 v[36:51], v[108:111], v[84:87], v[36:51]
    v_exp_f32 v80, v80
    v_cvt_pk_bf16_f32 v88, v76, v77
    v_exp_f32 v81, v81
    v_exp_f32 v82, v82
    v_cvt_pk_bf16_f32 v89, v78, v79
    v_exp_f32 v83, v83
    v_cvt_pk_bf16_f32 v90, v80, v81
    v_cvt_pk_bf16_f32 v91, v82, v83
    s_waitcnt lgkmcnt(2)
    v_mfma_f32_32x32x16_bf16 v[68:83], v[96:99], v[4:7], v[20:35]
    ds_read_b128 v[92:95], v13 offset:8192
    v_exp_f32 v52, v52
    v_exp_f32 v53, v53
    v_exp_f32 v54, v54
    v_exp_f32 v55, v55
    v_exp_f32 v56, v56
    v_mfma_f32_32x32x16_bf16 v[36:51], v[112:115], v[88:91], v[36:51]
    ds_read_b128 v[108:111], v14 offset:7168
    v_exp_f32 v57, v57
    v_cvt_pk_bf16_f32 v84, v52, v53
    v_exp_f32 v58, v58
    ds_read_b128 v[112:115], v14 offset:7680
    v_cvt_pk_bf16_f32 v85, v54, v55
    v_exp_f32 v59, v59
    v_exp_f32 v60, v60
    v_cvt_pk_bf16_f32 v86, v56, v57
    v_exp_f32 v61, v61
    v_exp_f32 v62, v62
    v_cvt_pk_bf16_f32 v87, v58, v59
    v_exp_f32 v63, v63
    s_waitcnt lgkmcnt(4)
    v_mfma_f32_32x32x16_bf16 v[36:51], v[100:103], v[84:87], v[36:51]
    v_exp_f32 v64, v64
    v_cvt_pk_bf16_f32 v88, v60, v61
    v_exp_f32 v65, v65
    v_exp_f32 v66, v66
    v_cvt_pk_bf16_f32 v89, v62, v63
    v_exp_f32 v67, v67
    v_cvt_pk_bf16_f32 v90, v64, v65
    v_cvt_pk_bf16_f32 v91, v66, v67
    s_waitcnt lgkmcnt(2)
    v_mfma_f32_32x32x16_bf16 v[52:67], v[92:95], v[4:7], v[20:35]
    ds_read_b128 v[96:99], v13 offset:9216
    v_exp_f32 v68, v68
    v_exp_f32 v69, v69
    v_exp_f32 v70, v70
    v_exp_f32 v71, v71
    v_exp_f32 v72, v72
    v_mfma_f32_32x32x16_bf16 v[36:51], v[104:107], v[88:91], v[36:51]
    ds_read_b128 v[100:103], v14 offset:8192
    v_exp_f32 v73, v73
    v_cvt_pk_bf16_f32 v84, v68, v69
    v_exp_f32 v74, v74
    ds_read_b128 v[104:107], v14 offset:8704
    v_cvt_pk_bf16_f32 v85, v70, v71
    v_exp_f32 v75, v75
    v_exp_f32 v76, v76
    v_cvt_pk_bf16_f32 v86, v72, v73
    v_exp_f32 v77, v77
    v_exp_f32 v78, v78
    v_cvt_pk_bf16_f32 v87, v74, v75
    v_exp_f32 v79, v79
    s_waitcnt lgkmcnt(4)
    v_mfma_f32_32x32x16_bf16 v[36:51], v[108:111], v[84:87], v[36:51]
    v_exp_f32 v80, v80
    v_cvt_pk_bf16_f32 v88, v76, v77
    v_exp_f32 v81, v81
    v_exp_f32 v82, v82
    v_cvt_pk_bf16_f32 v89, v78, v79
    v_exp_f32 v83, v83
    v_cvt_pk_bf16_f32 v90, v80, v81
    v_cvt_pk_bf16_f32 v91, v82, v83
    v_add_u32 v13, 8192, v13
    v_add_u32 v14, v15, v14
attn_kernel_poll:
    ds_read_b32 v116, v118
    s_waitcnt lgkmcnt(0)
    v_readfirstlane_b32 s36, v116
    s_nop 0
    s_cmp_ge_u32 s36, 512
    s_cbranch_scc0 attn_kernel_poll
    s_mov_b32 s35, 2
attn_kernel_loop:
    s_cmp_eq_u32 s35, 4
    s_cbranch_scc0 attn_kernel_pr4
    s_setprio 2
attn_kernel_pr4:
    s_cmp_eq_u32 s35, 6
    s_cbranch_scc0 attn_kernel_pr6
    s_setprio 1
attn_kernel_pr6:
    s_cmp_eq_u32 s35, 7
    s_cbranch_scc0 attn_kernel_pr7
    s_setprio 0
attn_kernel_pr7:
    s_waitcnt lgkmcnt(2)
    v_mfma_f32_32x32x16_bf16 v[68:83], v[96:99], v[4:7], v[20:35]
    ds_read_b128 v[92:95], v13 offset:2048
    v_exp_f32 v52, v52
    v_exp_f32 v53, v53
    v_exp_f32 v54, v54
    v_exp_f32 v55, v55
    v_exp_f32 v56, v56
    v_mfma_f32_32x32x16_bf16 v[36:51], v[112:115], v[88:91], v[36:51]
    ds_read_b128 v[108:111], v14 offset:1024
    v_exp_f32 v57, v57
    v_cvt_pk_bf16_f32 v84, v52, v53
    v_exp_f32 v58, v58
    ds_read_b128 v[112:115], v14 offset:1536
    v_cvt_pk_bf16_f32 v85, v54, v55
    v_exp_f32 v59, v59
    v_exp_f32 v60, v60
    v_cvt_pk_bf16_f32 v86, v56, v57
    v_exp_f32 v61, v61
    v_exp_f32 v62, v62
    v_cvt_pk_bf16_f32 v87, v58, v59
    v_exp_f32 v63, v63
    s_waitcnt lgkmcnt(4)
    v_mfma_f32_32x32x16_bf16 v[36:51], v[100:103], v[84:87], v[36:51]
    v_exp_f32 v64, v64
    v_cvt_pk_bf16_f32 v88, v60, v61
    v_exp_f32 v65, v65
    v_exp_f32 v66, v66
    v_cvt_pk_bf16_f32 v89, v62, v63
    v_exp_f32 v67, v67
    v_cvt_pk_bf16_f32 v90, v64, v65
    v_cvt_pk_bf16_f32 v91, v66, v67
    s_waitcnt lgkmcnt(2)
    v_mfma_f32_32x32x16_bf16 v[52:67], v[92:95], v[4:7], v[20:35]
    ds_read_b128 v[96:99], v13 offset:3072
    v_exp_f32 v68, v68
    v_exp_f32 v69, v69
    v_exp_f32 v70, v70
    v_exp_f32 v71, v71
    v_exp_f32 v72, v72
    v_mfma_f32_32x32x16_bf16 v[36:51], v[104:107], v[88:91], v[36:51]
    ds_read_b128 v[100:103], v14 offset:2048
    v_exp_f32 v73, v73
    v_cvt_pk_bf16_f32 v84, v68, v69
    v_exp_f32 v74, v74
    ds_read_b128 v[104:107], v14 offset:2560
    v_cvt_pk_bf16_f32 v85, v70, v71
    v_exp_f32 v75, v75
    v_exp_f32 v76, v76
    v_cvt_pk_bf16_f32 v86, v72, v73
    v_exp_f32 v77, v77
    v_exp_f32 v78, v78
    v_cvt_pk_bf16_f32 v87, v74, v75
    v_exp_f32 v79, v79
    s_waitcnt lgkmcnt(4)
    v_mfma_f32_32x32x16_bf16 v[36:51], v[108:111], v[84:87], v[36:51]
    v_exp_f32 v80, v80
    v_cvt_pk_bf16_f32 v88, v76, v77
    v_exp_f32 v81, v81
    v_exp_f32 v82, v82
    v_cvt_pk_bf16_f32 v89, v78, v79
    v_exp_f32 v83, v83
    v_cvt_pk_bf16_f32 v90, v80, v81
    v_cvt_pk_bf16_f32 v91, v82, v83
    s_waitcnt lgkmcnt(2)
    v_mfma_f32_32x32x16_bf16 v[68:83], v[96:99], v[4:7], v[20:35]
    ds_read_b128 v[92:95], v13 offset:4096
    v_exp_f32 v52, v52
    v_exp_f32 v53, v53
    v_exp_f32 v54, v54
    v_exp_f32 v55, v55
    v_exp_f32 v56, v56
    v_mfma_f32_32x32x16_bf16 v[36:51], v[112:115], v[88:91], v[36:51]
    ds_read_b128 v[108:111], v14 offset:3072
    v_exp_f32 v57, v57
    v_cvt_pk_bf16_f32 v84, v52, v53
    v_exp_f32 v58, v58
    ds_read_b128 v[112:115], v14 offset:3584
    v_cvt_pk_bf16_f32 v85, v54, v55
    v_exp_f32 v59, v59
    v_exp_f32 v60, v60
    v_cvt_pk_bf16_f32 v86, v56, v57
    v_exp_f32 v61, v61
    v_exp_f32 v62, v62
    v_cvt_pk_bf16_f32 v87, v58, v59
    v_exp_f32 v63, v63
    s_waitcnt lgkmcnt(4)
    v_mfma_f32_32x32x16_bf16 v[36:51], v[100:103], v[84:87], v[36:51]
    v_exp_f32 v64, v64
    v_cvt_pk_bf16_f32 v88, v60, v61
    v_exp_f32 v65, v65
    v_exp_f32 v66, v66
    v_cvt_pk_bf16_f32 v89, v62, v63
    v_exp_f32 v67, v67
    v_cvt_pk_bf16_f32 v90, v64, v65
    v_cvt_pk_bf16_f32 v91, v66, v67
    s_waitcnt lgkmcnt(2)
    v_mfma_f32_32x32x16_bf16 v[52:67], v[92:95], v[4:7], v[20:35]
    ds_read_b128 v[96:99], v13 offset:5120
    v_exp_f32 v68, v68
    v_exp_f32 v69, v69
    v_exp_f32 v70, v70
    v_exp_f32 v71, v71
    v_exp_f32 v72, v72
    v_mfma_f32_32x32x16_bf16 v[36:51], v[104:107], v[88:91], v[36:51]
    ds_read_b128 v[100:103], v14 offset:4096
    v_exp_f32 v73, v73
    v_cvt_pk_bf16_f32 v84, v68, v69
    v_exp_f32 v74, v74
    ds_read_b128 v[104:107], v14 offset:4608
    v_cvt_pk_bf16_f32 v85, v70, v71
    v_exp_f32 v75, v75
    v_exp_f32 v76, v76
    v_cvt_pk_bf16_f32 v86, v72, v73
    v_exp_f32 v77, v77
    v_exp_f32 v78, v78
    v_cvt_pk_bf16_f32 v87, v74, v75
    v_exp_f32 v79, v79
    s_waitcnt lgkmcnt(4)
    v_mfma_f32_32x32x16_bf16 v[36:51], v[108:111], v[84:87], v[36:51]
    v_exp_f32 v80, v80
    v_cvt_pk_bf16_f32 v88, v76, v77
    v_exp_f32 v81, v81
    v_exp_f32 v82, v82
    v_cvt_pk_bf16_f32 v89, v78, v79
    v_exp_f32 v83, v83
    v_cvt_pk_bf16_f32 v90, v80, v81
    v_cvt_pk_bf16_f32 v91, v82, v83
    s_waitcnt lgkmcnt(2)
    v_mfma_f32_32x32x16_bf16 v[68:83], v[96:99], v[4:7], v[20:35]
    ds_read_b128 v[92:95], v13 offset:6144
    v_exp_f32 v52, v52
    v_exp_f32 v53, v53
    v_exp_f32 v54, v54
    v_exp_f32 v55, v55
    v_exp_f32 v56, v56
    v_mfma_f32_32x32x16_bf16 v[36:51], v[112:115], v[88:91], v[36:51]
    ds_read_b128 v[108:111], v14 offset:5120
    v_exp_f32 v57, v57
    v_cvt_pk_bf16_f32 v84, v52, v53
    v_exp_f32 v58, v58
    ds_read_b128 v[112:115], v14 offset:5632
    v_cvt_pk_bf16_f32 v85, v54, v55
    v_exp_f32 v59, v59
    v_exp_f32 v60, v60
    v_cvt_pk_bf16_f32 v86, v56, v57
    v_exp_f32 v61, v61
    v_exp_f32 v62, v62
    v_cvt_pk_bf16_f32 v87, v58, v59
    v_exp_f32 v63, v63
    s_waitcnt lgkmcnt(4)
    v_mfma_f32_32x32x16_bf16 v[36:51], v[100:103], v[84:87], v[36:51]
    v_exp_f32 v64, v64
    v_cvt_pk_bf16_f32 v88, v60, v61
    v_exp_f32 v65, v65
    v_exp_f32 v66, v66
    v_cvt_pk_bf16_f32 v89, v62, v63
    v_exp_f32 v67, v67
    v_cvt_pk_bf16_f32 v90, v64, v65
    v_cvt_pk_bf16_f32 v91, v66, v67
    s_waitcnt lgkmcnt(2)
    v_mfma_f32_32x32x16_bf16 v[52:67], v[92:95], v[4:7], v[20:35]
    ds_read_b128 v[96:99], v13 offset:7168
    v_exp_f32 v68, v68
    v_exp_f32 v69, v69
    v_exp_f32 v70, v70
    v_exp_f32 v71, v71
    v_exp_f32 v72, v72
    v_mfma_f32_32x32x16_bf16 v[36:51], v[104:107], v[88:91], v[36:51]
    ds_read_b128 v[100:103], v14 offset:6144
    v_exp_f32 v73, v73
    v_cvt_pk_bf16_f32 v84, v68, v69
    v_exp_f32 v74, v74
    ds_read_b128 v[104:107], v14 offset:6656
    v_cvt_pk_bf16_f32 v85, v70, v71
    v_exp_f32 v75, v75
    v_exp_f32 v76, v76
    v_cvt_pk_bf16_f32 v86, v72, v73
    v_exp_f32 v77, v77
    v_exp_f32 v78, v78
    v_cvt_pk_bf16_f32 v87, v74, v75
    v_exp_f32 v79, v79
    s_waitcnt lgkmcnt(4)
    v_mfma_f32_32x32x16_bf16 v[36:51], v[108:111], v[84:87], v[36:51]
    v_exp_f32 v80, v80
    v_cvt_pk_bf16_f32 v88, v76, v77
    v_exp_f32 v81, v81
    v_exp_f32 v82, v82
    v_cvt_pk_bf16_f32 v89, v78, v79
    v_exp_f32 v83, v83
    v_cvt_pk_bf16_f32 v90, v80, v81
    v_cvt_pk_bf16_f32 v91, v82, v83
    s_waitcnt lgkmcnt(2)
    v_mfma_f32_32x32x16_bf16 v[68:83], v[96:99], v[4:7], v[20:35]
    ds_read_b128 v[92:95], v13 offset:8192
    v_exp_f32 v52, v52
    v_exp_f32 v53, v53
    v_exp_f32 v54, v54
    v_exp_f32 v55, v55
    v_exp_f32 v56, v56
    v_mfma_f32_32x32x16_bf16 v[36:51], v[112:115], v[88:91], v[36:51]
    ds_read_b128 v[108:111], v14 offset:7168
    v_exp_f32 v57, v57
    v_cvt_pk_bf16_f32 v84, v52, v53
    v_exp_f32 v58, v58
    ds_read_b128 v[112:115], v14 offset:7680
    v_cvt_pk_bf16_f32 v85, v54, v55
    v_exp_f32 v59, v59
    v_exp_f32 v60, v60
    v_cvt_pk_bf16_f32 v86, v56, v57
    v_exp_f32 v61, v61
    v_exp_f32 v62, v62
    v_cvt_pk_bf16_f32 v87, v58, v59
    v_exp_f32 v63, v63
    s_waitcnt lgkmcnt(4)
    v_mfma_f32_32x32x16_bf16 v[36:51], v[100:103], v[84:87], v[36:51]
    v_exp_f32 v64, v64
    v_cvt_pk_bf16_f32 v88, v60, v61
    v_exp_f32 v65, v65
    v_exp_f32 v66, v66
    v_cvt_pk_bf16_f32 v89, v62, v63
    v_exp_f32 v67, v67
    v_cvt_pk_bf16_f32 v90, v64, v65
    v_cvt_pk_bf16_f32 v91, v66, v67
    s_waitcnt lgkmcnt(2)
    v_mfma_f32_32x32x16_bf16 v[52:67], v[92:95], v[4:7], v[20:35]
    ds_read_b128 v[96:99], v13 offset:9216
    v_exp_f32 v68, v68
    v_exp_f32 v69, v69
    v_exp_f32 v70, v70
    v_exp_f32 v71, v71
    v_exp_f32 v72, v72
    v_mfma_f32_32x32x16_bf16 v[36:51], v[104:107], v[88:91], v[36:51]
    ds_read_b128 v[100:103], v14 offset:8192
    v_exp_f32 v73, v73
    v_cvt_pk_bf16_f32 v84, v68, v69
    v_exp_f32 v74, v74
    ds_read_b128 v[104:107], v14 offset:8704
    v_cvt_pk_bf16_f32 v85, v70, v71
    v_exp_f32 v75, v75
    v_exp_f32 v76, v76
    v_cvt_pk_bf16_f32 v86, v72, v73
    v_exp_f32 v77, v77
    v_exp_f32 v78, v78
    v_cvt_pk_bf16_f32 v87, v74, v75
    v_exp_f32 v79, v79
    s_waitcnt lgkmcnt(4)
    v_mfma_f32_32x32x16_bf16 v[36:51], v[108:111], v[84:87], v[36:51]
    v_exp_f32 v80, v80
    v_cvt_pk_bf16_f32 v88, v76, v77
    v_exp_f32 v81, v81
    v_exp_f32 v82, v82
    v_cvt_pk_bf16_f32 v89, v78, v79
    v_exp_f32 v83, v83
    v_cvt_pk_bf16_f32 v90, v80, v81
    v_cvt_pk_bf16_f32 v91, v82, v83
    v_add_u32 v13, 8192, v13
    v_add_u32 v14, v15, v14
    s_add_u32 s35, s35, 1
    s_cmp_lt_u32 s35, 8
    s_cbranch_scc1 attn_kernel_loop
    s_waitcnt lgkmcnt(0)
    s_nop 1
    v_mfma_f32_32x32x16_bf16 v[36:51], v[112:115], v[88:91], v[36:51]
    s_nop 15
    s_nop 3
    v_add_f32 v116, abs(v44), abs(v36)
    v_add_f32 v116, v116, abs(v37)
    v_add_f32 v116, v116, abs(v38)
    v_add_f32 v116, v116, abs(v39)
    v_add_f32 v116, v116, abs(v40)
    v_add_f32 v116, v116, abs(v41)
    v_add_f32 v116, v116, abs(v42)
    v_add_f32 v116, v116, abs(v43)
    v_mov_b32 v117, 0x7f800000
    v_cmp_nlt_f32 vcc, v116, v117
    s_nop 4
    s_cbranch_vccz attn_kernel_fin
    s_sub_u32 s36, 0, 65536
    v_mov_b32 v16, 0xff800000
    v_subrev_u32 v13, 65536, v13
    v_lshlrev_b32 v17, 3, v15
    v_sub_u32 v14, v14, v17
    v_lshrrev_b32 v15, 3, v15
    v_mov_b32 v36, 0
    v_mov_b32 v37, 0
    v_mov_b32 v38, 0
    v_mov_b32 v39, 0
    v_mov_b32 v40, 0
    v_mov_b32 v41, 0
    v_mov_b32 v42, 0
    v_mov_b32 v43, 0
    v_mov_b32 v44, 0
    v_mov_b32 v45, 0
    v_mov_b32 v46, 0
    v_mov_b32 v47, 0
    v_mov_b32 v48, 0
    v_mov_b32 v49, 0
    v_mov_b32 v50, 0
    v_mov_b32 v51, 0
    s_mov_b32 s35, 0
attn_kernel_slow:
    ds_read_b128 v[92:95], v13
    ds_read_b128 v[100:103], v14
    ds_read_b128 v[104:107], v14 offset:512
    s_waitcnt lgkmcnt(0)
    v_mfma_f32_32x32x16_bf16 v[52:67], v[92:95], v[4:7], 0
    s_nop 15
    s_nop 3
    v_max3_f32 v116, v52, v53, v54
    v_max3_f32 v116, v116, v55, v56
    v_max3_f32 v116, v116, v57, v58
    v_max3_f32 v116, v116, v59, v60
    v_max3_f32 v116, v116, v61, v62
    v_max3_f32 v116, v116, v63, v64
    v_max3_f32 v116, v116, v65, v66
    v_max3_f32 v116, v116, v67, v16
    v_mov_b32 v117, v116
    s_nop 1
    v_permlane32_swap_b32 v116, v117
    s_nop 1
    v_max_f32 v116, v116, v117
    v_sub_f32 v117, v16, v116
    v_exp_f32 v117, v117
    v_mov_b32 v16, v116
    v_sub_f32 v52, v52, v116
    v_exp_f32 v52, v52
    v_mul_f32 v36, v36, v117
    v_sub_f32 v53, v53, v116
    v_exp_f32 v53, v53
    v_mul_f32 v37, v37, v117
    v_sub_f32 v54, v54, v116
    v_exp_f32 v54, v54
    v_mul_f32 v38, v38, v117
    v_sub_f32 v55, v55, v116
    v_exp_f32 v55, v55
    v_mul_f32 v39, v39, v117
    v_sub_f32 v56, v56, v116
    v_exp_f32 v56, v56
    v_mul_f32 v40, v40, v117
    v_sub_f32 v57, v57, v116
    v_exp_f32 v57, v57
    v_mul_f32 v41, v41, v117
    v_sub_f32 v58, v58, v116
    v_exp_f32 v58, v58
    v_mul_f32 v42, v42, v117
    v_sub_f32 v59, v59, v116
    v_exp_f32 v59, v59
    v_mul_f32 v43, v43, v117
    v_sub_f32 v60, v60, v116
    v_exp_f32 v60, v60
    v_mul_f32 v44, v44, v117
    v_sub_f32 v61, v61, v116
    v_exp_f32 v61, v61
    v_mul_f32 v45, v45, v117
    v_sub_f32 v62, v62, v116
    v_exp_f32 v62, v62
    v_mul_f32 v46, v46, v117
    v_sub_f32 v63, v63, v116
    v_exp_f32 v63, v63
    v_mul_f32 v47, v47, v117
    v_sub_f32 v64, v64, v116
    v_exp_f32 v64, v64
    v_mul_f32 v48, v48, v117
    v_sub_f32 v65, v65, v116
    v_exp_f32 v65, v65
    v_mul_f32 v49, v49, v117
    v_sub_f32 v66, v66, v116
    v_exp_f32 v66, v66
    v_mul_f32 v50, v50, v117
    v_sub_f32 v67, v67, v116
    v_exp_f32 v67, v67
    v_mul_f32 v51, v51, v117
    v_cvt_pk_bf16_f32 v84, v52, v53
    v_cvt_pk_bf16_f32 v85, v54, v55
    v_cvt_pk_bf16_f32 v86, v56, v57
    v_cvt_pk_bf16_f32 v87, v58, v59
    v_cvt_pk_bf16_f32 v88, v60, v61
    v_cvt_pk_bf16_f32 v89, v62, v63
    v_cvt_pk_bf16_f32 v90, v64, v65
    v_cvt_pk_bf16_f32 v91, v66, v67
    s_nop 1
    v_mfma_f32_32x32x16_bf16 v[36:51], v[100:103], v[84:87], v[36:51]
    v_mfma_f32_32x32x16_bf16 v[36:51], v[104:107], v[88:91], v[36:51]
    v_add_u32 v13, 1024, v13
    v_add_u32 v14, v15, v14
    s_add_u32 s35, s35, 1
    s_cmp_lt_u32 s35, 64
    s_nop 15
    s_nop 3
    s_cbranch_scc1 attn_kernel_slow
attn_kernel_fin:
    v_rcp_f32 v116, v44
    s_nop 0
    v_mul_f32 v36, v36, v116
    v_mul_f32 v37, v37, v116
    v_mul_f32 v38, v38, v116
    v_mul_f32 v39, v39, v116
    v_mul_f32 v40, v40, v116
    v_mul_f32 v41, v41, v116
    v_mul_f32 v42, v42, v116
    v_mul_f32 v43, v43, v116
    v_cvt_pk_bf16_f32 v84, v36, v37
    v_cvt_pk_bf16_f32 v85, v38, v39
    v_cvt_pk_bf16_f32 v86, v40, v41
    v_cvt_pk_bf16_f32 v87, v42, v43
    s_lshl_b32 s30, s29, 15
    s_lshl_b32 s31, s24, 10
    s_add_u32 s30, s30, s31
    buffer_store_dwordx4 v[84:87], v3, s[20:23], s30 offen sc0 sc1
attn_kernel_done:
    s_endpgm
.section .rodata,"a"
.p2align 6
.amdhsa_kernel attn_kernel
  .amdhsa_next_free_vgpr 120
  .amdhsa_next_free_sgpr 96
  .amdhsa_accum_offset 120
  .amdhsa_group_segment_fixed_size 0
  .amdhsa_kernarg_size 72
  .amdhsa_user_sgpr_count 2
  .amdhsa_user_sgpr_kernarg_segment_ptr 1
  .amdhsa_system_sgpr_workgroup_id_x 1
  .amdhsa_float_denorm_mode_32 3
.end_amdhsa_kernel
```
